```python
import torch

def _softmax(x, axis=-1):
    return torch.softmax(x, dim=axis)
def _gelu(x):
    return torch.nn.functional.gelu(x, approximate="tanh")
def _silu(x):
    return torch.nn.functional.silu(x)
def _sigmoid(x):
    return torch.sigmoid(x)
def _layernorm(x, axis=-1, eps=1e-5):
    m = x.mean(dim=axis, keepdim=True)
    v = x.var(dim=axis, keepdim=True, unbiased=False)
    return (x - m) / torch.sqrt(v + eps)
def _scatter_add(tgt, idx, src, axis=0):
    return tgt.clone().index_add_(axis, idx, src)
def _segment_sum(src, seg, n):
    out = torch.zeros((n,) + src.shape[1:], dtype=src.dtype)
    return out.index_add_(0, seg, src)
def _pad(x, pw):
    flat = tuple(v for pair in reversed(pw) for v in pair)
    return torch.nn.functional.pad(x, flat)

kernel_name = 'standalone__mha_block_cached__near_ridge'

def setup_inputs():

    _w = (lambda a: (lambda t: t.to(torch.bfloat16) if t.is_floating_point() else t)(torch.as_tensor(a)))
    B, Sq, D = 8, 240, 640
    H, Sk, Dh = 32, 1024, 192
    return {
        "x": _w((lambda *s: torch.randn(*s, dtype=torch.bfloat16) * 0.8)(B, Sq, D)),
        "k_cache": _w((lambda *s: torch.randn(*s, dtype=torch.bfloat16) * 0.8)(B, H, Sk, Dh)),
        "v_cache": _w((lambda *s: torch.randn(*s, dtype=torch.bfloat16) * 0.05)(B, H, Sk, Dh)),
        "wq": _w((lambda *s: torch.randn(*s, dtype=torch.bfloat16) * 0.8)(D, H * Dh) * (D ** -0.5)),
        "wo": _w((lambda *s: torch.randn(*s, dtype=torch.bfloat16) * 0.05)(H * Dh, D) * ((H * Dh) ** -0.5)),
    }

def reference(x, k_cache, v_cache, wq, wo):
    B, Sq, D = x.shape
    H, Dh = 32, 192
    q = (lambda x, *d: x.permute(*d))((x @ wq).reshape(B, Sq, H, Dh), 0, 2, 1, 3)
    scores = torch.einsum("bhqd,bhkd->bhqk", q, k_cache) * (Dh ** -0.5)
    p = _softmax(scores, axis=-1)
    o = torch.einsum("bhqk,bhkd->bhqd", p, v_cache)
    return (lambda x, *d: x.permute(*d))(o, 0, 2, 1, 3).reshape(B, Sq, H * Dh) @ wo
```

```asm
; @launch grid=(256,1,1) block=(256,1,1) lds=163840
.amdgcn_target "amdgcn-amd-amdhsa--gfx950"
.text
.globl standalone__mha_block_cached__near_ridge_kernel
.p2align 8
.type standalone__mha_block_cached__near_ridge_kernel,@function
standalone__mha_block_cached__near_ridge_kernel:
s_cmp_ge_u32 s2, 256
s_cbranch_scc1 KF_done
s_load_dwordx4 s[4:7], s[0:1], 0
s_load_dwordx4 s[28:31], s[0:1], 16
s_load_dwordx4 s[96:99], s[0:1], 32
s_load_dwordx2 s[100:101], s[0:1], 48
s_load_dwordx2 s[32:33], s[0:1], 56
v_lshrrev_b32 v1, 6, v0
v_and_b32 v0, 63, v0
v_readfirstlane_b32 s34, v1
s_getpc_b64 s[52:53]
KF_pc:
s_lshr_b32 s3, s2, 3
s_lshl_b32 s3, s3, 2
s_add_u32 s3, s3, s34
s_mul_i32 s3, s3, 640
v_min_u32 v2, 4, v0
v_lshl_add_u32 v2, v2, 7, s3
v_min_u32 v2, KF_end-KF_pc-4, v2
v_mov_b32 v3, s53
v_add_co_u32 v2, vcc, s52, v2
s_nop 1
v_addc_co_u32 v3, vcc, 0, v3, vcc
global_load_dword v42, v[2:3], off
s_and_b32 s45, s2, 7
s_lshr_b32 s35, s2, 5
s_bfe_u32 s51, s2, 0x20003
s_lshl_b32 s36, s45, 2
s_add_u32 s36, s36, s51
v_lshrrev_b32 v2, 3, v0
v_lshl_add_u32 v2, v1, 6, v2
v_mul_u32_u24 v2, 1280, v2
v_lshrrev_b32 v3, 4, v0
v_and_b32 v4, 7, v0
v_xor_b32 v3, v3, v4
v_lshl_add_u32 v31, v3, 4, v2
v_xor_b32 v3, 4, v3
v_lshl_add_u32 v4, v3, 4, v2
v_add_u32 v32, 9216, v4
v_add_u32 v33, 18432, v31
v_add_u32 v34, 27648, v4
v_add_u32 v35, 40960, v31
v_add_u32 v36, 50176, v4
v_add_u32 v37, 59392, v31
v_add_u32 v38, 68608, v4
s_mul_i32 s37, s34, 3072
s_lshl_b32 s38, s34, 13
s_add_u32 s39, s38, 98304
s_add_u32 s38, s38, 73728
s_cmp_eq_u32 s34, 3
s_cselect_b32 s38, 147456, s38
s_cselect_b32 s39, 155648, s39
s_cselect_b32 s50, 0xc47a0000, 0
s_lshl_b32 s52, s51, 2
s_add_u32 s52, s52, s34
s_lshl_b32 s91, s35, 4
s_add_u32 s91, s91, s52
s_mul_i32 s3, s91, 12288
s_mul_i32 s88, s51, 384
s_sub_u32 s3, s3, s88
s_mul_i32 s52, s52, 19200
v_min_u32 v2, 11, v0
v_lshl_add_u32 v44, v2, 7, s3
v_add_u32 v8, 1572864, v44
v_min_u32 v2, 14, v0
v_mul_u32_u24 v2, 1280, v2
v_add_u32 v45, s52, v2
s_waitcnt lgkmcnt(0)
s_mul_i32 s3, s35, 307200
s_add_u32 s8, s4, s3
s_addc_u32 s9, s5, 0
s_mov_b32 s10, 307200
s_mov_b32 s11, 0x20000
s_mul_i32 s3, s36, 384
s_add_u32 s12, s30, s3
s_addc_u32 s13, s31, 0
s_mov_b32 s14, 0
s_mov_b32 s15, 0x20000
s_sub_u32 s14, 7864320, s3
s_mov_b32 m0, s38
s_mov_b32 s41, 0
buffer_load_dwordx4 v31, s[8:11], s41 offen lds
buffer_load_dwordx4 v32, s[8:11], s41 offen offset:1024 lds
buffer_load_dwordx4 v33, s[8:11], s41 offen offset:2048 lds
buffer_load_dwordx4 v34, s[8:11], s41 offen offset:3072 lds
s_add_u32 m0, s38, 4096
s_nop 0
buffer_load_dwordx4 v35, s[8:11], s41 offen lds
buffer_load_dwordx4 v36, s[8:11], s41 offen offset:1024 lds
buffer_load_dwordx4 v37, s[8:11], s41 offen offset:2048 lds
buffer_load_dwordx4 v38, s[8:11], s41 offen offset:3072 lds
v_and_b32 v5, 1, v1
v_lshlrev_b32 v5, 2, v5
v_add_u32 v2, 0, v0
v_mul_u32_u24 v3, 2731, v2
v_lshrrev_b32 v3, 16, v3
v_mul_u32_u24 v4, 24, v3
v_sub_u32 v2, v2, v4
v_and_or_b32 v4, v3, 2, v5
v_xor_b32 v25, v2, v4
v_lshl_add_u32 v22, v1, 3, v3
v_mul_u32_u24 v7, 12288, v22
v_lshl_add_u32 v28, v25, 4, v7
v_add_u32 v2, 64, v0
v_mul_u32_u24 v3, 2731, v2
v_lshrrev_b32 v3, 16, v3
v_mul_u32_u24 v4, 24, v3
v_sub_u32 v2, v2, v4
v_and_or_b32 v4, v3, 2, v5
v_xor_b32 v26, v2, v4
v_lshl_add_u32 v23, v1, 3, v3
v_mul_u32_u24 v7, 12288, v23
v_lshl_add_u32 v29, v26, 4, v7
v_subrev_u32 v29, 1024, v29
v_add_u32 v2, 128, v0
v_mul_u32_u24 v3, 2731, v2
v_lshrrev_b32 v3, 16, v3
v_mul_u32_u24 v4, 24, v3
v_sub_u32 v2, v2, v4
v_and_or_b32 v4, v3, 2, v5
v_xor_b32 v27, v2, v4
v_lshl_add_u32 v24, v1, 3, v3
v_mul_u32_u24 v7, 12288, v24
v_lshl_add_u32 v30, v27, 4, v7
v_subrev_u32 v30, 2048, v30
s_add_u32 m0, s37, 122880
s_mov_b32 s40, 0
buffer_load_dwordx4 v28, s[12:15], s40 offen lds
buffer_load_dwordx4 v29, s[12:15], s40 offen offset:1024 lds
buffer_load_dwordx4 v30, s[12:15], s40 offen offset:2048 lds
s_lshl_b32 s3, s36, 2
s_add_u32 s3, s3, s34
s_mul_i32 s3, s3, 2560
v_bfe_u32 v2, v0, 1, 1
v_mul_u32_u24 v2, 1280, v2
v_and_b32 v3, 1, v0
v_lshl_add_u32 v2, v3, 7, v2
v_add_u32 v9, s3, v2
v_and_b32 v1, 15, v0
v_lshrrev_b32 v2, 4, v0
v_lshrrev_b32 v3, 1, v1
v_xor_b32 v3, v3, v2
v_lshlrev_b32 v3, 4, v3
v_lshl_add_u32 v3, v1, 7, v3
v_xor_b32 v4, 64, v3
v_add_u32 v18, s38, v3
v_add_u32 v19, s38, v4
v_add_u32 v20, s39, v3
v_add_u32 v21, s39, v4
v_lshrrev_b32 v3, 2, v1
v_lshl_add_u32 v4, v2, 3, v3
v_mul_u32_u24 v4, 384, v4
v_and_b32 v5, 3, v1
v_lshl_add_u32 v4, v5, 3, v4
v_lshrrev_b32 v3, 3, v1
v_and_b32 v5, 1, v2
v_lshl_or_b32 v3, v5, 1, v3
v_xor_b32 v5, 0, v3
v_lshl_add_u32 v14, v5, 5, v4
v_add_u32 v10, 73728, v14
v_xor_b32 v5, 1, v3
v_lshl_add_u32 v15, v5, 5, v4
v_add_u32 v11, 73728, v15
v_xor_b32 v5, 2, v3
v_lshl_add_u32 v16, v5, 5, v4
v_add_u32 v12, 73728, v16
v_xor_b32 v5, 3, v3
v_lshl_add_u32 v17, v5, 5, v4
v_add_u32 v13, 73728, v17
s_add_u32 m0, s37, 135168
s_mov_b32 s40, 393216
buffer_load_dwordx4 v28, s[12:15], s40 offen lds
buffer_load_dwordx4 v29, s[12:15], s40 offen offset:1024 lds
buffer_load_dwordx4 v30, s[12:15], s40 offen offset:2048 lds
s_mov_b64 exec, 0
s_cmp_eq_u32 s34, 1
s_cbranch_scc1 KF_pg1
s_cmp_eq_u32 s34, 2
s_cbranch_scc1 KF_pg2
s_cmp_eq_u32 s34, 3
s_cbranch_scc1 KF_pg3
s_branch KF_pg4
KF_tret:
s_mov_b64 exec, -1
s_branch KF_go
.p2align 12
KF_go:
s_add_u32 m0, s37, 24576
s_mov_b32 s40, 786432
buffer_load_dwordx4 v28, s[12:15], s40 offen lds
buffer_load_dwordx4 v29, s[12:15], s40 offen offset:1024 lds
buffer_load_dwordx4 v30, s[12:15], s40 offen offset:2048 lds
s_add_u32 m0, s37, 36864
s_mov_b32 s40, 1179648
buffer_load_dwordx4 v28, s[12:15], s40 offen lds
buffer_load_dwordx4 v29, s[12:15], s40 offen offset:1024 lds
buffer_load_dwordx4 v30, s[12:15], s40 offen offset:2048 lds
s_waitcnt vmcnt(6)
s_barrier
ds_read_b128 a[0:3], v18 offset:0
ds_read_b128 a[4:7], v18 offset:2048
ds_read_b128 a[8:11], v18 offset:4096
ds_read_b128 a[12:15], v18 offset:6144
ds_read_b128 a[16:19], v19 offset:0
ds_read_b128 a[20:23], v19 offset:2048
ds_read_b128 a[24:27], v19 offset:4096
ds_read_b128 a[28:31], v19 offset:6144
ds_read_b64_tr_b16 v[40:41], v10 offset:49152
ds_read_b64_tr_b16 v[42:43], v10 offset:50688
ds_read_b64_tr_b16 v[44:45], v10 offset:61440
ds_read_b64_tr_b16 v[46:47], v10 offset:62976
ds_read_b64_tr_b16 v[48:49], v11 offset:49152
ds_read_b64_tr_b16 v[50:51], v11 offset:50688
ds_read_b64_tr_b16 v[52:53], v11 offset:61440
ds_read_b64_tr_b16 v[54:55], v11 offset:62976
s_waitcnt lgkmcnt(4)
v_mfma_f32_16x16x32_bf16 v[160:163], v[40:43], a[0:3], 0
ds_read_b64_tr_b16 v[56:57], v12 offset:49152
v_mfma_f32_16x16x32_bf16 v[160:163], v[44:47], a[16:19], v[160:163]
s_mov_b32 s41, 128
v_mfma_f32_16x16x32_bf16 v[164:167], v[40:43], a[4:7], 0
s_mov_b32 m0, s39
ds_read_b64_tr_b16 v[58:59], v12 offset:50688
v_mfma_f32_16x16x32_bf16 v[164:167], v[44:47], a[20:23], v[164:167]
buffer_load_dwordx4 v31, s[8:11], s41 offen lds
v_mfma_f32_16x16x32_bf16 v[168:171], v[40:43], a[8:11], 0
ds_read_b64_tr_b16 v[60:61], v12 offset:61440
v_mfma_f32_16x16x32_bf16 v[168:171], v[44:47], a[24:27], v[168:171]
v_mfma_f32_16x16x32_bf16 v[172:175], v[40:43], a[12:15], 0
ds_read_b64_tr_b16 v[62:63], v12 offset:62976
v_mfma_f32_16x16x32_bf16 v[172:175], v[44:47], a[28:31], v[172:175]
s_waitcnt lgkmcnt(4)
v_mfma_f32_16x16x32_bf16 v[64:67], v[48:51], a[0:3], 0
ds_read_b64_tr_b16 v[40:41], v13 offset:49152
v_mfma_f32_16x16x32_bf16 v[64:67], v[52:55], a[16:19], v[64:67]
buffer_load_dwordx4 v32, s[8:11], s41 offen offset:1024 lds
v_mfma_f32_16x16x32_bf16 v[68:71], v[48:51], a[4:7], 0
ds_read_b64_tr_b16 v[42:43], v13 offset:50688
v_mfma_f32_16x16x32_bf16 v[68:71], v[52:55], a[20:23], v[68:71]
v_mfma_f32_16x16x32_bf16 v[72:75], v[48:51], a[8:11], 0
ds_read_b64_tr_b16 v[44:45], v13 offset:61440
v_mfma_f32_16x16x32_bf16 v[72:75], v[52:55], a[24:27], v[72:75]
buffer_load_dwordx4 v33, s[8:11], s41 offen offset:2048 lds
v_mfma_f32_16x16x32_bf16 v[76:79], v[48:51], a[12:15], 0
ds_read_b64_tr_b16 v[46:47], v13 offset:62976
v_mfma_f32_16x16x32_bf16 v[76:79], v[52:55], a[28:31], v[76:79]
s_waitcnt lgkmcnt(4)
v_mfma_f32_16x16x32_bf16 v[176:179], v[56:59], a[0:3], 0
ds_read_b64_tr_b16 v[48:49], v10 offset:49280
v_mfma_f32_16x16x32_bf16 v[176:179], v[60:63], a[16:19], v[176:179]
buffer_load_dwordx4 v34, s[8:11], s41 offen offset:3072 lds
v_mfma_f32_16x16x32_bf16 v[180:183], v[56:59], a[4:7], 0
ds_read_b64_tr_b16 v[50:51], v10 offset:50816
v_mfma_f32_16x16x32_bf16 v[180:183], v[60:63], a[20:23], v[180:183]
v_mfma_f32_16x16x32_bf16 v[184:187], v[56:59], a[8:11], 0
ds_read_b64_tr_b16 v[52:53], v10 offset:61568
v_mfma_f32_16x16x32_bf16 v[184:187], v[60:63], a[24:27], v[184:187]
v_mfma_f32_16x16x32_bf16 v[188:191], v[56:59], a[12:15], 0
ds_read_b64_tr_b16 v[54:55], v10 offset:63104
v_mfma_f32_16x16x32_bf16 v[188:191], v[60:63], a[28:31], v[188:191]
s_waitcnt lgkmcnt(4)
v_mfma_f32_16x16x32_bf16 v[80:83], v[40:43], a[0:3], 0
s_add_u32 m0, s39, 4096
ds_read_b64_tr_b16 v[56:57], v11 offset:49280
v_mfma_f32_16x16x32_bf16 v[80:83], v[44:47], a[16:19], v[80:83]
buffer_load_dwordx4 v35, s[8:11], s41 offen lds
v_mfma_f32_16x16x32_bf16 v[84:87], v[40:43], a[4:7], 0
ds_read_b64_tr_b16 v[58:59], v11 offset:50816
v_mfma_f32_16x16x32_bf16 v[84:87], v[44:47], a[20:23], v[84:87]
buffer_load_dwordx4 v36, s[8:11], s41 offen offset:1024 lds
v_mfma_f32_16x16x32_bf16 v[88:91], v[40:43], a[8:11], 0
ds_read_b64_tr_b16 v[60:61], v11 offset:61568
v_mfma_f32_16x16x32_bf16 v[88:91], v[44:47], a[24:27], v[88:91]
v_mfma_f32_16x16x32_bf16 v[92:95], v[40:43], a[12:15], 0
ds_read_b64_tr_b16 v[62:63], v11 offset:63104
v_mfma_f32_16x16x32_bf16 v[92:95], v[44:47], a[28:31], v[92:95]
s_waitcnt lgkmcnt(4)
v_mfma_f32_16x16x32_bf16 v[192:195], v[48:51], a[0:3], 0
ds_read_b64_tr_b16 v[40:41], v12 offset:49280
v_mfma_f32_16x16x32_bf16 v[192:195], v[52:55], a[16:19], v[192:195]
buffer_load_dwordx4 v37, s[8:11], s41 offen offset:2048 lds
v_mfma_f32_16x16x32_bf16 v[196:199], v[48:51], a[4:7], 0
ds_read_b64_tr_b16 v[42:43], v12 offset:50816
v_mfma_f32_16x16x32_bf16 v[196:199], v[52:55], a[20:23], v[196:199]
v_mfma_f32_16x16x32_bf16 v[200:203], v[48:51], a[8:11], 0
ds_read_b64_tr_b16 v[44:45], v12 offset:61568
v_mfma_f32_16x16x32_bf16 v[200:203], v[52:55], a[24:27], v[200:203]
buffer_load_dwordx4 v38, s[8:11], s41 offen offset:3072 lds
v_mfma_f32_16x16x32_bf16 v[204:207], v[48:51], a[12:15], 0
ds_read_b64_tr_b16 v[46:47], v12 offset:63104
v_mfma_f32_16x16x32_bf16 v[204:207], v[52:55], a[28:31], v[204:207]
s_waitcnt lgkmcnt(4)
v_mfma_f32_16x16x32_bf16 v[96:99], v[56:59], a[0:3], 0
ds_read_b64_tr_b16 v[48:49], v13 offset:49280
v_mfma_f32_16x16x32_bf16 v[96:99], v[60:63], a[16:19], v[96:99]
s_mov_b32 s40, 1572864
v_mfma_f32_16x16x32_bf16 v[100:103], v[56:59], a[4:7], 0
s_add_u32 m0, s37, 49152
ds_read_b64_tr_b16 v[50:51], v13 offset:50816
v_mfma_f32_16x16x32_bf16 v[100:103], v[60:63], a[20:23], v[100:103]
buffer_load_dwordx4 v28, s[12:15], s40 offen lds
v_mfma_f32_16x16x32_bf16 v[104:107], v[56:59], a[8:11], 0
ds_read_b64_tr_b16 v[52:53], v13 offset:61568
v_mfma_f32_16x16x32_bf16 v[104:107], v[60:63], a[24:27], v[104:107]
v_mfma_f32_16x16x32_bf16 v[108:111], v[56:59], a[12:15], 0
ds_read_b64_tr_b16 v[54:55], v13 offset:63104
v_mfma_f32_16x16x32_bf16 v[108:111], v[60:63], a[28:31], v[108:111]
s_waitcnt lgkmcnt(4)
v_mfma_f32_16x16x32_bf16 v[208:211], v[40:43], a[0:3], 0
ds_read_b64_tr_b16 v[56:57], v10 offset:49408
v_mfma_f32_16x16x32_bf16 v[208:211], v[44:47], a[16:19], v[208:211]
buffer_load_dwordx4 v29, s[12:15], s40 offen offset:1024 lds
v_mfma_f32_16x16x32_bf16 v[212:215], v[40:43], a[4:7], 0
ds_read_b64_tr_b16 v[58:59], v10 offset:50944
v_mfma_f32_16x16x32_bf16 v[212:215], v[44:47], a[20:23], v[212:215]
v_mfma_f32_16x16x32_bf16 v[216:219], v[40:43], a[8:11], 0
ds_read_b64_tr_b16 v[60:61], v10 offset:61696
v_mfma_f32_16x16x32_bf16 v[216:219], v[44:47], a[24:27], v[216:219]
buffer_load_dwordx4 v30, s[12:15], s40 offen offset:2048 lds
v_mfma_f32_16x16x32_bf16 v[220:223], v[40:43], a[12:15], 0
s_mov_b32 s40, 1966080
ds_read_b64_tr_b16 v[62:63], v10 offset:63232
v_mfma_f32_16x16x32_bf16 v[220:223], v[44:47], a[28:31], v[220:223]
s_waitcnt lgkmcnt(4)
v_mfma_f32_16x16x32_bf16 v[112:115], v[48:51], a[0:3], 0
s_add_u32 m0, s37, 61440
ds_read_b64_tr_b16 v[40:41], v11 offset:49408
v_mfma_f32_16x16x32_bf16 v[112:115], v[52:55], a[16:19], v[112:115]
buffer_load_dwordx4 v28, s[12:15], s40 offen lds
v_mfma_f32_16x16x32_bf16 v[116:119], v[48:51], a[4:7], 0
ds_read_b64_tr_b16 v[42:43], v11 offset:50944
v_mfma_f32_16x16x32_bf16 v[116:119], v[52:55], a[20:23], v[116:119]
v_mfma_f32_16x16x32_bf16 v[120:123], v[48:51], a[8:11], 0
ds_read_b64_tr_b16 v[44:45], v11 offset:61696
v_mfma_f32_16x16x32_bf16 v[120:123], v[52:55], a[24:27], v[120:123]
v_mfma_f32_16x16x32_bf16 v[124:127], v[48:51], a[12:15], 0
ds_read_b64_tr_b16 v[46:47], v11 offset:63232
v_mfma_f32_16x16x32_bf16 v[124:127], v[52:55], a[28:31], v[124:127]
s_waitcnt lgkmcnt(4)
v_mfma_f32_16x16x32_bf16 v[224:227], v[56:59], a[0:3], 0
ds_read_b64_tr_b16 v[48:49], v12 offset:49408
v_mfma_f32_16x16x32_bf16 v[224:227], v[60:63], a[16:19], v[224:227]
buffer_load_dwordx4 v29, s[12:15], s40 offen offset:1024 lds
v_mfma_f32_16x16x32_bf16 v[228:231], v[56:59], a[4:7], 0
ds_read_b64_tr_b16 v[50:51], v12 offset:50944
v_mfma_f32_16x16x32_bf16 v[228:231], v[60:63], a[20:23], v[228:231]
buffer_load_dwordx4 v30, s[12:15], s40 offen offset:2048 lds
v_mfma_f32_16x16x32_bf16 v[232:235], v[56:59], a[8:11], 0
ds_read_b64_tr_b16 v[52:53], v12 offset:61696
v_mfma_f32_16x16x32_bf16 v[232:235], v[60:63], a[24:27], v[232:235]
v_mfma_f32_16x16x32_bf16 v[236:239], v[56:59], a[12:15], 0
ds_read_b64_tr_b16 v[54:55], v12 offset:63232
v_mfma_f32_16x16x32_bf16 v[236:239], v[60:63], a[28:31], v[236:239]
s_waitcnt lgkmcnt(4)
v_mfma_f32_16x16x32_bf16 v[128:131], v[40:43], a[0:3], 0
ds_read_b64_tr_b16 v[56:57], v13 offset:49408
v_mfma_f32_16x16x32_bf16 v[128:131], v[44:47], a[16:19], v[128:131]
ds_read_b64_tr_b16 v[58:59], v13 offset:50944
v_mfma_f32_16x16x32_bf16 v[132:135], v[40:43], a[4:7], 0
s_mov_b32 s41, 256
ds_read_b64_tr_b16 v[60:61], v13 offset:61696
v_mfma_f32_16x16x32_bf16 v[132:135], v[44:47], a[20:23], v[132:135]
s_mov_b32 m0, s38
ds_read_b64_tr_b16 v[62:63], v13 offset:63232
v_mfma_f32_16x16x32_bf16 v[136:139], v[40:43], a[8:11], 0
buffer_load_dwordx4 v31, s[8:11], s41 offen lds
v_mfma_f32_16x16x32_bf16 v[136:139], v[44:47], a[24:27], v[136:139]
buffer_load_dwordx4 v32, s[8:11], s41 offen offset:1024 lds
v_mfma_f32_16x16x32_bf16 v[140:143], v[40:43], a[12:15], 0
v_mfma_f32_16x16x32_bf16 v[140:143], v[44:47], a[28:31], v[140:143]
s_waitcnt lgkmcnt(4)
v_mfma_f32_16x16x32_bf16 v[240:243], v[48:51], a[0:3], 0
s_waitcnt vmcnt(16) lgkmcnt(0)
v_mfma_f32_16x16x32_bf16 v[240:243], v[52:55], a[16:19], v[240:243]
s_barrier
s_waitcnt vmcnt(8)
v_mfma_f32_16x16x32_bf16 v[244:247], v[48:51], a[4:7], 0
ds_read_b64_tr_b16 v[40:41], v14 offset:24576
ds_read_b128 a[32:35], v20 offset:0
v_mfma_f32_16x16x32_bf16 v[244:247], v[52:55], a[20:23], v[244:247]
ds_read_b64_tr_b16 v[42:43], v14 offset:26112
ds_read_b128 a[48:51], v21 offset:0
v_mfma_f32_16x16x32_bf16 v[248:251], v[48:51], a[8:11], 0
ds_read_b64_tr_b16 v[44:45], v14 offset:36864
ds_read_b128 a[36:39], v20 offset:2048
v_mfma_f32_16x16x32_bf16 v[248:251], v[52:55], a[24:27], v[248:251]
ds_read_b64_tr_b16 v[46:47], v14 offset:38400
ds_read_b128 a[52:55], v21 offset:2048
v_mfma_f32_16x16x32_bf16 v[252:255], v[48:51], a[12:15], 0
ds_read_b128 a[40:43], v20 offset:4096
v_mfma_f32_16x16x32_bf16 v[252:255], v[52:55], a[28:31], v[252:255]
ds_read_b128 a[56:59], v21 offset:4096
v_mfma_f32_16x16x32_bf16 v[144:147], v[56:59], a[0:3], 0
ds_read_b64_tr_b16 v[48:49], v15 offset:24576
ds_read_b128 a[44:47], v20 offset:6144
v_mfma_f32_16x16x32_bf16 v[144:147], v[60:63], a[16:19], v[144:147]
ds_read_b128 a[60:63], v21 offset:6144
v_mfma_f32_16x16x32_bf16 v[148:151], v[56:59], a[4:7], 0
ds_read_b64_tr_b16 v[50:51], v15 offset:26112
v_mfma_f32_16x16x32_bf16 v[148:151], v[60:63], a[20:23], v[148:151]
buffer_load_dwordx4 v33, s[8:11], s41 offen offset:2048 lds
v_mfma_f32_16x16x32_bf16 v[152:155], v[56:59], a[8:11], 0
ds_read_b64_tr_b16 v[52:53], v15 offset:36864
v_mfma_f32_16x16x32_bf16 v[152:155], v[60:63], a[24:27], v[152:155]
buffer_load_dwordx4 v34, s[8:11], s41 offen offset:3072 lds
v_mfma_f32_16x16x32_bf16 v[156:159], v[56:59], a[12:15], 0
ds_read_b64_tr_b16 v[54:55], v15 offset:38400
v_mfma_f32_16x16x32_bf16 v[156:159], v[60:63], a[28:31], v[156:159]
s_waitcnt lgkmcnt(3)
v_mfma_f32_16x16x32_bf16 v[160:163], v[40:43], a[32:35], v[160:163]
s_add_u32 m0, s38, 4096
ds_read_b64_tr_b16 v[56:57], v16 offset:24576
v_mfma_f32_16x16x32_bf16 v[160:163], v[44:47], a[48:51], v[160:163]
buffer_load_dwordx4 v35, s[8:11], s41 offen lds
v_mfma_f32_16x16x32_bf16 v[164:167], v[40:43], a[36:39], v[164:167]
ds_read_b64_tr_b16 v[58:59], v16 offset:26112
v_mfma_f32_16x16x32_bf16 v[164:167], v[44:47], a[52:55], v[164:167]
buffer_load_dwordx4 v36, s[8:11], s41 offen offset:1024 lds
v_mfma_f32_16x16x32_bf16 v[168:171], v[40:43], a[40:43], v[168:171]
ds_read_b64_tr_b16 v[60:61], v16 offset:36864
v_mfma_f32_16x16x32_bf16 v[168:171], v[44:47], a[56:59], v[168:171]
v_mfma_f32_16x16x32_bf16 v[172:175], v[40:43], a[44:47], v[172:175]
ds_read_b64_tr_b16 v[62:63], v16 offset:38400
v_mfma_f32_16x16x32_bf16 v[172:175], v[44:47], a[60:63], v[172:175]
s_waitcnt lgkmcnt(4)
v_mfma_f32_16x16x32_bf16 v[64:67], v[48:51], a[32:35], v[64:67]
ds_read_b64_tr_b16 v[40:41], v17 offset:24576
v_mfma_f32_16x16x32_bf16 v[64:67], v[52:55], a[48:51], v[64:67]
buffer_load_dwordx4 v37, s[8:11], s41 offen offset:2048 lds
v_mfma_f32_16x16x32_bf16 v[68:71], v[48:51], a[36:39], v[68:71]
ds_read_b64_tr_b16 v[42:43], v17 offset:26112
v_mfma_f32_16x16x32_bf16 v[68:71], v[52:55], a[52:55], v[68:71]
buffer_load_dwordx4 v38, s[8:11], s41 offen offset:3072 lds
v_mfma_f32_16x16x32_bf16 v[72:75], v[48:51], a[40:43], v[72:75]
ds_read_b64_tr_b16 v[44:45], v17 offset:36864
v_mfma_f32_16x16x32_bf16 v[72:75], v[52:55], a[56:59], v[72:75]
v_mfma_f32_16x16x32_bf16 v[76:79], v[48:51], a[44:47], v[76:79]
s_mov_b32 s40, 2359296
ds_read_b64_tr_b16 v[46:47], v17 offset:38400
v_mfma_f32_16x16x32_bf16 v[76:79], v[52:55], a[60:63], v[76:79]
s_waitcnt lgkmcnt(4)
v_mfma_f32_16x16x32_bf16 v[176:179], v[56:59], a[32:35], v[176:179]
s_add_u32 m0, s37, 122880
ds_read_b64_tr_b16 v[48:49], v14 offset:24704
v_mfma_f32_16x16x32_bf16 v[176:179], v[60:63], a[48:51], v[176:179]
buffer_load_dwordx4 v28, s[12:15], s40 offen lds
v_mfma_f32_16x16x32_bf16 v[180:183], v[56:59], a[36:39], v[180:183]
ds_read_b64_tr_b16 v[50:51], v14 offset:26240
v_mfma_f32_16x16x32_bf16 v[180:183], v[60:63], a[52:55], v[180:183]
v_mfma_f32_16x16x32_bf16 v[184:187], v[56:59], a[40:43], v[184:187]
ds_read_b64_tr_b16 v[52:53], v14 offset:36992
v_mfma_f32_16x16x32_bf16 v[184:187], v[60:63], a[56:59], v[184:187]
buffer_load_dwordx4 v29, s[12:15], s40 offen offset:1024 lds
v_mfma_f32_16x16x32_bf16 v[188:191], v[56:59], a[44:47], v[188:191]
ds_read_b64_tr_b16 v[54:55], v14 offset:38528
v_mfma_f32_16x16x32_bf16 v[188:191], v[60:63], a[60:63], v[188:191]
s_waitcnt lgkmcnt(4)
v_mfma_f32_16x16x32_bf16 v[80:83], v[40:43], a[32:35], v[80:83]
ds_read_b64_tr_b16 v[56:57], v15 offset:24704
v_mfma_f32_16x16x32_bf16 v[80:83], v[44:47], a[48:51], v[80:83]
v_mfma_f32_16x16x32_bf16 v[84:87], v[40:43], a[36:39], v[84:87]
ds_read_b64_tr_b16 v[58:59], v15 offset:26240
v_mfma_f32_16x16x32_bf16 v[84:87], v[44:47], a[52:55], v[84:87]
buffer_load_dwordx4 v30, s[12:15], s40 offen offset:2048 lds
v_mfma_f32_16x16x32_bf16 v[88:91], v[40:43], a[40:43], v[88:91]
ds_read_b64_tr_b16 v[60:61], v15 offset:36992
v_mfma_f32_16x16x32_bf16 v[88:91], v[44:47], a[56:59], v[88:91]
v_mfma_f32_16x16x32_bf16 v[92:95], v[40:43], a[44:47], v[92:95]
s_mov_b32 s40, 2752512
ds_read_b64_tr_b16 v[62:63], v15 offset:38528
v_mfma_f32_16x16x32_bf16 v[92:95], v[44:47], a[60:63], v[92:95]
s_waitcnt lgkmcnt(4)
v_mfma_f32_16x16x32_bf16 v[192:195], v[48:51], a[32:35], v[192:195]
s_add_u32 m0, s37, 135168
ds_read_b64_tr_b16 v[40:41], v16 offset:24704
v_mfma_f32_16x16x32_bf16 v[192:195], v[52:55], a[48:51], v[192:195]
buffer_load_dwordx4 v28, s[12:15], s40 offen lds
v_mfma_f32_16x16x32_bf16 v[196:199], v[48:51], a[36:39], v[196:199]
ds_read_b64_tr_b16 v[42:43], v16 offset:26240
v_mfma_f32_16x16x32_bf16 v[196:199], v[52:55], a[52:55], v[196:199]
v_mfma_f32_16x16x32_bf16 v[200:203], v[48:51], a[40:43], v[200:203]
ds_read_b64_tr_b16 v[44:45], v16 offset:36992
v_mfma_f32_16x16x32_bf16 v[200:203], v[52:55], a[56:59], v[200:203]
buffer_load_dwordx4 v29, s[12:15], s40 offen offset:1024 lds
v_mfma_f32_16x16x32_bf16 v[204:207], v[48:51], a[44:47], v[204:207]
ds_read_b64_tr_b16 v[46:47], v16 offset:38528
v_mfma_f32_16x16x32_bf16 v[204:207], v[52:55], a[60:63], v[204:207]
s_waitcnt lgkmcnt(4)
v_mfma_f32_16x16x32_bf16 v[96:99], v[56:59], a[32:35], v[96:99]
ds_read_b64_tr_b16 v[48:49], v17 offset:24704
v_mfma_f32_16x16x32_bf16 v[96:99], v[60:63], a[48:51], v[96:99]
buffer_load_dwordx4 v30, s[12:15], s40 offen offset:2048 lds
v_mfma_f32_16x16x32_bf16 v[100:103], v[56:59], a[36:39], v[100:103]
ds_read_b64_tr_b16 v[50:51], v17 offset:26240
v_mfma_f32_16x16x32_bf16 v[100:103], v[60:63], a[52:55], v[100:103]
v_mfma_f32_16x16x32_bf16 v[104:107], v[56:59], a[40:43], v[104:107]
ds_read_b64_tr_b16 v[52:53], v17 offset:36992
v_mfma_f32_16x16x32_bf16 v[104:107], v[60:63], a[56:59], v[104:107]
v_mfma_f32_16x16x32_bf16 v[108:111], v[56:59], a[44:47], v[108:111]
s_mov_b32 s41, 384
ds_read_b64_tr_b16 v[54:55], v17 offset:38528
v_mfma_f32_16x16x32_bf16 v[108:111], v[60:63], a[60:63], v[108:111]
s_waitcnt lgkmcnt(4)
v_mfma_f32_16x16x32_bf16 v[208:211], v[40:43], a[32:35], v[208:211]
s_mov_b32 m0, s39
ds_read_b64_tr_b16 v[56:57], v14 offset:24832
v_mfma_f32_16x16x32_bf16 v[208:211], v[44:47], a[48:51], v[208:211]
buffer_load_dwordx4 v31, s[8:11], s41 offen lds
v_mfma_f32_16x16x32_bf16 v[212:215], v[40:43], a[36:39], v[212:215]
ds_read_b64_tr_b16 v[58:59], v14 offset:26368
v_mfma_f32_16x16x32_bf16 v[212:215], v[44:47], a[52:55], v[212:215]
buffer_load_dwordx4 v32, s[8:11], s41 offen offset:1024 lds
v_mfma_f32_16x16x32_bf16 v[216:219], v[40:43], a[40:43], v[216:219]
ds_read_b64_tr_b16 v[60:61], v14 offset:37120
v_mfma_f32_16x16x32_bf16 v[216:219], v[44:47], a[56:59], v[216:219]
v_mfma_f32_16x16x32_bf16 v[220:223], v[40:43], a[44:47], v[220:223]
ds_read_b64_tr_b16 v[62:63], v14 offset:38656
v_mfma_f32_16x16x32_bf16 v[220:223], v[44:47], a[60:63], v[220:223]
s_waitcnt lgkmcnt(4)
v_mfma_f32_16x16x32_bf16 v[112:115], v[48:51], a[32:35], v[112:115]
ds_read_b64_tr_b16 v[40:41], v15 offset:24832
v_mfma_f32_16x16x32_bf16 v[112:115], v[52:55], a[48:51], v[112:115]
buffer_load_dwordx4 v33, s[8:11], s41 offen offset:2048 lds
v_mfma_f32_16x16x32_bf16 v[116:119], v[48:51], a[36:39], v[116:119]
ds_read_b64_tr_b16 v[42:43], v15 offset:26368
v_mfma_f32_16x16x32_bf16 v[116:119], v[52:55], a[52:55], v[116:119]
v_mfma_f32_16x16x32_bf16 v[120:123], v[48:51], a[40:43], v[120:123]
ds_read_b64_tr_b16 v[44:45], v15 offset:37120
v_mfma_f32_16x16x32_bf16 v[120:123], v[52:55], a[56:59], v[120:123]
buffer_load_dwordx4 v34, s[8:11], s41 offen offset:3072 lds
v_mfma_f32_16x16x32_bf16 v[124:127], v[48:51], a[44:47], v[124:127]
ds_read_b64_tr_b16 v[46:47], v15 offset:38656
v_mfma_f32_16x16x32_bf16 v[124:127], v[52:55], a[60:63], v[124:127]
s_waitcnt lgkmcnt(4)
v_mfma_f32_16x16x32_bf16 v[224:227], v[56:59], a[32:35], v[224:227]
ds_read_b64_tr_b16 v[48:49], v16 offset:24832
v_mfma_f32_16x16x32_bf16 v[224:227], v[60:63], a[48:51], v[224:227]
v_mfma_f32_16x16x32_bf16 v[228:231], v[56:59], a[36:39], v[228:231]
s_add_u32 m0, s39, 4096
ds_read_b64_tr_b16 v[50:51], v16 offset:26368
v_mfma_f32_16x16x32_bf16 v[228:231], v[60:63], a[52:55], v[228:231]
buffer_load_dwordx4 v35, s[8:11], s41 offen lds
v_mfma_f32_16x16x32_bf16 v[232:235], v[56:59], a[40:43], v[232:235]
ds_read_b64_tr_b16 v[52:53], v16 offset:37120
v_mfma_f32_16x16x32_bf16 v[232:235], v[60:63], a[56:59], v[232:235]
v_mfma_f32_16x16x32_bf16 v[236:239], v[56:59], a[44:47], v[236:239]
ds_read_b64_tr_b16 v[54:55], v16 offset:38656
v_mfma_f32_16x16x32_bf16 v[236:239], v[60:63], a[60:63], v[236:239]
s_waitcnt lgkmcnt(4)
v_mfma_f32_16x16x32_bf16 v[128:131], v[40:43], a[32:35], v[128:131]
ds_read_b64_tr_b16 v[56:57], v17 offset:24832
v_mfma_f32_16x16x32_bf16 v[128:131], v[44:47], a[48:51], v[128:131]
ds_read_b64_tr_b16 v[58:59], v17 offset:26368
v_mfma_f32_16x16x32_bf16 v[132:135], v[40:43], a[36:39], v[132:135]
ds_read_b64_tr_b16 v[60:61], v17 offset:37120
v_mfma_f32_16x16x32_bf16 v[132:135], v[44:47], a[52:55], v[132:135]
ds_read_b64_tr_b16 v[62:63], v17 offset:38656
v_mfma_f32_16x16x32_bf16 v[136:139], v[40:43], a[40:43], v[136:139]
buffer_load_dwordx4 v36, s[8:11], s41 offen offset:1024 lds
v_mfma_f32_16x16x32_bf16 v[136:139], v[44:47], a[56:59], v[136:139]
buffer_load_dwordx4 v37, s[8:11], s41 offen offset:2048 lds
v_mfma_f32_16x16x32_bf16 v[140:143], v[40:43], a[44:47], v[140:143]
v_mfma_f32_16x16x32_bf16 v[140:143], v[44:47], a[60:63], v[140:143]
s_waitcnt lgkmcnt(4)
v_mfma_f32_16x16x32_bf16 v[240:243], v[48:51], a[32:35], v[240:243]
s_waitcnt vmcnt(21) lgkmcnt(0)
v_mfma_f32_16x16x32_bf16 v[240:243], v[52:55], a[48:51], v[240:243]
s_barrier
s_waitcnt vmcnt(13)
v_mfma_f32_16x16x32_bf16 v[244:247], v[48:51], a[36:39], v[244:247]
ds_read_b64_tr_b16 v[40:41], v14 offset:49152
ds_read_b128 a[0:3], v18 offset:0
v_mfma_f32_16x16x32_bf16 v[244:247], v[52:55], a[52:55], v[244:247]
ds_read_b64_tr_b16 v[42:43], v14 offset:50688
ds_read_b128 a[16:19], v19 offset:0
v_mfma_f32_16x16x32_bf16 v[248:251], v[48:51], a[40:43], v[248:251]
ds_read_b64_tr_b16 v[44:45], v14 offset:61440
ds_read_b128 a[4:7], v18 offset:2048
v_mfma_f32_16x16x32_bf16 v[248:251], v[52:55], a[56:59], v[248:251]
ds_read_b64_tr_b16 v[46:47], v14 offset:62976
ds_read_b128 a[20:23], v19 offset:2048
v_mfma_f32_16x16x32_bf16 v[252:255], v[48:51], a[44:47], v[252:255]
ds_read_b128 a[8:11], v18 offset:4096
v_mfma_f32_16x16x32_bf16 v[252:255], v[52:55], a[60:63], v[252:255]
ds_read_b128 a[24:27], v19 offset:4096
v_mfma_f32_16x16x32_bf16 v[144:147], v[56:59], a[32:35], v[144:147]
ds_read_b64_tr_b16 v[48:49], v15 offset:49152
ds_read_b128 a[12:15], v18 offset:6144
v_mfma_f32_16x16x32_bf16 v[144:147], v[60:63], a[48:51], v[144:147]
ds_read_b128 a[28:31], v19 offset:6144
v_mfma_f32_16x16x32_bf16 v[148:151], v[56:59], a[36:39], v[148:151]
ds_read_b64_tr_b16 v[50:51], v15 offset:50688
v_mfma_f32_16x16x32_bf16 v[148:151], v[60:63], a[52:55], v[148:151]
buffer_load_dwordx4 v38, s[8:11], s41 offen offset:3072 lds
v_mfma_f32_16x16x32_bf16 v[152:155], v[56:59], a[40:43], v[152:155]
ds_read_b64_tr_b16 v[52:53], v15 offset:61440
v_mfma_f32_16x16x32_bf16 v[152:155], v[60:63], a[56:59], v[152:155]
v_mfma_f32_16x16x32_bf16 v[156:159], v[56:59], a[44:47], v[156:159]
s_mov_b32 s40, 3145728
ds_read_b64_tr_b16 v[54:55], v15 offset:62976
v_mfma_f32_16x16x32_bf16 v[156:159], v[60:63], a[60:63], v[156:159]
s_waitcnt lgkmcnt(3)
v_mfma_f32_16x16x32_bf16 v[160:163], v[40:43], a[0:3], v[160:163]
s_add_u32 m0, s37, 24576
ds_read_b64_tr_b16 v[56:57], v16 offset:49152
v_mfma_f32_16x16x32_bf16 v[160:163], v[44:47], a[16:19], v[160:163]
buffer_load_dwordx4 v28, s[12:15], s40 offen lds
v_mfma_f32_16x16x32_bf16 v[164:167], v[40:43], a[4:7], v[164:167]
ds_read_b64_tr_b16 v[58:59], v16 offset:50688
v_mfma_f32_16x16x32_bf16 v[164:167], v[44:47], a[20:23], v[164:167]
buffer_load_dwordx4 v29, s[12:15], s40 offen offset:1024 lds
v_mfma_f32_16x16x32_bf16 v[168:171], v[40:43], a[8:11], v[168:171]
ds_read_b64_tr_b16 v[60:61], v16 offset:61440
v_mfma_f32_16x16x32_bf16 v[168:171], v[44:47], a[24:27], v[168:171]
buffer_load_dwordx4 v30, s[12:15], s40 offen offset:2048 lds
v_mfma_f32_16x16x32_bf16 v[172:175], v[40:43], a[12:15], v[172:175]
s_mov_b32 s40, 3538944
ds_read_b64_tr_b16 v[62:63], v16 offset:62976
v_mfma_f32_16x16x32_bf16 v[172:175], v[44:47], a[28:31], v[172:175]
s_waitcnt lgkmcnt(4)
v_mfma_f32_16x16x32_bf16 v[64:67], v[48:51], a[0:3], v[64:67]
s_add_u32 m0, s37, 36864
ds_read_b64_tr_b16 v[40:41], v17 offset:49152
v_mfma_f32_16x16x32_bf16 v[64:67], v[52:55], a[16:19], v[64:67]
buffer_load_dwordx4 v28, s[12:15], s40 offen lds
v_mfma_f32_16x16x32_bf16 v[68:71], v[48:51], a[4:7], v[68:71]
ds_read_b64_tr_b16 v[42:43], v17 offset:50688
v_mfma_f32_16x16x32_bf16 v[68:71], v[52:55], a[20:23], v[68:71]
buffer_load_dwordx4 v29, s[12:15], s40 offen offset:1024 lds
v_mfma_f32_16x16x32_bf16 v[72:75], v[48:51], a[8:11], v[72:75]
ds_read_b64_tr_b16 v[44:45], v17 offset:61440
v_mfma_f32_16x16x32_bf16 v[72:75], v[52:55], a[24:27], v[72:75]
v_mfma_f32_16x16x32_bf16 v[76:79], v[48:51], a[12:15], v[76:79]
ds_read_b64_tr_b16 v[46:47], v17 offset:62976
v_mfma_f32_16x16x32_bf16 v[76:79], v[52:55], a[28:31], v[76:79]
s_waitcnt lgkmcnt(4)
v_mfma_f32_16x16x32_bf16 v[176:179], v[56:59], a[0:3], v[176:179]
ds_read_b64_tr_b16 v[48:49], v14 offset:49280
v_mfma_f32_16x16x32_bf16 v[176:179], v[60:63], a[16:19], v[176:179]
buffer_load_dwordx4 v30, s[12:15], s40 offen offset:2048 lds
v_mfma_f32_16x16x32_bf16 v[180:183], v[56:59], a[4:7], v[180:183]
ds_read_b64_tr_b16 v[50:51], v14 offset:50816
v_mfma_f32_16x16x32_bf16 v[180:183], v[60:63], a[20:23], v[180:183]
v_mfma_f32_16x16x32_bf16 v[184:187], v[56:59], a[8:11], v[184:187]
s_mov_b32 s55, 3145728
ds_read_b64_tr_b16 v[52:53], v14 offset:61568
v_mfma_f32_16x16x32_bf16 v[184:187], v[60:63], a[24:27], v[184:187]
buffer_load_dword a190, v9, s[8:11], 0 offen offset:768
v_mfma_f32_16x16x32_bf16 v[188:191], v[56:59], a[12:15], v[188:191]
ds_read_b64_tr_b16 v[54:55], v14 offset:63104
v_mfma_f32_16x16x32_bf16 v[188:191], v[60:63], a[28:31], v[188:191]
s_waitcnt lgkmcnt(4)
v_mfma_f32_16x16x32_bf16 v[80:83], v[40:43], a[0:3], v[80:83]
ds_read_b64_tr_b16 v[56:57], v15 offset:49280
v_mfma_f32_16x16x32_bf16 v[80:83], v[44:47], a[16:19], v[80:83]
buffer_load_dword a191, v8, s[12:15], s55 offen
v_mfma_f32_16x16x32_bf16 v[84:87], v[40:43], a[4:7], v[84:87]
ds_read_b64_tr_b16 v[58:59], v15 offset:50816
v_mfma_f32_16x16x32_bf16 v[84:87], v[44:47], a[20:23], v[84:87]
v_mfma_f32_16x16x32_bf16 v[88:91], v[40:43], a[8:11], v[88:91]
ds_read_b64_tr_b16 v[60:61], v15 offset:61568
v_mfma_f32_16x16x32_bf16 v[88:91], v[44:47], a[24:27], v[88:91]
v_mfma_f32_16x16x32_bf16 v[92:95], v[40:43], a[12:15], v[92:95]
s_mov_b32 s41, 512
ds_read_b64_tr_b16 v[62:63], v15 offset:63104
v_mfma_f32_16x16x32_bf16 v[92:95], v[44:47], a[28:31], v[92:95]
s_waitcnt lgkmcnt(4)
v_mfma_f32_16x16x32_bf16 v[192:195], v[48:51], a[0:3], v[192:195]
s_mov_b32 m0, s38
ds_read_b64_tr_b16 v[40:41], v16 offset:49280
v_mfma_f32_16x16x32_bf16 v[192:195], v[52:55], a[16:19], v[192:195]
buffer_load_dwordx4 v31, s[8:11], s41 offen lds
v_mfma_f32_16x16x32_bf16 v[196:199], v[48:51], a[4:7], v[196:199]
ds_read_b64_tr_b16 v[42:43], v16 offset:50816
v_mov_b32 v1, s34
v_mfma_f32_16x16x32_bf16 v[196:199], v[52:55], a[20:23], v[196:199]
buffer_load_dwordx4 v32, s[8:11], s41 offen offset:1024 lds
v_mfma_f32_16x16x32_bf16 v[200:203], v[48:51], a[8:11], v[200:203]
ds_read_b64_tr_b16 v[44:45], v16 offset:61568
s_and_b32 s3, s34, 1
v_mfma_f32_16x16x32_bf16 v[200:203], v[52:55], a[24:27], v[200:203]
s_mul_i32 s3, s3, 5
s_lshr_b32 s88, s34, 1
v_mfma_f32_16x16x32_bf16 v[204:207], v[48:51], a[12:15], v[204:207]
ds_read_b64_tr_b16 v[46:47], v16 offset:63104
s_lshl_b32 s88, s88, 2
v_mfma_f32_16x16x32_bf16 v[204:207], v[52:55], a[28:31], v[204:207]
s_waitcnt lgkmcnt(4)
s_xor_b32 s3, s3, s88
s_lshl_b32 s88, s34, 8
v_mfma_f32_16x16x32_bf16 v[96:99], v[56:59], a[0:3], v[96:99]
ds_read_b64_tr_b16 v[48:49], v17 offset:49280
s_add_u32 s88, s88, 1
v_mfma_f32_16x16x32_bf16 v[96:99], v[60:63], a[16:19], v[96:99]
buffer_load_dwordx4 v33, s[8:11], s41 offen offset:2048 lds
v_mfma_f32_16x16x32_bf16 v[100:103], v[56:59], a[4:7], v[100:103]
ds_read_b64_tr_b16 v[50:51], v17 offset:50816
s_mul_i32 s88, s88, 21846
v_mfma_f32_16x16x32_bf16 v[100:103], v[60:63], a[20:23], v[100:103]
s_lshr_b32 s88, s88, 16
s_lshl_b32 s84, s34, 3
v_mfma_f32_16x16x32_bf16 v[104:107], v[56:59], a[8:11], v[104:107]
ds_read_b64_tr_b16 v[52:53], v17 offset:61568
s_sub_u32 s88, s88, s84
v_mfma_f32_16x16x32_bf16 v[104:107], v[60:63], a[24:27], v[104:107]
buffer_load_dwordx4 v34, s[8:11], s41 offen offset:3072 lds
v_mfma_f32_16x16x32_bf16 v[108:111], v[56:59], a[12:15], v[108:111]
ds_read_b64_tr_b16 v[54:55], v17 offset:63104
s_mul_i32 s88, s88, 384
v_mfma_f32_16x16x32_bf16 v[108:111], v[60:63], a[28:31], v[108:111]
s_waitcnt lgkmcnt(4)
s_cmp_eq_u32 s34, 1
s_cselect_b32 s84, 24, 0
v_mfma_f32_16x16x32_bf16 v[208:211], v[40:43], a[0:3], v[208:211]
ds_read_b64_tr_b16 v[56:57], v14 offset:49408
s_add_u32 s84, s84, 119
v_mfma_f32_16x16x32_bf16 v[208:211], v[44:47], a[16:19], v[208:211]
s_cmp_eq_u32 s34, 2
s_cselect_b32 s85, 47, 71
v_mfma_f32_16x16x32_bf16 v[212:215], v[40:43], a[4:7], v[212:215]
s_add_u32 m0, s38, 4096
ds_read_b64_tr_b16 v[58:59], v14 offset:50944
v_mul_u32_u24 v3, 384, v22
v_mfma_f32_16x16x32_bf16 v[212:215], v[44:47], a[20:23], v[212:215]
buffer_load_dwordx4 v35, s[8:11], s41 offen lds
v_mfma_f32_16x16x32_bf16 v[216:219], v[40:43], a[8:11], v[216:219]
ds_read_b64_tr_b16 v[60:61], v14 offset:61696
v_add_u32 v3, s88, v3
v_mfma_f32_16x16x32_bf16 v[216:219], v[44:47], a[24:27], v[216:219]
KF_pg1:
s_cbranch_execz KF_pg5
v_add_u32 v2, 0, v0
v_sub_u32 v4, s84, v2
v_mfma_f32_16x16x32_bf16 v[220:223], v[40:43], a[12:15], v[220:223]
ds_read_b64_tr_b16 v[62:63], v14 offset:63232
v_ashrrev_i32 v4, 31, v4
v_mfma_f32_16x16x32_bf16 v[220:223], v[44:47], a[28:31], v[220:223]
s_waitcnt lgkmcnt(4)
v_and_b32 v4, 129024, v4
v_sub_u32 v5, s85, v2
v_mfma_f32_16x16x32_bf16 v[112:115], v[48:51], a[0:3], v[112:115]
ds_read_b64_tr_b16 v[40:41], v15 offset:49408
v_ashrrev_i32 v5, 31, v5
v_mfma_f32_16x16x32_bf16 v[112:115], v[52:55], a[16:19], v[112:115]
buffer_load_dwordx4 v36, s[8:11], s41 offen offset:1024 lds
v_mfma_f32_16x16x32_bf16 v[116:119], v[48:51], a[4:7], v[116:119]
ds_read_b64_tr_b16 v[42:43], v15 offset:50944
v_and_b32 v5, 129024, v5
v_mfma_f32_16x16x32_bf16 v[116:119], v[52:55], a[20:23], v[116:119]
v_add_u32 v3, v3, v4
v_sub_u32 v4, v5, v4
v_mfma_f32_16x16x32_bf16 v[120:123], v[48:51], a[8:11], v[120:123]
ds_read_b64_tr_b16 v[44:45], v15 offset:61696
v_accvgpr_write_b32 a160, v4
v_mfma_f32_16x16x32_bf16 v[120:123], v[52:55], a[24:27], v[120:123]
buffer_load_dwordx4 v37, s[8:11], s41 offen offset:2048 lds
v_mfma_f32_16x16x32_bf16 v[124:127], v[48:51], a[12:15], v[124:127]
ds_read_b64_tr_b16 v[46:47], v15 offset:63232
v_accvgpr_write_b32 a163, v5
v_mfma_f32_16x16x32_bf16 v[124:127], v[52:55], a[28:31], v[124:127]
s_waitcnt lgkmcnt(4)
v_xor_b32 v2, s3, v25
v_lshl_add_u32 v22, v2, 4, v3
v_mfma_f32_16x16x32_bf16 v[224:227], v[56:59], a[0:3], v[224:227]
ds_read_b64_tr_b16 v[48:49], v16 offset:49408
v_lshl_add_u32 v25, v25, 4, v3
v_mfma_f32_16x16x32_bf16 v[224:227], v[60:63], a[16:19], v[224:227]
buffer_load_dwordx4 v38, s[8:11], s41 offen offset:3072 lds
v_mfma_f32_16x16x32_bf16 v[228:231], v[56:59], a[4:7], v[228:231]
ds_read_b64_tr_b16 v[50:51], v16 offset:50944
v_mul_u32_u24 v3, 384, v23
v_mfma_f32_16x16x32_bf16 v[228:231], v[60:63], a[20:23], v[228:231]
v_add_u32 v3, s88, v3
v_subrev_u32 v3, 1024, v3
v_mfma_f32_16x16x32_bf16 v[232:235], v[56:59], a[8:11], v[232:235]
ds_read_b64_tr_b16 v[52:53], v16 offset:61696
v_add_u32 v2, 64, v0
v_mfma_f32_16x16x32_bf16 v[232:235], v[60:63], a[24:27], v[232:235]
v_sub_u32 v4, s84, v2
v_ashrrev_i32 v4, 31, v4
v_mfma_f32_16x16x32_bf16 v[236:239], v[56:59], a[12:15], v[236:239]
ds_read_b64_tr_b16 v[54:55], v16 offset:63232
v_and_b32 v4, 129024, v4
v_mfma_f32_16x16x32_bf16 v[236:239], v[60:63], a[28:31], v[236:239]
s_waitcnt lgkmcnt(4)
v_sub_u32 v5, s85, v2
v_ashrrev_i32 v5, 31, v5
v_mfma_f32_16x16x32_bf16 v[128:131], v[40:43], a[0:3], v[128:131]
ds_read_b64_tr_b16 v[56:57], v17 offset:49408
v_and_b32 v5, 129024, v5
v_mfma_f32_16x16x32_bf16 v[128:131], v[44:47], a[16:19], v[128:131]
ds_read_b64_tr_b16 v[58:59], v17 offset:50944
v_add_u32 v3, v3, v4
v_mfma_f32_16x16x32_bf16 v[132:135], v[40:43], a[4:7], v[132:135]
ds_read_b64_tr_b16 v[60:61], v17 offset:61696
v_sub_u32 v4, v5, v4
v_mfma_f32_16x16x32_bf16 v[132:135], v[44:47], a[20:23], v[132:135]
ds_read_b64_tr_b16 v[62:63], v17 offset:63232
v_accvgpr_write_b32 a161, v4
v_mfma_f32_16x16x32_bf16 v[136:139], v[40:43], a[8:11], v[136:139]
v_accvgpr_write_b32 a164, v5
v_xor_b32 v2, s3, v26
v_mfma_f32_16x16x32_bf16 v[136:139], v[44:47], a[24:27], v[136:139]
v_lshl_add_u32 v23, v2, 4, v3
v_lshl_add_u32 v26, v26, 4, v3
v_mfma_f32_16x16x32_bf16 v[140:143], v[40:43], a[12:15], v[140:143]
v_mul_u32_u24 v3, 384, v24
v_add_u32 v3, s88, v3
v_mfma_f32_16x16x32_bf16 v[140:143], v[44:47], a[28:31], v[140:143]
s_waitcnt lgkmcnt(4)
v_subrev_u32 v3, 2048, v3
v_add_u32 v2, 128, v0
v_mfma_f32_16x16x32_bf16 v[240:243], v[48:51], a[0:3], v[240:243]
s_waitcnt vmcnt(24) lgkmcnt(0)
v_sub_u32 v4, s84, v2
v_ashrrev_i32 v4, 31, v4
v_mfma_f32_16x16x32_bf16 v[240:243], v[52:55], a[16:19], v[240:243]
s_barrier
s_waitcnt vmcnt(16)
v_and_b32 v4, 129024, v4
v_sub_u32 v5, s85, v2
v_mfma_f32_16x16x32_bf16 v[244:247], v[48:51], a[4:7], v[244:247]
ds_read_b64_tr_b16 v[40:41], v10 offset:49152
ds_read_b128 a[32:35], v20 offset:0
v_mfma_f32_16x16x32_bf16 v[244:247], v[52:55], a[20:23], v[244:247]
ds_read_b64_tr_b16 v[42:43], v10 offset:50688
ds_read_b128 a[48:51], v21 offset:0
v_mfma_f32_16x16x32_bf16 v[248:251], v[48:51], a[8:11], v[248:251]
ds_read_b64_tr_b16 v[44:45], v10 offset:61440
ds_read_b128 a[36:39], v20 offset:2048
v_mfma_f32_16x16x32_bf16 v[248:251], v[52:55], a[24:27], v[248:251]
ds_read_b64_tr_b16 v[46:47], v10 offset:62976
ds_read_b128 a[52:55], v21 offset:2048
v_mfma_f32_16x16x32_bf16 v[252:255], v[48:51], a[12:15], v[252:255]
ds_read_b128 a[40:43], v20 offset:4096
v_ashrrev_i32 v5, 31, v5
v_mfma_f32_16x16x32_bf16 v[252:255], v[52:55], a[28:31], v[252:255]
ds_read_b128 a[56:59], v21 offset:4096
v_and_b32 v5, 129024, v5
v_mfma_f32_16x16x32_bf16 v[144:147], v[56:59], a[0:3], v[144:147]
ds_read_b64_tr_b16 v[48:49], v11 offset:49152
ds_read_b128 a[44:47], v20 offset:6144
v_mfma_f32_16x16x32_bf16 v[144:147], v[60:63], a[16:19], v[144:147]
s_mov_b32 s40, 3932160
ds_read_b128 a[60:63], v21 offset:6144
v_add_u32 v3, v3, v4
v_mfma_f32_16x16x32_bf16 v[148:151], v[56:59], a[4:7], v[148:151]
s_add_u32 m0, s37, 49152
ds_read_b64_tr_b16 v[50:51], v11 offset:50688
v_sub_u32 v4, v5, v4
v_mfma_f32_16x16x32_bf16 v[148:151], v[60:63], a[20:23], v[148:151]
buffer_load_dwordx4 v28, s[12:15], s40 offen lds
v_mfma_f32_16x16x32_bf16 v[152:155], v[56:59], a[8:11], v[152:155]
ds_read_b64_tr_b16 v[52:53], v11 offset:61440
v_accvgpr_write_b32 a162, v4
v_mfma_f32_16x16x32_bf16 v[152:155], v[60:63], a[24:27], v[152:155]
buffer_load_dwordx4 v29, s[12:15], s40 offen offset:1024 lds
v_mfma_f32_16x16x32_bf16 v[156:159], v[56:59], a[12:15], v[156:159]
ds_read_b64_tr_b16 v[54:55], v11 offset:62976
v_accvgpr_write_b32 a165, v5
v_mfma_f32_16x16x32_bf16 v[156:159], v[60:63], a[28:31], v[156:159]
s_waitcnt lgkmcnt(3)
v_xor_b32 v2, s3, v27
v_lshl_add_u32 v24, v2, 4, v3
v_mfma_f32_16x16x32_bf16 v[160:163], v[40:43], a[32:35], v[160:163]
ds_read_b64_tr_b16 v[56:57], v12 offset:49152
v_lshl_add_u32 v27, v27, 4, v3
v_mfma_f32_16x16x32_bf16 v[160:163], v[44:47], a[48:51], v[160:163]
buffer_load_dwordx4 v30, s[12:15], s40 offen offset:2048 lds
v_mfma_f32_16x16x32_bf16 v[164:167], v[40:43], a[36:39], v[164:167]
ds_read_b64_tr_b16 v[58:59], v12 offset:50688
s_lshl_b32 s43, s35, 5
v_mfma_f32_16x16x32_bf16 v[164:167], v[44:47], a[52:55], v[164:167]
s_mov_b32 s40, 4325376
s_add_u32 s43, s43, s36
s_mul_i32 s3, s43, 393216
v_mfma_f32_16x16x32_bf16 v[168:171], v[40:43], a[40:43], v[168:171]
s_add_u32 m0, s37, 61440
ds_read_b64_tr_b16 v[60:61], v12 offset:61440
v_mfma_f32_16x16x32_bf16 v[168:171], v[44:47], a[56:59], v[168:171]
buffer_load_dwordx4 v28, s[12:15], s40 offen lds
v_mfma_f32_16x16x32_bf16 v[172:175], v[40:43], a[44:47], v[172:175]
ds_read_b64_tr_b16 v[62:63], v12 offset:62976
v_mfma_f32_16x16x32_bf16 v[172:175], v[44:47], a[60:63], v[172:175]
s_waitcnt lgkmcnt(4)
s_add_u32 s16, s6, s3
s_addc_u32 s17, s7, 0
v_mfma_f32_16x16x32_bf16 v[64:67], v[48:51], a[32:35], v[64:67]
ds_read_b64_tr_b16 v[40:41], v13 offset:49152
s_mov_b32 s18, 393216
v_mfma_f32_16x16x32_bf16 v[64:67], v[52:55], a[48:51], v[64:67]
buffer_load_dwordx4 v29, s[12:15], s40 offen offset:1024 lds
v_mfma_f32_16x16x32_bf16 v[68:71], v[48:51], a[36:39], v[68:71]
ds_read_b64_tr_b16 v[42:43], v13 offset:50688
s_mov_b32 s19, 0x20000
v_mfma_f32_16x16x32_bf16 v[68:71], v[52:55], a[52:55], v[68:71]
s_add_u32 s20, s28, s3
s_addc_u32 s21, s29, 0
v_mfma_f32_16x16x32_bf16 v[72:75], v[48:51], a[40:43], v[72:75]
ds_read_b64_tr_b16 v[44:45], v13 offset:61440
s_mov_b32 s22, 393216
v_mfma_f32_16x16x32_bf16 v[72:75], v[52:55], a[56:59], v[72:75]
buffer_load_dwordx4 v30, s[12:15], s40 offen offset:2048 lds
v_mfma_f32_16x16x32_bf16 v[76:79], v[48:51], a[44:47], v[76:79]
ds_read_b64_tr_b16 v[46:47], v13 offset:62976
s_mov_b32 s23, 0x20000
v_mfma_f32_16x16x32_bf16 v[76:79], v[52:55], a[60:63], v[76:79]
s_waitcnt lgkmcnt(4)
s_add_u32 s56, s32, 67108864
s_addc_u32 s57, s33, 0
v_mfma_f32_16x16x32_bf16 v[176:179], v[56:59], a[32:35], v[176:179]
ds_read_b64_tr_b16 v[48:49], v10 offset:49280
s_mov_b32 s58, 393216
v_mfma_f32_16x16x32_bf16 v[176:179], v[60:63], a[48:51], v[176:179]
s_mov_b32 s41, 640
s_mov_b32 s59, 0x20000
s_sub_u32 s3, s43, s51
v_mfma_f32_16x16x32_bf16 v[180:183], v[56:59], a[36:39], v[180:183]
s_mov_b32 m0, s39
ds_read_b64_tr_b16 v[50:51], v10 offset:50816
s_mul_i32 s3, s3, 92160
v_mfma_f32_16x16x32_bf16 v[180:183], v[60:63], a[52:55], v[180:183]
buffer_load_dwordx4 v31, s[8:11], s41 offen lds
v_mfma_f32_16x16x32_bf16 v[184:187], v[56:59], a[40:43], v[184:187]
ds_read_b64_tr_b16 v[52:53], v10 offset:61568
v_mfma_f32_16x16x32_bf16 v[184:187], v[60:63], a[56:59], v[184:187]
s_add_u32 s24, s32, s3
s_addc_u32 s25, s33, 0
v_mfma_f32_16x16x32_bf16 v[188:191], v[56:59], a[44:47], v[188:191]
ds_read_b64_tr_b16 v[54:55], v10 offset:63104
s_mov_b32 s26, 368640
v_mfma_f32_16x16x32_bf16 v[188:191], v[60:63], a[60:63], v[188:191]
s_waitcnt lgkmcnt(4)
s_mov_b32 s27, 0x20000
s_mul_i32 s3, s45, 983040
v_mfma_f32_16x16x32_bf16 v[80:83], v[40:43], a[32:35], v[80:83]
ds_read_b64_tr_b16 v[56:57], v11 offset:49280
s_mul_i32 s52, s51, 320
v_mfma_f32_16x16x32_bf16 v[80:83], v[44:47], a[48:51], v[80:83]
buffer_load_dwordx4 v32, s[8:11], s41 offen offset:1024 lds
v_mfma_f32_16x16x32_bf16 v[84:87], v[40:43], a[36:39], v[84:87]
ds_read_b64_tr_b16 v[58:59], v11 offset:50816
s_add_u32 s3, s3, s52
v_mfma_f32_16x16x32_bf16 v[84:87], v[44:47], a[52:55], v[84:87]
s_add_u32 s64, s96, s3
s_addc_u32 s65, s97, 0
v_mfma_f32_16x16x32_bf16 v[88:91], v[40:43], a[40:43], v[88:91]
ds_read_b64_tr_b16 v[60:61], v11 offset:61568
s_mov_b32 s66, 0
v_mfma_f32_16x16x32_bf16 v[88:91], v[44:47], a[56:59], v[88:91]
buffer_load_dwordx4 v33, s[8:11], s41 offen offset:2048 lds
v_mfma_f32_16x16x32_bf16 v[92:95], v[40:43], a[44:47], v[92:95]
ds_read_b64_tr_b16 v[62:63], v11 offset:63104
s_mov_b32 s67, 0x20000
v_mfma_f32_16x16x32_bf16 v[92:95], v[44:47], a[60:63], v[92:95]
s_waitcnt lgkmcnt(4)
s_sub_u32 s66, 7864320, s3
s_lshl_b32 s3, s35, 2
v_mfma_f32_16x16x32_bf16 v[192:195], v[48:51], a[32:35], v[192:195]
ds_read_b64_tr_b16 v[40:41], v12 offset:49280
s_add_u32 s3, s3, s51
v_mfma_f32_16x16x32_bf16 v[192:195], v[52:55], a[48:51], v[192:195]
buffer_load_dwordx4 v34, s[8:11], s41 offen offset:3072 lds
v_mfma_f32_16x16x32_bf16 v[196:199], v[48:51], a[36:39], v[196:199]
ds_read_b64_tr_b16 v[42:43], v12 offset:50816
s_mul_i32 s3, s3, 614400
v_mfma_f32_16x16x32_bf16 v[196:199], v[52:55], a[52:55], v[196:199]
s_waitcnt vmcnt(10)
s_add_u32 s3, s3, 33554432
v_mfma_f32_16x16x32_bf16 v[200:203], v[48:51], a[40:43], v[200:203]
ds_read_b64_tr_b16 v[44:45], v12 offset:61568
ds_read_b128 a[0:3], v18 offset:0
v_mfma_f32_16x16x32_bf16 v[200:203], v[52:55], a[56:59], v[200:203]
s_add_u32 s68, s32, s3
s_addc_u32 s69, s33, 0
v_mfma_f32_16x16x32_bf16 v[204:207], v[48:51], a[44:47], v[204:207]
ds_read_b64_tr_b16 v[46:47], v12 offset:63104
ds_read_b128 a[16:19], v19 offset:0
v_mfma_f32_16x16x32_bf16 v[204:207], v[52:55], a[60:63], v[204:207]
s_waitcnt lgkmcnt(6)
s_mov_b32 s70, 614400
s_mov_b32 s71, 0x20000
v_mfma_f32_16x16x32_bf16 v[96:99], v[56:59], a[32:35], v[96:99]
s_add_u32 m0, s39, 4096
ds_read_b64_tr_b16 v[48:49], v13 offset:49280
ds_read_b128 a[4:7], v18 offset:2048
v_mfma_f32_16x16x32_bf16 v[96:99], v[60:63], a[48:51], v[96:99]
buffer_load_dwordx4 v35, s[8:11], s41 offen lds
v_mfma_f32_16x16x32_bf16 v[100:103], v[56:59], a[36:39], v[100:103]
ds_read_b64_tr_b16 v[50:51], v13 offset:50816
ds_read_b128 a[20:23], v19 offset:2048
v_mfma_f32_16x16x32_bf16 v[100:103], v[60:63], a[52:55], v[100:103]
buffer_load_dwordx4 v36, s[8:11], s41 offen offset:1024 lds
v_mfma_f32_16x16x32_bf16 v[104:107], v[56:59], a[40:43], v[104:107]
ds_read_b64_tr_b16 v[52:53], v13 offset:61568
ds_read_b128 a[8:11], v18 offset:4096
v_mfma_f32_16x16x32_bf16 v[104:107], v[60:63], a[56:59], v[104:107]
s_mul_i32 s3, s35, 307200
s_add_u32 s3, s3, s52
v_mfma_f32_16x16x32_bf16 v[108:111], v[56:59], a[44:47], v[108:111]
ds_read_b64_tr_b16 v[54:55], v13 offset:63104
ds_read_b128 a[24:27], v19 offset:4096
v_mfma_f32_16x16x32_bf16 v[108:111], v[60:63], a[60:63], v[108:111]
s_waitcnt lgkmcnt(9)
s_add_u32 s72, s98, s3
s_addc_u32 s73, s99, 0
v_mfma_f32_16x16x32_bf16 v[208:211], v[40:43], a[32:35], v[208:211]
ds_read_b64_tr_b16 v[56:57], v10 offset:49408
ds_read_b128 a[12:15], v18 offset:6144
v_mfma_f32_16x16x32_bf16 v[208:211], v[44:47], a[48:51], v[208:211]
buffer_load_dwordx4 v37, s[8:11], s41 offen offset:2048 lds
v_mfma_f32_16x16x32_bf16 v[212:215], v[40:43], a[36:39], v[212:215]
ds_read_b64_tr_b16 v[58:59], v10 offset:50944
ds_read_b128 a[28:31], v19 offset:6144
v_mfma_f32_16x16x32_bf16 v[212:215], v[44:47], a[52:55], v[212:215]
s_mov_b32 s74, 0
s_mov_b32 s75, 0x20000
v_mfma_f32_16x16x32_bf16 v[216:219], v[40:43], a[40:43], v[216:219]
ds_read_b64_tr_b16 v[60:61], v10 offset:61696
s_sub_u32 s74, 2457600, s3
v_mfma_f32_16x16x32_bf16 v[216:219], v[44:47], a[56:59], v[216:219]
buffer_load_dwordx4 v38, s[8:11], s41 offen offset:3072 lds
v_mfma_f32_16x16x32_bf16 v[220:223], v[40:43], a[44:47], v[220:223]
ds_read_b64_tr_b16 v[62:63], v10 offset:63232
s_lshl_b32 s3, s35, 5
v_mfma_f32_16x16x32_bf16 v[220:223], v[44:47], a[60:63], v[220:223]
s_waitcnt lgkmcnt(7)
s_add_u32 s60, s100, s3
s_addc_u32 s61, s101, 0
v_mfma_f32_16x16x32_bf16 v[112:115], v[48:51], a[32:35], v[112:115]
ds_read_b64_tr_b16 v[40:41], v11 offset:49408
s_mov_b32 s62, 4
v_mfma_f32_16x16x32_bf16 v[112:115], v[52:55], a[48:51], v[112:115]
s_mov_b32 s63, 0x20000
s_add_u32 s54, s51, 1
v_mfma_f32_16x16x32_bf16 v[116:119], v[48:51], a[36:39], v[116:119]
ds_read_b64_tr_b16 v[42:43], v11 offset:50944
s_add_u32 s3, s51, 0
v_mfma_f32_16x16x32_bf16 v[116:119], v[52:55], a[52:55], v[116:119]
s_and_b32 s3, s3, 3
s_mul_i32 s76, s3, 245760
v_mfma_f32_16x16x32_bf16 v[120:123], v[48:51], a[40:43], v[120:123]
ds_read_b64_tr_b16 v[44:45], v11 offset:61696
s_mul_i32 s80, s3, 92160
v_mfma_f32_16x16x32_bf16 v[120:123], v[52:55], a[56:59], v[120:123]
s_add_u32 s3, s51, 1
s_and_b32 s3, s3, 3
v_mfma_f32_16x16x32_bf16 v[124:127], v[48:51], a[44:47], v[124:127]
s_mov_b32 s41, 768
ds_read_b64_tr_b16 v[46:47], v11 offset:63232
s_mul_i32 s77, s3, 245760
v_mfma_f32_16x16x32_bf16 v[124:127], v[52:55], a[60:63], v[124:127]
s_waitcnt lgkmcnt(4)
s_mul_i32 s81, s3, 92160
s_add_u32 s3, s51, 2
v_mfma_f32_16x16x32_bf16 v[224:227], v[56:59], a[32:35], v[224:227]
s_mov_b32 m0, s38
ds_read_b64_tr_b16 v[48:49], v12 offset:49408
s_and_b32 s3, s3, 3
v_mfma_f32_16x16x32_bf16 v[224:227], v[60:63], a[48:51], v[224:227]
buffer_load_dwordx4 v31, s[8:11], s41 offen lds
v_mfma_f32_16x16x32_bf16 v[228:231], v[56:59], a[36:39], v[228:231]
ds_read_b64_tr_b16 v[50:51], v12 offset:50944
s_mul_i32 s78, s3, 245760
v_mfma_f32_16x16x32_bf16 v[228:231], v[60:63], a[52:55], v[228:231]
buffer_load_dwordx4 v32, s[8:11], s41 offen offset:1024 lds
v_mfma_f32_16x16x32_bf16 v[232:235], v[56:59], a[40:43], v[232:235]
ds_read_b64_tr_b16 v[52:53], v12 offset:61696
s_mul_i32 s82, s3, 92160
v_mfma_f32_16x16x32_bf16 v[232:235], v[60:63], a[56:59], v[232:235]
s_add_u32 s3, s51, 3
s_and_b32 s3, s3, 3
v_mfma_f32_16x16x32_bf16 v[236:239], v[56:59], a[44:47], v[236:239]
ds_read_b64_tr_b16 v[54:55], v12 offset:63232
s_mul_i32 s79, s3, 245760
v_mfma_f32_16x16x32_bf16 v[236:239], v[60:63], a[60:63], v[236:239]
s_waitcnt lgkmcnt(4)
s_mul_i32 s83, s3, 92160
s_mov_b32 s46, 0x3dd53b95
v_mfma_f32_16x16x32_bf16 v[128:131], v[40:43], a[32:35], v[128:131]
ds_read_b64_tr_b16 v[56:57], v13 offset:49408
s_mov_b32 s44, 0x4b800000
v_mfma_f32_16x16x32_bf16 v[128:131], v[44:47], a[48:51], v[128:131]
ds_read_b64_tr_b16 v[58:59], v13 offset:50944
s_lshr_b32 s3, s91, 5
v_mfma_f32_16x16x32_bf16 v[132:135], v[40:43], a[36:39], v[132:135]
ds_read_b64_tr_b16 v[60:61], v13 offset:61696
s_mul_i32 s3, s3, 160
v_mfma_f32_16x16x32_bf16 v[132:135], v[44:47], a[52:55], v[132:135]
ds_read_b64_tr_b16 v[62:63], v13 offset:63232
s_add_u32 s3, s3, s91
v_mfma_f32_16x16x32_bf16 v[136:139], v[40:43], a[40:43], v[136:139]
buffer_load_dwordx4 v33, s[8:11], s41 offen offset:2048 lds
v_mfma_f32_16x16x32_bf16 v[136:139], v[44:47], a[56:59], v[136:139]
buffer_load_dwordx4 v34, s[8:11], s41 offen offset:3072 lds
v_mfma_f32_16x16x32_bf16 v[140:143], v[40:43], a[44:47], v[140:143]
v_min_u32 v2, 59, v0
v_mul_u32_u24 v3, 6554, v2
v_mfma_f32_16x16x32_bf16 v[140:143], v[44:47], a[60:63], v[140:143]
s_waitcnt lgkmcnt(4)
v_lshrrev_b32 v3, 16, v3
v_mul_u32_u24 v4, 10, v3
v_mfma_f32_16x16x32_bf16 v[240:243], v[48:51], a[32:35], v[240:243]
s_waitcnt lgkmcnt(0)
v_sub_u32 v2, v2, v4
v_lshl_add_u32 v3, v3, 5, s3
v_mfma_f32_16x16x32_bf16 v[240:243], v[52:55], a[48:51], v[240:243]
s_barrier
v_mul_u32_u24 v3, 1280, v3
v_lshl_add_u32 v2, v2, 7, v3
v_mfma_f32_16x16x32_bf16 v[244:247], v[48:51], a[36:39], v[244:247]
ds_read_b64_tr_b16 v[40:41], v14 offset:24576
v_subrev_u32 v2, s52, v2
v_mfma_f32_16x16x32_bf16 v[244:247], v[52:55], a[52:55], v[244:247]
ds_read_b64_tr_b16 v[42:43], v14 offset:26112
v_max_i32 v2, 0, v2
v_mfma_f32_16x16x32_bf16 v[248:251], v[48:51], a[40:43], v[248:251]
ds_read_b64_tr_b16 v[44:45], v14 offset:36864
v_accvgpr_write_b32 a159, v2
v_mfma_f32_16x16x32_bf16 v[248:251], v[52:55], a[56:59], v[248:251]
s_add_u32 m0, s38, 4096
ds_read_b64_tr_b16 v[46:47], v14 offset:38400
s_mov_b32 s96, 30720
v_mfma_f32_16x16x32_bf16 v[252:255], v[48:51], a[44:47], v[252:255]
buffer_load_dwordx4 v35, s[8:11], s41 offen lds
v_mfma_f32_16x16x32_bf16 v[252:255], v[52:55], a[60:63], v[252:255]
s_mov_b32 s97, 162816
v_and_b32 v5, 1, v1
v_mfma_f32_16x16x32_bf16 v[144:147], v[56:59], a[32:35], v[144:147]
ds_read_b64_tr_b16 v[48:49], v15 offset:24576
v_lshrrev_b32 v4, 1, v1
v_mfma_f32_16x16x32_bf16 v[144:147], v[60:63], a[48:51], v[144:147]
buffer_load_dwordx4 v36, s[8:11], s41 offen offset:1024 lds
v_mfma_f32_16x16x32_bf16 v[148:151], v[56:59], a[36:39], v[148:151]
ds_read_b64_tr_b16 v[50:51], v15 offset:26112
v_lshl_or_b32 v5, v5, 1, v4
v_mfma_f32_16x16x32_bf16 v[148:151], v[60:63], a[52:55], v[148:151]
v_add_u32 v2, 0, v0
v_mul_u32_u24 v3, 3277, v2
v_mfma_f32_16x16x32_bf16 v[152:155], v[56:59], a[40:43], v[152:155]
ds_read_b64_tr_b16 v[52:53], v15 offset:36864
v_lshrrev_b32 v3, 16, v3
v_mfma_f32_16x16x32_bf16 v[152:155], v[60:63], a[56:59], v[152:155]
buffer_load_dwordx4 v37, s[8:11], s41 offen offset:2048 lds
v_mfma_f32_16x16x32_bf16 v[156:159], v[56:59], a[44:47], v[156:159]
ds_read_b64_tr_b16 v[54:55], v15 offset:38400
v_mul_u32_u24 v4, 20, v3
v_mfma_f32_16x16x32_bf16 v[156:159], v[60:63], a[60:63], v[156:159]
s_waitcnt lgkmcnt(4)
v_sub_u32 v2, v2, v4
v_lshrrev_b32 v4, 1, v3
v_mfma_f32_16x16x32_bf16 v[160:163], v[40:43], a[0:3], v[160:163]
ds_read_b64_tr_b16 v[56:57], v16 offset:24576
v_and_b32 v4, 2, v4
v_mfma_f32_16x16x32_bf16 v[160:163], v[44:47], a[16:19], v[160:163]
buffer_load_dwordx4 v38, s[8:11], s41 offen offset:3072 lds
v_mfma_f32_16x16x32_bf16 v[164:167], v[40:43], a[4:7], v[164:167]
ds_read_b64_tr_b16 v[58:59], v16 offset:26112
v_xor_b32 v2, v2, v4
v_mfma_f32_16x16x32_bf16 v[164:167], v[44:47], a[20:23], v[164:167]
v_lshl_add_u32 v3, v5, 3, v3
v_mul_u32_u24 v3, 1280, v3
v_mfma_f32_16x16x32_bf16 v[168:171], v[40:43], a[8:11], v[168:171]
ds_read_b64_tr_b16 v[60:61], v16 offset:36864
v_lshl_add_u32 v2, v2, 4, v3
v_mfma_f32_16x16x32_bf16 v[168:171], v[44:47], a[24:27], v[168:171]
v_accvgpr_write_b32 a150, v2
v_add_u32 v2, 64, v0
v_mfma_f32_16x16x32_bf16 v[172:175], v[40:43], a[12:15], v[172:175]
s_mov_b32 s40, 4718592
ds_read_b64_tr_b16 v[62:63], v16 offset:38400
v_mul_u32_u24 v3, 3277, v2
v_mfma_f32_16x16x32_bf16 v[172:175], v[44:47], a[28:31], v[172:175]
s_waitcnt lgkmcnt(4)
v_lshrrev_b32 v3, 16, v3
v_mul_u32_u24 v4, 20, v3
v_mfma_f32_16x16x32_bf16 v[64:67], v[48:51], a[0:3], v[64:67]
s_add_u32 m0, s37, 122880
ds_read_b64_tr_b16 v[40:41], v17 offset:24576
v_sub_u32 v2, v2, v4
v_mfma_f32_16x16x32_bf16 v[64:67], v[52:55], a[16:19], v[64:67]
buffer_load_dwordx4 v28, s[12:15], s40 offen lds
v_mfma_f32_16x16x32_bf16 v[68:71], v[48:51], a[4:7], v[68:71]
ds_read_b64_tr_b16 v[42:43], v17 offset:26112
v_lshrrev_b32 v4, 1, v3
v_mfma_f32_16x16x32_bf16 v[68:71], v[52:55], a[20:23], v[68:71]
buffer_load_dwordx4 v29, s[12:15], s40 offen offset:1024 lds
v_mfma_f32_16x16x32_bf16 v[72:75], v[48:51], a[8:11], v[72:75]
ds_read_b64_tr_b16 v[44:45], v17 offset:36864
v_and_b32 v4, 2, v4
v_mfma_f32_16x16x32_bf16 v[72:75], v[52:55], a[24:27], v[72:75]
v_xor_b32 v2, v2, v4
v_lshl_add_u32 v3, v5, 3, v3
v_mfma_f32_16x16x32_bf16 v[76:79], v[48:51], a[12:15], v[76:79]
ds_read_b64_tr_b16 v[46:47], v17 offset:38400
v_mul_u32_u24 v3, 1280, v3
v_mfma_f32_16x16x32_bf16 v[76:79], v[52:55], a[28:31], v[76:79]
s_waitcnt lgkmcnt(4)
v_lshl_add_u32 v2, v2, 4, v3
v_subrev_u32 v2, 1024, v2
v_mfma_f32_16x16x32_bf16 v[176:179], v[56:59], a[0:3], v[176:179]
ds_read_b64_tr_b16 v[48:49], v14 offset:24704
v_accvgpr_write_b32 a151, v2
v_mfma_f32_16x16x32_bf16 v[176:179], v[60:63], a[16:19], v[176:179]
buffer_load_dwordx4 v30, s[12:15], s40 offen offset:2048 lds
v_mfma_f32_16x16x32_bf16 v[180:183], v[56:59], a[4:7], v[180:183]
s_mov_b32 s40, 5111808
ds_read_b64_tr_b16 v[50:51], v14 offset:26240
v_add_u32 v2, 128, v0
v_mfma_f32_16x16x32_bf16 v[180:183], v[60:63], a[20:23], v[180:183]
s_waitcnt vmcnt(11)
v_mul_u32_u24 v3, 3277, v2
v_lshrrev_b32 v3, 16, v3
v_mfma_f32_16x16x32_bf16 v[184:187], v[56:59], a[8:11], v[184:187]
s_add_u32 m0, s37, 135168
ds_read_b64_tr_b16 v[52:53], v14 offset:36992
ds_read_b128 a[32:35], v20 offset:0
v_mfma_f32_16x16x32_bf16 v[184:187], v[60:63], a[24:27], v[184:187]
buffer_load_dwordx4 v28, s[12:15], s40 offen lds
v_mfma_f32_16x16x32_bf16 v[188:191], v[56:59], a[12:15], v[188:191]
ds_read_b64_tr_b16 v[54:55], v14 offset:38528
ds_read_b128 a[48:51], v21 offset:0
v_mfma_f32_16x16x32_bf16 v[188:191], v[60:63], a[28:31], v[188:191]
s_waitcnt lgkmcnt(6)
v_mul_u32_u24 v4, 20, v3
v_sub_u32 v2, v2, v4
v_mfma_f32_16x16x32_bf16 v[80:83], v[40:43], a[0:3], v[80:83]
ds_read_b64_tr_b16 v[56:57], v15 offset:24704
ds_read_b128 a[36:39], v20 offset:2048
v_mfma_f32_16x16x32_bf16 v[80:83], v[44:47], a[16:19], v[80:83]
v_lshrrev_b32 v4, 1, v3
v_and_b32 v4, 2, v4
v_mfma_f32_16x16x32_bf16 v[84:87], v[40:43], a[4:7], v[84:87]
ds_read_b64_tr_b16 v[58:59], v15 offset:26240
ds_read_b128 a[52:55], v21 offset:2048
v_mfma_f32_16x16x32_bf16 v[84:87], v[44:47], a[20:23], v[84:87]
buffer_load_dwordx4 v29, s[12:15], s40 offen offset:1024 lds
v_mfma_f32_16x16x32_bf16 v[88:91], v[40:43], a[8:11], v[88:91]
ds_read_b64_tr_b16 v[60:61], v15 offset:36992
ds_read_b128 a[40:43], v20 offset:4096
v_mfma_f32_16x16x32_bf16 v[88:91], v[44:47], a[24:27], v[88:91]
v_xor_b32 v2, v2, v4
v_lshl_add_u32 v3, v5, 3, v3
v_mfma_f32_16x16x32_bf16 v[92:95], v[40:43], a[12:15], v[92:95]
ds_read_b64_tr_b16 v[62:63], v15 offset:38528
ds_read_b128 a[56:59], v21 offset:4096
v_mfma_f32_16x16x32_bf16 v[92:95], v[44:47], a[28:31], v[92:95]
s_waitcnt lgkmcnt(9)
v_mul_u32_u24 v3, 1280, v3
v_lshl_add_u32 v2, v2, 4, v3
v_mfma_f32_16x16x32_bf16 v[192:195], v[48:51], a[0:3], v[192:195]
ds_read_b64_tr_b16 v[40:41], v16 offset:24704
ds_read_b128 a[44:47], v20 offset:6144
v_mfma_f32_16x16x32_bf16 v[192:195], v[52:55], a[16:19], v[192:195]
buffer_load_dwordx4 v30, s[12:15], s40 offen offset:2048 lds
v_mfma_f32_16x16x32_bf16 v[196:199], v[48:51], a[4:7], v[196:199]
ds_read_b64_tr_b16 v[42:43], v16 offset:26240
ds_read_b128 a[60:63], v21 offset:6144
v_mfma_f32_16x16x32_bf16 v[196:199], v[52:55], a[20:23], v[196:199]
v_subrev_u32 v2, 2048, v2
v_lshrrev_b32 v3, 5, v0
v_mfma_f32_16x16x32_bf16 v[200:203], v[48:51], a[8:11], v[200:203]
s_mov_b32 s55, 4718592
ds_read_b64_tr_b16 v[44:45], v16 offset:36992
v_lshl_or_b32 v2, v3, 30, v2
v_mfma_f32_16x16x32_bf16 v[200:203], v[52:55], a[24:27], v[200:203]
buffer_load_dword a190, v9, s[8:11], 0 offen offset:1024
v_mfma_f32_16x16x32_bf16 v[204:207], v[48:51], a[12:15], v[204:207]
ds_read_b64_tr_b16 v[46:47], v16 offset:38528
v_accvgpr_write_b32 a152, v2
v_mfma_f32_16x16x32_bf16 v[204:207], v[52:55], a[28:31], v[204:207]
s_waitcnt lgkmcnt(7)
s_cmp_eq_u32 s34, 3
s_cselect_b32 s88, 1073741824, 0
v_mfma_f32_16x16x32_bf16 v[96:99], v[56:59], a[0:3], v[96:99]
ds_read_b64_tr_b16 v[48:49], v17 offset:24704
v_mul_u32_u24 v2, 24576, v1
v_mfma_f32_16x16x32_bf16 v[96:99], v[60:63], a[16:19], v[96:99]
buffer_load_dword a191, v8, s[12:15], s55 offen
v_mfma_f32_16x16x32_bf16 v[100:103], v[56:59], a[4:7], v[100:103]
ds_read_b64_tr_b16 v[50:51], v17 offset:26240
v_lshl_add_u32 v2, v0, 4, v2
v_mfma_f32_16x16x32_bf16 v[100:103], v[60:63], a[20:23], v[100:103]
v_add_u32 v3, s88, v2
v_add_u32 v3, 18432, v3
v_mfma_f32_16x16x32_bf16 v[104:107], v[56:59], a[8:11], v[104:107]
ds_read_b64_tr_b16 v[52:53], v17 offset:36992
v_accvgpr_write_b32 a148, v2
v_mfma_f32_16x16x32_bf16 v[104:107], v[60:63], a[24:27], v[104:107]
v_accvgpr_write_b32 a149, v3
s_lshl_b32 s3, s45, 10
v_mfma_f32_16x16x32_bf16 v[108:111], v[56:59], a[12:15], v[108:111]
s_mov_b32 s41, 896
ds_read_b64_tr_b16 v[54:55], v17 offset:38528
v_lshlrev_b32 v2, 15, v1
v_mfma_f32_16x16x32_bf16 v[108:111], v[60:63], a[28:31], v[108:111]
s_waitcnt lgkmcnt(4)
v_lshl_add_u32 v2, v0, 4, v2
v_add_u32 v3, s88, v2
v_mfma_f32_16x16x32_bf16 v[208:211], v[40:43], a[0:3], v[208:211]
s_mov_b32 m0, s39
ds_read_b64_tr_b16 v[56:57], v14 offset:24832
v_add_u32 v3, 24576, v3
v_mfma_f32_16x16x32_bf16 v[208:211], v[44:47], a[16:19], v[208:211]
buffer_load_dwordx4 v31, s[8:11], s41 offen lds
v_mfma_f32_16x16x32_bf16 v[212:215], v[40:43], a[4:7], v[212:215]
KF_pg2:
s_cbranch_execz KF_pg6
ds_read_b64_tr_b16 v[58:59], v14 offset:26368
v_accvgpr_write_b32 a153, v2
v_mfma_f32_16x16x32_bf16 v[212:215], v[44:47], a[20:23], v[212:215]
buffer_load_dwordx4 v32, s[8:11], s41 offen offset:1024 lds
v_mfma_f32_16x16x32_bf16 v[216:219], v[40:43], a[8:11], v[216:219]
ds_read_b64_tr_b16 v[60:61], v14 offset:37120
v_accvgpr_write_b32 a154, v3
v_mfma_f32_16x16x32_bf16 v[216:219], v[44:47], a[24:27], v[216:219]
v_and_b32 v1, 15, v0
v_lshrrev_b32 v2, 4, v0
v_mfma_f32_16x16x32_bf16 v[220:223], v[40:43], a[12:15], v[220:223]
ds_read_b64_tr_b16 v[62:63], v14 offset:38656
v_lshrrev_b32 v3, 1, v2
v_mfma_f32_16x16x32_bf16 v[220:223], v[44:47], a[28:31], v[220:223]
s_waitcnt lgkmcnt(4)
v_mul_u32_u24 v3, 6144, v3
v_and_b32 v4, 1, v2
v_mfma_f32_16x16x32_bf16 v[112:115], v[48:51], a[0:3], v[112:115]
ds_read_b64_tr_b16 v[40:41], v15 offset:24832
v_lshrrev_b32 v5, 2, v1
v_mfma_f32_16x16x32_bf16 v[112:115], v[52:55], a[16:19], v[112:115]
buffer_load_dwordx4 v33, s[8:11], s41 offen offset:2048 lds
v_mfma_f32_16x16x32_bf16 v[116:119], v[48:51], a[4:7], v[116:119]
ds_read_b64_tr_b16 v[42:43], v15 offset:26368
v_lshl_add_u32 v5, v4, 2, v5
v_mfma_f32_16x16x32_bf16 v[116:119], v[52:55], a[20:23], v[116:119]
v_mul_u32_u24 v5, 320, v5
v_add_u32 v3, v3, v5
v_mfma_f32_16x16x32_bf16 v[120:123], v[48:51], a[8:11], v[120:123]
ds_read_b64_tr_b16 v[44:45], v15 offset:37120
v_and_b32 v5, 3, v1
v_mfma_f32_16x16x32_bf16 v[120:123], v[52:55], a[24:27], v[120:123]
buffer_load_dwordx4 v34, s[8:11], s41 offen offset:3072 lds
v_mfma_f32_16x16x32_bf16 v[124:127], v[48:51], a[12:15], v[124:127]
ds_read_b64_tr_b16 v[46:47], v15 offset:38656
v_lshl_add_u32 v3, v5, 3, v3
v_mfma_f32_16x16x32_bf16 v[124:127], v[52:55], a[28:31], v[124:127]
s_waitcnt lgkmcnt(4)
v_lshl_add_u32 v5, v4, 5, v3
v_xor_b32 v4, 1, v4
v_mfma_f32_16x16x32_bf16 v[224:227], v[56:59], a[0:3], v[224:227]
ds_read_b64_tr_b16 v[48:49], v16 offset:24832
v_lshl_add_u32 v4, v4, 5, v3
v_mfma_f32_16x16x32_bf16 v[224:227], v[60:63], a[16:19], v[224:227]
v_add_u32 v6, 73728, v5
v_add_u32 v7, 73728, v4
v_mfma_f32_16x16x32_bf16 v[228:231], v[56:59], a[4:7], v[228:231]
s_add_u32 m0, s39, 4096
ds_read_b64_tr_b16 v[50:51], v16 offset:26368
v_accvgpr_write_b32 a144, v5
v_mfma_f32_16x16x32_bf16 v[228:231], v[60:63], a[20:23], v[228:231]
buffer_load_dwordx4 v35, s[8:11], s41 offen lds
v_mfma_f32_16x16x32_bf16 v[232:235], v[56:59], a[8:11], v[232:235]
ds_read_b64_tr_b16 v[52:53], v16 offset:37120
v_accvgpr_write_b32 a145, v4
v_mfma_f32_16x16x32_bf16 v[232:235], v[60:63], a[24:27], v[232:235]
v_accvgpr_write_b32 a146, v6
v_accvgpr_write_b32 a147, v7
v_mfma_f32_16x16x32_bf16 v[236:239], v[56:59], a[12:15], v[236:239]
ds_read_b64_tr_b16 v[54:55], v16 offset:38656
v_lshrrev_b32 v3, 2, v1
v_mfma_f32_16x16x32_bf16 v[236:239], v[60:63], a[28:31], v[236:239]
s_waitcnt lgkmcnt(4)
v_and_b32 v4, 3, v1
v_lshl_add_u32 v4, v3, 3, v4
v_mfma_f32_16x16x32_bf16 v[128:131], v[40:43], a[0:3], v[128:131]
ds_read_b64_tr_b16 v[56:57], v17 offset:24832
v_mul_u32_u24 v4, 384, v4
v_mfma_f32_16x16x32_bf16 v[128:131], v[44:47], a[16:19], v[128:131]
ds_read_b64_tr_b16 v[58:59], v17 offset:26368
v_and_b32 v3, 1, v3
v_mfma_f32_16x16x32_bf16 v[132:135], v[40:43], a[4:7], v[132:135]
ds_read_b64_tr_b16 v[60:61], v17 offset:37120
v_and_b32 v5, 2, v1
v_mfma_f32_16x16x32_bf16 v[132:135], v[44:47], a[20:23], v[132:135]
ds_read_b64_tr_b16 v[62:63], v17 offset:38656
v_or_b32 v3, v3, v5
v_mfma_f32_16x16x32_bf16 v[136:139], v[40:43], a[8:11], v[136:139]
buffer_load_dwordx4 v36, s[8:11], s41 offen offset:1024 lds
v_mfma_f32_16x16x32_bf16 v[136:139], v[44:47], a[24:27], v[136:139]
buffer_load_dwordx4 v37, s[8:11], s41 offen offset:2048 lds
v_mfma_f32_16x16x32_bf16 v[140:143], v[40:43], a[12:15], v[140:143]
v_lshrrev_b32 v5, 3, v1
v_lshl_or_b32 v3, v5, 2, v3
v_mfma_f32_16x16x32_bf16 v[140:143], v[44:47], a[28:31], v[140:143]
s_waitcnt lgkmcnt(4)
v_lshrrev_b32 v5, 1, v2
v_and_b32 v6, 1, v2
v_mfma_f32_16x16x32_bf16 v[240:243], v[48:51], a[0:3], v[240:243]
s_waitcnt lgkmcnt(0)
v_lshl_or_b32 v5, v6, 1, v5
v_xor_b32 v3, v3, v5
v_mfma_f32_16x16x32_bf16 v[240:243], v[52:55], a[16:19], v[240:243]
s_barrier
v_lshl_add_u32 v6, v3, 4, v4
v_xor_b32 v3, 4, v3
v_mfma_f32_16x16x32_bf16 v[244:247], v[48:51], a[4:7], v[244:247]
ds_read_b64_tr_b16 v[40:41], v14 offset:49152
v_lshl_add_u32 v7, v3, 4, v4
v_mfma_f32_16x16x32_bf16 v[244:247], v[52:55], a[20:23], v[244:247]
ds_read_b64_tr_b16 v[42:43], v14 offset:50688
v_mov_b32 v1, s34
v_mfma_f32_16x16x32_bf16 v[248:251], v[48:51], a[8:11], v[248:251]
ds_read_b64_tr_b16 v[44:45], v14 offset:61440
s_lshl_b32 s84, s35, 3
v_mfma_f32_16x16x32_bf16 v[248:251], v[52:55], a[24:27], v[248:251]
ds_read_b64_tr_b16 v[46:47], v14 offset:62976
s_add_u32 s84, s84, s45
v_mfma_f32_16x16x32_bf16 v[252:255], v[48:51], a[12:15], v[252:255]
buffer_load_dwordx4 v38, s[8:11], s41 offen offset:3072 lds
v_mfma_f32_16x16x32_bf16 v[252:255], v[52:55], a[28:31], v[252:255]
s_lshl_b32 s84, s84, 2
s_add_u32 s84, s84, s34
v_mfma_f32_16x16x32_bf16 v[144:147], v[56:59], a[0:3], v[144:147]
ds_read_b64_tr_b16 v[48:49], v15 offset:49152
s_lshl_b32 s84, s84, 9
v_mfma_f32_16x16x32_bf16 v[144:147], v[60:63], a[16:19], v[144:147]
s_mov_b32 s40, 5505024
s_lshl_b32 s85, s35, 2
s_add_u32 s85, s85, s51
v_mfma_f32_16x16x32_bf16 v[148:151], v[56:59], a[4:7], v[148:151]
s_add_u32 m0, s37, 24576
ds_read_b64_tr_b16 v[50:51], v15 offset:50688
s_lshl_b32 s85, s85, 13
v_mfma_f32_16x16x32_bf16 v[148:151], v[60:63], a[20:23], v[148:151]
buffer_load_dwordx4 v28, s[12:15], s40 offen lds
v_mfma_f32_16x16x32_bf16 v[152:155], v[56:59], a[8:11], v[152:155]
ds_read_b64_tr_b16 v[52:53], v15 offset:61440
s_add_u32 s85, s85, 0x20000
v_mfma_f32_16x16x32_bf16 v[152:155], v[60:63], a[24:27], v[152:155]
buffer_load_dwordx4 v29, s[12:15], s40 offen offset:1024 lds
v_mfma_f32_16x16x32_bf16 v[156:159], v[56:59], a[12:15], v[156:159]
ds_read_b64_tr_b16 v[54:55], v15 offset:62976
s_lshl_b32 s86, s51, 7
v_mfma_f32_16x16x32_bf16 v[156:159], v[60:63], a[28:31], v[156:159]
s_waitcnt lgkmcnt(4)
s_add_u32 s86, s86, s84
s_add_u32 s3, s3, s85
v_mfma_f32_16x16x32_bf16 v[160:163], v[40:43], a[32:35], v[160:163]
ds_read_b64_tr_b16 v[56:57], v16 offset:49152
v_bfe_u32 v4, v0, 4, 2
v_mfma_f32_16x16x32_bf16 v[160:163], v[44:47], a[48:51], v[160:163]
buffer_load_dwordx4 v30, s[12:15], s40 offen offset:2048 lds
v_mfma_f32_16x16x32_bf16 v[164:167], v[40:43], a[36:39], v[164:167]
ds_read_b64_tr_b16 v[58:59], v16 offset:50688
v_lshl_add_u32 v4, v4, 7, s84
v_mfma_f32_16x16x32_bf16 v[164:167], v[44:47], a[52:55], v[164:167]
s_mov_b32 s40, 5898240
v_lshrrev_b32 v2, 3, v0
v_max_u32 v5, 1, v2
v_mfma_f32_16x16x32_bf16 v[168:171], v[40:43], a[40:43], v[168:171]
s_add_u32 m0, s37, 36864
ds_read_b64_tr_b16 v[60:61], v16 offset:61440
v_lshl_add_u32 v5, v5, 7, s3
v_mfma_f32_16x16x32_bf16 v[168:171], v[44:47], a[56:59], v[168:171]
buffer_load_dwordx4 v28, s[12:15], s40 offen lds
v_mfma_f32_16x16x32_bf16 v[172:175], v[40:43], a[44:47], v[172:175]
ds_read_b64_tr_b16 v[62:63], v16 offset:62976
v_lshl_add_u32 v3, v2, 10, s85
v_mfma_f32_16x16x32_bf16 v[172:175], v[44:47], a[60:63], v[172:175]
s_waitcnt lgkmcnt(4)
v_xor_b32 v2, s45, v2
v_lshl_add_u32 v3, v2, 7, v3
v_mfma_f32_16x16x32_bf16 v[64:67], v[48:51], a[32:35], v[64:67]
ds_read_b64_tr_b16 v[40:41], v17 offset:49152
v_and_b32 v2, 7, v0
v_mfma_f32_16x16x32_bf16 v[64:67], v[52:55], a[48:51], v[64:67]
v_lshl_add_u32 v3, v2, 4, v3
v_min_u32 v2, 1, v1
v_mfma_f32_16x16x32_bf16 v[68:71], v[48:51], a[36:39], v[68:71]
ds_read_b64_tr_b16 v[42:43], v17 offset:50688
v_lshl_or_b32 v3, v2, 30, v3
v_mfma_f32_16x16x32_bf16 v[68:71], v[52:55], a[52:55], v[68:71]
buffer_load_dwordx4 v29, s[12:15], s40 offen offset:1024 lds
v_mfma_f32_16x16x32_bf16 v[72:75], v[48:51], a[40:43], v[72:75]
ds_read_b64_tr_b16 v[44:45], v17 offset:61440
v_and_b32 v2, 31, v0
v_mfma_f32_16x16x32_bf16 v[72:75], v[52:55], a[56:59], v[72:75]
v_lshl_add_u32 v2, v2, 2, s86
v_accvgpr_write_b32 a155, v2
v_mfma_f32_16x16x32_bf16 v[76:79], v[48:51], a[44:47], v[76:79]
ds_read_b64_tr_b16 v[46:47], v17 offset:62976
v_accvgpr_write_b32 a157, v3
v_mfma_f32_16x16x32_bf16 v[76:79], v[52:55], a[60:63], v[76:79]
s_waitcnt lgkmcnt(4)
v_accvgpr_write_b32 a156, v4
v_accvgpr_write_b32 a158, v5
v_mfma_f32_16x16x32_bf16 v[176:179], v[56:59], a[32:35], v[176:179]
ds_read_b64_tr_b16 v[48:49], v14 offset:49280
v_accvgpr_write_b32 a184, 0
v_mfma_f32_16x16x32_bf16 v[176:179], v[60:63], a[48:51], v[176:179]
buffer_load_dwordx4 v30, s[12:15], s40 offen offset:2048 lds
v_mfma_f32_16x16x32_bf16 v[180:183], v[56:59], a[36:39], v[180:183]
ds_read_b64_tr_b16 v[50:51], v14 offset:50816
v_accvgpr_write_b32 a185, 0
v_mfma_f32_16x16x32_bf16 v[180:183], v[60:63], a[52:55], v[180:183]
s_waitcnt vmcnt(22)
v_accvgpr_write_b32 a186, 0
v_accvgpr_write_b32 a187, 0
v_mfma_f32_16x16x32_bf16 v[184:187], v[56:59], a[40:43], v[184:187]
s_add_u32 m0, s37, 0
ds_read_b64_tr_b16 v[52:53], v14 offset:61568
ds_read_b128 a[0:3], v18 offset:0
v_mfma_f32_16x16x32_bf16 v[184:187], v[60:63], a[56:59], v[184:187]
buffer_load_dwordx4 v22, s[16:19], s96 offen nt lds
v_mfma_f32_16x16x32_bf16 v[188:191], v[56:59], a[44:47], v[188:191]
ds_read_b64_tr_b16 v[54:55], v14 offset:63104
ds_read_b128 a[16:19], v19 offset:0
v_mfma_f32_16x16x32_bf16 v[188:191], v[60:63], a[60:63], v[188:191]
s_waitcnt lgkmcnt(6)
s_and_b32 s3, s34, 1
s_lshl_b32 s3, s3, 2
v_mfma_f32_16x16x32_bf16 v[80:83], v[40:43], a[32:35], v[80:83]
ds_read_b64_tr_b16 v[56:57], v15 offset:49280
ds_read_b128 a[4:7], v18 offset:2048
v_mfma_f32_16x16x32_bf16 v[80:83], v[44:47], a[48:51], v[80:83]
buffer_load_dwordx4 v23, s[16:19], s96 offen offset:1024 nt lds
v_mfma_f32_16x16x32_bf16 v[84:87], v[40:43], a[36:39], v[84:87]
ds_read_b64_tr_b16 v[58:59], v15 offset:50816
ds_read_b128 a[20:23], v19 offset:2048
v_mfma_f32_16x16x32_bf16 v[84:87], v[44:47], a[52:55], v[84:87]
s_xor_b32 s47, s3, s45
s_and_b32 s3, s47, 3
v_mfma_f32_16x16x32_bf16 v[88:91], v[40:43], a[40:43], v[88:91]
ds_read_b64_tr_b16 v[60:61], v15 offset:61568
ds_read_b128 a[8:11], v18 offset:4096
v_mfma_f32_16x16x32_bf16 v[88:91], v[44:47], a[56:59], v[88:91]
s_lshl_b32 s91, s34, 2
s_add_u32 s3, s3, s91
v_mfma_f32_16x16x32_bf16 v[92:95], v[40:43], a[44:47], v[92:95]
ds_read_b64_tr_b16 v[62:63], v15 offset:63104
ds_read_b128 a[24:27], v19 offset:4096
v_mfma_f32_16x16x32_bf16 v[92:95], v[44:47], a[60:63], v[92:95]
s_waitcnt lgkmcnt(9)
s_lshr_b32 s90, s47, 2
s_mul_i32 s84, s90, 15
v_mfma_f32_16x16x32_bf16 v[192:195], v[48:51], a[32:35], v[192:195]
ds_read_b64_tr_b16 v[40:41], v16 offset:49280
ds_read_b128 a[12:15], v18 offset:6144
v_mfma_f32_16x16x32_bf16 v[192:195], v[52:55], a[48:51], v[192:195]
buffer_load_dwordx4 v24, s[16:19], s96 offen offset:2048 nt lds
v_mfma_f32_16x16x32_bf16 v[196:199], v[48:51], a[36:39], v[196:199]
ds_read_b64_tr_b16 v[42:43], v16 offset:50816
ds_read_b128 a[28:31], v19 offset:6144
v_mfma_f32_16x16x32_bf16 v[196:199], v[52:55], a[52:55], v[196:199]
s_add_u32 s84, s84, s3
s_lshl_b32 s84, s84, 13
v_mfma_f32_16x16x32_bf16 v[200:203], v[48:51], a[40:43], v[200:203]
ds_read_b64_tr_b16 v[44:45], v16 offset:61568
s_mul_i32 s87, s3, 20480
v_mfma_f32_16x16x32_bf16 v[200:203], v[52:55], a[56:59], v[200:203]
s_lshl_b32 s91, s90, 6
s_add_u32 s87, s87, s91
v_mfma_f32_16x16x32_bf16 v[204:207], v[48:51], a[44:47], v[204:207]
ds_read_b64_tr_b16 v[46:47], v16 offset:63104
v_accvgpr_read_b32 v9, a160
v_mfma_f32_16x16x32_bf16 v[204:207], v[52:55], a[60:63], v[204:207]
s_waitcnt lgkmcnt(7)
s_cmp_eq_u32 s3, 15
s_cselect_b32 s91, 1073741824, 0
v_mfma_f32_16x16x32_bf16 v[96:99], v[56:59], a[32:35], v[96:99]
ds_read_b64_tr_b16 v[48:49], v17 offset:49280
s_or_b32 s84, s84, s91
v_mfma_f32_16x16x32_bf16 v[96:99], v[60:63], a[48:51], v[96:99]
s_or_b32 s87, s87, s91
s_add_u32 s85, s84, 245760
v_mfma_f32_16x16x32_bf16 v[100:103], v[56:59], a[36:39], v[100:103]
ds_read_b64_tr_b16 v[50:51], v17 offset:50816
s_add_u32 s88, s87, 128
v_mfma_f32_16x16x32_bf16 v[100:103], v[60:63], a[52:55], v[100:103]
s_add_u32 s86, s84, 491520
s_add_u32 s89, s87, 256
v_mfma_f32_16x16x32_bf16 v[104:107], v[56:59], a[40:43], v[104:107]
ds_read_b64_tr_b16 v[52:53], v17 offset:61568
s_lshl_b32 s91, s90, 30
v_mfma_f32_16x16x32_bf16 v[104:107], v[60:63], a[56:59], v[104:107]
s_or_b32 s86, s86, s91
s_or_b32 s89, s89, s91
v_mfma_f32_16x16x32_bf16 v[108:111], v[56:59], a[44:47], v[108:111]
s_mov_b32 s41, 1024
ds_read_b64_tr_b16 v[54:55], v17 offset:63104
s_lshl_b32 s47, s47, 10
v_mfma_f32_16x16x32_bf16 v[108:111], v[60:63], a[60:63], v[108:111]
s_waitcnt lgkmcnt(4)
s_lshr_b32 s3, s2, 3
s_add_u32 s3, s3, s45
v_mfma_f32_16x16x32_bf16 v[208:211], v[40:43], a[32:35], v[208:211]
s_mov_b32 m0, s38
ds_read_b64_tr_b16 v[56:57], v14 offset:49408
s_mov_b32 s5, 0
v_mfma_f32_16x16x32_bf16 v[208:211], v[44:47], a[48:51], v[208:211]
buffer_load_dwordx4 v31, s[8:11], s41 offen lds
v_mfma_f32_16x16x32_bf16 v[212:215], v[40:43], a[36:39], v[212:215]
ds_read_b64_tr_b16 v[58:59], v14 offset:50944
s_mul_i32 s91, s3, 7282
v_mfma_f32_16x16x32_bf16 v[212:215], v[44:47], a[52:55], v[212:215]
buffer_load_dwordx4 v32, s[8:11], s41 offen offset:1024 lds
v_mfma_f32_16x16x32_bf16 v[216:219], v[40:43], a[40:43], v[216:219]
ds_read_b64_tr_b16 v[60:61], v14 offset:61696
s_lshr_b32 s91, s91, 16
v_mfma_f32_16x16x32_bf16 v[216:219], v[44:47], a[56:59], v[216:219]
s_mul_i32 s91, s91, 9
s_sub_u32 s91, s3, s91
v_mfma_f32_16x16x32_bf16 v[220:223], v[40:43], a[44:47], v[220:223]
ds_read_b64_tr_b16 v[62:63], v14 offset:63232
s_lshl_b32 s91, 2, s91
v_mfma_f32_16x16x32_bf16 v[220:223], v[44:47], a[60:63], v[220:223]
s_waitcnt lgkmcnt(4)
s_or_b32 s5, s5, s91
s_mul_i32 s91, s3, 7282
v_mfma_f32_16x16x32_bf16 v[112:115], v[48:51], a[32:35], v[112:115]
ds_read_b64_tr_b16 v[40:41], v15 offset:49408
s_lshr_b32 s91, s91, 16
v_mfma_f32_16x16x32_bf16 v[112:115], v[52:55], a[48:51], v[112:115]
buffer_load_dwordx4 v33, s[8:11], s41 offen offset:2048 lds
v_mfma_f32_16x16x32_bf16 v[116:119], v[48:51], a[36:39], v[116:119]
ds_read_b64_tr_b16 v[42:43], v15 offset:50944
s_mul_i32 s91, s91, 9
v_mfma_f32_16x16x32_bf16 v[116:119], v[52:55], a[52:55], v[116:119]
s_sub_u32 s91, s3, s91
s_lshl_b32 s91, 1024, s91
v_mfma_f32_16x16x32_bf16 v[120:123], v[48:51], a[40:43], v[120:123]
ds_read_b64_tr_b16 v[44:45], v15 offset:61696
s_or_b32 s5, s5, s91
v_mfma_f32_16x16x32_bf16 v[120:123], v[52:55], a[56:59], v[120:123]
buffer_load_dwordx4 v34, s[8:11], s41 offen offset:3072 lds
v_mfma_f32_16x16x32_bf16 v[124:127], v[48:51], a[44:47], v[124:127]
ds_read_b64_tr_b16 v[46:47], v15 offset:63232
s_mul_i32 s91, s3, 6554
v_mfma_f32_16x16x32_bf16 v[124:127], v[52:55], a[60:63], v[124:127]
s_waitcnt lgkmcnt(4)
s_lshr_b32 s91, s91, 16
s_mul_i32 s91, s91, 10
v_mfma_f32_16x16x32_bf16 v[224:227], v[56:59], a[32:35], v[224:227]
ds_read_b64_tr_b16 v[48:49], v16 offset:49408
s_sub_u32 s91, s3, s91
v_mfma_f32_16x16x32_bf16 v[224:227], v[60:63], a[48:51], v[224:227]
s_lshl_b32 s91, 524288, s91
s_or_b32 s5, s5, s91
v_mfma_f32_16x16x32_bf16 v[228:231], v[56:59], a[36:39], v[228:231]
s_add_u32 m0, s38, 4096
ds_read_b64_tr_b16 v[50:51], v16 offset:50944
s_mov_b32 s4, 0
v_mfma_f32_16x16x32_bf16 v[228:231], v[60:63], a[52:55], v[228:231]
buffer_load_dwordx4 v35, s[8:11], s41 offen lds
v_mfma_f32_16x16x32_bf16 v[232:235], v[56:59], a[40:43], v[232:235]
ds_read_b64_tr_b16 v[52:53], v16 offset:61696
s_mov_b32 s6, 0
v_mfma_f32_16x16x32_bf16 v[232:235], v[60:63], a[56:59], v[232:235]
s_add_u32 s31, s37, 73728
v_add_u32 v22, v22, v9
v_mfma_f32_16x16x32_bf16 v[236:239], v[56:59], a[44:47], v[236:239]
ds_read_b64_tr_b16 v[54:55], v16 offset:63232
v_accvgpr_read_b32 v9, a161
v_mfma_f32_16x16x32_bf16 v[236:239], v[60:63], a[60:63], v[236:239]
s_waitcnt lgkmcnt(4)
s_cmp_eq_u32 s34, 1
s_cselect_b32 s3, 384, 0
v_mfma_f32_16x16x32_bf16 v[128:131], v[40:43], a[32:35], v[128:131]
ds_read_b64_tr_b16 v[56:57], v17 offset:49408
s_add_u32 s52, s3, 100224
v_mfma_f32_16x16x32_bf16 v[128:131], v[44:47], a[48:51], v[128:131]
ds_read_b64_tr_b16 v[58:59], v17 offset:50944
v_add_u32 v23, v23, v9
v_mfma_f32_16x16x32_bf16 v[132:135], v[40:43], a[36:39], v[132:135]
ds_read_b64_tr_b16 v[60:61], v17 offset:61696
v_accvgpr_read_b32 v9, a162
v_mfma_f32_16x16x32_bf16 v[132:135], v[44:47], a[52:55], v[132:135]
ds_read_b64_tr_b16 v[62:63], v17 offset:63232
v_add_u32 v24, v24, v9
v_mfma_f32_16x16x32_bf16 v[136:139], v[40:43], a[40:43], v[136:139]
buffer_load_dwordx4 v36, s[8:11], s41 offen offset:1024 lds
v_mfma_f32_16x16x32_bf16 v[136:139], v[44:47], a[56:59], v[136:139]
buffer_load_dwordx4 v37, s[8:11], s41 offen offset:2048 lds
v_mfma_f32_16x16x32_bf16 v[140:143], v[40:43], a[44:47], v[140:143]
s_cmp_eq_u32 s34, 2
s_cselect_b32 s3, 384, 0
v_mfma_f32_16x16x32_bf16 v[140:143], v[44:47], a[60:63], v[140:143]
s_waitcnt lgkmcnt(4)
s_sub_u32 s45, 200832, s3
s_mul_i32 s1, s35, 2
v_mfma_f32_16x16x32_bf16 v[240:243], v[48:51], a[32:35], v[240:243]
s_waitcnt vmcnt(26) lgkmcnt(0)
s_lshr_b32 s1, s1, 0
v_mfma_f32_16x16x32_bf16 v[240:243], v[52:55], a[48:51], v[240:243]
s_barrier
s_cmp_eq_u32 s1, 30
s_cselect_b32 s1, 0, s1
v_mfma_f32_16x16x32_bf16 v[244:247], v[48:51], a[36:39], v[244:247]
ds_read_b64_tr_b16 v[40:41], v10 offset:49152
v_mfma_f32_16x16x32_bf16 v[244:247], v[52:55], a[52:55], v[244:247]
ds_read_b64_tr_b16 v[42:43], v10 offset:50688
v_mfma_f32_16x16x32_bf16 v[248:251], v[48:51], a[40:43], v[248:251]
ds_read_b64_tr_b16 v[44:45], v10 offset:61440
v_mfma_f32_16x16x32_bf16 v[248:251], v[52:55], a[56:59], v[248:251]
ds_read_b64_tr_b16 v[46:47], v10 offset:62976
v_mfma_f32_16x16x32_bf16 v[252:255], v[48:51], a[44:47], v[252:255]
buffer_load_dwordx4 v38, s[8:11], s41 offen offset:3072 lds
v_mfma_f32_16x16x32_bf16 v[252:255], v[52:55], a[60:63], v[252:255]
s_cmp_ge_u32 s1, 10
s_cselect_b32 s3, s52, 0
v_mfma_f32_16x16x32_bf16 v[144:147], v[56:59], a[32:35], v[144:147]
ds_read_b64_tr_b16 v[48:49], v11 offset:49152
v_mfma_f32_16x16x32_bf16 v[144:147], v[60:63], a[48:51], v[144:147]
buffer_store_dword a184, v2, s[56:59], 0 offen sc1
v_mfma_f32_16x16x32_bf16 v[148:151], v[56:59], a[36:39], v[148:151]
ds_read_b64_tr_b16 v[50:51], v11 offset:50688
v_mfma_f32_16x16x32_bf16 v[148:151], v[60:63], a[52:55], v[148:151]
buffer_store_dwordx4 a[184:187], v3, s[56:59], 0 offen sc1
v_mfma_f32_16x16x32_bf16 v[152:155], v[56:59], a[40:43], v[152:155]
ds_read_b64_tr_b16 v[52:53], v11 offset:61440
v_mfma_f32_16x16x32_bf16 v[152:155], v[60:63], a[56:59], v[152:155]
s_cmp_ge_u32 s1, 20
s_cselect_b32 s3, s45, s3
v_mfma_f32_16x16x32_bf16 v[156:159], v[56:59], a[44:47], v[156:159]
s_mov_b32 s40, 6291456
ds_read_b64_tr_b16 v[54:55], v11 offset:62976
s_mul_i32 s98, s1, 3072
v_mfma_f32_16x16x32_bf16 v[156:159], v[60:63], a[60:63], v[156:159]
s_waitcnt lgkmcnt(4)
s_add_u32 s98, s98, s3
s_add_u32 s1, s1, 1
v_mfma_f32_16x16x32_bf16 v[160:163], v[40:43], a[0:3], v[160:163]
s_add_u32 m0, s37, 49152
ds_read_b64_tr_b16 v[56:57], v12 offset:49152
v_mfma_f32_16x16x32_bf16 v[160:163], v[44:47], a[16:19], v[160:163]
buffer_load_dwordx4 v28, s[12:15], s40 offen lds
v_mfma_f32_16x16x32_bf16 v[164:167], v[40:43], a[4:7], v[164:167]
ds_read_b64_tr_b16 v[58:59], v12 offset:50688
v_mfma_f32_16x16x32_bf16 v[164:167], v[44:47], a[20:23], v[164:167]
s_cmp_eq_u32 s1, 30
s_cselect_b32 s1, 0, s1
v_mfma_f32_16x16x32_bf16 v[168:171], v[40:43], a[8:11], v[168:171]
ds_read_b64_tr_b16 v[60:61], v12 offset:61440
v_mfma_f32_16x16x32_bf16 v[168:171], v[44:47], a[24:27], v[168:171]
buffer_load_dwordx4 v29, s[12:15], s40 offen offset:1024 lds
v_mfma_f32_16x16x32_bf16 v[172:175], v[40:43], a[12:15], v[172:175]
ds_read_b64_tr_b16 v[62:63], v12 offset:62976
v_mfma_f32_16x16x32_bf16 v[172:175], v[44:47], a[28:31], v[172:175]
s_waitcnt lgkmcnt(4)
s_cmp_ge_u32 s1, 10
s_cselect_b32 s3, s52, 0
v_mfma_f32_16x16x32_bf16 v[64:67], v[48:51], a[0:3], v[64:67]
ds_read_b64_tr_b16 v[40:41], v13 offset:49152
v_mfma_f32_16x16x32_bf16 v[64:67], v[52:55], a[16:19], v[64:67]
s_cmp_ge_u32 s1, 20
s_cselect_b32 s3, s45, s3
v_mfma_f32_16x16x32_bf16 v[68:71], v[48:51], a[4:7], v[68:71]
ds_read_b64_tr_b16 v[42:43], v13 offset:50688
s_mul_i32 s99, s1, 3072
v_mfma_f32_16x16x32_bf16 v[68:71], v[52:55], a[20:23], v[68:71]
buffer_load_dwordx4 v30, s[12:15], s40 offen offset:2048 lds
v_mfma_f32_16x16x32_bf16 v[72:75], v[48:51], a[8:11], v[72:75]
ds_read_b64_tr_b16 v[44:45], v13 offset:61440
s_add_u32 s99, s99, s3
v_mfma_f32_16x16x32_bf16 v[72:75], v[52:55], a[24:27], v[72:75]
s_add_u32 s1, s1, 1
v_mfma_f32_16x16x32_bf16 v[76:79], v[48:51], a[12:15], v[76:79]
s_mov_b32 s40, 6684672
ds_read_b64_tr_b16 v[46:47], v13 offset:62976
v_mfma_f32_16x16x32_bf16 v[76:79], v[52:55], a[28:31], v[76:79]
s_waitcnt lgkmcnt(4)
s_cmp_eq_u32 s1, 30
s_cselect_b32 s1, 0, s1
v_mfma_f32_16x16x32_bf16 v[176:179], v[56:59], a[0:3], v[176:179]
s_add_u32 m0, s37, 61440
ds_read_b64_tr_b16 v[48:49], v10 offset:49280
v_mfma_f32_16x16x32_bf16 v[176:179], v[60:63], a[16:19], v[176:179]
buffer_load_dwordx4 v28, s[12:15], s40 offen lds
v_mfma_f32_16x16x32_bf16 v[180:183], v[56:59], a[4:7], v[180:183]
ds_read_b64_tr_b16 v[50:51], v10 offset:50816
v_mfma_f32_16x16x32_bf16 v[180:183], v[60:63], a[20:23], v[180:183]
s_waitcnt vmcnt(23)
s_cmp_ge_u32 s1, 10
s_cselect_b32 s3, s52, 0
v_mfma_f32_16x16x32_bf16 v[184:187], v[56:59], a[8:11], v[184:187]
ds_read_b64_tr_b16 v[52:53], v10 offset:61568
ds_read_b128 a[32:35], v20 offset:0
v_mfma_f32_16x16x32_bf16 v[184:187], v[60:63], a[24:27], v[184:187]
buffer_load_dwordx4 v29, s[12:15], s40 offen offset:1024 lds
v_mfma_f32_16x16x32_bf16 v[188:191], v[56:59], a[12:15], v[188:191]
ds_read_b64_tr_b16 v[54:55], v10 offset:63104
ds_read_b128 a[48:51], v21 offset:0
v_mfma_f32_16x16x32_bf16 v[188:191], v[60:63], a[28:31], v[188:191]
s_waitcnt lgkmcnt(6)
s_cmp_ge_u32 s1, 20
s_cselect_b32 s3, s45, s3
v_mfma_f32_16x16x32_bf16 v[80:83], v[40:43], a[0:3], v[80:83]
ds_read_b64_tr_b16 v[56:57], v11 offset:49280
ds_read_b128 a[36:39], v20 offset:2048
v_mfma_f32_16x16x32_bf16 v[80:83], v[44:47], a[16:19], v[80:83]
buffer_load_dwordx4 v30, s[12:15], s40 offen offset:2048 lds
v_mfma_f32_16x16x32_bf16 v[84:87], v[40:43], a[4:7], v[84:87]
ds_read_b64_tr_b16 v[58:59], v11 offset:50816
ds_read_b128 a[52:55], v21 offset:2048
v_mfma_f32_16x16x32_bf16 v[84:87], v[44:47], a[20:23], v[84:87]
s_mul_i32 s100, s1, 3072
s_add_u32 s100, s100, s3
v_mfma_f32_16x16x32_bf16 v[88:91], v[40:43], a[8:11], v[88:91]
ds_read_b64_tr_b16 v[60:61], v11 offset:61568
ds_read_b128 a[40:43], v20 offset:4096
v_mfma_f32_16x16x32_bf16 v[88:91], v[44:47], a[24:27], v[88:91]
s_add_u32 s1, s1, 1
v_mfma_f32_16x16x32_bf16 v[92:95], v[40:43], a[12:15], v[92:95]
ds_read_b64_tr_b16 v[62:63], v11 offset:63104
ds_read_b128 a[56:59], v21 offset:4096
v_mfma_f32_16x16x32_bf16 v[92:95], v[44:47], a[28:31], v[92:95]
s_waitcnt lgkmcnt(9)
s_cmp_eq_u32 s1, 30
s_cselect_b32 s1, 0, s1
v_mfma_f32_16x16x32_bf16 v[192:195], v[48:51], a[0:3], v[192:195]
s_add_u32 m0, s37, 12288
ds_read_b64_tr_b16 v[40:41], v12 offset:49280
ds_read_b128 a[44:47], v20 offset:6144
v_mfma_f32_16x16x32_bf16 v[192:195], v[52:55], a[16:19], v[192:195]
buffer_load_dwordx4 v22, s[16:19], s97 offen nt lds
v_mfma_f32_16x16x32_bf16 v[196:199], v[48:51], a[4:7], v[196:199]
ds_read_b64_tr_b16 v[42:43], v12 offset:50816
ds_read_b128 a[60:63], v21 offset:6144
v_mfma_f32_16x16x32_bf16 v[196:199], v[52:55], a[20:23], v[196:199]
buffer_load_dwordx4 v23, s[16:19], s97 offen offset:1024 nt lds
v_mfma_f32_16x16x32_bf16 v[200:203], v[48:51], a[8:11], v[200:203]
ds_read_b64_tr_b16 v[44:45], v12 offset:61568
v_mfma_f32_16x16x32_bf16 v[200:203], v[52:55], a[24:27], v[200:203]
s_cmp_ge_u32 s1, 10
s_cselect_b32 s3, s52, 0
v_mfma_f32_16x16x32_bf16 v[204:207], v[48:51], a[12:15], v[204:207]
ds_read_b64_tr_b16 v[46:47], v12 offset:63104
v_mfma_f32_16x16x32_bf16 v[204:207], v[52:55], a[28:31], v[204:207]
s_waitcnt lgkmcnt(7)
s_cmp_ge_u32 s1, 20
s_cselect_b32 s3, s45, s3
v_mfma_f32_16x16x32_bf16 v[96:99], v[56:59], a[0:3], v[96:99]
ds_read_b64_tr_b16 v[48:49], v13 offset:49280
s_mul_i32 s101, s1, 3072
v_mfma_f32_16x16x32_bf16 v[96:99], v[60:63], a[16:19], v[96:99]
buffer_load_dwordx4 v24, s[16:19], s97 offen offset:2048 nt lds
v_mfma_f32_16x16x32_bf16 v[100:103], v[56:59], a[4:7], v[100:103]
ds_read_b64_tr_b16 v[50:51], v13 offset:50816
s_add_u32 s101, s101, s3
v_mfma_f32_16x16x32_bf16 v[100:103], v[60:63], a[20:23], v[100:103]
s_add_u32 s1, s1, 1
v_accvgpr_read_b32 v9, a163
v_mfma_f32_16x16x32_bf16 v[104:107], v[56:59], a[8:11], v[104:107]
ds_read_b64_tr_b16 v[52:53], v13 offset:61568
v_sub_u32 v22, v22, v9
v_mfma_f32_16x16x32_bf16 v[104:107], v[60:63], a[24:27], v[104:107]
s_cmp_eq_u32 s1, 30
s_cselect_b32 s1, 0, s1
v_mfma_f32_16x16x32_bf16 v[108:111], v[56:59], a[12:15], v[108:111]
s_mov_b32 s41, 1152
ds_read_b64_tr_b16 v[54:55], v13 offset:63104
v_accvgpr_read_b32 v9, a164
v_mfma_f32_16x16x32_bf16 v[108:111], v[60:63], a[28:31], v[108:111]
s_waitcnt lgkmcnt(4)
s_cmp_ge_u32 s1, 10
s_cselect_b32 s3, s52, 0
v_mfma_f32_16x16x32_bf16 v[208:211], v[40:43], a[0:3], v[208:211]
s_mov_b32 m0, s39
ds_read_b64_tr_b16 v[56:57], v10 offset:49408
v_sub_u32 v23, v23, v9
v_mfma_f32_16x16x32_bf16 v[208:211], v[44:47], a[16:19], v[208:211]
buffer_load_dwordx4 v31, s[8:11], s41 offen lds
v_mfma_f32_16x16x32_bf16 v[212:215], v[40:43], a[4:7], v[212:215]
ds_read_b64_tr_b16 v[58:59], v10 offset:50944
v_accvgpr_read_b32 v9, a165
v_mfma_f32_16x16x32_bf16 v[212:215], v[44:47], a[20:23], v[212:215]
buffer_load_dwordx4 v32, s[8:11], s41 offen offset:1024 lds
v_mfma_f32_16x16x32_bf16 v[216:219], v[40:43], a[8:11], v[216:219]
ds_read_b64_tr_b16 v[60:61], v10 offset:61696
v_sub_u32 v24, v24, v9
v_mfma_f32_16x16x32_bf16 v[216:219], v[44:47], a[24:27], v[216:219]
s_cmp_ge_u32 s1, 20
s_cselect_b32 s3, s45, s3
v_mfma_f32_16x16x32_bf16 v[220:223], v[40:43], a[12:15], v[220:223]
ds_read_b64_tr_b16 v[62:63], v10 offset:63232
s_mul_i32 s0, s1, 3072
v_mfma_f32_16x16x32_bf16 v[220:223], v[44:47], a[28:31], v[220:223]
s_waitcnt vmcnt(13) lgkmcnt(4)
s_add_u32 s0, s0, s3
s_mov_b32 s42, s0
v_mfma_f32_16x16x32_bf16 v[112:115], v[48:51], a[0:3], v[112:115]
ds_read_b64_tr_b16 v[40:41], v11 offset:49408
ds_read_b128 a[208:211], v18 offset:0
v_mfma_f32_16x16x32_bf16 v[112:115], v[52:55], a[16:19], v[112:115]
buffer_load_dwordx4 v33, s[8:11], s41 offen offset:2048 lds
v_mfma_f32_16x16x32_bf16 v[116:119], v[48:51], a[4:7], v[116:119]
ds_read_b64_tr_b16 v[42:43], v11 offset:50944
ds_read_b128 a[224:227], v19 offset:0
v_mfma_f32_16x16x32_bf16 v[116:119], v[52:55], a[20:23], v[116:119]
KF_pg3:
s_cbranch_execz KF_pg7
v_and_b32 v2, 15, v0
v_xor_b32 v4, 0, v2
v_mfma_f32_16x16x32_bf16 v[120:123], v[48:51], a[8:11], v[120:123]
ds_read_b64_tr_b16 v[44:45], v11 offset:61696
ds_read_b128 a[212:215], v18 offset:2048
v_mfma_f32_16x16x32_bf16 v[120:123], v[52:55], a[24:27], v[120:123]
buffer_load_dwordx4 v34, s[8:11], s41 offen offset:3072 lds
v_mfma_f32_16x16x32_bf16 v[124:127], v[48:51], a[12:15], v[124:127]
ds_read_b64_tr_b16 v[46:47], v11 offset:63232
ds_read_b128 a[228:231], v19 offset:2048
v_mfma_f32_16x16x32_bf16 v[124:127], v[52:55], a[28:31], v[124:127]
s_waitcnt lgkmcnt(8)
v_min_u32 v4, 1, v4
v_add_u32 v4, -1, v4
v_mfma_f32_16x16x32_bf16 v[224:227], v[56:59], a[0:3], v[224:227]
ds_read_b64_tr_b16 v[48:49], v12 offset:49408
ds_read_b128 a[216:219], v18 offset:4096
v_mfma_f32_16x16x32_bf16 v[224:227], v[60:63], a[16:19], v[224:227]
v_and_b32 v4, 0x3f803f80, v4
v_accvgpr_write_b32 a240, v4
v_mfma_f32_16x16x32_bf16 v[228:231], v[56:59], a[4:7], v[228:231]
s_add_u32 m0, s39, 4096
ds_read_b64_tr_b16 v[50:51], v12 offset:50944
ds_read_b128 a[232:235], v19 offset:4096
v_mfma_f32_16x16x32_bf16 v[228:231], v[60:63], a[20:23], v[228:231]
buffer_load_dwordx4 v35, s[8:11], s41 offen lds
v_mfma_f32_16x16x32_bf16 v[232:235], v[56:59], a[8:11], v[232:235]
ds_read_b64_tr_b16 v[52:53], v12 offset:61696
ds_read_b128 a[220:223], v18 offset:6144
v_mfma_f32_16x16x32_bf16 v[232:235], v[60:63], a[24:27], v[232:235]
v_accvgpr_write_b32 a241, v4
v_accvgpr_write_b32 a242, v4
v_mfma_f32_16x16x32_bf16 v[236:239], v[56:59], a[12:15], v[236:239]
ds_read_b64_tr_b16 v[54:55], v12 offset:63232
ds_read_b128 a[236:239], v19 offset:6144
v_mfma_f32_16x16x32_bf16 v[236:239], v[60:63], a[28:31], v[236:239]
s_waitcnt lgkmcnt(9)
v_accvgpr_write_b32 a243, v4
v_xor_b32 v4, 1, v2
v_mfma_f32_16x16x32_bf16 v[128:131], v[40:43], a[0:3], v[128:131]
ds_read_b64_tr_b16 v[56:57], v13 offset:49408
v_min_u32 v4, 1, v4
v_mfma_f32_16x16x32_bf16 v[128:131], v[44:47], a[16:19], v[128:131]
ds_read_b64_tr_b16 v[58:59], v13 offset:50944
v_add_u32 v4, -1, v4
v_mfma_f32_16x16x32_bf16 v[132:135], v[40:43], a[4:7], v[132:135]
ds_read_b64_tr_b16 v[60:61], v13 offset:61696
v_and_b32 v4, 0x3f803f80, v4
v_mfma_f32_16x16x32_bf16 v[132:135], v[44:47], a[20:23], v[132:135]
ds_read_b64_tr_b16 v[62:63], v13 offset:63232
v_accvgpr_write_b32 a244, v4
v_mfma_f32_16x16x32_bf16 v[136:139], v[40:43], a[8:11], v[136:139]
buffer_load_dwordx4 v36, s[8:11], s41 offen offset:1024 lds
v_mfma_f32_16x16x32_bf16 v[136:139], v[44:47], a[24:27], v[136:139]
buffer_load_dwordx4 v37, s[8:11], s41 offen offset:2048 lds
v_mfma_f32_16x16x32_bf16 v[140:143], v[40:43], a[12:15], v[140:143]
v_accvgpr_write_b32 a245, v4
v_accvgpr_write_b32 a246, v4
v_mfma_f32_16x16x32_bf16 v[140:143], v[44:47], a[28:31], v[140:143]
s_waitcnt lgkmcnt(5)
v_accvgpr_write_b32 a247, v4
v_xor_b32 v4, 2, v2
v_mfma_f32_16x16x32_bf16 v[240:243], v[48:51], a[0:3], v[240:243]
s_waitcnt lgkmcnt(0)
v_min_u32 v4, 1, v4
v_add_u32 v4, -1, v4
v_mfma_f32_16x16x32_bf16 v[240:243], v[52:55], a[16:19], v[240:243]
s_barrier
v_and_b32 v4, 0x3f803f80, v4
v_accvgpr_write_b32 a248, v4
v_mfma_f32_16x16x32_bf16 v[244:247], v[48:51], a[4:7], v[244:247]
ds_read_b64_tr_b16 v[40:41], v14 offset:24576
v_accvgpr_write_b32 a249, v4
v_mfma_f32_16x16x32_bf16 v[244:247], v[52:55], a[20:23], v[244:247]
ds_read_b64_tr_b16 v[42:43], v14 offset:26112
v_accvgpr_write_b32 a250, v4
v_mfma_f32_16x16x32_bf16 v[248:251], v[48:51], a[8:11], v[248:251]
ds_read_b64_tr_b16 v[44:45], v14 offset:36864
v_accvgpr_write_b32 a251, v4
v_mfma_f32_16x16x32_bf16 v[248:251], v[52:55], a[24:27], v[248:251]
ds_read_b64_tr_b16 v[46:47], v14 offset:38400
v_xor_b32 v4, 3, v2
v_mfma_f32_16x16x32_bf16 v[252:255], v[48:51], a[12:15], v[252:255]
buffer_load_dwordx4 v38, s[8:11], s41 offen offset:3072 lds
v_mfma_f32_16x16x32_bf16 v[252:255], v[52:55], a[28:31], v[252:255]
v_min_u32 v4, 1, v4
v_add_u32 v4, -1, v4
v_mfma_f32_16x16x32_bf16 v[144:147], v[56:59], a[0:3], v[144:147]
ds_read_b64_tr_b16 v[48:49], v15 offset:24576
v_and_b32 v4, 0x3f803f80, v4
v_mfma_f32_16x16x32_bf16 v[144:147], v[60:63], a[16:19], v[144:147]
s_mov_b32 s40, 7077888
v_accvgpr_write_b32 a252, v4
v_accvgpr_write_b32 a253, v4
v_mfma_f32_16x16x32_bf16 v[148:151], v[56:59], a[4:7], v[148:151]
s_add_u32 m0, s37, 122880
ds_read_b64_tr_b16 v[50:51], v15 offset:26112
v_accvgpr_write_b32 a254, v4
v_mfma_f32_16x16x32_bf16 v[148:151], v[60:63], a[20:23], v[148:151]
buffer_load_dwordx4 v28, s[12:15], s40 offen lds
v_mfma_f32_16x16x32_bf16 v[152:155], v[56:59], a[8:11], v[152:155]
ds_read_b64_tr_b16 v[52:53], v15 offset:36864
v_accvgpr_write_b32 a255, v4
v_mfma_f32_16x16x32_bf16 v[152:155], v[60:63], a[24:27], v[152:155]
buffer_load_dwordx4 v29, s[12:15], s40 offen offset:1024 lds
v_mfma_f32_16x16x32_bf16 v[156:159], v[56:59], a[12:15], v[156:159]
ds_read_b64_tr_b16 v[54:55], v15 offset:38400
v_mfma_f32_16x16x32_bf16 v[156:159], v[60:63], a[28:31], v[156:159]
s_waitcnt lgkmcnt(4)
v_mfma_f32_16x16x32_bf16 v[160:163], v[40:43], a[32:35], v[160:163]
ds_read_b64_tr_b16 v[56:57], v16 offset:24576
v_mfma_f32_16x16x32_bf16 v[160:163], v[44:47], a[48:51], v[160:163]
buffer_load_dwordx4 v30, s[12:15], s40 offen offset:2048 lds
v_mfma_f32_16x16x32_bf16 v[164:167], v[40:43], a[36:39], v[164:167]
ds_read_b64_tr_b16 v[58:59], v16 offset:26112
v_mfma_f32_16x16x32_bf16 v[164:167], v[44:47], a[52:55], v[164:167]
s_mov_b32 s40, 7471104
v_mfma_f32_16x16x32_bf16 v[168:171], v[40:43], a[40:43], v[168:171]
s_add_u32 m0, s37, 135168
ds_read_b64_tr_b16 v[60:61], v16 offset:36864
v_mfma_f32_16x16x32_bf16 v[168:171], v[44:47], a[56:59], v[168:171]
buffer_load_dwordx4 v28, s[12:15], s40 offen lds
v_mfma_f32_16x16x32_bf16 v[172:175], v[40:43], a[44:47], v[172:175]
ds_read_b64_tr_b16 v[62:63], v16 offset:38400
v_mfma_f32_16x16x32_bf16 v[172:175], v[44:47], a[60:63], v[172:175]
s_waitcnt lgkmcnt(4)
v_mfma_f32_16x16x32_bf16 v[64:67], v[48:51], a[32:35], v[64:67]
ds_read_b64_tr_b16 v[40:41], v17 offset:24576
v_mfma_f32_16x16x32_bf16 v[64:67], v[52:55], a[48:51], v[64:67]
v_mfma_f32_16x16x32_bf16 v[68:71], v[48:51], a[36:39], v[68:71]
ds_read_b64_tr_b16 v[42:43], v17 offset:26112
v_mfma_f32_16x16x32_bf16 v[68:71], v[52:55], a[52:55], v[68:71]
buffer_load_dwordx4 v29, s[12:15], s40 offen offset:1024 lds
v_mfma_f32_16x16x32_bf16 v[72:75], v[48:51], a[40:43], v[72:75]
ds_read_b64_tr_b16 v[44:45], v17 offset:36864
v_mfma_f32_16x16x32_bf16 v[72:75], v[52:55], a[56:59], v[72:75]
v_mfma_f32_16x16x32_bf16 v[76:79], v[48:51], a[44:47], v[76:79]
ds_read_b64_tr_b16 v[46:47], v17 offset:38400
v_mfma_f32_16x16x32_bf16 v[76:79], v[52:55], a[60:63], v[76:79]
s_waitcnt lgkmcnt(4)
v_mfma_f32_16x16x32_bf16 v[176:179], v[56:59], a[32:35], v[176:179]
ds_read_b64_tr_b16 v[48:49], v14 offset:24704
v_mfma_f32_16x16x32_bf16 v[176:179], v[60:63], a[48:51], v[176:179]
buffer_load_dwordx4 v30, s[12:15], s40 offen offset:2048 lds
v_mfma_f32_16x16x32_bf16 v[180:183], v[56:59], a[36:39], v[180:183]
ds_read_b64_tr_b16 v[50:51], v14 offset:26240
v_accvgpr_read_b32 v28, a150
v_mfma_f32_16x16x32_bf16 v[180:183], v[60:63], a[52:55], v[180:183]
v_accvgpr_read_b32 v29, a151
v_accvgpr_read_b32 v30, a152
v_mfma_f32_16x16x32_bf16 v[184:187], v[56:59], a[40:43], v[184:187]
s_add_u32 m0, s37, 73728
ds_read_b64_tr_b16 v[52:53], v14 offset:36992
v_accvgpr_read_b32 v31, a153
v_mfma_f32_16x16x32_bf16 v[184:187], v[60:63], a[56:59], v[184:187]
buffer_load_dwordx4 v25, s[20:23], s96 offen nt lds
v_mfma_f32_16x16x32_bf16 v[188:191], v[56:59], a[44:47], v[188:191]
ds_read_b64_tr_b16 v[54:55], v14 offset:38528
v_accvgpr_read_b32 v34, a154
v_mfma_f32_16x16x32_bf16 v[188:191], v[60:63], a[60:63], v[188:191]
s_waitcnt lgkmcnt(4)
v_accvgpr_read_b32 v35, a155
v_accvgpr_read_b32 v36, a156
v_mfma_f32_16x16x32_bf16 v[80:83], v[40:43], a[32:35], v[80:83]
ds_read_b64_tr_b16 v[56:57], v15 offset:24704
v_accvgpr_read_b32 v37, a157
v_mfma_f32_16x16x32_bf16 v[80:83], v[44:47], a[48:51], v[80:83]
buffer_load_dwordx4 v26, s[20:23], s96 offen offset:1024 nt lds
v_mfma_f32_16x16x32_bf16 v[84:87], v[40:43], a[36:39], v[84:87]
ds_read_b64_tr_b16 v[58:59], v15 offset:26240
v_accvgpr_read_b32 v38, a158
v_mfma_f32_16x16x32_bf16 v[84:87], v[44:47], a[52:55], v[84:87]
v_accvgpr_read_b32 v5, a159
v_add_u32 v32, 8192, v31
v_mfma_f32_16x16x32_bf16 v[88:91], v[40:43], a[40:43], v[88:91]
ds_read_b64_tr_b16 v[60:61], v15 offset:36992
v_add_u32 v33, 16384, v31
v_mfma_f32_16x16x32_bf16 v[88:91], v[44:47], a[56:59], v[88:91]
v_mfma_f32_16x16x32_bf16 v[92:95], v[40:43], a[44:47], v[92:95]
ds_read_b64_tr_b16 v[62:63], v15 offset:38528
v_mfma_f32_16x16x32_bf16 v[92:95], v[44:47], a[60:63], v[92:95]
s_waitcnt lgkmcnt(4)
v_mfma_f32_16x16x32_bf16 v[192:195], v[48:51], a[32:35], v[192:195]
ds_read_b64_tr_b16 v[40:41], v16 offset:24704
v_mfma_f32_16x16x32_bf16 v[192:195], v[52:55], a[48:51], v[192:195]
buffer_load_dwordx4 v27, s[20:23], s96 offen offset:2048 nt lds
v_mfma_f32_16x16x32_bf16 v[196:199], v[48:51], a[36:39], v[196:199]
ds_read_b64_tr_b16 v[42:43], v16 offset:26240
v_accvgpr_read_b32 v9, a160
v_mfma_f32_16x16x32_bf16 v[196:199], v[52:55], a[52:55], v[196:199]
v_add_u32 v25, v25, v9
v_accvgpr_read_b32 v9, a161
v_mfma_f32_16x16x32_bf16 v[200:203], v[48:51], a[40:43], v[200:203]
s_add_u32 m0, s37, 86016
ds_read_b64_tr_b16 v[44:45], v16 offset:36992
v_add_u32 v26, v26, v9
v_accvgpr_read_b32 v9, a162
v_add_u32 v27, v27, v9
v_mfma_f32_16x16x32_bf16 v[200:203], v[52:55], a[56:59], v[200:203]
buffer_load_dwordx4 v25, s[20:23], s97 offen nt lds
v_mfma_f32_16x16x32_bf16 v[204:207], v[48:51], a[44:47], v[204:207]
ds_read_b64_tr_b16 v[46:47], v16 offset:38528
v_mfma_f32_16x16x32_bf16 v[204:207], v[52:55], a[60:63], v[204:207]
s_waitcnt lgkmcnt(4)
v_mfma_f32_16x16x32_bf16 v[96:99], v[56:59], a[32:35], v[96:99]
ds_read_b64_tr_b16 v[48:49], v17 offset:24704
v_mfma_f32_16x16x32_bf16 v[96:99], v[60:63], a[48:51], v[96:99]
v_mfma_f32_16x16x32_bf16 v[100:103], v[56:59], a[36:39], v[100:103]
ds_read_b64_tr_b16 v[50:51], v17 offset:26240
v_mfma_f32_16x16x32_bf16 v[100:103], v[60:63], a[52:55], v[100:103]
v_mfma_f32_16x16x32_bf16 v[104:107], v[56:59], a[40:43], v[104:107]
ds_read_b64_tr_b16 v[52:53], v17 offset:36992
v_mfma_f32_16x16x32_bf16 v[104:107], v[60:63], a[56:59], v[104:107]
buffer_load_dwordx4 v26, s[20:23], s97 offen offset:1024 nt lds
v_mfma_f32_16x16x32_bf16 v[108:111], v[56:59], a[44:47], v[108:111]
ds_read_b64_tr_b16 v[54:55], v17 offset:38528
v_mfma_f32_16x16x32_bf16 v[108:111], v[60:63], a[60:63], v[108:111]
s_waitcnt lgkmcnt(4)
v_mfma_f32_16x16x32_bf16 v[208:211], v[40:43], a[32:35], v[208:211]
ds_read_b64_tr_b16 v[56:57], v14 offset:24832
v_mfma_f32_16x16x32_bf16 v[208:211], v[44:47], a[48:51], v[208:211]
v_mfma_f32_16x16x32_bf16 v[212:215], v[40:43], a[36:39], v[212:215]
ds_read_b64_tr_b16 v[58:59], v14 offset:26368
v_mfma_f32_16x16x32_bf16 v[212:215], v[44:47], a[52:55], v[212:215]
v_mfma_f32_16x16x32_bf16 v[216:219], v[40:43], a[40:43], v[216:219]
ds_read_b64_tr_b16 v[60:61], v14 offset:37120
v_mfma_f32_16x16x32_bf16 v[216:219], v[44:47], a[56:59], v[216:219]
v_mfma_f32_16x16x32_bf16 v[220:223], v[40:43], a[44:47], v[220:223]
ds_read_b64_tr_b16 v[62:63], v14 offset:38656
v_mfma_f32_16x16x32_bf16 v[220:223], v[44:47], a[60:63], v[220:223]
s_waitcnt lgkmcnt(4)
v_mfma_f32_16x16x32_bf16 v[112:115], v[48:51], a[32:35], v[112:115]
ds_read_b64_tr_b16 v[40:41], v15 offset:24832
v_mfma_f32_16x16x32_bf16 v[112:115], v[52:55], a[48:51], v[112:115]
buffer_load_dwordx4 v27, s[20:23], s97 offen offset:2048 nt lds
v_mfma_f32_16x16x32_bf16 v[116:119], v[48:51], a[36:39], v[116:119]
ds_read_b64_tr_b16 v[42:43], v15 offset:26368
v_accvgpr_read_b32 v9, a163
v_mfma_f32_16x16x32_bf16 v[116:119], v[52:55], a[52:55], v[116:119]
v_sub_u32 v25, v25, v9
v_accvgpr_read_b32 v9, a164
v_mfma_f32_16x16x32_bf16 v[120:123], v[48:51], a[40:43], v[120:123]
ds_read_b64_tr_b16 v[44:45], v15 offset:37120
v_sub_u32 v26, v26, v9
v_mfma_f32_16x16x32_bf16 v[120:123], v[52:55], a[56:59], v[120:123]
v_accvgpr_read_b32 v9, a165
v_sub_u32 v27, v27, v9
v_mfma_f32_16x16x32_bf16 v[124:127], v[48:51], a[44:47], v[124:127]
ds_read_b64_tr_b16 v[46:47], v15 offset:38656
v_mov_b32 v8, v6
v_mfma_f32_16x16x32_bf16 v[124:127], v[52:55], a[60:63], v[124:127]
s_waitcnt lgkmcnt(4)
v_mov_b32 v9, v7
v_or_b32 v6, s34, v0
v_mfma_f32_16x16x32_bf16 v[224:227], v[56:59], a[32:35], v[224:227]
ds_read_b64_tr_b16 v[48:49], v16 offset:24832
v_lshlrev_b32 v6, 8, v6
v_mfma_f32_16x16x32_bf16 v[224:227], v[60:63], a[48:51], v[224:227]
v_mov_b32 v7, 1
v_mfma_f32_16x16x32_bf16 v[228:231], v[56:59], a[36:39], v[228:231]
ds_read_b64_tr_b16 v[50:51], v16 offset:26368
v_mfma_f32_16x16x32_bf16 v[228:231], v[60:63], a[52:55], v[228:231]
v_mfma_f32_16x16x32_bf16 v[232:235], v[56:59], a[40:43], v[232:235]
ds_read_b64_tr_b16 v[52:53], v16 offset:37120
v_mfma_f32_16x16x32_bf16 v[232:235], v[60:63], a[56:59], v[232:235]
v_mfma_f32_16x16x32_bf16 v[236:239], v[56:59], a[44:47], v[236:239]
ds_read_b64_tr_b16 v[54:55], v16 offset:38656
v_mfma_f32_16x16x32_bf16 v[236:239], v[60:63], a[60:63], v[236:239]
s_waitcnt lgkmcnt(4)
v_mfma_f32_16x16x32_bf16 v[128:131], v[40:43], a[32:35], v[128:131]
ds_read_b64_tr_b16 v[56:57], v17 offset:24832
v_mfma_f32_16x16x32_bf16 v[128:131], v[44:47], a[48:51], v[128:131]
ds_read_b64_tr_b16 v[58:59], v17 offset:26368
v_mfma_f32_16x16x32_bf16 v[132:135], v[40:43], a[36:39], v[132:135]
ds_read_b64_tr_b16 v[60:61], v17 offset:37120
v_mfma_f32_16x16x32_bf16 v[132:135], v[44:47], a[52:55], v[132:135]
ds_read_b64_tr_b16 v[62:63], v17 offset:38656
v_mfma_f32_16x16x32_bf16 v[136:139], v[40:43], a[40:43], v[136:139]
v_mfma_f32_16x16x32_bf16 v[136:139], v[44:47], a[56:59], v[136:139]
v_mfma_f32_16x16x32_bf16 v[140:143], v[40:43], a[44:47], v[140:143]
v_mfma_f32_16x16x32_bf16 v[140:143], v[44:47], a[60:63], v[140:143]
s_waitcnt lgkmcnt(4)
v_mfma_f32_16x16x32_bf16 v[240:243], v[48:51], a[32:35], v[240:243]
s_waitcnt vmcnt(6) lgkmcnt(0)
v_mfma_f32_16x16x32_bf16 v[240:243], v[52:55], a[48:51], v[240:243]
s_barrier
v_mfma_f32_16x16x32_bf16 v[244:247], v[48:51], a[36:39], v[244:247]
ds_read_b64_tr_b16 a[96:97], v14 offset:49152
ds_read_b64_tr_b16 a[98:99], v14 offset:50688
v_mfma_f32_16x16x32_bf16 v[244:247], v[52:55], a[52:55], v[244:247]
ds_read_b64_tr_b16 a[100:101], v14 offset:61440
ds_read_b64_tr_b16 a[102:103], v14 offset:62976
v_mfma_f32_16x16x32_bf16 v[248:251], v[48:51], a[40:43], v[248:251]
ds_read_b64_tr_b16 a[104:105], v10 offset:49152
ds_read_b64_tr_b16 a[106:107], v10 offset:50688
v_mfma_f32_16x16x32_bf16 v[248:251], v[52:55], a[56:59], v[248:251]
ds_read_b64_tr_b16 a[108:109], v10 offset:61440
ds_read_b64_tr_b16 a[110:111], v10 offset:62976
v_mfma_f32_16x16x32_bf16 v[252:255], v[48:51], a[44:47], v[252:255]
ds_read_b128 a[64:67], v20 offset:0
v_mfma_f32_16x16x32_bf16 v[252:255], v[52:55], a[60:63], v[252:255]
ds_read_b128 a[80:83], v21 offset:0
v_mfma_f32_16x16x32_bf16 v[144:147], v[56:59], a[32:35], v[144:147]
ds_read_b128 a[68:71], v20 offset:2048
v_mfma_f32_16x16x32_bf16 v[144:147], v[60:63], a[48:51], v[144:147]
ds_read_b128 a[84:87], v21 offset:2048
v_mfma_f32_16x16x32_bf16 v[148:151], v[56:59], a[36:39], v[148:151]
ds_read_b128 a[72:75], v20 offset:4096
v_mfma_f32_16x16x32_bf16 v[148:151], v[60:63], a[52:55], v[148:151]
ds_read_b128 a[88:91], v21 offset:4096
v_mfma_f32_16x16x32_bf16 v[152:155], v[56:59], a[40:43], v[152:155]
ds_read_b128 a[76:79], v20 offset:6144
v_mfma_f32_16x16x32_bf16 v[152:155], v[60:63], a[56:59], v[152:155]
s_add_u32 m0, s37, 24576
ds_read_b128 a[92:95], v21 offset:6144
v_mfma_f32_16x16x32_bf16 v[156:159], v[56:59], a[44:47], v[156:159]
buffer_load_dwordx4 v22, s[16:19], s98 offen nt lds
v_mfma_f32_16x16x32_bf16 v[156:159], v[60:63], a[60:63], v[156:159]
s_waitcnt lgkmcnt(6)
v_mfma_f32_16x16x32_bf16 v[160:163], a[96:99], a[208:211], v[160:163]
ds_read_b64_tr_b16 a[112:113], v15 offset:49152
v_mfma_f32_16x16x32_bf16 v[160:163], a[100:103], a[224:227], v[160:163]
ds_read_b64_tr_b16 a[114:115], v15 offset:50688
v_mfma_f32_16x16x32_bf16 v[160:163], a[104:107], a[64:67], v[160:163]
ds_read_b64_tr_b16 a[116:117], v15 offset:61440
v_mfma_f32_16x16x32_bf16 v[160:163], a[108:111], a[80:83], v[160:163]
s_waitcnt lgkmcnt(7)
ds_read_b64_tr_b16 a[118:119], v15 offset:62976
v_mfma_f32_16x16x32_bf16 v[164:167], a[96:99], a[212:215], v[164:167]
ds_read_b64_tr_b16 a[120:121], v11 offset:49152
v_mfma_f32_16x16x32_bf16 v[164:167], a[100:103], a[228:231], v[164:167]
ds_read_b64_tr_b16 a[122:123], v11 offset:50688
v_mfma_f32_16x16x32_bf16 v[164:167], a[104:107], a[68:71], v[164:167]
ds_read_b64_tr_b16 a[124:125], v11 offset:61440
v_mfma_f32_16x16x32_bf16 v[164:167], a[108:111], a[84:87], v[164:167]
s_waitcnt lgkmcnt(9)
ds_read_b64_tr_b16 a[126:127], v11 offset:62976
v_mfma_f32_16x16x32_bf16 v[168:171], a[96:99], a[216:219], v[168:171]
ds_read_b64_tr_b16 a[128:129], v16 offset:49152
ds_read_b64_tr_b16 a[130:131], v16 offset:50688
v_mfma_f32_16x16x32_bf16 v[168:171], a[100:103], a[232:235], v[168:171]
v_accvgpr_read_b32 v18, a148
v_accvgpr_read_b32 v21, a149
v_mul_f32 v160, s46, v160
v_mfma_f32_16x16x32_bf16 v[168:171], a[104:107], a[72:75], v[168:171]
ds_read_b64_tr_b16 a[132:133], v16 offset:61440
v_mul_f32 v161, s46, v161
v_mfma_f32_16x16x32_bf16 v[168:171], a[108:111], a[88:91], v[168:171]
s_waitcnt lgkmcnt(11)
ds_read_b64_tr_b16 a[134:135], v16 offset:62976
v_mul_f32 v162, s46, v162
v_mfma_f32_16x16x32_bf16 v[172:175], a[96:99], a[220:223], v[172:175]
ds_read_b64_tr_b16 a[136:137], v12 offset:49152
v_mul_f32 v163, s46, v163
v_mul_f32 v164, s46, v164
v_mfma_f32_16x16x32_bf16 v[172:175], a[100:103], a[236:239], v[172:175]
s_barrier
v_mul_f32 v165, s46, v165
v_mul_f32 v166, s46, v166
v_mfma_f32_16x16x32_bf16 v[172:175], a[104:107], a[76:79], v[172:175]
ds_read_b64_tr_b16 a[138:139], v12 offset:50688
v_mul_f32 v167, s46, v167
v_mfma_f32_16x16x32_bf16 v[172:175], a[108:111], a[92:95], v[172:175]
s_waitcnt lgkmcnt(6)
ds_read_b64_tr_b16 a[140:141], v12 offset:61440
v_mfma_f32_16x16x32_bf16 v[64:67], a[112:115], a[208:211], v[64:67]
ds_read_b64_tr_b16 a[142:143], v12 offset:62976
ds_read_b64_tr_b16 a[0:1], v17 offset:49152
v_mfma_f32_16x16x32_bf16 v[64:67], a[116:119], a[224:227], v[64:67]
buffer_load_dwordx4 v23, s[16:19], s98 offen offset:1024 nt lds
v_mfma_f32_16x16x32_bf16 v[64:67], a[120:123], a[64:67], v[64:67]
ds_read_b64_tr_b16 a[2:3], v17 offset:50688
v_mul_f32 v168, s46, v168
v_mul_f32 v169, s46, v169
v_mfma_f32_16x16x32_bf16 v[64:67], a[124:127], a[80:83], v[64:67]
ds_read_b64_tr_b16 a[4:5], v17 offset:61440
v_mul_f32 v170, s46, v170
v_mfma_f32_16x16x32_bf16 v[68:71], a[112:115], a[212:215], v[68:71]
ds_read_b64_tr_b16 a[6:7], v17 offset:62976
v_mul_f32 v171, s46, v171
v_mfma_f32_16x16x32_bf16 v[68:71], a[116:119], a[228:231], v[68:71]
buffer_load_dwordx4 v24, s[16:19], s98 offen offset:2048 nt lds
v_mfma_f32_16x16x32_bf16 v[68:71], a[120:123], a[68:71], v[68:71]
ds_read_b64_tr_b16 a[8:9], v13 offset:49152
v_mul_f32 v172, s46, v172
v_mfma_f32_16x16x32_bf16 v[68:71], a[124:127], a[84:87], v[68:71]
ds_read_b64_tr_b16 a[10:11], v13 offset:50688
v_mul_f32 v173, s46, v173
v_mfma_f32_16x16x32_bf16 v[72:75], a[112:115], a[216:219], v[72:75]
s_add_u32 m0, s37, 36864
ds_read_b64_tr_b16 a[12:13], v13 offset:61440
ds_read_b64_tr_b16 a[14:15], v13 offset:62976
v_mul_f32 v174, s46, v174
v_mfma_f32_16x16x32_bf16 v[72:75], a[116:119], a[232:235], v[72:75]
buffer_load_dwordx4 v22, s[16:19], s99 offen nt lds
v_mfma_f32_16x16x32_bf16 v[72:75], a[120:123], a[72:75], v[72:75]
ds_read_b64_tr_b16 a[16:17], v14 offset:49280
v_mul_f32 v175, s46, v175
v_mfma_f32_16x16x32_bf16 v[72:75], a[124:127], a[88:91], v[72:75]
ds_read_b64_tr_b16 a[18:19], v14 offset:50816
v_mul_f32 v64, s46, v64
v_mul_f32 v65, s46, v65
v_mfma_f32_16x16x32_bf16 v[76:79], a[112:115], a[220:223], v[76:79]
ds_read_b64_tr_b16 a[20:21], v14 offset:61568
v_mul_f32 v66, s46, v66
v_mfma_f32_16x16x32_bf16 v[76:79], a[116:119], a[236:239], v[76:79]
v_mul_f32 v67, s46, v67
v_cvt_pk_bf16_f32 v160, v160, v161
v_mfma_f32_16x16x32_bf16 v[76:79], a[120:123], a[76:79], v[76:79]
ds_read_b64_tr_b16 a[22:23], v14 offset:63104
v_cvt_pk_bf16_f32 v161, v162, v163
v_cvt_pk_bf16_f32 v162, v64, v65
v_mfma_f32_16x16x32_bf16 v[76:79], a[124:127], a[92:95], v[76:79]
s_waitcnt lgkmcnt(12)
ds_read_b64_tr_b16 a[24:25], v10 offset:49280
v_cvt_pk_bf16_f32 v163, v66, v67
v_mfma_f32_16x16x32_bf16 v[176:179], a[128:131], a[208:211], v[176:179]
ds_read_b64_tr_b16 a[26:27], v10 offset:50816
ds_read_b64_tr_b16 a[28:29], v10 offset:61568
v_mfma_f32_16x16x32_bf16 v[176:179], a[132:135], a[224:227], v[176:179]
buffer_load_dwordx4 v23, s[16:19], s99 offen offset:1024 nt lds
v_mfma_f32_16x16x32_bf16 v[176:179], a[136:139], a[64:67], v[176:179]
ds_read_b64_tr_b16 a[30:31], v10 offset:63104
v_mul_f32 v68, s46, v68
v_mfma_f32_16x16x32_bf16 v[176:179], a[140:143], a[80:83], v[176:179]
ds_read_b64_tr_b16 a[32:33], v15 offset:49280
v_mul_f32 v69, s46, v69
v_mfma_f32_16x16x32_bf16 v[180:183], a[128:131], a[212:215], v[180:183]
ds_read_b64_tr_b16 a[34:35], v15 offset:50816
v_mul_f32 v70, s46, v70
v_mul_f32 v71, s46, v71
v_mfma_f32_16x16x32_bf16 v[180:183], a[132:135], a[228:231], v[180:183]
v_permlane16_swap_b32 v160, v162
v_permlane16_swap_b32 v161, v163
v_mfma_f32_16x16x32_bf16 v[180:183], a[136:139], a[68:71], v[180:183]
ds_read_b64_tr_b16 a[36:37], v15 offset:61568
v_cvt_pk_bf16_f32 v164, v164, v165
v_mfma_f32_16x16x32_bf16 v[180:183], a[140:143], a[84:87], v[180:183]
ds_read_b64_tr_b16 a[38:39], v15 offset:63104
v_cvt_pk_bf16_f32 v165, v166, v167
v_cvt_pk_bf16_f32 v166, v68, v69
v_mfma_f32_16x16x32_bf16 v[184:187], a[128:131], a[216:219], v[184:187]
ds_read_b64_tr_b16 a[40:41], v11 offset:49280
v_cvt_pk_bf16_f32 v167, v70, v71
v_mfma_f32_16x16x32_bf16 v[184:187], a[132:135], a[232:235], v[184:187]
v_mul_f32 v72, s46, v72
v_mul_f32 v73, s46, v73
v_mfma_f32_16x16x32_bf16 v[184:187], a[136:139], a[72:75], v[184:187]
ds_read_b64_tr_b16 a[42:43], v11 offset:50816
ds_read_b64_tr_b16 a[44:45], v11 offset:61568
v_mul_f32 v74, s46, v74
v_mfma_f32_16x16x32_bf16 v[184:187], a[140:143], a[88:91], v[184:187]
ds_read_b64_tr_b16 a[46:47], v11 offset:63104
v_mul_f32 v75, s46, v75
v_mfma_f32_16x16x32_bf16 v[188:191], a[128:131], a[220:223], v[188:191]
ds_read_b64_tr_b16 a[48:49], v16 offset:49280
v_permlane16_swap_b32 v164, v166
v_mfma_f32_16x16x32_bf16 v[188:191], a[132:135], a[236:239], v[188:191]
buffer_load_dwordx4 v24, s[16:19], s99 offen offset:2048 nt lds
v_mfma_f32_16x16x32_bf16 v[188:191], a[136:139], a[76:79], v[188:191]
ds_read_b64_tr_b16 a[50:51], v16 offset:50816
v_permlane16_swap_b32 v165, v167
v_mfma_f32_16x16x32_bf16 v[188:191], a[140:143], a[92:95], v[188:191]
s_waitcnt lgkmcnt(15)
ds_read_b64_tr_b16 a[52:53], v16 offset:61568
v_cvt_pk_bf16_f32 v168, v168, v169
v_mfma_f32_16x16x32_bf16 v[80:83], a[0:3], a[208:211], v[80:83]
ds_read_b64_tr_b16 a[54:55], v16 offset:63104
v_cvt_pk_bf16_f32 v169, v170, v171
v_cvt_pk_bf16_f32 v170, v72, v73
v_mfma_f32_16x16x32_bf16 v[80:83], a[4:7], a[224:227], v[80:83]
v_cvt_pk_bf16_f32 v171, v74, v75
v_mul_f32 v76, s46, v76
v_mfma_f32_16x16x32_bf16 v[80:83], a[8:11], a[64:67], v[80:83]
ds_read_b64_tr_b16 a[56:57], v12 offset:49280
ds_read_b64_tr_b16 a[58:59], v12 offset:50816
v_mfma_f32_16x16x32_bf16 v[80:83], a[12:15], a[80:83], v[80:83]
ds_read_b64_tr_b16 a[60:61], v12 offset:61568
v_mul_f32 v77, s46, v77
v_mul_f32 v78, s46, v78
v_mfma_f32_16x16x32_bf16 v[84:87], a[0:3], a[212:215], v[84:87]
ds_read_b64_tr_b16 a[62:63], v12 offset:63104
v_mul_f32 v79, s46, v79
v_mfma_f32_16x16x32_bf16 v[84:87], a[4:7], a[228:231], v[84:87]
v_permlane16_swap_b32 v168, v170
v_permlane16_swap_b32 v169, v171
v_mfma_f32_16x16x32_bf16 v[84:87], a[8:11], a[68:71], v[84:87]
ds_read_b64_tr_b16 a[192:193], v17 offset:49280
v_cvt_pk_bf16_f32 v172, v172, v173
v_cvt_pk_bf16_f32 v173, v174, v175
v_mfma_f32_16x16x32_bf16 v[84:87], a[12:15], a[84:87], v[84:87]
ds_read_b64_tr_b16 a[194:195], v17 offset:50816
v_cvt_pk_bf16_f32 v174, v76, v77
v_mfma_f32_16x16x32_bf16 v[88:91], a[0:3], a[216:219], v[88:91]
s_add_u32 m0, s37, 98304
ds_read_b64_tr_b16 a[196:197], v17 offset:61568
v_cvt_pk_bf16_f32 v175, v78, v79
v_mfma_f32_16x16x32_bf16 v[88:91], a[4:7], a[232:235], v[88:91]
buffer_load_dwordx4 v25, s[20:23], s98 offen nt lds
v_mfma_f32_16x16x32_bf16 v[88:91], a[8:11], a[72:75], v[88:91]
ds_read_b64_tr_b16 a[198:199], v17 offset:63104
ds_read_b64_tr_b16 a[200:201], v13 offset:49280
v_mfma_f32_16x16x32_bf16 v[88:91], a[12:15], a[88:91], v[88:91]
ds_read_b64_tr_b16 a[202:203], v13 offset:50816
v_mul_f32 v176, s46, v176
v_mfma_f32_16x16x32_bf16 v[92:95], a[0:3], a[220:223], v[92:95]
ds_read_b64_tr_b16 a[204:205], v13 offset:61568
v_mul_f32 v177, s46, v177
v_mul_f32 v178, s46, v178
v_mfma_f32_16x16x32_bf16 v[92:95], a[4:7], a[236:239], v[92:95]
v_mul_f32 v179, s46, v179
v_mul_f32 v180, s46, v180
v_mfma_f32_16x16x32_bf16 v[92:95], a[8:11], a[76:79], v[92:95]
ds_read_b64_tr_b16 a[206:207], v13 offset:63104
v_mul_f32 v181, s46, v181
v_mfma_f32_16x16x32_bf16 v[92:95], a[12:15], a[92:95], v[92:95]
s_waitcnt lgkmcnt(15)
ds_read_b64_tr_b16 a[96:97], v14 offset:49408
v_mul_f32 v182, s46, v182
v_mul_f32 v183, s46, v183
v_mfma_f32_16x16x32_bf16 v[192:195], a[16:19], a[208:211], v[192:195]
ds_read_b64_tr_b16 a[98:99], v14 offset:50944
v_mul_f32 v184, s46, v184
v_mfma_f32_16x16x32_bf16 v[192:195], a[20:23], a[224:227], v[192:195]
v_mul_f32 v185, s46, v185
v_mul_f32 v186, s46, v186
v_mfma_f32_16x16x32_bf16 v[192:195], a[24:27], a[64:67], v[192:195]
ds_read_b64_tr_b16 a[100:101], v14 offset:61696
ds_read_b64_tr_b16 a[102:103], v14 offset:63232
v_mul_f32 v187, s46, v187
v_mfma_f32_16x16x32_bf16 v[192:195], a[28:31], a[80:83], v[192:195]
ds_read_b64_tr_b16 a[104:105], v10 offset:49408
v_mul_f32 v188, s46, v188
v_mfma_f32_16x16x32_bf16 v[196:199], a[16:19], a[212:215], v[196:199]
ds_read_b64_tr_b16 a[106:107], v10 offset:50944
v_mul_f32 v189, s46, v189
v_mfma_f32_16x16x32_bf16 v[196:199], a[20:23], a[228:231], v[196:199]
buffer_load_dwordx4 v26, s[20:23], s98 offen offset:1024 nt lds
v_mfma_f32_16x16x32_bf16 v[196:199], a[24:27], a[68:71], v[196:199]
ds_read_b64_tr_b16 a[108:109], v10 offset:61696
v_mul_f32 v190, s46, v190
v_mfma_f32_16x16x32_bf16 v[196:199], a[28:31], a[84:87], v[196:199]
ds_read_b64_tr_b16 a[110:111], v10 offset:63232
v_mul_f32 v191, s46, v191
v_mfma_f32_16x16x32_bf16 v[200:203], a[16:19], a[216:219], v[200:203]
ds_read_b64_tr_b16 a[112:113], v15 offset:49408
v_mul_f32 v80, s46, v80
v_mul_f32 v81, s46, v81
v_mfma_f32_16x16x32_bf16 v[200:203], a[20:23], a[232:235], v[200:203]
v_mul_f32 v82, s46, v82
v_mul_f32 v83, s46, v83
v_mfma_f32_16x16x32_bf16 v[200:203], a[24:27], a[72:75], v[200:203]
ds_read_b64_tr_b16 a[114:115], v15 offset:50944
v_permlane16_swap_b32 v172, v174
v_mfma_f32_16x16x32_bf16 v[200:203], a[28:31], a[88:91], v[200:203]
ds_read_b64_tr_b16 a[116:117], v15 offset:61696
ds_read_b64_tr_b16 a[118:119], v15 offset:63232
v_permlane16_swap_b32 v173, v175
v_mfma_f32_16x16x32_bf16 v[204:207], a[16:19], a[220:223], v[204:207]
ds_read_b64_tr_b16 a[120:121], v11 offset:49408
v_cvt_pk_bf16_f32 v176, v176, v177
v_mfma_f32_16x16x32_bf16 v[204:207], a[20:23], a[236:239], v[204:207]
buffer_load_dwordx4 v27, s[20:23], s98 offen offset:2048 nt lds
v_mfma_f32_16x16x32_bf16 v[204:207], a[24:27], a[76:79], v[204:207]
ds_read_b64_tr_b16 a[122:123], v11 offset:50944
v_cvt_pk_bf16_f32 v177, v178, v179
v_cvt_pk_bf16_f32 v178, v80, v81
v_mfma_f32_16x16x32_bf16 v[204:207], a[28:31], a[92:95], v[204:207]
KF_pg4:
s_cbranch_execz KF_pg8
ds_read_b64_tr_b16 a[124:125], v11 offset:61696
v_cvt_pk_bf16_f32 v179, v82, v83
v_mfma_f32_16x16x32_bf16 v[96:99], a[32:35], a[208:211], v[96:99]
ds_read_b64_tr_b16 a[126:127], v11 offset:63232
v_mul_f32 v84, s46, v84
v_mfma_f32_16x16x32_bf16 v[96:99], a[36:39], a[224:227], v[96:99]
v_mul_f32 v85, s46, v85
v_mul_f32 v86, s46, v86
v_mul_f32 v87, s46, v87
v_mfma_f32_16x16x32_bf16 v[96:99], a[40:43], a[64:67], v[96:99]
ds_read_b64_tr_b16 a[128:129], v16 offset:49408
v_permlane16_swap_b32 v176, v178
v_mfma_f32_16x16x32_bf16 v[96:99], a[44:47], a[80:83], v[96:99]
ds_read_b64_tr_b16 a[130:131], v16 offset:50944
ds_read_b64_tr_b16 a[132:133], v16 offset:61696
v_mfma_f32_16x16x32_bf16 v[100:103], a[32:35], a[212:215], v[100:103]
ds_read_b64_tr_b16 a[134:135], v16 offset:63232
v_permlane16_swap_b32 v177, v179
v_cvt_pk_bf16_f32 v180, v180, v181
v_mfma_f32_16x16x32_bf16 v[100:103], a[36:39], a[228:231], v[100:103]
v_cvt_pk_bf16_f32 v181, v182, v183
v_cvt_pk_bf16_f32 v182, v84, v85
v_mfma_f32_16x16x32_bf16 v[100:103], a[40:43], a[68:71], v[100:103]
ds_read_b64_tr_b16 a[136:137], v12 offset:49408
v_cvt_pk_bf16_f32 v183, v86, v87
v_mfma_f32_16x16x32_bf16 v[100:103], a[44:47], a[84:87], v[100:103]
ds_read_b64_tr_b16 a[138:139], v12 offset:50944
v_mul_f32 v88, s46, v88
v_mul_f32 v89, s46, v89
v_mfma_f32_16x16x32_bf16 v[104:107], a[32:35], a[216:219], v[104:107]
s_add_u32 m0, s37, 110592
ds_read_b64_tr_b16 a[140:141], v12 offset:61696
v_mul_f32 v90, s46, v90
v_mfma_f32_16x16x32_bf16 v[104:107], a[36:39], a[232:235], v[104:107]
buffer_load_dwordx4 v25, s[20:23], s99 offen nt lds
v_mfma_f32_16x16x32_bf16 v[104:107], a[40:43], a[72:75], v[104:107]
ds_read_b64_tr_b16 a[142:143], v12 offset:63232
v_mul_f32 v91, s46, v91
v_permlane16_swap_b32 v180, v182
v_mfma_f32_16x16x32_bf16 v[104:107], a[44:47], a[88:91], v[104:107]
ds_read_b64_tr_b16 a[0:1], v17 offset:49408
ds_read_b64_tr_b16 a[2:3], v17 offset:50944
v_mfma_f32_16x16x32_bf16 v[108:111], a[32:35], a[220:223], v[108:111]
ds_read_b64_tr_b16 a[4:5], v17 offset:61696
v_permlane16_swap_b32 v181, v183
v_mfma_f32_16x16x32_bf16 v[108:111], a[36:39], a[236:239], v[108:111]
v_cvt_pk_bf16_f32 v184, v184, v185
v_cvt_pk_bf16_f32 v185, v186, v187
v_cvt_pk_bf16_f32 v186, v88, v89
v_mfma_f32_16x16x32_bf16 v[108:111], a[40:43], a[76:79], v[108:111]
ds_read_b64_tr_b16 a[6:7], v17 offset:63232
v_cvt_pk_bf16_f32 v187, v90, v91
v_mfma_f32_16x16x32_bf16 v[108:111], a[44:47], a[92:95], v[108:111]
s_waitcnt lgkmcnt(15)
ds_read_b64_tr_b16 a[8:9], v13 offset:49408
v_mul_f32 v92, s46, v92
v_mfma_f32_16x16x32_bf16 v[208:211], a[48:51], a[208:211], v[208:211]
ds_read_b64_tr_b16 a[10:11], v13 offset:50944
v_mul_f32 v93, s46, v93
v_mul_f32 v94, s46, v94
v_mfma_f32_16x16x32_bf16 v[208:211], a[52:55], a[224:227], v[208:211]
v_mul_f32 v95, s46, v95
v_permlane16_swap_b32 v184, v186
v_mfma_f32_16x16x32_bf16 v[208:211], a[56:59], a[64:67], v[208:211]
ds_read_b64_tr_b16 a[12:13], v13 offset:61696
v_permlane16_swap_b32 v185, v187
v_mfma_f32_16x16x32_bf16 v[208:211], a[60:63], a[80:83], v[208:211]
ds_read_b64_tr_b16 a[14:15], v13 offset:63232
v_cvt_pk_bf16_f32 v188, v188, v189
v_cvt_pk_bf16_f32 v189, v190, v191
v_mfma_f32_16x16x32_bf16 v[212:215], a[48:51], a[212:215], v[212:215]
buffer_load_dwordx4 v26, s[20:23], s99 offen offset:1024 nt lds
v_mfma_f32_16x16x32_bf16 v[212:215], a[52:55], a[228:231], v[212:215]
v_cvt_pk_bf16_f32 v190, v92, v93
v_cvt_pk_bf16_f32 v191, v94, v95
v_mfma_f32_16x16x32_bf16 v[212:215], a[56:59], a[68:71], v[212:215]
v_mul_f32 v192, s46, v192
v_mul_f32 v193, s46, v193
v_mul_f32 v194, s46, v194
v_mfma_f32_16x16x32_bf16 v[212:215], a[60:63], a[84:87], v[212:215]
v_mul_f32 v195, s46, v195
v_mul_f32 v196, s46, v196
v_mfma_f32_16x16x32_bf16 v[216:219], a[48:51], a[216:219], v[216:219]
v_mul_f32 v197, s46, v197
v_mul_f32 v198, s46, v198
v_mfma_f32_16x16x32_bf16 v[216:219], a[52:55], a[232:235], v[216:219]
v_mul_f32 v199, s46, v199
v_mul_f32 v200, s46, v200
v_mul_f32 v201, s46, v201
v_mfma_f32_16x16x32_bf16 v[216:219], a[56:59], a[72:75], v[216:219]
v_mul_f32 v202, s46, v202
v_mul_f32 v203, s46, v203
v_mfma_f32_16x16x32_bf16 v[216:219], a[60:63], a[88:91], v[216:219]
v_mul_f32 v204, s46, v204
v_mul_f32 v205, s46, v205
v_mfma_f32_16x16x32_bf16 v[220:223], a[48:51], a[220:223], v[220:223]
s_waitcnt lgkmcnt(0)
v_mul_f32 v206, s46, v206
v_mul_f32 v207, s46, v207
v_mul_f32 v96, s46, v96
v_mfma_f32_16x16x32_bf16 v[220:223], a[52:55], a[236:239], v[220:223]
s_barrier
v_mul_f32 v97, s46, v97
v_mul_f32 v98, s46, v98
v_mfma_f32_16x16x32_bf16 v[220:223], a[56:59], a[76:79], v[220:223]
buffer_load_dwordx4 v27, s[20:23], s99 offen offset:2048 nt lds
v_mfma_f32_16x16x32_bf16 v[220:223], a[60:63], a[92:95], v[220:223]
v_mul_f32 v99, s46, v99
v_permlane16_swap_b32 v188, v190
v_permlane16_swap_b32 v189, v191
v_mfma_f32_16x16x32_bf16 v[112:115], a[192:195], a[208:211], v[112:115]
v_cvt_pk_bf16_f32 v192, v192, v193
v_cvt_pk_bf16_f32 v193, v194, v195
v_mfma_f32_16x16x32_bf16 v[112:115], a[196:199], a[224:227], v[112:115]
v_cvt_pk_bf16_f32 v194, v96, v97
v_cvt_pk_bf16_f32 v195, v98, v99
v_mfma_f32_16x16x32_bf16 v[112:115], a[200:203], a[64:67], v[112:115]
v_mul_f32 v100, s46, v100
v_mul_f32 v101, s46, v101
v_mul_f32 v102, s46, v102
v_mfma_f32_16x16x32_bf16 v[112:115], a[204:207], a[80:83], v[112:115]
v_mul_f32 v103, s46, v103
v_permlane16_swap_b32 v192, v194
v_mfma_f32_16x16x32_bf16 v[116:119], a[192:195], a[212:215], v[116:119]
v_permlane16_swap_b32 v193, v195
v_cvt_pk_bf16_f32 v196, v196, v197
v_mfma_f32_16x16x32_bf16 v[116:119], a[196:199], a[228:231], v[116:119]
v_cvt_pk_bf16_f32 v197, v198, v199
v_cvt_pk_bf16_f32 v198, v100, v101
v_cvt_pk_bf16_f32 v199, v102, v103
v_mfma_f32_16x16x32_bf16 v[116:119], a[200:203], a[68:71], v[116:119]
v_mul_f32 v104, s46, v104
v_mul_f32 v105, s46, v105
v_mfma_f32_16x16x32_bf16 v[116:119], a[204:207], a[84:87], v[116:119]
v_mul_f32 v106, s46, v106
v_mul_f32 v107, s46, v107
v_mfma_f32_16x16x32_bf16 v[120:123], a[192:195], a[216:219], v[120:123]
v_permlane16_swap_b32 v196, v198
v_permlane16_swap_b32 v197, v199
v_cvt_pk_bf16_f32 v200, v200, v201
v_mfma_f32_16x16x32_bf16 v[120:123], a[196:199], a[232:235], v[120:123]
v_cvt_pk_bf16_f32 v201, v202, v203
v_cvt_pk_bf16_f32 v202, v104, v105
v_mfma_f32_16x16x32_bf16 v[120:123], a[200:203], a[72:75], v[120:123]
s_add_u32 m0, s37, 49152
v_cvt_pk_bf16_f32 v203, v106, v107
v_mul_f32 v108, s46, v108
v_mfma_f32_16x16x32_bf16 v[120:123], a[204:207], a[88:91], v[120:123]
buffer_load_dwordx4 v22, s[16:19], s100 offen nt lds
v_mfma_f32_16x16x32_bf16 v[124:127], a[192:195], a[220:223], v[124:127]
v_mul_f32 v109, s46, v109
v_mul_f32 v110, s46, v110
v_mfma_f32_16x16x32_bf16 v[124:127], a[196:199], a[236:239], v[124:127]
v_mul_f32 v111, s46, v111
v_permlane16_swap_b32 v200, v202
v_mfma_f32_16x16x32_bf16 v[124:127], a[200:203], a[76:79], v[124:127]
v_permlane16_swap_b32 v201, v203
v_cvt_pk_bf16_f32 v204, v204, v205
v_cvt_pk_bf16_f32 v205, v206, v207
v_mfma_f32_16x16x32_bf16 v[124:127], a[204:207], a[92:95], v[124:127]
v_cvt_pk_bf16_f32 v206, v108, v109
v_cvt_pk_bf16_f32 v207, v110, v111
v_mfma_f32_16x16x32_bf16 v[224:227], a[96:99], a[208:211], v[224:227]
v_mul_f32 v208, s46, v208
v_mul_f32 v209, s46, v209
v_mfma_f32_16x16x32_bf16 v[224:227], a[100:103], a[224:227], v[224:227]
v_mul_f32 v210, s46, v210
v_mul_f32 v211, s46, v211
v_mul_f32 v212, s46, v212
v_mfma_f32_16x16x32_bf16 v[224:227], a[104:107], a[64:67], v[224:227]
v_mul_f32 v213, s46, v213
v_mul_f32 v214, s46, v214
v_mfma_f32_16x16x32_bf16 v[224:227], a[108:111], a[80:83], v[224:227]
v_mul_f32 v215, s46, v215
v_mul_f32 v216, s46, v216
v_mfma_f32_16x16x32_bf16 v[228:231], a[96:99], a[212:215], v[228:231]
v_mul_f32 v217, s46, v217
v_mul_f32 v218, s46, v218
v_mul_f32 v219, s46, v219
v_mfma_f32_16x16x32_bf16 v[228:231], a[100:103], a[228:231], v[228:231]
v_mul_f32 v220, s46, v220
v_mul_f32 v221, s46, v221
v_mfma_f32_16x16x32_bf16 v[228:231], a[104:107], a[68:71], v[228:231]
v_mul_f32 v222, s46, v222
v_mul_f32 v223, s46, v223
v_mfma_f32_16x16x32_bf16 v[228:231], a[108:111], a[84:87], v[228:231]
v_mul_f32 v112, s46, v112
v_mul_f32 v113, s46, v113
v_mul_f32 v114, s46, v114
v_mfma_f32_16x16x32_bf16 v[232:235], a[96:99], a[216:219], v[232:235]
buffer_load_dwordx4 v23, s[16:19], s100 offen offset:1024 nt lds
v_mfma_f32_16x16x32_bf16 v[232:235], a[100:103], a[232:235], v[232:235]
v_mul_f32 v115, s46, v115
v_permlane16_swap_b32 v204, v206
v_mfma_f32_16x16x32_bf16 v[232:235], a[104:107], a[72:75], v[232:235]
v_permlane16_swap_b32 v205, v207
v_cvt_pk_bf16_f32 v208, v208, v209
v_cvt_pk_bf16_f32 v209, v210, v211
v_mfma_f32_16x16x32_bf16 v[232:235], a[108:111], a[88:91], v[232:235]
v_cvt_pk_bf16_f32 v210, v112, v113
v_cvt_pk_bf16_f32 v211, v114, v115
v_mfma_f32_16x16x32_bf16 v[236:239], a[96:99], a[220:223], v[236:239]
v_mul_f32 v116, s46, v116
v_mul_f32 v117, s46, v117
v_mfma_f32_16x16x32_bf16 v[236:239], a[100:103], a[236:239], v[236:239]
v_mul_f32 v118, s46, v118
v_mul_f32 v119, s46, v119
v_permlane16_swap_b32 v208, v210
v_mfma_f32_16x16x32_bf16 v[236:239], a[104:107], a[76:79], v[236:239]
v_permlane16_swap_b32 v209, v211
v_cvt_pk_bf16_f32 v212, v212, v213
v_mfma_f32_16x16x32_bf16 v[236:239], a[108:111], a[92:95], v[236:239]
v_cvt_pk_bf16_f32 v213, v214, v215
v_cvt_pk_bf16_f32 v214, v116, v117
v_mfma_f32_16x16x32_bf16 v[128:131], a[112:115], a[208:211], v[128:131]
v_cvt_pk_bf16_f32 v215, v118, v119
v_mul_f32 v120, s46, v120
v_mul_f32 v121, s46, v121
v_mfma_f32_16x16x32_bf16 v[128:131], a[116:119], a[224:227], v[128:131]
v_mul_f32 v122, s46, v122
v_mul_f32 v123, s46, v123
v_mfma_f32_16x16x32_bf16 v[128:131], a[120:123], a[64:67], v[128:131]
v_permlane16_swap_b32 v212, v214
v_permlane16_swap_b32 v213, v215
v_mfma_f32_16x16x32_bf16 v[128:131], a[124:127], a[80:83], v[128:131]
v_cvt_pk_bf16_f32 v216, v216, v217
v_cvt_pk_bf16_f32 v217, v218, v219
v_cvt_pk_bf16_f32 v218, v120, v121
v_mfma_f32_16x16x32_bf16 v[132:135], a[112:115], a[212:215], v[132:135]
v_cvt_pk_bf16_f32 v219, v122, v123
v_mul_f32 v124, s46, v124
v_mfma_f32_16x16x32_bf16 v[132:135], a[116:119], a[228:231], v[132:135]
buffer_load_dwordx4 v24, s[16:19], s100 offen offset:2048 nt lds
v_mfma_f32_16x16x32_bf16 v[132:135], a[120:123], a[68:71], v[132:135]
v_mul_f32 v125, s46, v125
v_mul_f32 v126, s46, v126
v_mul_f32 v127, s46, v127
v_mfma_f32_16x16x32_bf16 v[132:135], a[124:127], a[84:87], v[132:135]
v_permlane16_swap_b32 v216, v218
v_permlane16_swap_b32 v217, v219
v_mfma_f32_16x16x32_bf16 v[136:139], a[112:115], a[216:219], v[136:139]
v_cvt_pk_bf16_f32 v220, v220, v221
v_cvt_pk_bf16_f32 v221, v222, v223
v_mfma_f32_16x16x32_bf16 v[136:139], a[116:119], a[232:235], v[136:139]
v_cvt_pk_bf16_f32 v222, v124, v125
v_cvt_pk_bf16_f32 v223, v126, v127
v_mul_f32 v224, s46, v224
v_mfma_f32_16x16x32_bf16 v[136:139], a[120:123], a[72:75], v[136:139]
v_mul_f32 v225, s46, v225
v_mul_f32 v226, s46, v226
v_mfma_f32_16x16x32_bf16 v[136:139], a[124:127], a[88:91], v[136:139]
v_accvgpr_read_b32 v14, a144
v_accvgpr_read_b32 v15, a145
v_mfma_f32_16x16x32_bf16 v[140:143], a[112:115], a[220:223], v[140:143]
v_mul_f32 v227, s46, v227
v_mul_f32 v228, s46, v228
v_mul_f32 v229, s46, v229
v_mfma_f32_16x16x32_bf16 v[140:143], a[116:119], a[236:239], v[140:143]
v_mul_f32 v230, s46, v230
v_mul_f32 v231, s46, v231
v_mfma_f32_16x16x32_bf16 v[140:143], a[120:123], a[76:79], v[140:143]
v_mul_f32 v232, s46, v232
v_mul_f32 v233, s46, v233
v_mfma_f32_16x16x32_bf16 v[140:143], a[124:127], a[92:95], v[140:143]
v_mul_f32 v234, s46, v234
v_mul_f32 v235, s46, v235
v_mul_f32 v236, s46, v236
v_mfma_f32_16x16x32_bf16 v[240:243], a[128:131], a[208:211], v[240:243]
v_mul_f32 v237, s46, v237
v_mul_f32 v238, s46, v238
v_mfma_f32_16x16x32_bf16 v[240:243], a[132:135], a[224:227], v[240:243]
v_mul_f32 v239, s46, v239
v_mul_f32 v128, s46, v128
v_mfma_f32_16x16x32_bf16 v[240:243], a[136:139], a[64:67], v[240:243]
s_add_u32 m0, s37, 61440
ds_read_b128 a[144:147], v8 offset:0
v_mul_f32 v129, s46, v129
v_mul_f32 v130, s46, v130
v_mfma_f32_16x16x32_bf16 v[240:243], a[140:143], a[80:83], v[240:243]
buffer_load_dwordx4 v22, s[16:19], s101 offen nt lds
v_mfma_f32_16x16x32_bf16 v[144:147], a[0:3], a[208:211], v[144:147]
ds_read_b128 a[148:151], v9 offset:0
v_mul_f32 v131, s46, v131
v_mfma_f32_16x16x32_bf16 v[144:147], a[4:7], a[224:227], v[144:147]
v_permlane16_swap_b32 v220, v222
v_permlane16_swap_b32 v221, v223
v_cvt_pk_bf16_f32 v224, v224, v225
v_mfma_f32_16x16x32_bf16 v[144:147], a[8:11], a[64:67], v[144:147]
ds_read_b128 a[152:155], v8 offset:128
v_cvt_pk_bf16_f32 v225, v226, v227
v_mfma_f32_16x16x32_bf16 v[144:147], a[12:15], a[80:83], v[144:147]
v_cvt_pk_bf16_f32 v226, v128, v129
v_cvt_pk_bf16_f32 v227, v130, v131
v_mfma_f32_16x16x32_bf16 v[244:247], a[128:131], a[212:215], v[244:247]
ds_read_b128 a[156:159], v9 offset:128
v_mul_f32 v132, s46, v132
v_mul_f32 v133, s46, v133
v_mfma_f32_16x16x32_bf16 v[244:247], a[132:135], a[228:231], v[244:247]
v_mul_f32 v134, s46, v134
v_mul_f32 v135, s46, v135
v_mfma_f32_16x16x32_bf16 v[244:247], a[136:139], a[68:71], v[244:247]
ds_read_b128 a[160:163], v8 offset:256
v_permlane16_swap_b32 v224, v226
v_mfma_f32_16x16x32_bf16 v[244:247], a[140:143], a[84:87], v[244:247]
v_permlane16_swap_b32 v225, v227
v_cvt_pk_bf16_f32 v228, v228, v229
v_cvt_pk_bf16_f32 v229, v230, v231
v_mfma_f32_16x16x32_bf16 v[148:151], a[0:3], a[212:215], v[148:151]
ds_read_b128 a[164:167], v9 offset:256
v_cvt_pk_bf16_f32 v230, v132, v133
v_mfma_f32_16x16x32_bf16 v[148:151], a[4:7], a[228:231], v[148:151]
v_cvt_pk_bf16_f32 v231, v134, v135
v_mul_f32 v136, s46, v136
v_mfma_f32_16x16x32_bf16 v[148:151], a[8:11], a[68:71], v[148:151]
ds_read_b128 a[168:171], v8 offset:1536
v_mul_f32 v137, s46, v137
v_mul_f32 v138, s46, v138
v_mfma_f32_16x16x32_bf16 v[148:151], a[12:15], a[84:87], v[148:151]
v_mul_f32 v139, s46, v139
v_permlane16_swap_b32 v228, v230
v_mfma_f32_16x16x32_bf16 v[248:251], a[128:131], a[216:219], v[248:251]
ds_read_b128 a[172:175], v9 offset:1536
v_permlane16_swap_b32 v229, v231
v_mfma_f32_16x16x32_bf16 v[248:251], a[132:135], a[232:235], v[248:251]
buffer_load_dwordx4 v23, s[16:19], s101 offen offset:1024 nt lds
v_mfma_f32_16x16x32_bf16 v[248:251], a[136:139], a[72:75], v[248:251]
ds_read_b128 a[176:179], v8 offset:1664
v_cvt_pk_bf16_f32 v232, v232, v233
v_mfma_f32_16x16x32_bf16 v[248:251], a[140:143], a[88:91], v[248:251]
v_cvt_pk_bf16_f32 v233, v234, v235
v_cvt_pk_bf16_f32 v234, v136, v137
v_mfma_f32_16x16x32_bf16 v[152:155], a[0:3], a[216:219], v[152:155]
ds_read_b128 a[180:183], v9 offset:1664
v_cvt_pk_bf16_f32 v235, v138, v139
v_mul_f32 v140, s46, v140
v_mfma_f32_16x16x32_bf16 v[152:155], a[4:7], a[232:235], v[152:155]
v_mul_f32 v141, s46, v141
v_mul_f32 v142, s46, v142
v_mfma_f32_16x16x32_bf16 v[152:155], a[8:11], a[72:75], v[152:155]
ds_read_b128 a[184:187], v8 offset:1792
v_mul_f32 v143, s46, v143
v_mfma_f32_16x16x32_bf16 v[152:155], a[12:15], a[88:91], v[152:155]
v_permlane16_swap_b32 v232, v234
v_permlane16_swap_b32 v233, v235
v_cvt_pk_bf16_f32 v236, v236, v237
v_mfma_f32_16x16x32_bf16 v[252:255], a[128:131], a[220:223], v[252:255]
ds_read_b128 a[188:191], v9 offset:1792
v_cvt_pk_bf16_f32 v237, v238, v239
v_mfma_f32_16x16x32_bf16 v[252:255], a[132:135], a[236:239], v[252:255]
v_cvt_pk_bf16_f32 v238, v140, v141
v_cvt_pk_bf16_f32 v239, v142, v143
v_mfma_f32_16x16x32_bf16 v[252:255], a[136:139], a[76:79], v[252:255]
v_mul_f32 v240, s46, v240
v_mul_f32 v241, s46, v241
v_mul_f32 v242, s46, v242
v_mfma_f32_16x16x32_bf16 v[252:255], a[140:143], a[92:95], v[252:255]
v_mul_f32 v243, s46, v243
v_mul_f32 v144, s46, v144
v_mfma_f32_16x16x32_bf16 v[156:159], a[0:3], a[220:223], v[156:159]
v_mul_f32 v145, s46, v145
v_mul_f32 v146, s46, v146
v_mfma_f32_16x16x32_bf16 v[156:159], a[4:7], a[236:239], v[156:159]
buffer_load_dwordx4 v24, s[16:19], s101 offen offset:2048 nt lds
v_mfma_f32_16x16x32_bf16 v[156:159], a[8:11], a[76:79], v[156:159]
v_mul_f32 v147, s46, v147
v_permlane16_swap_b32 v236, v238
v_mfma_f32_16x16x32_bf16 v[156:159], a[12:15], a[92:95], v[156:159]
s_waitcnt lgkmcnt(6)
v_permlane16_swap_b32 v237, v239
v_cvt_pk_bf16_f32 v240, v240, v241
v_mfma_f32_16x16x32_bf16 v[64:67], a[144:147], v[160:163], 0
v_cvt_pk_bf16_f32 v241, v242, v243
v_cvt_pk_bf16_f32 v242, v144, v145
v_cvt_pk_bf16_f32 v243, v146, v147
v_mfma_f32_16x16x32_bf16 v[64:67], a[148:151], v[176:179], v[64:67]
v_permlane16_swap_b32 v240, v242
v_permlane16_swap_b32 v241, v243
v_mfma_f32_16x16x32_bf16 v[64:67], a[152:155], v[192:195], v[64:67]
v_mul_f32 v244, s46, v244
v_mul_f32 v245, s46, v245
v_mfma_f32_16x16x32_bf16 v[64:67], a[156:159], v[208:211], v[64:67]
v_mul_f32 v246, s46, v246
v_mul_f32 v247, s46, v247
v_mul_f32 v148, s46, v148
v_mfma_f32_16x16x32_bf16 v[64:67], a[160:163], v[224:227], v[64:67]
ds_read_b128 a[192:195], v8 offset:12288
v_mul_f32 v149, s46, v149
v_mfma_f32_16x16x32_bf16 v[64:67], a[164:167], v[240:243], v[64:67]
s_waitcnt lgkmcnt(1)
v_mul_f32 v150, s46, v150
v_mul_f32 v151, s46, v151
v_mfma_f32_16x16x32_bf16 v[80:83], a[168:171], v[160:163], 0
v_cvt_pk_bf16_f32 v244, v244, v245
v_cvt_pk_bf16_f32 v245, v246, v247
v_cvt_pk_bf16_f32 v246, v148, v149
v_mfma_f32_16x16x32_bf16 v[80:83], a[172:175], v[176:179], v[80:83]
ds_read_b128 a[196:199], v9 offset:12288
v_cvt_pk_bf16_f32 v247, v150, v151
v_mfma_f32_16x16x32_bf16 v[80:83], a[176:179], v[192:195], v[80:83]
v_permlane16_swap_b32 v244, v246
v_permlane16_swap_b32 v245, v247
v_mfma_f32_16x16x32_bf16 v[80:83], a[180:183], v[208:211], v[80:83]
v_mul_f32 v248, s46, v248
v_mul_f32 v249, s46, v249
v_mul_f32 v250, s46, v250
v_mfma_f32_16x16x32_bf16 v[80:83], a[184:187], v[224:227], v[80:83]
s_add_u32 m0, s37, 122880
ds_read_b128 a[200:203], v8 offset:12416
v_mul_f32 v251, s46, v251
v_mul_f32 v152, s46, v152
v_mfma_f32_16x16x32_bf16 v[80:83], a[188:191], v[240:243], v[80:83]
buffer_load_dwordx4 v25, s[20:23], s100 offen nt lds
v_mfma_f32_16x16x32_bf16 v[68:71], a[144:147], v[164:167], 0
v_mul_f32 v153, s46, v153
v_mul_f32 v154, s46, v154
v_mul_f32 v155, s46, v155
v_mfma_f32_16x16x32_bf16 v[68:71], a[148:151], v[180:183], v[68:71]
ds_read_b128 a[204:207], v9 offset:12416
v_cvt_pk_bf16_f32 v248, v248, v249
v_cvt_pk_bf16_f32 v249, v250, v251
v_mfma_f32_16x16x32_bf16 v[68:71], a[152:155], v[196:199], v[68:71]
v_cvt_pk_bf16_f32 v250, v152, v153
v_cvt_pk_bf16_f32 v251, v154, v155
s_nop 0
v_permlane16_swap_b32 v248, v250
v_mfma_f32_16x16x32_bf16 v[68:71], a[156:159], v[212:215], v[68:71]
v_permlane16_swap_b32 v249, v251
v_mul_f32 v252, s46, v252
v_mul_f32 v253, s46, v253
v_mfma_f32_16x16x32_bf16 v[68:71], a[160:163], v[228:231], v[68:71]
ds_read_b128 a[208:211], v8 offset:12544
v_mul_f32 v254, s46, v254
v_mul_f32 v255, s46, v255
v_mfma_f32_16x16x32_bf16 v[68:71], a[164:167], v[244:247], v[68:71]
v_mul_f32 v156, s46, v156
v_mul_f32 v157, s46, v157
v_mul_f32 v158, s46, v158
v_mfma_f32_16x16x32_bf16 v[84:87], a[168:171], v[164:167], 0
v_mul_f32 v159, s46, v159
v_cvt_pk_bf16_f32 v252, v252, v253
v_cvt_pk_bf16_f32 v253, v254, v255
v_mfma_f32_16x16x32_bf16 v[84:87], a[172:175], v[180:183], v[84:87]
s_waitcnt vmcnt(22)
ds_read_b128 a[212:215], v9 offset:12544
v_cvt_pk_bf16_f32 v254, v156, v157
v_cvt_pk_bf16_f32 v255, v158, v159
v_mfma_f32_16x16x32_bf16 v[84:87], a[176:179], v[196:199], v[84:87]
s_barrier
v_permlane16_swap_b32 v252, v254
v_permlane16_swap_b32 v253, v255
v_max3_f32 v1, v64, v65, v66
v_mfma_f32_16x16x32_bf16 v[84:87], a[180:183], v[212:215], v[84:87]
v_max3_f32 v1, v1, v67, v80
v_max3_f32 v1, v1, v81, v82
v_max_f32 v1, v1, v83
v_mfma_f32_16x16x32_bf16 v[84:87], a[184:187], v[228:231], v[84:87]
v_mov_b32 v144, v1
s_nop 1
v_permlane32_swap_b32 v144, v1
v_max_f32 v1, v1, v144
v_mfma_f32_16x16x32_bf16 v[84:87], a[188:191], v[244:247], v[84:87]
v_mov_b32 v144, v1
s_nop 1
v_permlane16_swap_b32 v144, v1
v_max_f32 v1, v1, v144
v_mfma_f32_16x16x32_bf16 v[72:75], a[144:147], v[168:171], 0
buffer_load_dwordx4 v26, s[20:23], s100 offen offset:1024 nt lds
v_mfma_f32_16x16x32_bf16 v[72:75], a[148:151], v[184:187], v[72:75]
v_sub_f32 v128, 0, v1
v_sub_f32 v129, 0, v1
v_sub_f32 v130, 0, v1
v_mfma_f32_16x16x32_bf16 v[72:75], a[152:155], v[200:203], v[72:75]
v_sub_f32 v131, 0, v1
v_sub_f32 v152, v64, v1
v_sub_f32 v153, v65, v1
v_mfma_f32_16x16x32_bf16 v[72:75], a[156:159], v[216:219], v[72:75]
v_sub_f32 v154, v66, v1
v_sub_f32 v155, v67, v1
v_sub_f32 v156, v80, v1
v_mfma_f32_16x16x32_bf16 v[72:75], a[160:163], v[232:235], v[72:75]
v_sub_f32 v157, v81, v1
v_sub_f32 v158, v82, v1
v_sub_f32 v159, v83, v1
v_mfma_f32_16x16x32_bf16 v[72:75], a[164:167], v[248:251], v[72:75]
v_mov_b32 v148, 0
v_exp_f32 v152, v152
v_mfma_f32_16x16x32_bf16 v[88:91], a[168:171], v[168:171], 0
v_exp_f32 v153, v153
v_mfma_f32_16x16x32_bf16 v[88:91], a[172:175], v[184:187], v[88:91]
v_exp_f32 v154, v154
v_cvt_pk_bf16_f32 v96, v152, v153
v_mfma_f32_16x16x32_bf16 v[88:91], a[176:179], v[200:203], v[88:91]
v_exp_f32 v155, v155
v_max3_f32 v2, v68, v69, v70
v_mfma_f32_16x16x32_bf16 v[88:91], a[180:183], v[216:219], v[88:91]
v_cvt_pk_bf16_f32 v97, v154, v155
v_max3_f32 v2, v2, v71, v84
v_max3_f32 v2, v2, v85, v86
v_mfma_f32_16x16x32_bf16 v[88:91], a[184:187], v[232:235], v[88:91]
v_max_f32 v2, v2, v87
v_mov_b32 v144, v2
s_nop 1
v_permlane32_swap_b32 v144, v2
v_mfma_f32_16x16x32_bf16 v[88:91], a[188:191], v[248:251], v[88:91]
v_max_f32 v2, v2, v144
v_mov_b32 v144, v2
s_nop 1
v_permlane16_swap_b32 v144, v2
v_mfma_f32_16x16x32_bf16 v[76:79], a[144:147], v[172:175], 0
buffer_load_dwordx4 v27, s[20:23], s100 offen offset:2048 nt lds
v_mfma_f32_16x16x32_bf16 v[76:79], a[148:151], v[188:191], v[76:79]
v_max_f32 v2, v2, v144
v_sub_f32 v132, 0, v2
v_sub_f32 v133, 0, v2
v_mfma_f32_16x16x32_bf16 v[76:79], a[152:155], v[204:207], v[76:79]
v_sub_f32 v134, 0, v2
v_sub_f32 v135, 0, v2
v_sub_f32 v40, v68, v2
v_mfma_f32_16x16x32_bf16 v[76:79], a[156:159], v[220:223], v[76:79]
v_sub_f32 v41, v69, v2
v_sub_f32 v42, v70, v2
v_sub_f32 v43, v71, v2
v_mfma_f32_16x16x32_bf16 v[76:79], a[160:163], v[236:239], v[76:79]
v_sub_f32 v44, v84, v2
v_sub_f32 v45, v85, v2
v_sub_f32 v46, v86, v2
v_mfma_f32_16x16x32_bf16 v[76:79], a[164:167], v[252:255], v[76:79]
v_sub_f32 v47, v87, v2
v_mov_b32 v149, 0
v_max3_f32 v3, v72, v73, v74
v_mfma_f32_16x16x32_bf16 v[92:95], a[168:171], v[172:175], 0
v_max3_f32 v3, v3, v75, v88
v_max3_f32 v3, v3, v89, v90
v_max_f32 v3, v3, v91
v_mfma_f32_16x16x32_bf16 v[92:95], a[172:175], v[188:191], v[92:95]
v_mov_b32 v144, v3
s_nop 1
v_permlane32_swap_b32 v144, v3
v_max_f32 v3, v3, v144
v_mfma_f32_16x16x32_bf16 v[92:95], a[176:179], v[204:207], v[92:95]
v_mov_b32 v144, v3
s_nop 1
v_permlane16_swap_b32 v144, v3
v_max_f32 v3, v3, v144
v_mfma_f32_16x16x32_bf16 v[92:95], a[180:183], v[220:223], v[92:95]
v_sub_f32 v136, 0, v3
v_sub_f32 v137, 0, v3
v_sub_f32 v138, 0, v3
v_mfma_f32_16x16x32_bf16 v[92:95], a[184:187], v[236:239], v[92:95]
v_sub_f32 v139, 0, v3
v_sub_f32 v48, v72, v3
v_sub_f32 v49, v73, v3
v_mfma_f32_16x16x32_bf16 v[92:95], a[188:191], v[252:255], v[92:95]
s_waitcnt lgkmcnt(3)
v_sub_f32 v50, v74, v3
v_sub_f32 v51, v75, v3
v_sub_f32 v52, v88, v3
v_mfma_f32_16x16x32_bf16 v[64:67], a[192:195], v[160:163], v[128:131]
ds_read_b128 a[216:219], v8 offset:13824
v_sub_f32 v53, v89, v3
v_sub_f32 v54, v90, v3
v_mfma_f32_16x16x32_bf16 v[64:67], a[196:199], v[176:179], v[64:67]
s_add_u32 m0, s37, 0
v_sub_f32 v55, v91, v3
v_mov_b32 v150, 0
v_mfma_f32_16x16x32_bf16 v[64:67], a[200:203], v[192:195], v[64:67]
s_waitcnt lgkmcnt(1)
ds_read_b128 a[220:223], v9 offset:13824
v_exp_f32 v156, v156
v_mfma_f32_16x16x32_bf16 v[64:67], a[204:207], v[208:211], v[64:67]
buffer_load_dwordx4 v22, s[16:19], s0 offen nt lds
v_mfma_f32_16x16x32_bf16 v[64:67], a[208:211], v[224:227], v[64:67]
ds_read_b128 a[224:227], v8 offset:13952
v_exp_f32 v157, v157
v_mfma_f32_16x16x32_bf16 v[64:67], a[212:215], v[240:243], v[64:67]
v_exp_f32 v158, v158
v_cvt_pk_bf16_f32 v98, v156, v157
v_mfma_f32_16x16x32_bf16 v[68:71], a[192:195], v[164:167], v[132:135]
ds_read_b128 a[228:231], v9 offset:13952
v_exp_f32 v159, v159
v_mfma_f32_16x16x32_bf16 v[68:71], a[196:199], v[180:183], v[68:71]
v_max3_f32 v4, v76, v77, v78
v_cvt_pk_bf16_f32 v99, v158, v159
v_max3_f32 v4, v4, v79, v92
v_mfma_f32_16x16x32_bf16 v[68:71], a[200:203], v[196:199], v[68:71]
ds_read_b128 a[232:235], v8 offset:14080
v_max3_f32 v4, v4, v93, v94
v_max_f32 v4, v4, v95
v_mfma_f32_16x16x32_bf16 v[68:71], a[204:207], v[212:215], v[68:71]
v_mov_b32 v144, v4
s_nop 1
v_permlane32_swap_b32 v144, v4
v_max_f32 v4, v4, v144
v_mfma_f32_16x16x32_bf16 v[68:71], a[208:211], v[228:231], v[68:71]
ds_read_b128 a[236:239], v9 offset:14080
v_mov_b32 v144, v4
s_nop 1
v_permlane16_swap_b32 v144, v4
v_mfma_f32_16x16x32_bf16 v[68:71], a[212:215], v[244:247], v[68:71]
v_max_f32 v4, v4, v144
v_subrev_f32 v4, s50, v4
v_sub_f32 v140, 0, v4
v_mfma_f32_16x16x32_bf16 v[72:75], a[192:195], v[168:171], v[136:139]
v_sub_f32 v141, 0, v4
v_sub_f32 v142, 0, v4
v_sub_f32 v143, 0, v4
v_mfma_f32_16x16x32_bf16 v[72:75], a[196:199], v[184:187], v[72:75]
v_sub_f32 v56, v76, v4
v_sub_f32 v57, v77, v4
v_sub_f32 v58, v78, v4
v_mfma_f32_16x16x32_bf16 v[72:75], a[200:203], v[200:203], v[72:75]
v_sub_f32 v59, v79, v4
v_sub_f32 v60, v92, v4
v_sub_f32 v61, v93, v4
v_mfma_f32_16x16x32_bf16 v[72:75], a[204:207], v[216:219], v[72:75]
v_sub_f32 v62, v94, v4
v_sub_f32 v63, v95, v4
v_sub_f32 v151, 0, s50
v_mfma_f32_16x16x32_bf16 v[72:75], a[208:211], v[232:235], v[72:75]
buffer_load_dwordx4 v23, s[16:19], s0 offen offset:1024 nt lds
v_mfma_f32_16x16x32_bf16 v[72:75], a[212:215], v[248:251], v[72:75]
v_exp_f32 v40, v40
v_mfma_f32_16x16x32_bf16 v[76:79], a[192:195], v[172:175], v[140:143]
v_exp_f32 v41, v41
v_mfma_f32_16x16x32_bf16 v[76:79], a[196:199], v[188:191], v[76:79]
v_exp_f32 v42, v42
v_cvt_pk_bf16_f32 v100, v40, v41
v_mfma_f32_16x16x32_bf16 v[76:79], a[200:203], v[204:207], v[76:79]
v_exp_f32 v43, v43
v_mfma_f32_16x16x32_bf16 v[76:79], a[204:207], v[220:223], v[76:79]
v_exp_f32 v44, v44
v_cvt_pk_bf16_f32 v101, v42, v43
v_mfma_f32_16x16x32_bf16 v[76:79], a[208:211], v[236:239], v[76:79]
v_exp_f32 v45, v45
v_mfma_f32_16x16x32_bf16 v[76:79], a[212:215], v[252:255], v[76:79]
s_waitcnt lgkmcnt(3)
v_exp_f32 v46, v46
v_cvt_pk_bf16_f32 v102, v44, v45
v_mfma_f32_16x16x32_bf16 v[80:83], a[216:219], v[160:163], v[128:131]
v_exp_f32 v47, v47
v_mfma_f32_16x16x32_bf16 v[80:83], a[220:223], v[176:179], v[80:83]
v_exp_f32 v48, v48
v_cvt_pk_bf16_f32 v103, v46, v47
v_mfma_f32_16x16x32_bf16 v[80:83], a[224:227], v[192:195], v[80:83]
s_waitcnt lgkmcnt(0)
v_exp_f32 v49, v49
v_mfma_f32_16x16x32_bf16 v[80:83], a[228:231], v[208:211], v[80:83]
v_exp_f32 v50, v50
v_cvt_pk_bf16_f32 v104, v48, v49
v_mfma_f32_16x16x32_bf16 v[80:83], a[232:235], v[224:227], v[80:83]
buffer_load_dwordx4 v24, s[16:19], s0 offen offset:2048 nt lds
v_mfma_f32_16x16x32_bf16 v[80:83], a[236:239], v[240:243], v[80:83]
v_exp_f32 v51, v51
v_mfma_f32_16x16x32_bf16 v[84:87], a[216:219], v[164:167], v[132:135]
v_exp_f32 v52, v52
v_cvt_pk_bf16_f32 v105, v50, v51
v_mfma_f32_16x16x32_bf16 v[84:87], a[220:223], v[180:183], v[84:87]
v_exp_f32 v53, v53
v_mfma_f32_16x16x32_bf16 v[84:87], a[224:227], v[196:199], v[84:87]
v_exp_f32 v54, v54
v_cvt_pk_bf16_f32 v106, v52, v53
v_mfma_f32_16x16x32_bf16 v[84:87], a[228:231], v[212:215], v[84:87]
KF_pg5:
s_cbranch_execz KF_pg9
v_exp_f32 v55, v55
v_mfma_f32_16x16x32_bf16 v[84:87], a[232:235], v[228:231], v[84:87]
ds_read_b64_tr_b16 v[40:41], v10 offset:0
v_exp_f32 v56, v56
v_mfma_f32_16x16x32_bf16 v[84:87], a[236:239], v[244:247], v[84:87]
v_cvt_pk_bf16_f32 v107, v54, v55
v_exp_f32 v57, v57
v_mfma_f32_16x16x32_bf16 v[88:91], a[216:219], v[168:171], v[136:139]
ds_read_b64_tr_b16 v[42:43], v10 offset:1536
v_exp_f32 v58, v58
v_mfma_f32_16x16x32_bf16 v[88:91], a[220:223], v[184:187], v[88:91]
v_cvt_pk_bf16_f32 v108, v56, v57
v_exp_f32 v59, v59
v_mfma_f32_16x16x32_bf16 v[88:91], a[224:227], v[200:203], v[88:91]
ds_read_b64_tr_b16 v[44:45], v11 offset:0
v_exp_f32 v60, v60
v_mfma_f32_16x16x32_bf16 v[88:91], a[228:231], v[216:219], v[88:91]
v_cvt_pk_bf16_f32 v109, v58, v59
v_exp_f32 v61, v61
v_mfma_f32_16x16x32_bf16 v[88:91], a[232:235], v[232:235], v[88:91]
s_add_u32 m0, s37, 135168
ds_read_b64_tr_b16 v[46:47], v11 offset:1536
v_exp_f32 v62, v62
v_mfma_f32_16x16x32_bf16 v[88:91], a[236:239], v[248:251], v[88:91]
buffer_load_dwordx4 v25, s[20:23], s101 offen nt lds
v_mfma_f32_16x16x32_bf16 v[92:95], a[216:219], v[172:175], v[140:143]
v_cvt_pk_bf16_f32 v110, v60, v61
v_exp_f32 v63, v63
v_mfma_f32_16x16x32_bf16 v[92:95], a[220:223], v[188:191], v[92:95]
v_exp_f32 v152, v64
v_cvt_pk_bf16_f32 v111, v62, v63
v_mfma_f32_16x16x32_bf16 v[92:95], a[224:227], v[204:207], v[92:95]
ds_read_b64_tr_b16 v[48:49], v12 offset:0
v_exp_f32 v153, v65
v_mfma_f32_16x16x32_bf16 v[92:95], a[228:231], v[220:223], v[92:95]
v_exp_f32 v154, v66
v_cvt_pk_bf16_f32 v112, v152, v153
v_mfma_f32_16x16x32_bf16 v[92:95], a[232:235], v[236:239], v[92:95]
ds_read_b64_tr_b16 v[50:51], v12 offset:1536
v_exp_f32 v155, v67
v_mfma_f32_16x16x32_bf16 v[92:95], a[236:239], v[252:255], v[92:95]
s_waitcnt lgkmcnt(4)
v_exp_f32 v156, v68
v_cvt_pk_bf16_f32 v113, v154, v155
v_mfma_f32_16x16x32_bf16 a[0:3], v[40:43], v[96:99], 0
ds_read_b64_tr_b16 v[52:53], v13 offset:0
v_exp_f32 v157, v69
v_mfma_f32_16x16x32_bf16 a[4:7], v[40:43], v[100:103], 0
v_exp_f32 v158, v70
v_cvt_pk_bf16_f32 v116, v156, v157
v_mfma_f32_16x16x32_bf16 a[8:11], v[40:43], v[104:107], 0
ds_read_b64_tr_b16 v[54:55], v13 offset:1536
v_exp_f32 v159, v71
v_mfma_f32_16x16x32_bf16 a[12:15], v[40:43], v[108:111], 0
s_waitcnt lgkmcnt(4)
v_exp_f32 v152, v72
v_cvt_pk_bf16_f32 v117, v158, v159
v_mfma_f32_16x16x32_bf16 a[16:19], v[44:47], v[96:99], 0
v_exp_f32 v153, v73
v_mfma_f32_16x16x32_bf16 a[20:23], v[44:47], v[100:103], 0
v_exp_f32 v154, v74
v_cvt_pk_bf16_f32 v120, v152, v153
v_mfma_f32_16x16x32_bf16 a[24:27], v[44:47], v[104:107], 0
ds_read_b64_tr_b16 v[56:57], v10 offset:128
v_exp_f32 v155, v75
v_mfma_f32_16x16x32_bf16 a[28:31], v[44:47], v[108:111], 0
s_waitcnt lgkmcnt(3)
v_exp_f32 v156, v76
v_cvt_pk_bf16_f32 v121, v154, v155
v_mfma_f32_16x16x32_bf16 a[32:35], v[48:51], v[96:99], 0
ds_read_b64_tr_b16 v[58:59], v10 offset:1664
v_exp_f32 v157, v77
v_mfma_f32_16x16x32_bf16 a[36:39], v[48:51], v[100:103], 0
buffer_load_dwordx4 v26, s[20:23], s101 offen offset:1024 nt lds
v_mfma_f32_16x16x32_bf16 a[40:43], v[48:51], v[104:107], 0
ds_read_b64_tr_b16 v[60:61], v11 offset:128
v_exp_f32 v158, v78
v_mfma_f32_16x16x32_bf16 a[44:47], v[48:51], v[108:111], 0
v_cvt_pk_bf16_f32 v124, v156, v157
v_exp_f32 v159, v79
v_mfma_f32_16x16x32_bf16 v[144:147], a[240:243], v[96:99], v[148:151]
ds_read_b64_tr_b16 v[62:63], v11 offset:1664
v_exp_f32 v152, v80
v_mfma_f32_16x16x32_bf16 v[144:147], a[244:247], v[100:103], v[144:147]
ds_read_b64_tr_b16 v[40:41], v12 offset:128
v_cvt_pk_bf16_f32 v125, v158, v159
v_mfma_f32_16x16x32_bf16 v[144:147], a[248:251], v[104:107], v[144:147]
v_exp_f32 v153, v81
v_mfma_f32_16x16x32_bf16 v[144:147], a[252:255], v[108:111], v[144:147]
s_waitcnt lgkmcnt(5)
ds_read_b64_tr_b16 v[42:43], v12 offset:1664
v_exp_f32 v154, v82
v_mfma_f32_16x16x32_bf16 a[48:51], v[52:55], v[96:99], 0
v_cvt_pk_bf16_f32 v114, v152, v153
v_exp_f32 v155, v83
v_mfma_f32_16x16x32_bf16 a[52:55], v[52:55], v[100:103], 0
ds_read_b64_tr_b16 v[44:45], v13 offset:128
v_exp_f32 v156, v84
v_mfma_f32_16x16x32_bf16 a[56:59], v[52:55], v[104:107], 0
ds_read_b64_tr_b16 v[46:47], v13 offset:1664
v_cvt_pk_bf16_f32 v115, v154, v155
v_mfma_f32_16x16x32_bf16 a[60:63], v[52:55], v[108:111], 0
s_waitcnt lgkmcnt(6)
v_exp_f32 v157, v85
v_mfma_f32_16x16x32_bf16 a[64:67], v[56:59], v[96:99], 0
ds_read_b64_tr_b16 v[48:49], v10 offset:256
v_exp_f32 v158, v86
v_mfma_f32_16x16x32_bf16 a[68:71], v[56:59], v[100:103], 0
ds_read_b64_tr_b16 v[50:51], v10 offset:1792
v_cvt_pk_bf16_f32 v118, v156, v157
v_mfma_f32_16x16x32_bf16 a[72:75], v[56:59], v[104:107], 0
buffer_load_dwordx4 v27, s[20:23], s101 offen offset:2048 nt lds
v_mfma_f32_16x16x32_bf16 a[76:79], v[56:59], v[108:111], 0
s_waitcnt lgkmcnt(6)
ds_read_b64_tr_b16 v[52:53], v11 offset:256
v_exp_f32 v159, v87
v_mfma_f32_16x16x32_bf16 a[80:83], v[60:63], v[96:99], 0
s_add_u32 s4, s4, 1
ds_read_b64_tr_b16 v[54:55], v11 offset:1792
v_exp_f32 v152, v88
v_mfma_f32_16x16x32_bf16 a[84:87], v[60:63], v[100:103], 0
s_bitcmp0_b32 s5, s4
v_cvt_pk_bf16_f32 v119, v158, v159
v_exp_f32 v153, v89
v_mfma_f32_16x16x32_bf16 a[88:91], v[60:63], v[104:107], 0
s_cselect_b32 s28, s6, 73728
ds_read_b64_tr_b16 v[56:57], v12 offset:256
v_exp_f32 v154, v90
v_mfma_f32_16x16x32_bf16 a[92:95], v[60:63], v[108:111], 0
s_waitcnt lgkmcnt(7)
ds_read_b64_tr_b16 v[58:59], v12 offset:1792
v_cvt_pk_bf16_f32 v122, v152, v153
v_mfma_f32_16x16x32_bf16 a[96:99], v[40:43], v[96:99], 0
s_cselect_b32 s30, 12288, 0
v_exp_f32 v155, v91
v_mfma_f32_16x16x32_bf16 a[100:103], v[40:43], v[100:103], 0
s_cselect_b32 s53, s42, 1073741824
ds_read_b64_tr_b16 v[60:61], v13 offset:256
v_exp_f32 v156, v92
v_mfma_f32_16x16x32_bf16 a[104:107], v[40:43], v[104:107], 0
s_addc_u32 s1, s1, 0
ds_read_b64_tr_b16 v[62:63], v13 offset:1792
v_cvt_pk_bf16_f32 v123, v154, v155
v_mfma_f32_16x16x32_bf16 a[108:111], v[40:43], v[108:111], 0
s_waitcnt lgkmcnt(8)
v_exp_f32 v157, v93
v_mfma_f32_16x16x32_bf16 a[112:115], v[44:47], v[96:99], 0
s_cmp_eq_u32 s1, 30
v_exp_f32 v158, v94
v_cvt_pk_bf16_f32 v126, v156, v157
v_mfma_f32_16x16x32_bf16 a[116:119], v[44:47], v[100:103], 0
s_cselect_b32 s1, 0, s1
v_exp_f32 v159, v95
s_nop 0
v_cvt_pk_bf16_f32 v127, v158, v159
v_mfma_f32_16x16x32_bf16 a[120:123], v[44:47], v[104:107], 0
s_cmp_ge_u32 s1, 10
v_mfma_f32_16x16x32_bf16 a[124:127], v[44:47], v[108:111], 0
s_waitcnt lgkmcnt(6)
v_mfma_f32_16x16x32_bf16 a[128:131], v[48:51], v[96:99], 0
s_cselect_b32 s3, s52, 0
v_mfma_f32_16x16x32_bf16 a[132:135], v[48:51], v[100:103], 0
s_cmp_ge_u32 s1, 20
v_mfma_f32_16x16x32_bf16 a[136:139], v[48:51], v[104:107], 0
s_cselect_b32 s3, s45, s3
v_mfma_f32_16x16x32_bf16 a[140:143], v[48:51], v[108:111], 0
s_waitcnt vmcnt(24) lgkmcnt(0)
v_mfma_f32_16x16x32_bf16 v[148:151], a[240:243], v[112:115], v[144:147]
s_barrier
v_mfma_f32_16x16x32_bf16 v[148:151], a[244:247], v[116:119], v[148:151]
s_mul_i32 s42, s1, 3072
ds_read_b128 a[192:195], v8 offset:24576
v_mfma_f32_16x16x32_bf16 v[148:151], a[248:251], v[120:123], v[148:151]
s_add_u32 s42, s42, s3
ds_read_b128 a[196:199], v9 offset:24576
v_mfma_f32_16x16x32_bf16 v[148:151], a[252:255], v[124:127], v[148:151]
s_add_u32 s6, s6, s30
ds_read_b128 a[200:203], v8 offset:24704
v_mfma_f32_16x16x32_bf16 a[144:147], v[52:55], v[96:99], 0
s_cmp_eq_u32 s6, 73728
ds_read_b128 a[204:207], v9 offset:24704
v_mfma_f32_16x16x32_bf16 a[148:151], v[52:55], v[100:103], 0
s_cselect_b32 s6, 0, s6
ds_read_b128 a[208:211], v8 offset:24832
v_mfma_f32_16x16x32_bf16 a[152:155], v[52:55], v[104:107], 0
s_cmp_eq_u32 s30, 0
ds_read_b128 a[212:215], v9 offset:24832
v_mfma_f32_16x16x32_bf16 a[156:159], v[52:55], v[108:111], 0
s_cselect_b32 s7, 147456, s6
v_mfma_f32_16x16x32_bf16 a[160:163], v[56:59], v[96:99], 0
s_cselect_b32 s29, 1073741824, s42
v_mfma_f32_16x16x32_bf16 a[164:167], v[56:59], v[100:103], 0
v_mfma_f32_16x16x32_bf16 a[168:171], v[56:59], v[104:107], 0
v_mfma_f32_16x16x32_bf16 a[172:175], v[56:59], v[108:111], 0
v_mfma_f32_16x16x32_bf16 a[176:179], v[60:63], v[96:99], 0
v_max3_f32 v1, v148, v149, v150
v_max_f32 v1, v1, v151
v_mfma_f32_16x16x32_bf16 a[180:183], v[60:63], v[100:103], 0
v_cmp_nge_f32 vcc, s44, v1
v_mfma_f32_16x16x32_bf16 a[184:187], v[60:63], v[104:107], 0
s_waitcnt lgkmcnt(3)
v_mfma_f32_16x16x32_bf16 a[188:191], v[60:63], v[108:111], 0
s_cbranch_vccnz KF_fxp0
KF_bkp0:
s_mov_b32 s43, 4
KF_loop:
v_mfma_f32_16x16x32_bf16 v[64:67], a[192:195], v[160:163], v[128:131]
s_add_u32 m0, s37, s7
ds_read_b128 a[216:219], v8 offset:26112
v_mfma_f32_16x16x32_bf16 v[64:67], a[196:199], v[176:179], v[64:67]
ds_read_b128 a[220:223], v9 offset:26112
v_mfma_f32_16x16x32_bf16 v[64:67], a[200:203], v[192:195], v[64:67]
s_waitcnt lgkmcnt(2)
ds_read_b128 a[224:227], v8 offset:26240
v_mfma_f32_16x16x32_bf16 v[64:67], a[204:207], v[208:211], v[64:67]
ds_read_b128 a[228:231], v9 offset:26240
v_mfma_f32_16x16x32_bf16 v[64:67], a[208:211], v[224:227], v[64:67]
buffer_load_dwordx4 v22, s[16:19], s29 offen nt lds
v_mfma_f32_16x16x32_bf16 v[64:67], a[212:215], v[240:243], v[64:67]
ds_read_b128 a[232:235], v8 offset:26368
ds_read_b128 a[236:239], v9 offset:26368
v_mfma_f32_16x16x32_bf16 v[68:71], a[192:195], v[164:167], v[132:135]
buffer_load_dwordx4 v23, s[16:19], s29 offen offset:1024 nt lds
v_mfma_f32_16x16x32_bf16 v[68:71], a[196:199], v[180:183], v[68:71]
ds_read_b64_tr_b16 v[40:41], v10 offset:12288
v_mfma_f32_16x16x32_bf16 v[68:71], a[200:203], v[196:199], v[68:71]
buffer_load_dwordx4 v24, s[16:19], s29 offen offset:2048 nt lds
v_mfma_f32_16x16x32_bf16 v[68:71], a[204:207], v[212:215], v[68:71]
s_add_u32 m0, s31, s28
ds_read_b64_tr_b16 v[42:43], v10 offset:13824
v_mfma_f32_16x16x32_bf16 v[68:71], a[208:211], v[228:231], v[68:71]
v_exp_f32 v152, v64
v_mfma_f32_16x16x32_bf16 v[68:71], a[212:215], v[244:247], v[68:71]
v_add_f32 v144, v148, v152
v_mfma_f32_16x16x32_bf16 v[72:75], a[192:195], v[168:171], v[136:139]
v_exp_f32 v153, v65
v_mfma_f32_16x16x32_bf16 v[72:75], a[196:199], v[184:187], v[72:75]
ds_read_b64_tr_b16 v[44:45], v11 offset:12288
v_add_f32 v144, v144, v153
v_mfma_f32_16x16x32_bf16 v[72:75], a[200:203], v[200:203], v[72:75]
v_exp_f32 v154, v66
v_mfma_f32_16x16x32_bf16 v[72:75], a[204:207], v[216:219], v[72:75]
ds_read_b64_tr_b16 v[46:47], v11 offset:13824
v_cvt_pk_bf16_f32 v96, v152, v153
v_mfma_f32_16x16x32_bf16 v[72:75], a[208:211], v[232:235], v[72:75]
v_add_f32 v144, v144, v154
v_mfma_f32_16x16x32_bf16 v[72:75], a[212:215], v[248:251], v[72:75]
v_exp_f32 v155, v67
v_mfma_f32_16x16x32_bf16 v[76:79], a[192:195], v[172:175], v[140:143]
ds_read_b64_tr_b16 v[48:49], v12 offset:12288
v_add_f32 v144, v144, v155
v_mfma_f32_16x16x32_bf16 v[76:79], a[196:199], v[188:191], v[76:79]
v_exp_f32 v156, v68
v_mfma_f32_16x16x32_bf16 v[76:79], a[200:203], v[204:207], v[76:79]
v_cvt_pk_bf16_f32 v97, v154, v155
v_add_f32 v145, v149, v156
v_mfma_f32_16x16x32_bf16 v[76:79], a[204:207], v[220:223], v[76:79]
buffer_load_dwordx4 v25, s[20:23], s53 offen nt lds
v_mfma_f32_16x16x32_bf16 v[76:79], a[208:211], v[236:239], v[76:79]
v_exp_f32 v157, v69
v_mfma_f32_16x16x32_bf16 v[76:79], a[212:215], v[252:255], v[76:79]
s_waitcnt lgkmcnt(8)
ds_read_b64_tr_b16 v[50:51], v12 offset:13824
v_add_f32 v145, v145, v157
v_mfma_f32_16x16x32_bf16 v[80:83], a[216:219], v[160:163], v[128:131]
v_exp_f32 v158, v70
v_mfma_f32_16x16x32_bf16 v[80:83], a[220:223], v[176:179], v[80:83]
ds_read_b64_tr_b16 v[52:53], v13 offset:12288
v_cvt_pk_bf16_f32 v100, v156, v157
v_mfma_f32_16x16x32_bf16 v[80:83], a[224:227], v[192:195], v[80:83]
s_waitcnt lgkmcnt(7)
v_exp_f32 v159, v71
v_mfma_f32_16x16x32_bf16 v[80:83], a[228:231], v[208:211], v[80:83]
ds_read_b64_tr_b16 v[54:55], v13 offset:13824
v_add_f32 v145, v145, v158
v_mfma_f32_16x16x32_bf16 v[80:83], a[232:235], v[224:227], v[80:83]
v_add_f32 v145, v145, v159
v_cvt_pk_bf16_f32 v101, v158, v159
v_mfma_f32_16x16x32_bf16 v[80:83], a[236:239], v[240:243], v[80:83]
v_exp_f32 v152, v72
v_mfma_f32_16x16x32_bf16 v[84:87], a[216:219], v[164:167], v[132:135]
ds_read_b64_tr_b16 v[56:57], v10 offset:12416
v_add_f32 v146, v150, v152
v_mfma_f32_16x16x32_bf16 v[84:87], a[220:223], v[180:183], v[84:87]
v_exp_f32 v153, v73
v_mfma_f32_16x16x32_bf16 v[84:87], a[224:227], v[196:199], v[84:87]
v_add_f32 v146, v146, v153
v_cvt_pk_bf16_f32 v104, v152, v153
v_mfma_f32_16x16x32_bf16 v[84:87], a[228:231], v[212:215], v[84:87]
buffer_load_dwordx4 v26, s[20:23], s53 offen offset:1024 nt lds
v_mfma_f32_16x16x32_bf16 v[84:87], a[232:235], v[228:231], v[84:87]
v_exp_f32 v154, v74
v_mfma_f32_16x16x32_bf16 v[84:87], a[236:239], v[244:247], v[84:87]
ds_read_b64_tr_b16 v[58:59], v10 offset:13952
v_add_f32 v146, v146, v154
v_mfma_f32_16x16x32_bf16 v[88:91], a[216:219], v[168:171], v[136:139]
v_exp_f32 v155, v75
v_mfma_f32_16x16x32_bf16 v[88:91], a[220:223], v[184:187], v[88:91]
ds_read_b64_tr_b16 v[60:61], v11 offset:12416
v_add_f32 v146, v146, v155
v_mfma_f32_16x16x32_bf16 v[88:91], a[224:227], v[200:203], v[88:91]
v_exp_f32 v156, v76
v_mfma_f32_16x16x32_bf16 v[88:91], a[228:231], v[216:219], v[88:91]
ds_read_b64_tr_b16 v[62:63], v11 offset:13952
v_cvt_pk_bf16_f32 v105, v154, v155
v_mfma_f32_16x16x32_bf16 v[88:91], a[232:235], v[232:235], v[88:91]
v_add_f32 v147, v151, v156
v_mfma_f32_16x16x32_bf16 v[88:91], a[236:239], v[248:251], v[88:91]
v_exp_f32 v157, v77
v_mfma_f32_16x16x32_bf16 v[92:95], a[216:219], v[172:175], v[140:143]
v_add_f32 v147, v147, v157
v_cvt_pk_bf16_f32 v108, v156, v157
v_mfma_f32_16x16x32_bf16 v[92:95], a[220:223], v[188:191], v[92:95]
v_exp_f32 v158, v78
v_mfma_f32_16x16x32_bf16 v[92:95], a[224:227], v[204:207], v[92:95]
v_add_f32 v147, v147, v158
v_mfma_f32_16x16x32_bf16 v[92:95], a[228:231], v[220:223], v[92:95]
buffer_load_dwordx4 v27, s[20:23], s53 offen offset:2048 nt lds
v_mfma_f32_16x16x32_bf16 v[92:95], a[232:235], v[236:239], v[92:95]
s_add_u32 s4, s4, 1
v_exp_f32 v159, v79
v_mfma_f32_16x16x32_bf16 v[92:95], a[236:239], v[252:255], v[92:95]
s_waitcnt lgkmcnt(10)
v_add_f32 v147, v147, v159
v_cvt_pk_bf16_f32 v109, v158, v159
v_mfma_f32_16x16x32_bf16 a[0:3], v[40:43], v[112:115], a[0:3]
s_bitcmp0_b32 s5, s4
v_exp_f32 v152, v80
v_mfma_f32_16x16x32_bf16 a[4:7], v[40:43], v[116:119], a[4:7]
s_cselect_b32 s28, s6, 73728
v_add_f32 v144, v144, v152
v_mfma_f32_16x16x32_bf16 a[8:11], v[40:43], v[120:123], a[8:11]
s_cselect_b32 s30, 12288, 0
v_exp_f32 v153, v81
v_mfma_f32_16x16x32_bf16 a[12:15], v[40:43], v[124:127], a[12:15]
s_waitcnt lgkmcnt(8)
ds_read_b64_tr_b16 v[40:41], v12 offset:12416
v_add_f32 v144, v144, v153
v_mfma_f32_16x16x32_bf16 a[16:19], v[44:47], v[112:115], a[16:19]
s_cselect_b32 s53, s42, 1073741824
ds_read_b64_tr_b16 v[42:43], v12 offset:13952
v_cvt_pk_bf16_f32 v98, v152, v153
v_mfma_f32_16x16x32_bf16 a[20:23], v[44:47], v[116:119], a[20:23]
s_addc_u32 s1, s1, 0
v_exp_f32 v154, v82
v_mfma_f32_16x16x32_bf16 a[24:27], v[44:47], v[120:123], a[24:27]
s_cmp_eq_u32 s1, 30
v_add_f32 v144, v144, v154
v_mfma_f32_16x16x32_bf16 a[28:31], v[44:47], v[124:127], a[28:31]
s_waitcnt lgkmcnt(8)
v_exp_f32 v155, v83
v_mfma_f32_16x16x32_bf16 a[32:35], v[48:51], v[112:115], a[32:35]
s_cselect_b32 s1, 0, s1
ds_read_b64_tr_b16 v[44:45], v13 offset:12416
v_add_f32 v144, v144, v155
v_mfma_f32_16x16x32_bf16 a[36:39], v[48:51], v[116:119], a[36:39]
s_cmp_ge_u32 s1, 10
ds_read_b64_tr_b16 v[46:47], v13 offset:13952
v_cvt_pk_bf16_f32 v99, v154, v155
v_mfma_f32_16x16x32_bf16 a[40:43], v[48:51], v[120:123], a[40:43]
s_cselect_b32 s3, s52, 0
v_exp_f32 v156, v84
v_mfma_f32_16x16x32_bf16 a[44:47], v[48:51], v[124:127], a[44:47]
s_waitcnt lgkmcnt(8)
ds_read_b64_tr_b16 v[48:49], v10 offset:12544
v_add_f32 v145, v145, v156
v_mfma_f32_16x16x32_bf16 a[48:51], v[52:55], v[112:115], a[48:51]
s_cmp_ge_u32 s1, 20
v_exp_f32 v157, v85
v_mfma_f32_16x16x32_bf16 a[52:55], v[52:55], v[116:119], a[52:55]
s_cselect_b32 s3, s45, s3
ds_read_b64_tr_b16 v[50:51], v10 offset:14080
v_add_f32 v145, v145, v157
v_mfma_f32_16x16x32_bf16 a[56:59], v[52:55], v[120:123], a[56:59]
s_mul_i32 s42, s1, 3072
v_exp_f32 v158, v86
v_mfma_f32_16x16x32_bf16 a[60:63], v[52:55], v[124:127], a[60:63]
s_waitcnt lgkmcnt(8)
ds_read_b64_tr_b16 v[52:53], v11 offset:12544
v_cvt_pk_bf16_f32 v102, v156, v157
v_mfma_f32_16x16x32_bf16 a[64:67], v[56:59], v[112:115], a[64:67]
s_add_u32 s42, s42, s3
ds_read_b64_tr_b16 v[54:55], v11 offset:14080
v_add_f32 v145, v145, v158
v_mfma_f32_16x16x32_bf16 a[68:71], v[56:59], v[116:119], a[68:71]
s_add_u32 s6, s6, s30
v_exp_f32 v159, v87
v_mfma_f32_16x16x32_bf16 a[72:75], v[56:59], v[120:123], a[72:75]
s_cmp_eq_u32 s6, 73728
v_add_f32 v145, v145, v159
v_cvt_pk_bf16_f32 v103, v158, v159
v_mfma_f32_16x16x32_bf16 a[76:79], v[56:59], v[124:127], a[76:79]
s_waitcnt lgkmcnt(8)
v_exp_f32 v152, v88
v_mfma_f32_16x16x32_bf16 a[80:83], v[60:63], v[112:115], a[80:83]
s_cselect_b32 s6, 0, s6
ds_read_b64_tr_b16 v[56:57], v12 offset:12544
v_add_f32 v146, v146, v152
v_mfma_f32_16x16x32_bf16 a[84:87], v[60:63], v[116:119], a[84:87]
s_cmp_eq_u32 s30, 0
ds_read_b64_tr_b16 v[58:59], v12 offset:14080
v_mfma_f32_16x16x32_bf16 a[88:91], v[60:63], v[120:123], a[88:91]
s_cselect_b32 s7, 147456, s6
v_exp_f32 v153, v89
v_mfma_f32_16x16x32_bf16 a[92:95], v[60:63], v[124:127], a[92:95]
s_waitcnt lgkmcnt(8)
ds_read_b64_tr_b16 v[60:61], v13 offset:12544
ds_read_b64_tr_b16 v[62:63], v13 offset:14080
v_mfma_f32_16x16x32_bf16 a[96:99], v[40:43], v[112:115], a[96:99]
s_cselect_b32 s29, 1073741824, s42
v_exp_f32 v154, v90
v_mfma_f32_16x16x32_bf16 a[100:103], v[40:43], v[116:119], a[100:103]
v_add_f32 v146, v146, v153
v_cvt_pk_bf16_f32 v106, v152, v153
v_mfma_f32_16x16x32_bf16 a[104:107], v[40:43], v[120:123], a[104:107]
v_exp_f32 v155, v91
v_mfma_f32_16x16x32_bf16 a[108:111], v[40:43], v[124:127], a[108:111]
s_waitcnt lgkmcnt(8)
v_add_f32 v146, v146, v154
v_add_f32 v146, v146, v155
v_mfma_f32_16x16x32_bf16 a[112:115], v[44:47], v[112:115], a[112:115]
v_cvt_pk_bf16_f32 v107, v154, v155
v_mfma_f32_16x16x32_bf16 a[116:119], v[44:47], v[116:119], a[116:119]
v_exp_f32 v156, v92
v_mfma_f32_16x16x32_bf16 a[120:123], v[44:47], v[120:123], a[120:123]
v_add_f32 v147, v147, v156
v_mfma_f32_16x16x32_bf16 a[124:127], v[44:47], v[124:127], a[124:127]
s_waitcnt lgkmcnt(6)
v_exp_f32 v157, v93
v_mfma_f32_16x16x32_bf16 a[128:131], v[48:51], v[112:115], a[128:131]
s_waitcnt vmcnt(6) lgkmcnt(0)
v_add_f32 v147, v147, v157
v_cvt_pk_bf16_f32 v110, v156, v157
v_mfma_f32_16x16x32_bf16 a[132:135], v[48:51], v[116:119], a[132:135]
s_barrier
v_mfma_f32_16x16x32_bf16 a[136:139], v[48:51], v[120:123], a[136:139]
v_exp_f32 v158, v94
v_mfma_f32_16x16x32_bf16 a[140:143], v[48:51], v[124:127], a[140:143]
ds_read_b128 a[192:195], v8 offset:36864
v_add_f32 v147, v147, v158
v_mfma_f32_16x16x32_bf16 a[144:147], v[52:55], v[112:115], a[144:147]
v_exp_f32 v159, v95
v_mfma_f32_16x16x32_bf16 a[148:151], v[52:55], v[116:119], a[148:151]
ds_read_b128 a[196:199], v9 offset:36864
v_add_f32 v147, v147, v159
v_mfma_f32_16x16x32_bf16 a[152:155], v[52:55], v[120:123], a[152:155]
ds_read_b128 a[200:203], v8 offset:36992
v_cvt_pk_bf16_f32 v111, v158, v159
v_mfma_f32_16x16x32_bf16 a[156:159], v[52:55], v[124:127], a[156:159]
ds_read_b128 a[204:207], v9 offset:36992
ds_read_b128 a[208:211], v8 offset:37120
v_mfma_f32_16x16x32_bf16 a[160:163], v[56:59], v[112:115], a[160:163]
ds_read_b128 a[212:215], v9 offset:37120
v_mfma_f32_16x16x32_bf16 a[164:167], v[56:59], v[116:119], a[164:167]
v_mfma_f32_16x16x32_bf16 a[168:171], v[56:59], v[120:123], a[168:171]
v_mfma_f32_16x16x32_bf16 a[172:175], v[56:59], v[124:127], a[172:175]
v_mfma_f32_16x16x32_bf16 a[176:179], v[60:63], v[112:115], a[176:179]
v_max3_f32 v1, v144, v145, v146
v_max_f32 v1, v1, v147
v_mfma_f32_16x16x32_bf16 a[180:183], v[60:63], v[116:119], a[180:183]
v_cmp_nge_f32 vcc, s44, v1
v_mfma_f32_16x16x32_bf16 a[184:187], v[60:63], v[120:123], a[184:187]
s_waitcnt lgkmcnt(3)
v_mfma_f32_16x16x32_bf16 a[188:191], v[60:63], v[124:127], a[188:191]
s_cbranch_vccnz KF_fx0
KF_bk0:
v_mfma_f32_16x16x32_bf16 v[64:67], a[192:195], v[160:163], v[128:131]
s_add_u32 m0, s37, s7
ds_read_b128 a[216:219], v8 offset:38400
v_mfma_f32_16x16x32_bf16 v[64:67], a[196:199], v[176:179], v[64:67]
ds_read_b128 a[220:223], v9 offset:38400
v_mfma_f32_16x16x32_bf16 v[64:67], a[200:203], v[192:195], v[64:67]
s_waitcnt lgkmcnt(2)
ds_read_b128 a[224:227], v8 offset:38528
v_mfma_f32_16x16x32_bf16 v[64:67], a[204:207], v[208:211], v[64:67]
ds_read_b128 a[228:231], v9 offset:38528
v_mfma_f32_16x16x32_bf16 v[64:67], a[208:211], v[224:227], v[64:67]
buffer_load_dwordx4 v22, s[16:19], s29 offen nt lds
v_mfma_f32_16x16x32_bf16 v[64:67], a[212:215], v[240:243], v[64:67]
ds_read_b128 a[232:235], v8 offset:38656
ds_read_b128 a[236:239], v9 offset:38656
v_mfma_f32_16x16x32_bf16 v[68:71], a[192:195], v[164:167], v[132:135]
buffer_load_dwordx4 v23, s[16:19], s29 offen offset:1024 nt lds
v_mfma_f32_16x16x32_bf16 v[68:71], a[196:199], v[180:183], v[68:71]
ds_read_b64_tr_b16 v[40:41], v10 offset:24576
v_mfma_f32_16x16x32_bf16 v[68:71], a[200:203], v[196:199], v[68:71]
buffer_load_dwordx4 v24, s[16:19], s29 offen offset:2048 nt lds
v_mfma_f32_16x16x32_bf16 v[68:71], a[204:207], v[212:215], v[68:71]
s_add_u32 m0, s31, s28
ds_read_b64_tr_b16 v[42:43], v10 offset:26112
v_mfma_f32_16x16x32_bf16 v[68:71], a[208:211], v[228:231], v[68:71]
v_exp_f32 v152, v64
v_mfma_f32_16x16x32_bf16 v[68:71], a[212:215], v[244:247], v[68:71]
v_add_f32 v148, v144, v152
v_mfma_f32_16x16x32_bf16 v[72:75], a[192:195], v[168:171], v[136:139]
v_exp_f32 v153, v65
v_mfma_f32_16x16x32_bf16 v[72:75], a[196:199], v[184:187], v[72:75]
ds_read_b64_tr_b16 v[44:45], v11 offset:24576
v_add_f32 v148, v148, v153
v_mfma_f32_16x16x32_bf16 v[72:75], a[200:203], v[200:203], v[72:75]
v_exp_f32 v154, v66
v_mfma_f32_16x16x32_bf16 v[72:75], a[204:207], v[216:219], v[72:75]
ds_read_b64_tr_b16 v[46:47], v11 offset:26112
v_cvt_pk_bf16_f32 v112, v152, v153
v_mfma_f32_16x16x32_bf16 v[72:75], a[208:211], v[232:235], v[72:75]
v_add_f32 v148, v148, v154
v_mfma_f32_16x16x32_bf16 v[72:75], a[212:215], v[248:251], v[72:75]
v_exp_f32 v155, v67
v_mfma_f32_16x16x32_bf16 v[76:79], a[192:195], v[172:175], v[140:143]
ds_read_b64_tr_b16 v[48:49], v12 offset:24576
v_add_f32 v148, v148, v155
v_mfma_f32_16x16x32_bf16 v[76:79], a[196:199], v[188:191], v[76:79]
v_exp_f32 v156, v68
v_mfma_f32_16x16x32_bf16 v[76:79], a[200:203], v[204:207], v[76:79]
v_cvt_pk_bf16_f32 v113, v154, v155
v_add_f32 v149, v145, v156
v_mfma_f32_16x16x32_bf16 v[76:79], a[204:207], v[220:223], v[76:79]
buffer_load_dwordx4 v25, s[20:23], s53 offen nt lds
v_mfma_f32_16x16x32_bf16 v[76:79], a[208:211], v[236:239], v[76:79]
v_exp_f32 v157, v69
v_mfma_f32_16x16x32_bf16 v[76:79], a[212:215], v[252:255], v[76:79]
s_waitcnt lgkmcnt(8)
ds_read_b64_tr_b16 v[50:51], v12 offset:26112
v_add_f32 v149, v149, v157
v_mfma_f32_16x16x32_bf16 v[80:83], a[216:219], v[160:163], v[128:131]
v_exp_f32 v158, v70
v_mfma_f32_16x16x32_bf16 v[80:83], a[220:223], v[176:179], v[80:83]
ds_read_b64_tr_b16 v[52:53], v13 offset:24576
v_cvt_pk_bf16_f32 v116, v156, v157
v_mfma_f32_16x16x32_bf16 v[80:83], a[224:227], v[192:195], v[80:83]
s_waitcnt lgkmcnt(7)
v_exp_f32 v159, v71
v_mfma_f32_16x16x32_bf16 v[80:83], a[228:231], v[208:211], v[80:83]
ds_read_b64_tr_b16 v[54:55], v13 offset:26112
v_add_f32 v149, v149, v158
v_mfma_f32_16x16x32_bf16 v[80:83], a[232:235], v[224:227], v[80:83]
v_add_f32 v149, v149, v159
v_cvt_pk_bf16_f32 v117, v158, v159
v_mfma_f32_16x16x32_bf16 v[80:83], a[236:239], v[240:243], v[80:83]
v_exp_f32 v152, v72
v_mfma_f32_16x16x32_bf16 v[84:87], a[216:219], v[164:167], v[132:135]
ds_read_b64_tr_b16 v[56:57], v10 offset:24704
v_add_f32 v150, v146, v152
v_mfma_f32_16x16x32_bf16 v[84:87], a[220:223], v[180:183], v[84:87]
v_exp_f32 v153, v73
v_mfma_f32_16x16x32_bf16 v[84:87], a[224:227], v[196:199], v[84:87]
v_add_f32 v150, v150, v153
v_cvt_pk_bf16_f32 v120, v152, v153
v_mfma_f32_16x16x32_bf16 v[84:87], a[228:231], v[212:215], v[84:87]
buffer_load_dwordx4 v26, s[20:23], s53 offen offset:1024 nt lds
v_mfma_f32_16x16x32_bf16 v[84:87], a[232:235], v[228:231], v[84:87]
v_exp_f32 v154, v74
v_mfma_f32_16x16x32_bf16 v[84:87], a[236:239], v[244:247], v[84:87]
ds_read_b64_tr_b16 v[58:59], v10 offset:26240
v_add_f32 v150, v150, v154
v_mfma_f32_16x16x32_bf16 v[88:91], a[216:219], v[168:171], v[136:139]
v_exp_f32 v155, v75
v_mfma_f32_16x16x32_bf16 v[88:91], a[220:223], v[184:187], v[88:91]
ds_read_b64_tr_b16 v[60:61], v11 offset:24704
v_add_f32 v150, v150, v155
v_mfma_f32_16x16x32_bf16 v[88:91], a[224:227], v[200:203], v[88:91]
v_exp_f32 v156, v76
v_mfma_f32_16x16x32_bf16 v[88:91], a[228:231], v[216:219], v[88:91]
ds_read_b64_tr_b16 v[62:63], v11 offset:26240
v_cvt_pk_bf16_f32 v121, v154, v155
v_mfma_f32_16x16x32_bf16 v[88:91], a[232:235], v[232:235], v[88:91]
v_add_f32 v151, v147, v156
v_mfma_f32_16x16x32_bf16 v[88:91], a[236:239], v[248:251], v[88:91]
v_exp_f32 v157, v77
v_mfma_f32_16x16x32_bf16 v[92:95], a[216:219], v[172:175], v[140:143]
v_add_f32 v151, v151, v157
v_cvt_pk_bf16_f32 v124, v156, v157
v_mfma_f32_16x16x32_bf16 v[92:95], a[220:223], v[188:191], v[92:95]
v_exp_f32 v158, v78
v_mfma_f32_16x16x32_bf16 v[92:95], a[224:227], v[204:207], v[92:95]
v_add_f32 v151, v151, v158
v_mfma_f32_16x16x32_bf16 v[92:95], a[228:231], v[220:223], v[92:95]
buffer_load_dwordx4 v27, s[20:23], s53 offen offset:2048 nt lds
v_mfma_f32_16x16x32_bf16 v[92:95], a[232:235], v[236:239], v[92:95]
s_add_u32 s4, s4, 1
v_exp_f32 v159, v79
v_mfma_f32_16x16x32_bf16 v[92:95], a[236:239], v[252:255], v[92:95]
s_waitcnt lgkmcnt(10)
v_add_f32 v151, v151, v159
v_cvt_pk_bf16_f32 v125, v158, v159
v_mfma_f32_16x16x32_bf16 a[0:3], v[40:43], v[96:99], a[0:3]
s_bitcmp0_b32 s5, s4
v_exp_f32 v152, v80
v_mfma_f32_16x16x32_bf16 a[4:7], v[40:43], v[100:103], a[4:7]
s_cselect_b32 s28, s6, 73728
v_add_f32 v148, v148, v152
v_mfma_f32_16x16x32_bf16 a[8:11], v[40:43], v[104:107], a[8:11]
s_cselect_b32 s30, 12288, 0
v_exp_f32 v153, v81
v_mfma_f32_16x16x32_bf16 a[12:15], v[40:43], v[108:111], a[12:15]
s_waitcnt lgkmcnt(8)
ds_read_b64_tr_b16 v[40:41], v12 offset:24704
v_add_f32 v148, v148, v153
v_mfma_f32_16x16x32_bf16 a[16:19], v[44:47], v[96:99], a[16:19]
s_cselect_b32 s53, s42, 1073741824
ds_read_b64_tr_b16 v[42:43], v12 offset:26240
v_cvt_pk_bf16_f32 v114, v152, v153
v_mfma_f32_16x16x32_bf16 a[20:23], v[44:47], v[100:103], a[20:23]
s_addc_u32 s1, s1, 0
v_exp_f32 v154, v82
v_mfma_f32_16x16x32_bf16 a[24:27], v[44:47], v[104:107], a[24:27]
s_cmp_eq_u32 s1, 30
v_add_f32 v148, v148, v154
v_mfma_f32_16x16x32_bf16 a[28:31], v[44:47], v[108:111], a[28:31]
s_waitcnt lgkmcnt(8)
v_exp_f32 v155, v83
v_mfma_f32_16x16x32_bf16 a[32:35], v[48:51], v[96:99], a[32:35]
s_cselect_b32 s1, 0, s1
ds_read_b64_tr_b16 v[44:45], v13 offset:24704
v_add_f32 v148, v148, v155
v_mfma_f32_16x16x32_bf16 a[36:39], v[48:51], v[100:103], a[36:39]
s_cmp_ge_u32 s1, 10
ds_read_b64_tr_b16 v[46:47], v13 offset:26240
v_cvt_pk_bf16_f32 v115, v154, v155
v_mfma_f32_16x16x32_bf16 a[40:43], v[48:51], v[104:107], a[40:43]
s_cselect_b32 s3, s52, 0
v_exp_f32 v156, v84
v_mfma_f32_16x16x32_bf16 a[44:47], v[48:51], v[108:111], a[44:47]
s_waitcnt lgkmcnt(8)
ds_read_b64_tr_b16 v[48:49], v10 offset:24832
v_add_f32 v149, v149, v156
v_mfma_f32_16x16x32_bf16 a[48:51], v[52:55], v[96:99], a[48:51]
s_cmp_ge_u32 s1, 20
v_exp_f32 v157, v85
v_mfma_f32_16x16x32_bf16 a[52:55], v[52:55], v[100:103], a[52:55]
KF_pg6:
s_cbranch_execz KF_pg10
s_cselect_b32 s3, s45, s3
ds_read_b64_tr_b16 v[50:51], v10 offset:26368
v_add_f32 v149, v149, v157
v_mfma_f32_16x16x32_bf16 a[56:59], v[52:55], v[104:107], a[56:59]
s_mul_i32 s42, s1, 3072
v_exp_f32 v158, v86
v_mfma_f32_16x16x32_bf16 a[60:63], v[52:55], v[108:111], a[60:63]
s_waitcnt lgkmcnt(8)
ds_read_b64_tr_b16 v[52:53], v11 offset:24832
v_cvt_pk_bf16_f32 v118, v156, v157
v_mfma_f32_16x16x32_bf16 a[64:67], v[56:59], v[96:99], a[64:67]
s_add_u32 s42, s42, s3
ds_read_b64_tr_b16 v[54:55], v11 offset:26368
v_add_f32 v149, v149, v158
v_mfma_f32_16x16x32_bf16 a[68:71], v[56:59], v[100:103], a[68:71]
s_add_u32 s6, s6, s30
v_exp_f32 v159, v87
v_mfma_f32_16x16x32_bf16 a[72:75], v[56:59], v[104:107], a[72:75]
s_cmp_eq_u32 s6, 73728
v_add_f32 v149, v149, v159
v_cvt_pk_bf16_f32 v119, v158, v159
v_mfma_f32_16x16x32_bf16 a[76:79], v[56:59], v[108:111], a[76:79]
s_waitcnt lgkmcnt(8)
v_exp_f32 v152, v88
v_mfma_f32_16x16x32_bf16 a[80:83], v[60:63], v[96:99], a[80:83]
s_cselect_b32 s6, 0, s6
ds_read_b64_tr_b16 v[56:57], v12 offset:24832
v_add_f32 v150, v150, v152
v_mfma_f32_16x16x32_bf16 a[84:87], v[60:63], v[100:103], a[84:87]
s_cmp_eq_u32 s30, 0
ds_read_b64_tr_b16 v[58:59], v12 offset:26368
v_mfma_f32_16x16x32_bf16 a[88:91], v[60:63], v[104:107], a[88:91]
s_cselect_b32 s7, 147456, s6
v_exp_f32 v153, v89
v_mfma_f32_16x16x32_bf16 a[92:95], v[60:63], v[108:111], a[92:95]
s_waitcnt lgkmcnt(8)
ds_read_b64_tr_b16 v[60:61], v13 offset:24832
ds_read_b64_tr_b16 v[62:63], v13 offset:26368
v_mfma_f32_16x16x32_bf16 a[96:99], v[40:43], v[96:99], a[96:99]
s_cselect_b32 s29, 1073741824, s42
v_exp_f32 v154, v90
v_mfma_f32_16x16x32_bf16 a[100:103], v[40:43], v[100:103], a[100:103]
v_add_f32 v150, v150, v153
v_cvt_pk_bf16_f32 v122, v152, v153
v_mfma_f32_16x16x32_bf16 a[104:107], v[40:43], v[104:107], a[104:107]
v_exp_f32 v155, v91
v_mfma_f32_16x16x32_bf16 a[108:111], v[40:43], v[108:111], a[108:111]
s_waitcnt lgkmcnt(8)
v_add_f32 v150, v150, v154
v_add_f32 v150, v150, v155
v_mfma_f32_16x16x32_bf16 a[112:115], v[44:47], v[96:99], a[112:115]
v_cvt_pk_bf16_f32 v123, v154, v155
v_mfma_f32_16x16x32_bf16 a[116:119], v[44:47], v[100:103], a[116:119]
v_exp_f32 v156, v92
v_mfma_f32_16x16x32_bf16 a[120:123], v[44:47], v[104:107], a[120:123]
v_add_f32 v151, v151, v156
v_mfma_f32_16x16x32_bf16 a[124:127], v[44:47], v[108:111], a[124:127]
s_waitcnt lgkmcnt(6)
v_exp_f32 v157, v93
v_mfma_f32_16x16x32_bf16 a[128:131], v[48:51], v[96:99], a[128:131]
s_waitcnt vmcnt(6) lgkmcnt(0)
v_add_f32 v151, v151, v157
v_cvt_pk_bf16_f32 v126, v156, v157
v_mfma_f32_16x16x32_bf16 a[132:135], v[48:51], v[100:103], a[132:135]
s_barrier
v_mfma_f32_16x16x32_bf16 a[136:139], v[48:51], v[104:107], a[136:139]
v_exp_f32 v158, v94
v_mfma_f32_16x16x32_bf16 a[140:143], v[48:51], v[108:111], a[140:143]
ds_read_b128 a[192:195], v8 offset:49152
v_add_f32 v151, v151, v158
v_mfma_f32_16x16x32_bf16 a[144:147], v[52:55], v[96:99], a[144:147]
v_exp_f32 v159, v95
v_mfma_f32_16x16x32_bf16 a[148:151], v[52:55], v[100:103], a[148:151]
ds_read_b128 a[196:199], v9 offset:49152
v_add_f32 v151, v151, v159
v_mfma_f32_16x16x32_bf16 a[152:155], v[52:55], v[104:107], a[152:155]
ds_read_b128 a[200:203], v8 offset:49280
v_cvt_pk_bf16_f32 v127, v158, v159
v_mfma_f32_16x16x32_bf16 a[156:159], v[52:55], v[108:111], a[156:159]
ds_read_b128 a[204:207], v9 offset:49280
ds_read_b128 a[208:211], v8 offset:49408
v_mfma_f32_16x16x32_bf16 a[160:163], v[56:59], v[96:99], a[160:163]
s_cmp_eq_u32 s43, s54
ds_read_b128 a[212:215], v9 offset:49408
v_mfma_f32_16x16x32_bf16 a[164:167], v[56:59], v[100:103], a[164:167]
s_cselect_b32 s55, 0, 1073741824
v_mfma_f32_16x16x32_bf16 a[168:171], v[56:59], v[104:107], a[168:171]
v_mfma_f32_16x16x32_bf16 a[172:175], v[56:59], v[108:111], a[172:175]
v_mfma_f32_16x16x32_bf16 a[176:179], v[60:63], v[96:99], a[176:179]
v_max3_f32 v1, v148, v149, v150
v_max_f32 v1, v1, v151
v_mfma_f32_16x16x32_bf16 a[180:183], v[60:63], v[100:103], a[180:183]
s_waitcnt lgkmcnt(3)
v_cmp_nge_f32 vcc, s44, v1
v_mfma_f32_16x16x32_bf16 a[184:187], v[60:63], v[104:107], a[184:187]
buffer_atomic_add v7, v6, s[60:63], s55 offen sc1
v_mfma_f32_16x16x32_bf16 a[188:191], v[60:63], v[108:111], a[188:191]
s_cbranch_vccnz KF_fx1
KF_bk1:
v_mfma_f32_16x16x32_bf16 v[64:67], a[192:195], v[160:163], v[128:131]
s_add_u32 m0, s37, s7
ds_read_b128 a[216:219], v8 offset:50688
v_mfma_f32_16x16x32_bf16 v[64:67], a[196:199], v[176:179], v[64:67]
ds_read_b128 a[220:223], v9 offset:50688
v_mfma_f32_16x16x32_bf16 v[64:67], a[200:203], v[192:195], v[64:67]
s_waitcnt lgkmcnt(2)
ds_read_b128 a[224:227], v8 offset:50816
v_mfma_f32_16x16x32_bf16 v[64:67], a[204:207], v[208:211], v[64:67]
ds_read_b128 a[228:231], v9 offset:50816
v_mfma_f32_16x16x32_bf16 v[64:67], a[208:211], v[224:227], v[64:67]
buffer_load_dwordx4 v22, s[16:19], s29 offen nt lds
v_mfma_f32_16x16x32_bf16 v[64:67], a[212:215], v[240:243], v[64:67]
ds_read_b128 a[232:235], v8 offset:50944
ds_read_b128 a[236:239], v9 offset:50944
v_mfma_f32_16x16x32_bf16 v[68:71], a[192:195], v[164:167], v[132:135]
buffer_load_dwordx4 v23, s[16:19], s29 offen offset:1024 nt lds
v_mfma_f32_16x16x32_bf16 v[68:71], a[196:199], v[180:183], v[68:71]
ds_read_b64_tr_b16 v[40:41], v10 offset:36864
v_mfma_f32_16x16x32_bf16 v[68:71], a[200:203], v[196:199], v[68:71]
buffer_load_dwordx4 v24, s[16:19], s29 offen offset:2048 nt lds
v_mfma_f32_16x16x32_bf16 v[68:71], a[204:207], v[212:215], v[68:71]
s_add_u32 m0, s31, s28
ds_read_b64_tr_b16 v[42:43], v10 offset:38400
v_mfma_f32_16x16x32_bf16 v[68:71], a[208:211], v[228:231], v[68:71]
v_exp_f32 v152, v64
v_mfma_f32_16x16x32_bf16 v[68:71], a[212:215], v[244:247], v[68:71]
v_add_f32 v144, v148, v152
v_mfma_f32_16x16x32_bf16 v[72:75], a[192:195], v[168:171], v[136:139]
v_exp_f32 v153, v65
v_mfma_f32_16x16x32_bf16 v[72:75], a[196:199], v[184:187], v[72:75]
ds_read_b64_tr_b16 v[44:45], v11 offset:36864
v_add_f32 v144, v144, v153
v_mfma_f32_16x16x32_bf16 v[72:75], a[200:203], v[200:203], v[72:75]
v_exp_f32 v154, v66
v_mfma_f32_16x16x32_bf16 v[72:75], a[204:207], v[216:219], v[72:75]
ds_read_b64_tr_b16 v[46:47], v11 offset:38400
v_cvt_pk_bf16_f32 v96, v152, v153
v_mfma_f32_16x16x32_bf16 v[72:75], a[208:211], v[232:235], v[72:75]
v_add_f32 v144, v144, v154
v_mfma_f32_16x16x32_bf16 v[72:75], a[212:215], v[248:251], v[72:75]
v_exp_f32 v155, v67
v_mfma_f32_16x16x32_bf16 v[76:79], a[192:195], v[172:175], v[140:143]
ds_read_b64_tr_b16 v[48:49], v12 offset:36864
v_add_f32 v144, v144, v155
v_mfma_f32_16x16x32_bf16 v[76:79], a[196:199], v[188:191], v[76:79]
v_exp_f32 v156, v68
v_mfma_f32_16x16x32_bf16 v[76:79], a[200:203], v[204:207], v[76:79]
v_cvt_pk_bf16_f32 v97, v154, v155
v_add_f32 v145, v149, v156
v_mfma_f32_16x16x32_bf16 v[76:79], a[204:207], v[220:223], v[76:79]
buffer_load_dwordx4 v25, s[20:23], s53 offen nt lds
v_mfma_f32_16x16x32_bf16 v[76:79], a[208:211], v[236:239], v[76:79]
v_exp_f32 v157, v69
v_mfma_f32_16x16x32_bf16 v[76:79], a[212:215], v[252:255], v[76:79]
s_waitcnt lgkmcnt(8)
ds_read_b64_tr_b16 v[50:51], v12 offset:38400
v_add_f32 v145, v145, v157
v_mfma_f32_16x16x32_bf16 v[80:83], a[216:219], v[160:163], v[128:131]
v_exp_f32 v158, v70
v_mfma_f32_16x16x32_bf16 v[80:83], a[220:223], v[176:179], v[80:83]
ds_read_b64_tr_b16 v[52:53], v13 offset:36864
v_cvt_pk_bf16_f32 v100, v156, v157
v_mfma_f32_16x16x32_bf16 v[80:83], a[224:227], v[192:195], v[80:83]
s_waitcnt lgkmcnt(7)
v_exp_f32 v159, v71
v_mfma_f32_16x16x32_bf16 v[80:83], a[228:231], v[208:211], v[80:83]
ds_read_b64_tr_b16 v[54:55], v13 offset:38400
v_add_f32 v145, v145, v158
v_mfma_f32_16x16x32_bf16 v[80:83], a[232:235], v[224:227], v[80:83]
v_add_f32 v145, v145, v159
v_cvt_pk_bf16_f32 v101, v158, v159
v_mfma_f32_16x16x32_bf16 v[80:83], a[236:239], v[240:243], v[80:83]
v_exp_f32 v152, v72
v_mfma_f32_16x16x32_bf16 v[84:87], a[216:219], v[164:167], v[132:135]
ds_read_b64_tr_b16 v[56:57], v10 offset:36992
v_add_f32 v146, v150, v152
v_mfma_f32_16x16x32_bf16 v[84:87], a[220:223], v[180:183], v[84:87]
v_exp_f32 v153, v73
v_mfma_f32_16x16x32_bf16 v[84:87], a[224:227], v[196:199], v[84:87]
v_add_f32 v146, v146, v153
v_cvt_pk_bf16_f32 v104, v152, v153
v_mfma_f32_16x16x32_bf16 v[84:87], a[228:231], v[212:215], v[84:87]
buffer_load_dwordx4 v26, s[20:23], s53 offen offset:1024 nt lds
v_mfma_f32_16x16x32_bf16 v[84:87], a[232:235], v[228:231], v[84:87]
v_exp_f32 v154, v74
v_mfma_f32_16x16x32_bf16 v[84:87], a[236:239], v[244:247], v[84:87]
ds_read_b64_tr_b16 v[58:59], v10 offset:38528
v_add_f32 v146, v146, v154
v_mfma_f32_16x16x32_bf16 v[88:91], a[216:219], v[168:171], v[136:139]
v_exp_f32 v155, v75
v_mfma_f32_16x16x32_bf16 v[88:91], a[220:223], v[184:187], v[88:91]
ds_read_b64_tr_b16 v[60:61], v11 offset:36992
v_add_f32 v146, v146, v155
v_mfma_f32_16x16x32_bf16 v[88:91], a[224:227], v[200:203], v[88:91]
v_exp_f32 v156, v76
v_mfma_f32_16x16x32_bf16 v[88:91], a[228:231], v[216:219], v[88:91]
ds_read_b64_tr_b16 v[62:63], v11 offset:38528
v_cvt_pk_bf16_f32 v105, v154, v155
v_mfma_f32_16x16x32_bf16 v[88:91], a[232:235], v[232:235], v[88:91]
v_add_f32 v147, v151, v156
v_mfma_f32_16x16x32_bf16 v[88:91], a[236:239], v[248:251], v[88:91]
v_exp_f32 v157, v77
v_mfma_f32_16x16x32_bf16 v[92:95], a[216:219], v[172:175], v[140:143]
v_add_f32 v147, v147, v157
v_cvt_pk_bf16_f32 v108, v156, v157
v_mfma_f32_16x16x32_bf16 v[92:95], a[220:223], v[188:191], v[92:95]
v_exp_f32 v158, v78
v_mfma_f32_16x16x32_bf16 v[92:95], a[224:227], v[204:207], v[92:95]
v_add_f32 v147, v147, v158
v_mfma_f32_16x16x32_bf16 v[92:95], a[228:231], v[220:223], v[92:95]
buffer_load_dwordx4 v27, s[20:23], s53 offen offset:2048 nt lds
v_mfma_f32_16x16x32_bf16 v[92:95], a[232:235], v[236:239], v[92:95]
s_add_u32 s4, s4, 1
v_exp_f32 v159, v79
v_mfma_f32_16x16x32_bf16 v[92:95], a[236:239], v[252:255], v[92:95]
s_waitcnt lgkmcnt(10)
v_add_f32 v147, v147, v159
v_cvt_pk_bf16_f32 v109, v158, v159
v_mfma_f32_16x16x32_bf16 a[0:3], v[40:43], v[112:115], a[0:3]
s_bitcmp0_b32 s5, s4
v_exp_f32 v152, v80
v_mfma_f32_16x16x32_bf16 a[4:7], v[40:43], v[116:119], a[4:7]
s_cselect_b32 s28, s6, 73728
v_add_f32 v144, v144, v152
v_mfma_f32_16x16x32_bf16 a[8:11], v[40:43], v[120:123], a[8:11]
s_cselect_b32 s30, 12288, 0
v_exp_f32 v153, v81
v_mfma_f32_16x16x32_bf16 a[12:15], v[40:43], v[124:127], a[12:15]
s_waitcnt lgkmcnt(8)
ds_read_b64_tr_b16 v[40:41], v12 offset:36992
v_add_f32 v144, v144, v153
v_mfma_f32_16x16x32_bf16 a[16:19], v[44:47], v[112:115], a[16:19]
s_cselect_b32 s53, s42, 1073741824
ds_read_b64_tr_b16 v[42:43], v12 offset:38528
v_cvt_pk_bf16_f32 v98, v152, v153
v_mfma_f32_16x16x32_bf16 a[20:23], v[44:47], v[116:119], a[20:23]
s_addc_u32 s1, s1, 0
v_exp_f32 v154, v82
v_mfma_f32_16x16x32_bf16 a[24:27], v[44:47], v[120:123], a[24:27]
s_cmp_eq_u32 s1, 30
v_add_f32 v144, v144, v154
v_mfma_f32_16x16x32_bf16 a[28:31], v[44:47], v[124:127], a[28:31]
s_waitcnt lgkmcnt(8)
v_exp_f32 v155, v83
v_mfma_f32_16x16x32_bf16 a[32:35], v[48:51], v[112:115], a[32:35]
s_cselect_b32 s1, 0, s1
ds_read_b64_tr_b16 v[44:45], v13 offset:36992
v_add_f32 v144, v144, v155
v_mfma_f32_16x16x32_bf16 a[36:39], v[48:51], v[116:119], a[36:39]
s_cmp_ge_u32 s1, 10
ds_read_b64_tr_b16 v[46:47], v13 offset:38528
v_cvt_pk_bf16_f32 v99, v154, v155
v_mfma_f32_16x16x32_bf16 a[40:43], v[48:51], v[120:123], a[40:43]
s_cselect_b32 s3, s52, 0
v_exp_f32 v156, v84
v_mfma_f32_16x16x32_bf16 a[44:47], v[48:51], v[124:127], a[44:47]
s_waitcnt lgkmcnt(8)
ds_read_b64_tr_b16 v[48:49], v10 offset:37120
v_add_f32 v145, v145, v156
v_mfma_f32_16x16x32_bf16 a[48:51], v[52:55], v[112:115], a[48:51]
s_cmp_ge_u32 s1, 20
v_exp_f32 v157, v85
v_mfma_f32_16x16x32_bf16 a[52:55], v[52:55], v[116:119], a[52:55]
s_cselect_b32 s3, s45, s3
ds_read_b64_tr_b16 v[50:51], v10 offset:38656
v_add_f32 v145, v145, v157
v_mfma_f32_16x16x32_bf16 a[56:59], v[52:55], v[120:123], a[56:59]
s_mul_i32 s42, s1, 3072
v_exp_f32 v158, v86
v_mfma_f32_16x16x32_bf16 a[60:63], v[52:55], v[124:127], a[60:63]
s_waitcnt lgkmcnt(8)
ds_read_b64_tr_b16 v[52:53], v11 offset:37120
v_cvt_pk_bf16_f32 v102, v156, v157
v_mfma_f32_16x16x32_bf16 a[64:67], v[56:59], v[112:115], a[64:67]
s_add_u32 s42, s42, s3
ds_read_b64_tr_b16 v[54:55], v11 offset:38656
v_add_f32 v145, v145, v158
v_mfma_f32_16x16x32_bf16 a[68:71], v[56:59], v[116:119], a[68:71]
s_add_u32 s6, s6, s30
v_exp_f32 v159, v87
v_mfma_f32_16x16x32_bf16 a[72:75], v[56:59], v[120:123], a[72:75]
s_cmp_eq_u32 s6, 73728
v_add_f32 v145, v145, v159
v_cvt_pk_bf16_f32 v103, v158, v159
v_mfma_f32_16x16x32_bf16 a[76:79], v[56:59], v[124:127], a[76:79]
s_waitcnt lgkmcnt(8)
v_exp_f32 v152, v88
v_mfma_f32_16x16x32_bf16 a[80:83], v[60:63], v[112:115], a[80:83]
s_cselect_b32 s6, 0, s6
ds_read_b64_tr_b16 v[56:57], v12 offset:37120
v_add_f32 v146, v146, v152
v_mfma_f32_16x16x32_bf16 a[84:87], v[60:63], v[116:119], a[84:87]
s_cmp_eq_u32 s30, 0
ds_read_b64_tr_b16 v[58:59], v12 offset:38656
v_mfma_f32_16x16x32_bf16 a[88:91], v[60:63], v[120:123], a[88:91]
s_cselect_b32 s7, 147456, s6
v_exp_f32 v153, v89
v_mfma_f32_16x16x32_bf16 a[92:95], v[60:63], v[124:127], a[92:95]
s_waitcnt lgkmcnt(8)
ds_read_b64_tr_b16 v[60:61], v13 offset:37120
ds_read_b64_tr_b16 v[62:63], v13 offset:38656
v_mfma_f32_16x16x32_bf16 a[96:99], v[40:43], v[112:115], a[96:99]
s_cselect_b32 s29, 1073741824, s42
v_exp_f32 v154, v90
v_mfma_f32_16x16x32_bf16 a[100:103], v[40:43], v[116:119], a[100:103]
v_add_f32 v146, v146, v153
v_cvt_pk_bf16_f32 v106, v152, v153
v_mfma_f32_16x16x32_bf16 a[104:107], v[40:43], v[120:123], a[104:107]
v_exp_f32 v155, v91
v_mfma_f32_16x16x32_bf16 a[108:111], v[40:43], v[124:127], a[108:111]
s_waitcnt lgkmcnt(8)
v_add_f32 v146, v146, v154
v_add_f32 v146, v146, v155
v_mfma_f32_16x16x32_bf16 a[112:115], v[44:47], v[112:115], a[112:115]
v_cvt_pk_bf16_f32 v107, v154, v155
v_mfma_f32_16x16x32_bf16 a[116:119], v[44:47], v[116:119], a[116:119]
v_exp_f32 v156, v92
v_mfma_f32_16x16x32_bf16 a[120:123], v[44:47], v[120:123], a[120:123]
v_add_f32 v147, v147, v156
v_mfma_f32_16x16x32_bf16 a[124:127], v[44:47], v[124:127], a[124:127]
s_waitcnt lgkmcnt(6)
v_exp_f32 v157, v93
v_mfma_f32_16x16x32_bf16 a[128:131], v[48:51], v[112:115], a[128:131]
s_waitcnt vmcnt(6) lgkmcnt(0)
v_add_f32 v147, v147, v157
v_cvt_pk_bf16_f32 v110, v156, v157
v_mfma_f32_16x16x32_bf16 a[132:135], v[48:51], v[116:119], a[132:135]
s_barrier
v_mfma_f32_16x16x32_bf16 a[136:139], v[48:51], v[120:123], a[136:139]
v_exp_f32 v158, v94
v_mfma_f32_16x16x32_bf16 a[140:143], v[48:51], v[124:127], a[140:143]
ds_read_b128 a[192:195], v8 offset:61440
v_add_f32 v147, v147, v158
v_mfma_f32_16x16x32_bf16 a[144:147], v[52:55], v[112:115], a[144:147]
v_exp_f32 v159, v95
v_mfma_f32_16x16x32_bf16 a[148:151], v[52:55], v[116:119], a[148:151]
ds_read_b128 a[196:199], v9 offset:61440
v_add_f32 v147, v147, v159
v_mfma_f32_16x16x32_bf16 a[152:155], v[52:55], v[120:123], a[152:155]
ds_read_b128 a[200:203], v8 offset:61568
v_cvt_pk_bf16_f32 v111, v158, v159
v_mfma_f32_16x16x32_bf16 a[156:159], v[52:55], v[124:127], a[156:159]
ds_read_b128 a[204:207], v9 offset:61568
ds_read_b128 a[208:211], v8 offset:61696
v_mfma_f32_16x16x32_bf16 a[160:163], v[56:59], v[112:115], a[160:163]
ds_read_b128 a[212:215], v9 offset:61696
v_mfma_f32_16x16x32_bf16 a[164:167], v[56:59], v[116:119], a[164:167]
v_mfma_f32_16x16x32_bf16 a[168:171], v[56:59], v[120:123], a[168:171]
v_mfma_f32_16x16x32_bf16 a[172:175], v[56:59], v[124:127], a[172:175]
v_mfma_f32_16x16x32_bf16 a[176:179], v[60:63], v[112:115], a[176:179]
v_max3_f32 v1, v144, v145, v146
v_max_f32 v1, v1, v147
v_mfma_f32_16x16x32_bf16 a[180:183], v[60:63], v[116:119], a[180:183]
v_cmp_nge_f32 vcc, s44, v1
v_mfma_f32_16x16x32_bf16 a[184:187], v[60:63], v[120:123], a[184:187]
s_waitcnt lgkmcnt(3)
v_mfma_f32_16x16x32_bf16 a[188:191], v[60:63], v[124:127], a[188:191]
s_cbranch_vccnz KF_fx2
KF_bk2:
v_mfma_f32_16x16x32_bf16 v[64:67], a[192:195], v[160:163], v[128:131]
s_add_u32 m0, s37, s7
ds_read_b128 a[216:219], v8 offset:62976
v_mfma_f32_16x16x32_bf16 v[64:67], a[196:199], v[176:179], v[64:67]
ds_read_b128 a[220:223], v9 offset:62976
v_mfma_f32_16x16x32_bf16 v[64:67], a[200:203], v[192:195], v[64:67]
s_waitcnt lgkmcnt(2)
ds_read_b128 a[224:227], v8 offset:63104
v_mfma_f32_16x16x32_bf16 v[64:67], a[204:207], v[208:211], v[64:67]
ds_read_b128 a[228:231], v9 offset:63104
v_mfma_f32_16x16x32_bf16 v[64:67], a[208:211], v[224:227], v[64:67]
buffer_load_dwordx4 v22, s[16:19], s29 offen nt lds
v_mfma_f32_16x16x32_bf16 v[64:67], a[212:215], v[240:243], v[64:67]
ds_read_b128 a[232:235], v8 offset:63232
ds_read_b128 a[236:239], v9 offset:63232
v_mfma_f32_16x16x32_bf16 v[68:71], a[192:195], v[164:167], v[132:135]
buffer_load_dwordx4 v23, s[16:19], s29 offen offset:1024 nt lds
v_mfma_f32_16x16x32_bf16 v[68:71], a[196:199], v[180:183], v[68:71]
ds_read_b64_tr_b16 v[40:41], v10 offset:49152
v_mfma_f32_16x16x32_bf16 v[68:71], a[200:203], v[196:199], v[68:71]
buffer_load_dwordx4 v24, s[16:19], s29 offen offset:2048 nt lds
v_mfma_f32_16x16x32_bf16 v[68:71], a[204:207], v[212:215], v[68:71]
s_add_u32 m0, s31, s28
ds_read_b64_tr_b16 v[42:43], v10 offset:50688
v_mfma_f32_16x16x32_bf16 v[68:71], a[208:211], v[228:231], v[68:71]
v_exp_f32 v152, v64
v_mfma_f32_16x16x32_bf16 v[68:71], a[212:215], v[244:247], v[68:71]
v_add_f32 v148, v144, v152
v_mfma_f32_16x16x32_bf16 v[72:75], a[192:195], v[168:171], v[136:139]
v_exp_f32 v153, v65
v_mfma_f32_16x16x32_bf16 v[72:75], a[196:199], v[184:187], v[72:75]
ds_read_b64_tr_b16 v[44:45], v11 offset:49152
v_add_f32 v148, v148, v153
v_mfma_f32_16x16x32_bf16 v[72:75], a[200:203], v[200:203], v[72:75]
v_exp_f32 v154, v66
v_mfma_f32_16x16x32_bf16 v[72:75], a[204:207], v[216:219], v[72:75]
ds_read_b64_tr_b16 v[46:47], v11 offset:50688
v_cvt_pk_bf16_f32 v112, v152, v153
v_mfma_f32_16x16x32_bf16 v[72:75], a[208:211], v[232:235], v[72:75]
v_add_f32 v148, v148, v154
v_mfma_f32_16x16x32_bf16 v[72:75], a[212:215], v[248:251], v[72:75]
v_exp_f32 v155, v67
v_mfma_f32_16x16x32_bf16 v[76:79], a[192:195], v[172:175], v[140:143]
ds_read_b64_tr_b16 v[48:49], v12 offset:49152
v_add_f32 v148, v148, v155
v_mfma_f32_16x16x32_bf16 v[76:79], a[196:199], v[188:191], v[76:79]
v_exp_f32 v156, v68
v_mfma_f32_16x16x32_bf16 v[76:79], a[200:203], v[204:207], v[76:79]
v_cvt_pk_bf16_f32 v113, v154, v155
v_add_f32 v149, v145, v156
v_mfma_f32_16x16x32_bf16 v[76:79], a[204:207], v[220:223], v[76:79]
buffer_load_dwordx4 v25, s[20:23], s53 offen nt lds
v_mfma_f32_16x16x32_bf16 v[76:79], a[208:211], v[236:239], v[76:79]
v_exp_f32 v157, v69
v_mfma_f32_16x16x32_bf16 v[76:79], a[212:215], v[252:255], v[76:79]
s_waitcnt lgkmcnt(8)
ds_read_b64_tr_b16 v[50:51], v12 offset:50688
v_add_f32 v149, v149, v157
v_mfma_f32_16x16x32_bf16 v[80:83], a[216:219], v[160:163], v[128:131]
v_exp_f32 v158, v70
v_mfma_f32_16x16x32_bf16 v[80:83], a[220:223], v[176:179], v[80:83]
ds_read_b64_tr_b16 v[52:53], v13 offset:49152
v_cvt_pk_bf16_f32 v116, v156, v157
v_mfma_f32_16x16x32_bf16 v[80:83], a[224:227], v[192:195], v[80:83]
s_waitcnt lgkmcnt(7)
v_exp_f32 v159, v71
v_mfma_f32_16x16x32_bf16 v[80:83], a[228:231], v[208:211], v[80:83]
ds_read_b64_tr_b16 v[54:55], v13 offset:50688
v_add_f32 v149, v149, v158
v_mfma_f32_16x16x32_bf16 v[80:83], a[232:235], v[224:227], v[80:83]
v_add_f32 v149, v149, v159
v_cvt_pk_bf16_f32 v117, v158, v159
v_mfma_f32_16x16x32_bf16 v[80:83], a[236:239], v[240:243], v[80:83]
v_exp_f32 v152, v72
v_mfma_f32_16x16x32_bf16 v[84:87], a[216:219], v[164:167], v[132:135]
ds_read_b64_tr_b16 v[56:57], v10 offset:49280
v_add_f32 v150, v146, v152
v_mfma_f32_16x16x32_bf16 v[84:87], a[220:223], v[180:183], v[84:87]
v_exp_f32 v153, v73
v_mfma_f32_16x16x32_bf16 v[84:87], a[224:227], v[196:199], v[84:87]
v_add_f32 v150, v150, v153
v_cvt_pk_bf16_f32 v120, v152, v153
v_mfma_f32_16x16x32_bf16 v[84:87], a[228:231], v[212:215], v[84:87]
buffer_load_dwordx4 v26, s[20:23], s53 offen offset:1024 nt lds
v_mfma_f32_16x16x32_bf16 v[84:87], a[232:235], v[228:231], v[84:87]
v_exp_f32 v154, v74
v_mfma_f32_16x16x32_bf16 v[84:87], a[236:239], v[244:247], v[84:87]
ds_read_b64_tr_b16 v[58:59], v10 offset:50816
v_add_f32 v150, v150, v154
v_mfma_f32_16x16x32_bf16 v[88:91], a[216:219], v[168:171], v[136:139]
v_exp_f32 v155, v75
v_mfma_f32_16x16x32_bf16 v[88:91], a[220:223], v[184:187], v[88:91]
ds_read_b64_tr_b16 v[60:61], v11 offset:49280
v_add_f32 v150, v150, v155
v_mfma_f32_16x16x32_bf16 v[88:91], a[224:227], v[200:203], v[88:91]
v_exp_f32 v156, v76
v_mfma_f32_16x16x32_bf16 v[88:91], a[228:231], v[216:219], v[88:91]
ds_read_b64_tr_b16 v[62:63], v11 offset:50816
v_cvt_pk_bf16_f32 v121, v154, v155
v_mfma_f32_16x16x32_bf16 v[88:91], a[232:235], v[232:235], v[88:91]
v_add_f32 v151, v147, v156
v_mfma_f32_16x16x32_bf16 v[88:91], a[236:239], v[248:251], v[88:91]
v_exp_f32 v157, v77
v_mfma_f32_16x16x32_bf16 v[92:95], a[216:219], v[172:175], v[140:143]
v_add_f32 v151, v151, v157
v_cvt_pk_bf16_f32 v124, v156, v157
v_mfma_f32_16x16x32_bf16 v[92:95], a[220:223], v[188:191], v[92:95]
v_exp_f32 v158, v78
v_mfma_f32_16x16x32_bf16 v[92:95], a[224:227], v[204:207], v[92:95]
v_add_f32 v151, v151, v158
v_mfma_f32_16x16x32_bf16 v[92:95], a[228:231], v[220:223], v[92:95]
buffer_load_dwordx4 v27, s[20:23], s53 offen offset:2048 nt lds
v_mfma_f32_16x16x32_bf16 v[92:95], a[232:235], v[236:239], v[92:95]
s_add_u32 s4, s4, 1
v_exp_f32 v159, v79
v_mfma_f32_16x16x32_bf16 v[92:95], a[236:239], v[252:255], v[92:95]
s_waitcnt lgkmcnt(10)
v_add_f32 v151, v151, v159
v_cvt_pk_bf16_f32 v125, v158, v159
v_mfma_f32_16x16x32_bf16 a[0:3], v[40:43], v[96:99], a[0:3]
s_bitcmp0_b32 s5, s4
v_exp_f32 v152, v80
v_mfma_f32_16x16x32_bf16 a[4:7], v[40:43], v[100:103], a[4:7]
s_cselect_b32 s28, s6, 73728
v_add_f32 v148, v148, v152
v_mfma_f32_16x16x32_bf16 a[8:11], v[40:43], v[104:107], a[8:11]
s_cselect_b32 s30, 12288, 0
v_exp_f32 v153, v81
v_mfma_f32_16x16x32_bf16 a[12:15], v[40:43], v[108:111], a[12:15]
s_waitcnt lgkmcnt(8)
ds_read_b64_tr_b16 v[40:41], v12 offset:49280
v_add_f32 v148, v148, v153
v_mfma_f32_16x16x32_bf16 a[16:19], v[44:47], v[96:99], a[16:19]
s_cselect_b32 s53, s42, 1073741824
ds_read_b64_tr_b16 v[42:43], v12 offset:50816
v_cvt_pk_bf16_f32 v114, v152, v153
v_mfma_f32_16x16x32_bf16 a[20:23], v[44:47], v[100:103], a[20:23]
s_addc_u32 s1, s1, 0
v_exp_f32 v154, v82
v_mfma_f32_16x16x32_bf16 a[24:27], v[44:47], v[104:107], a[24:27]
s_cmp_eq_u32 s1, 30
v_add_f32 v148, v148, v154
v_mfma_f32_16x16x32_bf16 a[28:31], v[44:47], v[108:111], a[28:31]
s_waitcnt lgkmcnt(8)
v_exp_f32 v155, v83
v_mfma_f32_16x16x32_bf16 a[32:35], v[48:51], v[96:99], a[32:35]
s_cselect_b32 s1, 0, s1
ds_read_b64_tr_b16 v[44:45], v13 offset:49280
v_add_f32 v148, v148, v155
v_mfma_f32_16x16x32_bf16 a[36:39], v[48:51], v[100:103], a[36:39]
s_cmp_ge_u32 s1, 10
ds_read_b64_tr_b16 v[46:47], v13 offset:50816
v_cvt_pk_bf16_f32 v115, v154, v155
v_mfma_f32_16x16x32_bf16 a[40:43], v[48:51], v[104:107], a[40:43]
s_cselect_b32 s3, s52, 0
v_exp_f32 v156, v84
v_mfma_f32_16x16x32_bf16 a[44:47], v[48:51], v[108:111], a[44:47]
s_waitcnt lgkmcnt(8)
ds_read_b64_tr_b16 v[48:49], v10 offset:49408
v_add_f32 v149, v149, v156
v_mfma_f32_16x16x32_bf16 a[48:51], v[52:55], v[96:99], a[48:51]
s_cmp_ge_u32 s1, 20
v_exp_f32 v157, v85
v_mfma_f32_16x16x32_bf16 a[52:55], v[52:55], v[100:103], a[52:55]
s_cselect_b32 s3, s45, s3
ds_read_b64_tr_b16 v[50:51], v10 offset:50944
v_add_f32 v149, v149, v157
v_mfma_f32_16x16x32_bf16 a[56:59], v[52:55], v[104:107], a[56:59]
s_mul_i32 s42, s1, 3072
v_exp_f32 v158, v86
v_mfma_f32_16x16x32_bf16 a[60:63], v[52:55], v[108:111], a[60:63]
s_waitcnt lgkmcnt(8)
ds_read_b64_tr_b16 v[52:53], v11 offset:49408
v_cvt_pk_bf16_f32 v118, v156, v157
v_mfma_f32_16x16x32_bf16 a[64:67], v[56:59], v[96:99], a[64:67]
s_add_u32 s42, s42, s3
ds_read_b64_tr_b16 v[54:55], v11 offset:50944
v_add_f32 v149, v149, v158
v_mfma_f32_16x16x32_bf16 a[68:71], v[56:59], v[100:103], a[68:71]
s_add_u32 s6, s6, s30
v_exp_f32 v159, v87
v_mfma_f32_16x16x32_bf16 a[72:75], v[56:59], v[104:107], a[72:75]
s_cmp_eq_u32 s6, 73728
v_add_f32 v149, v149, v159
v_cvt_pk_bf16_f32 v119, v158, v159
v_mfma_f32_16x16x32_bf16 a[76:79], v[56:59], v[108:111], a[76:79]
s_waitcnt lgkmcnt(8)
v_exp_f32 v152, v88
v_mfma_f32_16x16x32_bf16 a[80:83], v[60:63], v[96:99], a[80:83]
s_cselect_b32 s6, 0, s6
ds_read_b64_tr_b16 v[56:57], v12 offset:49408
v_add_f32 v150, v150, v152
v_mfma_f32_16x16x32_bf16 a[84:87], v[60:63], v[100:103], a[84:87]
s_cmp_eq_u32 s30, 0
ds_read_b64_tr_b16 v[58:59], v12 offset:50944
v_mfma_f32_16x16x32_bf16 a[88:91], v[60:63], v[104:107], a[88:91]
s_cselect_b32 s7, 147456, s6
v_exp_f32 v153, v89
v_mfma_f32_16x16x32_bf16 a[92:95], v[60:63], v[108:111], a[92:95]
s_waitcnt lgkmcnt(8)
ds_read_b64_tr_b16 v[60:61], v13 offset:49408
ds_read_b64_tr_b16 v[62:63], v13 offset:50944
v_mfma_f32_16x16x32_bf16 a[96:99], v[40:43], v[96:99], a[96:99]
s_cselect_b32 s29, 1073741824, s42
v_exp_f32 v154, v90
v_mfma_f32_16x16x32_bf16 a[100:103], v[40:43], v[100:103], a[100:103]
v_add_f32 v150, v150, v153
v_cvt_pk_bf16_f32 v122, v152, v153
v_mfma_f32_16x16x32_bf16 a[104:107], v[40:43], v[104:107], a[104:107]
v_exp_f32 v155, v91
v_mfma_f32_16x16x32_bf16 a[108:111], v[40:43], v[108:111], a[108:111]
s_waitcnt lgkmcnt(8)
v_add_f32 v150, v150, v154
v_add_f32 v150, v150, v155
v_mfma_f32_16x16x32_bf16 a[112:115], v[44:47], v[96:99], a[112:115]
v_cvt_pk_bf16_f32 v123, v154, v155
v_mfma_f32_16x16x32_bf16 a[116:119], v[44:47], v[100:103], a[116:119]
v_exp_f32 v156, v92
v_mfma_f32_16x16x32_bf16 a[120:123], v[44:47], v[104:107], a[120:123]
v_add_f32 v151, v151, v156
v_mfma_f32_16x16x32_bf16 a[124:127], v[44:47], v[108:111], a[124:127]
s_waitcnt lgkmcnt(6)
v_exp_f32 v157, v93
v_mfma_f32_16x16x32_bf16 a[128:131], v[48:51], v[96:99], a[128:131]
s_waitcnt vmcnt(6) lgkmcnt(0)
v_add_f32 v151, v151, v157
v_cvt_pk_bf16_f32 v126, v156, v157
v_mfma_f32_16x16x32_bf16 a[132:135], v[48:51], v[100:103], a[132:135]
s_barrier
v_mfma_f32_16x16x32_bf16 a[136:139], v[48:51], v[104:107], a[136:139]
v_exp_f32 v158, v94
v_mfma_f32_16x16x32_bf16 a[140:143], v[48:51], v[108:111], a[140:143]
ds_read_b128 a[192:195], v8 offset:0
v_add_f32 v151, v151, v158
v_mfma_f32_16x16x32_bf16 a[144:147], v[52:55], v[96:99], a[144:147]
v_exp_f32 v159, v95
v_mfma_f32_16x16x32_bf16 a[148:151], v[52:55], v[100:103], a[148:151]
ds_read_b128 a[196:199], v9 offset:0
v_add_f32 v151, v151, v159
v_mfma_f32_16x16x32_bf16 a[152:155], v[52:55], v[104:107], a[152:155]
ds_read_b128 a[200:203], v8 offset:128
v_cvt_pk_bf16_f32 v127, v158, v159
v_mfma_f32_16x16x32_bf16 a[156:159], v[52:55], v[108:111], a[156:159]
ds_read_b128 a[204:207], v9 offset:128
ds_read_b128 a[208:211], v8 offset:256
v_mfma_f32_16x16x32_bf16 a[160:163], v[56:59], v[96:99], a[160:163]
ds_read_b128 a[212:215], v9 offset:256
v_mfma_f32_16x16x32_bf16 a[164:167], v[56:59], v[100:103], a[164:167]
v_mfma_f32_16x16x32_bf16 a[168:171], v[56:59], v[104:107], a[168:171]
v_mfma_f32_16x16x32_bf16 a[172:175], v[56:59], v[108:111], a[172:175]
v_mfma_f32_16x16x32_bf16 a[176:179], v[60:63], v[96:99], a[176:179]
v_max3_f32 v1, v148, v149, v150
v_max_f32 v1, v1, v151
v_mfma_f32_16x16x32_bf16 a[180:183], v[60:63], v[100:103], a[180:183]
v_cmp_nge_f32 vcc, s44, v1
v_mfma_f32_16x16x32_bf16 a[184:187], v[60:63], v[104:107], a[184:187]
s_waitcnt lgkmcnt(3)
v_mfma_f32_16x16x32_bf16 a[188:191], v[60:63], v[108:111], a[188:191]
s_cbranch_vccnz KF_fx3
KF_bk3:
v_mfma_f32_16x16x32_bf16 v[64:67], a[192:195], v[160:163], v[128:131]
s_add_u32 m0, s37, s7
ds_read_b128 a[216:219], v8 offset:1536
v_mfma_f32_16x16x32_bf16 v[64:67], a[196:199], v[176:179], v[64:67]
ds_read_b128 a[220:223], v9 offset:1536
v_mfma_f32_16x16x32_bf16 v[64:67], a[200:203], v[192:195], v[64:67]
s_waitcnt lgkmcnt(2)
ds_read_b128 a[224:227], v8 offset:1664
v_mfma_f32_16x16x32_bf16 v[64:67], a[204:207], v[208:211], v[64:67]
ds_read_b128 a[228:231], v9 offset:1664
v_mfma_f32_16x16x32_bf16 v[64:67], a[208:211], v[224:227], v[64:67]
buffer_load_dwordx4 v22, s[16:19], s29 offen nt lds
v_mfma_f32_16x16x32_bf16 v[64:67], a[212:215], v[240:243], v[64:67]
ds_read_b128 a[232:235], v8 offset:1792
ds_read_b128 a[236:239], v9 offset:1792
v_mfma_f32_16x16x32_bf16 v[68:71], a[192:195], v[164:167], v[132:135]
buffer_load_dwordx4 v23, s[16:19], s29 offen offset:1024 nt lds
v_mfma_f32_16x16x32_bf16 v[68:71], a[196:199], v[180:183], v[68:71]
KF_pg7:
s_cbranch_execz KF_pg11
ds_read_b64_tr_b16 v[40:41], v10 offset:61440
v_mfma_f32_16x16x32_bf16 v[68:71], a[200:203], v[196:199], v[68:71]
buffer_load_dwordx4 v24, s[16:19], s29 offen offset:2048 nt lds
v_mfma_f32_16x16x32_bf16 v[68:71], a[204:207], v[212:215], v[68:71]
s_add_u32 m0, s31, s28
ds_read_b64_tr_b16 v[42:43], v10 offset:62976
v_mfma_f32_16x16x32_bf16 v[68:71], a[208:211], v[228:231], v[68:71]
v_exp_f32 v152, v64
v_mfma_f32_16x16x32_bf16 v[68:71], a[212:215], v[244:247], v[68:71]
v_add_f32 v144, v148, v152
v_mfma_f32_16x16x32_bf16 v[72:75], a[192:195], v[168:171], v[136:139]
v_exp_f32 v153, v65
v_mfma_f32_16x16x32_bf16 v[72:75], a[196:199], v[184:187], v[72:75]
ds_read_b64_tr_b16 v[44:45], v11 offset:61440
v_add_f32 v144, v144, v153
v_mfma_f32_16x16x32_bf16 v[72:75], a[200:203], v[200:203], v[72:75]
v_exp_f32 v154, v66
v_mfma_f32_16x16x32_bf16 v[72:75], a[204:207], v[216:219], v[72:75]
ds_read_b64_tr_b16 v[46:47], v11 offset:62976
v_cvt_pk_bf16_f32 v96, v152, v153
v_mfma_f32_16x16x32_bf16 v[72:75], a[208:211], v[232:235], v[72:75]
v_add_f32 v144, v144, v154
v_mfma_f32_16x16x32_bf16 v[72:75], a[212:215], v[248:251], v[72:75]
v_exp_f32 v155, v67
v_mfma_f32_16x16x32_bf16 v[76:79], a[192:195], v[172:175], v[140:143]
ds_read_b64_tr_b16 v[48:49], v12 offset:61440
v_add_f32 v144, v144, v155
v_mfma_f32_16x16x32_bf16 v[76:79], a[196:199], v[188:191], v[76:79]
v_exp_f32 v156, v68
v_mfma_f32_16x16x32_bf16 v[76:79], a[200:203], v[204:207], v[76:79]
v_cvt_pk_bf16_f32 v97, v154, v155
v_add_f32 v145, v149, v156
v_mfma_f32_16x16x32_bf16 v[76:79], a[204:207], v[220:223], v[76:79]
buffer_load_dwordx4 v25, s[20:23], s53 offen nt lds
v_mfma_f32_16x16x32_bf16 v[76:79], a[208:211], v[236:239], v[76:79]
v_exp_f32 v157, v69
v_mfma_f32_16x16x32_bf16 v[76:79], a[212:215], v[252:255], v[76:79]
s_waitcnt lgkmcnt(8)
ds_read_b64_tr_b16 v[50:51], v12 offset:62976
v_add_f32 v145, v145, v157
v_mfma_f32_16x16x32_bf16 v[80:83], a[216:219], v[160:163], v[128:131]
v_exp_f32 v158, v70
v_mfma_f32_16x16x32_bf16 v[80:83], a[220:223], v[176:179], v[80:83]
ds_read_b64_tr_b16 v[52:53], v13 offset:61440
v_cvt_pk_bf16_f32 v100, v156, v157
v_mfma_f32_16x16x32_bf16 v[80:83], a[224:227], v[192:195], v[80:83]
s_waitcnt lgkmcnt(7)
v_exp_f32 v159, v71
v_mfma_f32_16x16x32_bf16 v[80:83], a[228:231], v[208:211], v[80:83]
ds_read_b64_tr_b16 v[54:55], v13 offset:62976
v_add_f32 v145, v145, v158
v_mfma_f32_16x16x32_bf16 v[80:83], a[232:235], v[224:227], v[80:83]
v_add_f32 v145, v145, v159
v_cvt_pk_bf16_f32 v101, v158, v159
v_mfma_f32_16x16x32_bf16 v[80:83], a[236:239], v[240:243], v[80:83]
v_exp_f32 v152, v72
v_mfma_f32_16x16x32_bf16 v[84:87], a[216:219], v[164:167], v[132:135]
ds_read_b64_tr_b16 v[56:57], v10 offset:61568
v_add_f32 v146, v150, v152
v_mfma_f32_16x16x32_bf16 v[84:87], a[220:223], v[180:183], v[84:87]
v_exp_f32 v153, v73
v_mfma_f32_16x16x32_bf16 v[84:87], a[224:227], v[196:199], v[84:87]
v_add_f32 v146, v146, v153
v_cvt_pk_bf16_f32 v104, v152, v153
v_mfma_f32_16x16x32_bf16 v[84:87], a[228:231], v[212:215], v[84:87]
buffer_load_dwordx4 v26, s[20:23], s53 offen offset:1024 nt lds
v_mfma_f32_16x16x32_bf16 v[84:87], a[232:235], v[228:231], v[84:87]
v_exp_f32 v154, v74
v_mfma_f32_16x16x32_bf16 v[84:87], a[236:239], v[244:247], v[84:87]
ds_read_b64_tr_b16 v[58:59], v10 offset:63104
v_add_f32 v146, v146, v154
v_mfma_f32_16x16x32_bf16 v[88:91], a[216:219], v[168:171], v[136:139]
v_exp_f32 v155, v75
v_mfma_f32_16x16x32_bf16 v[88:91], a[220:223], v[184:187], v[88:91]
ds_read_b64_tr_b16 v[60:61], v11 offset:61568
v_add_f32 v146, v146, v155
v_mfma_f32_16x16x32_bf16 v[88:91], a[224:227], v[200:203], v[88:91]
v_exp_f32 v156, v76
v_mfma_f32_16x16x32_bf16 v[88:91], a[228:231], v[216:219], v[88:91]
ds_read_b64_tr_b16 v[62:63], v11 offset:63104
v_cvt_pk_bf16_f32 v105, v154, v155
v_mfma_f32_16x16x32_bf16 v[88:91], a[232:235], v[232:235], v[88:91]
v_add_f32 v147, v151, v156
v_mfma_f32_16x16x32_bf16 v[88:91], a[236:239], v[248:251], v[88:91]
v_exp_f32 v157, v77
v_mfma_f32_16x16x32_bf16 v[92:95], a[216:219], v[172:175], v[140:143]
v_add_f32 v147, v147, v157
v_cvt_pk_bf16_f32 v108, v156, v157
v_mfma_f32_16x16x32_bf16 v[92:95], a[220:223], v[188:191], v[92:95]
v_exp_f32 v158, v78
v_mfma_f32_16x16x32_bf16 v[92:95], a[224:227], v[204:207], v[92:95]
v_add_f32 v147, v147, v158
v_mfma_f32_16x16x32_bf16 v[92:95], a[228:231], v[220:223], v[92:95]
buffer_load_dwordx4 v27, s[20:23], s53 offen offset:2048 nt lds
v_mfma_f32_16x16x32_bf16 v[92:95], a[232:235], v[236:239], v[92:95]
s_add_u32 s4, s4, 1
v_exp_f32 v159, v79
v_mfma_f32_16x16x32_bf16 v[92:95], a[236:239], v[252:255], v[92:95]
s_waitcnt lgkmcnt(10)
v_add_f32 v147, v147, v159
v_cvt_pk_bf16_f32 v109, v158, v159
v_mfma_f32_16x16x32_bf16 a[0:3], v[40:43], v[112:115], a[0:3]
s_bitcmp0_b32 s5, s4
v_exp_f32 v152, v80
v_mfma_f32_16x16x32_bf16 a[4:7], v[40:43], v[116:119], a[4:7]
s_cselect_b32 s28, s6, 73728
v_add_f32 v144, v144, v152
v_mfma_f32_16x16x32_bf16 a[8:11], v[40:43], v[120:123], a[8:11]
s_cselect_b32 s30, 12288, 0
v_exp_f32 v153, v81
v_mfma_f32_16x16x32_bf16 a[12:15], v[40:43], v[124:127], a[12:15]
s_waitcnt lgkmcnt(8)
ds_read_b64_tr_b16 v[40:41], v12 offset:61568
v_add_f32 v144, v144, v153
v_mfma_f32_16x16x32_bf16 a[16:19], v[44:47], v[112:115], a[16:19]
s_cselect_b32 s53, s42, 1073741824
ds_read_b64_tr_b16 v[42:43], v12 offset:63104
v_cvt_pk_bf16_f32 v98, v152, v153
v_mfma_f32_16x16x32_bf16 a[20:23], v[44:47], v[116:119], a[20:23]
s_addc_u32 s1, s1, 0
v_exp_f32 v154, v82
v_mfma_f32_16x16x32_bf16 a[24:27], v[44:47], v[120:123], a[24:27]
s_cmp_eq_u32 s1, 30
v_add_f32 v144, v144, v154
v_mfma_f32_16x16x32_bf16 a[28:31], v[44:47], v[124:127], a[28:31]
s_waitcnt lgkmcnt(8)
v_exp_f32 v155, v83
v_mfma_f32_16x16x32_bf16 a[32:35], v[48:51], v[112:115], a[32:35]
s_cselect_b32 s1, 0, s1
ds_read_b64_tr_b16 v[44:45], v13 offset:61568
v_add_f32 v144, v144, v155
v_mfma_f32_16x16x32_bf16 a[36:39], v[48:51], v[116:119], a[36:39]
s_cmp_ge_u32 s1, 10
ds_read_b64_tr_b16 v[46:47], v13 offset:63104
v_cvt_pk_bf16_f32 v99, v154, v155
v_mfma_f32_16x16x32_bf16 a[40:43], v[48:51], v[120:123], a[40:43]
s_cselect_b32 s3, s52, 0
v_exp_f32 v156, v84
v_mfma_f32_16x16x32_bf16 a[44:47], v[48:51], v[124:127], a[44:47]
s_waitcnt lgkmcnt(8)
ds_read_b64_tr_b16 v[48:49], v10 offset:61696
v_add_f32 v145, v145, v156
v_mfma_f32_16x16x32_bf16 a[48:51], v[52:55], v[112:115], a[48:51]
s_cmp_ge_u32 s1, 20
v_exp_f32 v157, v85
v_mfma_f32_16x16x32_bf16 a[52:55], v[52:55], v[116:119], a[52:55]
s_cselect_b32 s3, s45, s3
ds_read_b64_tr_b16 v[50:51], v10 offset:63232
v_add_f32 v145, v145, v157
v_mfma_f32_16x16x32_bf16 a[56:59], v[52:55], v[120:123], a[56:59]
s_mul_i32 s42, s1, 3072
v_exp_f32 v158, v86
v_mfma_f32_16x16x32_bf16 a[60:63], v[52:55], v[124:127], a[60:63]
s_waitcnt lgkmcnt(8)
ds_read_b64_tr_b16 v[52:53], v11 offset:61696
v_cvt_pk_bf16_f32 v102, v156, v157
v_mfma_f32_16x16x32_bf16 a[64:67], v[56:59], v[112:115], a[64:67]
s_add_u32 s42, s42, s3
ds_read_b64_tr_b16 v[54:55], v11 offset:63232
v_add_f32 v145, v145, v158
v_mfma_f32_16x16x32_bf16 a[68:71], v[56:59], v[116:119], a[68:71]
s_add_u32 s6, s6, s30
v_exp_f32 v159, v87
v_mfma_f32_16x16x32_bf16 a[72:75], v[56:59], v[120:123], a[72:75]
s_cmp_eq_u32 s6, 73728
v_add_f32 v145, v145, v159
v_cvt_pk_bf16_f32 v103, v158, v159
v_mfma_f32_16x16x32_bf16 a[76:79], v[56:59], v[124:127], a[76:79]
s_waitcnt lgkmcnt(8)
v_exp_f32 v152, v88
v_mfma_f32_16x16x32_bf16 a[80:83], v[60:63], v[112:115], a[80:83]
s_cselect_b32 s6, 0, s6
ds_read_b64_tr_b16 v[56:57], v12 offset:61696
v_add_f32 v146, v146, v152
v_mfma_f32_16x16x32_bf16 a[84:87], v[60:63], v[116:119], a[84:87]
s_cmp_eq_u32 s30, 0
ds_read_b64_tr_b16 v[58:59], v12 offset:63232
v_mfma_f32_16x16x32_bf16 a[88:91], v[60:63], v[120:123], a[88:91]
s_cselect_b32 s7, 147456, s6
v_exp_f32 v153, v89
v_mfma_f32_16x16x32_bf16 a[92:95], v[60:63], v[124:127], a[92:95]
s_waitcnt lgkmcnt(8)
ds_read_b64_tr_b16 v[60:61], v13 offset:61696
ds_read_b64_tr_b16 v[62:63], v13 offset:63232
v_mfma_f32_16x16x32_bf16 a[96:99], v[40:43], v[112:115], a[96:99]
s_cselect_b32 s29, 1073741824, s42
v_exp_f32 v154, v90
v_mfma_f32_16x16x32_bf16 a[100:103], v[40:43], v[116:119], a[100:103]
v_add_f32 v146, v146, v153
v_cvt_pk_bf16_f32 v106, v152, v153
v_mfma_f32_16x16x32_bf16 a[104:107], v[40:43], v[120:123], a[104:107]
v_exp_f32 v155, v91
v_mfma_f32_16x16x32_bf16 a[108:111], v[40:43], v[124:127], a[108:111]
s_waitcnt lgkmcnt(8)
v_add_f32 v146, v146, v154
v_add_f32 v146, v146, v155
v_mfma_f32_16x16x32_bf16 a[112:115], v[44:47], v[112:115], a[112:115]
v_cvt_pk_bf16_f32 v107, v154, v155
v_mfma_f32_16x16x32_bf16 a[116:119], v[44:47], v[116:119], a[116:119]
v_exp_f32 v156, v92
v_mfma_f32_16x16x32_bf16 a[120:123], v[44:47], v[120:123], a[120:123]
v_add_f32 v147, v147, v156
v_mfma_f32_16x16x32_bf16 a[124:127], v[44:47], v[124:127], a[124:127]
s_waitcnt lgkmcnt(6)
v_exp_f32 v157, v93
v_mfma_f32_16x16x32_bf16 a[128:131], v[48:51], v[112:115], a[128:131]
s_waitcnt vmcnt(6) lgkmcnt(0)
v_add_f32 v147, v147, v157
v_cvt_pk_bf16_f32 v110, v156, v157
v_mfma_f32_16x16x32_bf16 a[132:135], v[48:51], v[116:119], a[132:135]
s_barrier
v_mfma_f32_16x16x32_bf16 a[136:139], v[48:51], v[120:123], a[136:139]
v_exp_f32 v158, v94
v_mfma_f32_16x16x32_bf16 a[140:143], v[48:51], v[124:127], a[140:143]
ds_read_b128 a[192:195], v8 offset:12288
v_add_f32 v147, v147, v158
v_mfma_f32_16x16x32_bf16 a[144:147], v[52:55], v[112:115], a[144:147]
v_exp_f32 v159, v95
v_mfma_f32_16x16x32_bf16 a[148:151], v[52:55], v[116:119], a[148:151]
ds_read_b128 a[196:199], v9 offset:12288
v_add_f32 v147, v147, v159
v_mfma_f32_16x16x32_bf16 a[152:155], v[52:55], v[120:123], a[152:155]
ds_read_b128 a[200:203], v8 offset:12416
v_cvt_pk_bf16_f32 v111, v158, v159
v_mfma_f32_16x16x32_bf16 a[156:159], v[52:55], v[124:127], a[156:159]
ds_read_b128 a[204:207], v9 offset:12416
ds_read_b128 a[208:211], v8 offset:12544
v_mfma_f32_16x16x32_bf16 a[160:163], v[56:59], v[112:115], a[160:163]
ds_read_b128 a[212:215], v9 offset:12544
v_mfma_f32_16x16x32_bf16 a[164:167], v[56:59], v[116:119], a[164:167]
v_mfma_f32_16x16x32_bf16 a[168:171], v[56:59], v[120:123], a[168:171]
v_mfma_f32_16x16x32_bf16 a[172:175], v[56:59], v[124:127], a[172:175]
v_mfma_f32_16x16x32_bf16 a[176:179], v[60:63], v[112:115], a[176:179]
v_max3_f32 v1, v144, v145, v146
v_max_f32 v1, v1, v147
v_mfma_f32_16x16x32_bf16 a[180:183], v[60:63], v[116:119], a[180:183]
v_cmp_nge_f32 vcc, s44, v1
v_mfma_f32_16x16x32_bf16 a[184:187], v[60:63], v[120:123], a[184:187]
s_waitcnt lgkmcnt(3)
v_mfma_f32_16x16x32_bf16 a[188:191], v[60:63], v[124:127], a[188:191]
s_cbranch_vccnz KF_fx4
KF_bk4:
v_mfma_f32_16x16x32_bf16 v[64:67], a[192:195], v[160:163], v[128:131]
s_add_u32 m0, s37, s7
ds_read_b128 a[216:219], v8 offset:13824
v_mfma_f32_16x16x32_bf16 v[64:67], a[196:199], v[176:179], v[64:67]
ds_read_b128 a[220:223], v9 offset:13824
v_mfma_f32_16x16x32_bf16 v[64:67], a[200:203], v[192:195], v[64:67]
s_waitcnt lgkmcnt(2)
ds_read_b128 a[224:227], v8 offset:13952
v_mfma_f32_16x16x32_bf16 v[64:67], a[204:207], v[208:211], v[64:67]
ds_read_b128 a[228:231], v9 offset:13952
v_mfma_f32_16x16x32_bf16 v[64:67], a[208:211], v[224:227], v[64:67]
buffer_load_dwordx4 v22, s[16:19], s29 offen nt lds
v_mfma_f32_16x16x32_bf16 v[64:67], a[212:215], v[240:243], v[64:67]
ds_read_b128 a[232:235], v8 offset:14080
ds_read_b128 a[236:239], v9 offset:14080
v_mfma_f32_16x16x32_bf16 v[68:71], a[192:195], v[164:167], v[132:135]
buffer_load_dwordx4 v23, s[16:19], s29 offen offset:1024 nt lds
v_mfma_f32_16x16x32_bf16 v[68:71], a[196:199], v[180:183], v[68:71]
ds_read_b64_tr_b16 v[40:41], v10 offset:0
v_mfma_f32_16x16x32_bf16 v[68:71], a[200:203], v[196:199], v[68:71]
buffer_load_dwordx4 v24, s[16:19], s29 offen offset:2048 nt lds
v_mfma_f32_16x16x32_bf16 v[68:71], a[204:207], v[212:215], v[68:71]
s_add_u32 m0, s31, s28
ds_read_b64_tr_b16 v[42:43], v10 offset:1536
v_mfma_f32_16x16x32_bf16 v[68:71], a[208:211], v[228:231], v[68:71]
v_exp_f32 v152, v64
v_mfma_f32_16x16x32_bf16 v[68:71], a[212:215], v[244:247], v[68:71]
v_add_f32 v148, v144, v152
v_mfma_f32_16x16x32_bf16 v[72:75], a[192:195], v[168:171], v[136:139]
v_exp_f32 v153, v65
v_mfma_f32_16x16x32_bf16 v[72:75], a[196:199], v[184:187], v[72:75]
ds_read_b64_tr_b16 v[44:45], v11 offset:0
v_add_f32 v148, v148, v153
v_mfma_f32_16x16x32_bf16 v[72:75], a[200:203], v[200:203], v[72:75]
v_exp_f32 v154, v66
v_mfma_f32_16x16x32_bf16 v[72:75], a[204:207], v[216:219], v[72:75]
ds_read_b64_tr_b16 v[46:47], v11 offset:1536
v_cvt_pk_bf16_f32 v112, v152, v153
v_mfma_f32_16x16x32_bf16 v[72:75], a[208:211], v[232:235], v[72:75]
v_add_f32 v148, v148, v154
v_mfma_f32_16x16x32_bf16 v[72:75], a[212:215], v[248:251], v[72:75]
v_exp_f32 v155, v67
v_mfma_f32_16x16x32_bf16 v[76:79], a[192:195], v[172:175], v[140:143]
ds_read_b64_tr_b16 v[48:49], v12 offset:0
v_add_f32 v148, v148, v155
v_mfma_f32_16x16x32_bf16 v[76:79], a[196:199], v[188:191], v[76:79]
v_exp_f32 v156, v68
v_mfma_f32_16x16x32_bf16 v[76:79], a[200:203], v[204:207], v[76:79]
v_cvt_pk_bf16_f32 v113, v154, v155
v_add_f32 v149, v145, v156
v_mfma_f32_16x16x32_bf16 v[76:79], a[204:207], v[220:223], v[76:79]
buffer_load_dwordx4 v25, s[20:23], s53 offen nt lds
v_mfma_f32_16x16x32_bf16 v[76:79], a[208:211], v[236:239], v[76:79]
v_exp_f32 v157, v69
v_mfma_f32_16x16x32_bf16 v[76:79], a[212:215], v[252:255], v[76:79]
s_waitcnt lgkmcnt(8)
ds_read_b64_tr_b16 v[50:51], v12 offset:1536
v_add_f32 v149, v149, v157
v_mfma_f32_16x16x32_bf16 v[80:83], a[216:219], v[160:163], v[128:131]
v_exp_f32 v158, v70
v_mfma_f32_16x16x32_bf16 v[80:83], a[220:223], v[176:179], v[80:83]
ds_read_b64_tr_b16 v[52:53], v13 offset:0
v_cvt_pk_bf16_f32 v116, v156, v157
v_mfma_f32_16x16x32_bf16 v[80:83], a[224:227], v[192:195], v[80:83]
s_waitcnt lgkmcnt(7)
v_exp_f32 v159, v71
v_mfma_f32_16x16x32_bf16 v[80:83], a[228:231], v[208:211], v[80:83]
ds_read_b64_tr_b16 v[54:55], v13 offset:1536
v_add_f32 v149, v149, v158
v_mfma_f32_16x16x32_bf16 v[80:83], a[232:235], v[224:227], v[80:83]
v_add_f32 v149, v149, v159
v_cvt_pk_bf16_f32 v117, v158, v159
v_mfma_f32_16x16x32_bf16 v[80:83], a[236:239], v[240:243], v[80:83]
v_exp_f32 v152, v72
v_mfma_f32_16x16x32_bf16 v[84:87], a[216:219], v[164:167], v[132:135]
ds_read_b64_tr_b16 v[56:57], v10 offset:128
v_add_f32 v150, v146, v152
v_mfma_f32_16x16x32_bf16 v[84:87], a[220:223], v[180:183], v[84:87]
v_exp_f32 v153, v73
v_mfma_f32_16x16x32_bf16 v[84:87], a[224:227], v[196:199], v[84:87]
v_add_f32 v150, v150, v153
v_cvt_pk_bf16_f32 v120, v152, v153
v_mfma_f32_16x16x32_bf16 v[84:87], a[228:231], v[212:215], v[84:87]
buffer_load_dwordx4 v26, s[20:23], s53 offen offset:1024 nt lds
v_mfma_f32_16x16x32_bf16 v[84:87], a[232:235], v[228:231], v[84:87]
v_exp_f32 v154, v74
v_mfma_f32_16x16x32_bf16 v[84:87], a[236:239], v[244:247], v[84:87]
ds_read_b64_tr_b16 v[58:59], v10 offset:1664
v_add_f32 v150, v150, v154
v_mfma_f32_16x16x32_bf16 v[88:91], a[216:219], v[168:171], v[136:139]
v_exp_f32 v155, v75
v_mfma_f32_16x16x32_bf16 v[88:91], a[220:223], v[184:187], v[88:91]
ds_read_b64_tr_b16 v[60:61], v11 offset:128
v_add_f32 v150, v150, v155
v_mfma_f32_16x16x32_bf16 v[88:91], a[224:227], v[200:203], v[88:91]
v_exp_f32 v156, v76
v_mfma_f32_16x16x32_bf16 v[88:91], a[228:231], v[216:219], v[88:91]
ds_read_b64_tr_b16 v[62:63], v11 offset:1664
v_cvt_pk_bf16_f32 v121, v154, v155
v_mfma_f32_16x16x32_bf16 v[88:91], a[232:235], v[232:235], v[88:91]
v_add_f32 v151, v147, v156
v_mfma_f32_16x16x32_bf16 v[88:91], a[236:239], v[248:251], v[88:91]
v_exp_f32 v157, v77
v_mfma_f32_16x16x32_bf16 v[92:95], a[216:219], v[172:175], v[140:143]
v_add_f32 v151, v151, v157
v_cvt_pk_bf16_f32 v124, v156, v157
v_mfma_f32_16x16x32_bf16 v[92:95], a[220:223], v[188:191], v[92:95]
v_exp_f32 v158, v78
v_mfma_f32_16x16x32_bf16 v[92:95], a[224:227], v[204:207], v[92:95]
v_add_f32 v151, v151, v158
v_mfma_f32_16x16x32_bf16 v[92:95], a[228:231], v[220:223], v[92:95]
buffer_load_dwordx4 v27, s[20:23], s53 offen offset:2048 nt lds
v_mfma_f32_16x16x32_bf16 v[92:95], a[232:235], v[236:239], v[92:95]
s_add_u32 s4, s4, 1
v_exp_f32 v159, v79
v_mfma_f32_16x16x32_bf16 v[92:95], a[236:239], v[252:255], v[92:95]
s_waitcnt lgkmcnt(10)
v_add_f32 v151, v151, v159
v_cvt_pk_bf16_f32 v125, v158, v159
v_mfma_f32_16x16x32_bf16 a[0:3], v[40:43], v[96:99], a[0:3]
s_bitcmp0_b32 s5, s4
v_exp_f32 v152, v80
v_mfma_f32_16x16x32_bf16 a[4:7], v[40:43], v[100:103], a[4:7]
s_cselect_b32 s28, s6, 73728
v_add_f32 v148, v148, v152
v_mfma_f32_16x16x32_bf16 a[8:11], v[40:43], v[104:107], a[8:11]
s_cselect_b32 s30, 12288, 0
v_exp_f32 v153, v81
v_mfma_f32_16x16x32_bf16 a[12:15], v[40:43], v[108:111], a[12:15]
s_waitcnt lgkmcnt(8)
ds_read_b64_tr_b16 v[40:41], v12 offset:128
v_add_f32 v148, v148, v153
v_mfma_f32_16x16x32_bf16 a[16:19], v[44:47], v[96:99], a[16:19]
s_cselect_b32 s53, s42, 1073741824
ds_read_b64_tr_b16 v[42:43], v12 offset:1664
v_cvt_pk_bf16_f32 v114, v152, v153
v_mfma_f32_16x16x32_bf16 a[20:23], v[44:47], v[100:103], a[20:23]
s_addc_u32 s1, s1, 0
v_exp_f32 v154, v82
v_mfma_f32_16x16x32_bf16 a[24:27], v[44:47], v[104:107], a[24:27]
s_cmp_eq_u32 s1, 30
v_add_f32 v148, v148, v154
v_mfma_f32_16x16x32_bf16 a[28:31], v[44:47], v[108:111], a[28:31]
s_waitcnt lgkmcnt(8)
v_exp_f32 v155, v83
v_mfma_f32_16x16x32_bf16 a[32:35], v[48:51], v[96:99], a[32:35]
s_cselect_b32 s1, 0, s1
ds_read_b64_tr_b16 v[44:45], v13 offset:128
v_add_f32 v148, v148, v155
v_mfma_f32_16x16x32_bf16 a[36:39], v[48:51], v[100:103], a[36:39]
s_cmp_ge_u32 s1, 10
ds_read_b64_tr_b16 v[46:47], v13 offset:1664
v_cvt_pk_bf16_f32 v115, v154, v155
v_mfma_f32_16x16x32_bf16 a[40:43], v[48:51], v[104:107], a[40:43]
s_cselect_b32 s3, s52, 0
v_exp_f32 v156, v84
v_mfma_f32_16x16x32_bf16 a[44:47], v[48:51], v[108:111], a[44:47]
s_waitcnt lgkmcnt(8)
ds_read_b64_tr_b16 v[48:49], v10 offset:256
v_add_f32 v149, v149, v156
v_mfma_f32_16x16x32_bf16 a[48:51], v[52:55], v[96:99], a[48:51]
s_cmp_ge_u32 s1, 20
v_exp_f32 v157, v85
v_mfma_f32_16x16x32_bf16 a[52:55], v[52:55], v[100:103], a[52:55]
s_cselect_b32 s3, s45, s3
ds_read_b64_tr_b16 v[50:51], v10 offset:1792
v_add_f32 v149, v149, v157
v_mfma_f32_16x16x32_bf16 a[56:59], v[52:55], v[104:107], a[56:59]
s_mul_i32 s42, s1, 3072
v_exp_f32 v158, v86
v_mfma_f32_16x16x32_bf16 a[60:63], v[52:55], v[108:111], a[60:63]
s_waitcnt lgkmcnt(8)
ds_read_b64_tr_b16 v[52:53], v11 offset:256
v_cvt_pk_bf16_f32 v118, v156, v157
v_mfma_f32_16x16x32_bf16 a[64:67], v[56:59], v[96:99], a[64:67]
s_add_u32 s42, s42, s3
ds_read_b64_tr_b16 v[54:55], v11 offset:1792
v_add_f32 v149, v149, v158
v_mfma_f32_16x16x32_bf16 a[68:71], v[56:59], v[100:103], a[68:71]
s_add_u32 s6, s6, s30
v_exp_f32 v159, v87
v_mfma_f32_16x16x32_bf16 a[72:75], v[56:59], v[104:107], a[72:75]
s_cmp_eq_u32 s6, 73728
v_add_f32 v149, v149, v159
v_cvt_pk_bf16_f32 v119, v158, v159
v_mfma_f32_16x16x32_bf16 a[76:79], v[56:59], v[108:111], a[76:79]
s_waitcnt lgkmcnt(8)
v_exp_f32 v152, v88
v_mfma_f32_16x16x32_bf16 a[80:83], v[60:63], v[96:99], a[80:83]
s_cselect_b32 s6, 0, s6
ds_read_b64_tr_b16 v[56:57], v12 offset:256
v_add_f32 v150, v150, v152
v_mfma_f32_16x16x32_bf16 a[84:87], v[60:63], v[100:103], a[84:87]
s_cmp_eq_u32 s30, 0
ds_read_b64_tr_b16 v[58:59], v12 offset:1792
v_mfma_f32_16x16x32_bf16 a[88:91], v[60:63], v[104:107], a[88:91]
s_cselect_b32 s7, 147456, s6
v_exp_f32 v153, v89
v_mfma_f32_16x16x32_bf16 a[92:95], v[60:63], v[108:111], a[92:95]
s_waitcnt lgkmcnt(8)
ds_read_b64_tr_b16 v[60:61], v13 offset:256
ds_read_b64_tr_b16 v[62:63], v13 offset:1792
v_mfma_f32_16x16x32_bf16 a[96:99], v[40:43], v[96:99], a[96:99]
s_cselect_b32 s29, 1073741824, s42
v_exp_f32 v154, v90
v_mfma_f32_16x16x32_bf16 a[100:103], v[40:43], v[100:103], a[100:103]
v_add_f32 v150, v150, v153
v_cvt_pk_bf16_f32 v122, v152, v153
v_mfma_f32_16x16x32_bf16 a[104:107], v[40:43], v[104:107], a[104:107]
v_exp_f32 v155, v91
v_mfma_f32_16x16x32_bf16 a[108:111], v[40:43], v[108:111], a[108:111]
s_waitcnt lgkmcnt(8)
v_add_f32 v150, v150, v154
v_add_f32 v150, v150, v155
v_mfma_f32_16x16x32_bf16 a[112:115], v[44:47], v[96:99], a[112:115]
v_cvt_pk_bf16_f32 v123, v154, v155
v_mfma_f32_16x16x32_bf16 a[116:119], v[44:47], v[100:103], a[116:119]
v_exp_f32 v156, v92
v_mfma_f32_16x16x32_bf16 a[120:123], v[44:47], v[104:107], a[120:123]
v_add_f32 v151, v151, v156
v_mfma_f32_16x16x32_bf16 a[124:127], v[44:47], v[108:111], a[124:127]
s_waitcnt lgkmcnt(6)
v_exp_f32 v157, v93
v_mfma_f32_16x16x32_bf16 a[128:131], v[48:51], v[96:99], a[128:131]
s_waitcnt vmcnt(6) lgkmcnt(0)
v_add_f32 v151, v151, v157
v_cvt_pk_bf16_f32 v126, v156, v157
v_mfma_f32_16x16x32_bf16 a[132:135], v[48:51], v[100:103], a[132:135]
s_barrier
v_mfma_f32_16x16x32_bf16 a[136:139], v[48:51], v[104:107], a[136:139]
s_sub_u32 s43, s43, 1
v_exp_f32 v158, v94
v_mfma_f32_16x16x32_bf16 a[140:143], v[48:51], v[108:111], a[140:143]
ds_read_b128 a[192:195], v8 offset:24576
v_add_f32 v151, v151, v158
v_mfma_f32_16x16x32_bf16 a[144:147], v[52:55], v[96:99], a[144:147]
v_exp_f32 v159, v95
v_mfma_f32_16x16x32_bf16 a[148:151], v[52:55], v[100:103], a[148:151]
ds_read_b128 a[196:199], v9 offset:24576
v_add_f32 v151, v151, v159
v_mfma_f32_16x16x32_bf16 a[152:155], v[52:55], v[104:107], a[152:155]
ds_read_b128 a[200:203], v8 offset:24704
v_cvt_pk_bf16_f32 v127, v158, v159
v_mfma_f32_16x16x32_bf16 a[156:159], v[52:55], v[108:111], a[156:159]
ds_read_b128 a[204:207], v9 offset:24704
ds_read_b128 a[208:211], v8 offset:24832
v_mfma_f32_16x16x32_bf16 a[160:163], v[56:59], v[96:99], a[160:163]
ds_read_b128 a[212:215], v9 offset:24832
v_mfma_f32_16x16x32_bf16 a[164:167], v[56:59], v[100:103], a[164:167]
v_mfma_f32_16x16x32_bf16 a[168:171], v[56:59], v[104:107], a[168:171]
v_mfma_f32_16x16x32_bf16 a[172:175], v[56:59], v[108:111], a[172:175]
v_mfma_f32_16x16x32_bf16 a[176:179], v[60:63], v[96:99], a[176:179]
v_max3_f32 v1, v148, v149, v150
v_max_f32 v1, v1, v151
v_mfma_f32_16x16x32_bf16 a[180:183], v[60:63], v[100:103], a[180:183]
s_waitcnt lgkmcnt(3)
v_cmp_nge_f32 vcc, s44, v1
v_mfma_f32_16x16x32_bf16 a[184:187], v[60:63], v[104:107], a[184:187]
s_cmp_lg_u32 s43, 0
v_mfma_f32_16x16x32_bf16 a[188:191], v[60:63], v[108:111], a[188:191]
s_cbranch_vccnz KF_fx5
KF_bk5:
s_cbranch_scc1 KF_loop
v_mfma_f32_16x16x32_bf16 v[64:67], a[192:195], v[160:163], v[128:131]
s_add_u32 m0, s37, s7
ds_read_b128 a[216:219], v8 offset:26112
v_add_u32 v19, 6144, v18
v_mfma_f32_16x16x32_bf16 v[64:67], a[196:199], v[176:179], v[64:67]
ds_read_b128 a[220:223], v9 offset:26112
v_add_u32 v20, 12288, v18
v_mfma_f32_16x16x32_bf16 v[64:67], a[200:203], v[192:195], v[64:67]
s_waitcnt lgkmcnt(2)
ds_read_b128 a[224:227], v8 offset:26240
v_add_u32 v16, 73728, v14
v_mfma_f32_16x16x32_bf16 v[64:67], a[204:207], v[208:211], v[64:67]
ds_read_b128 a[228:231], v9 offset:26240
v_add_u32 v17, 73728, v15
v_mfma_f32_16x16x32_bf16 v[64:67], a[208:211], v[224:227], v[64:67]
buffer_load_dwordx4 v22, s[16:19], s29 offen nt lds
v_mfma_f32_16x16x32_bf16 v[64:67], a[212:215], v[240:243], v[64:67]
ds_read_b128 a[232:235], v8 offset:26368
ds_read_b128 a[236:239], v9 offset:26368
v_mfma_f32_16x16x32_bf16 v[68:71], a[192:195], v[164:167], v[132:135]
buffer_load_dwordx4 v23, s[16:19], s29 offen offset:1024 nt lds
v_mfma_f32_16x16x32_bf16 v[68:71], a[196:199], v[180:183], v[68:71]
ds_read_b64_tr_b16 v[40:41], v10 offset:12288
v_mfma_f32_16x16x32_bf16 v[68:71], a[200:203], v[196:199], v[68:71]
buffer_load_dwordx4 v24, s[16:19], s29 offen offset:2048 nt lds
v_mfma_f32_16x16x32_bf16 v[68:71], a[204:207], v[212:215], v[68:71]
s_add_u32 m0, s31, s28
ds_read_b64_tr_b16 v[42:43], v10 offset:13824
v_mfma_f32_16x16x32_bf16 v[68:71], a[208:211], v[228:231], v[68:71]
v_exp_f32 v152, v64
v_mfma_f32_16x16x32_bf16 v[68:71], a[212:215], v[244:247], v[68:71]
v_add_f32 v144, v148, v152
v_mfma_f32_16x16x32_bf16 v[72:75], a[192:195], v[168:171], v[136:139]
v_exp_f32 v153, v65
v_mfma_f32_16x16x32_bf16 v[72:75], a[196:199], v[184:187], v[72:75]
ds_read_b64_tr_b16 v[44:45], v11 offset:12288
v_add_f32 v144, v144, v153
v_mfma_f32_16x16x32_bf16 v[72:75], a[200:203], v[200:203], v[72:75]
v_exp_f32 v154, v66
v_mfma_f32_16x16x32_bf16 v[72:75], a[204:207], v[216:219], v[72:75]
ds_read_b64_tr_b16 v[46:47], v11 offset:13824
v_cvt_pk_bf16_f32 v96, v152, v153
v_mfma_f32_16x16x32_bf16 v[72:75], a[208:211], v[232:235], v[72:75]
v_add_f32 v144, v144, v154
v_mfma_f32_16x16x32_bf16 v[72:75], a[212:215], v[248:251], v[72:75]
v_exp_f32 v155, v67
v_mfma_f32_16x16x32_bf16 v[76:79], a[192:195], v[172:175], v[140:143]
ds_read_b64_tr_b16 v[48:49], v12 offset:12288
v_add_f32 v144, v144, v155
v_mfma_f32_16x16x32_bf16 v[76:79], a[196:199], v[188:191], v[76:79]
v_exp_f32 v156, v68
v_mfma_f32_16x16x32_bf16 v[76:79], a[200:203], v[204:207], v[76:79]
v_cvt_pk_bf16_f32 v97, v154, v155
v_add_f32 v145, v149, v156
v_mfma_f32_16x16x32_bf16 v[76:79], a[204:207], v[220:223], v[76:79]
buffer_load_dwordx4 v25, s[20:23], s53 offen nt lds
v_mfma_f32_16x16x32_bf16 v[76:79], a[208:211], v[236:239], v[76:79]
v_exp_f32 v157, v69
v_mfma_f32_16x16x32_bf16 v[76:79], a[212:215], v[252:255], v[76:79]
s_waitcnt lgkmcnt(8)
ds_read_b64_tr_b16 v[50:51], v12 offset:13824
v_add_f32 v145, v145, v157
v_mfma_f32_16x16x32_bf16 v[80:83], a[216:219], v[160:163], v[128:131]
v_exp_f32 v158, v70
v_mfma_f32_16x16x32_bf16 v[80:83], a[220:223], v[176:179], v[80:83]
ds_read_b64_tr_b16 v[52:53], v13 offset:12288
v_cvt_pk_bf16_f32 v100, v156, v157
v_mfma_f32_16x16x32_bf16 v[80:83], a[224:227], v[192:195], v[80:83]
s_waitcnt lgkmcnt(7)
v_exp_f32 v159, v71
v_mfma_f32_16x16x32_bf16 v[80:83], a[228:231], v[208:211], v[80:83]
ds_read_b64_tr_b16 v[54:55], v13 offset:13824
v_add_f32 v145, v145, v158
v_mfma_f32_16x16x32_bf16 v[80:83], a[232:235], v[224:227], v[80:83]
v_add_f32 v145, v145, v159
v_cvt_pk_bf16_f32 v101, v158, v159
v_mfma_f32_16x16x32_bf16 v[80:83], a[236:239], v[240:243], v[80:83]
v_exp_f32 v152, v72
v_mfma_f32_16x16x32_bf16 v[84:87], a[216:219], v[164:167], v[132:135]
ds_read_b64_tr_b16 v[56:57], v10 offset:12416
v_add_f32 v146, v150, v152
v_mfma_f32_16x16x32_bf16 v[84:87], a[220:223], v[180:183], v[84:87]
v_exp_f32 v153, v73
v_mfma_f32_16x16x32_bf16 v[84:87], a[224:227], v[196:199], v[84:87]
v_add_f32 v146, v146, v153
v_cvt_pk_bf16_f32 v104, v152, v153
v_mfma_f32_16x16x32_bf16 v[84:87], a[228:231], v[212:215], v[84:87]
buffer_load_dwordx4 v26, s[20:23], s53 offen offset:1024 nt lds
v_mfma_f32_16x16x32_bf16 v[84:87], a[232:235], v[228:231], v[84:87]
v_exp_f32 v154, v74
v_mfma_f32_16x16x32_bf16 v[84:87], a[236:239], v[244:247], v[84:87]
ds_read_b64_tr_b16 v[58:59], v10 offset:13952
v_add_f32 v146, v146, v154
v_mfma_f32_16x16x32_bf16 v[88:91], a[216:219], v[168:171], v[136:139]
v_exp_f32 v155, v75
v_mfma_f32_16x16x32_bf16 v[88:91], a[220:223], v[184:187], v[88:91]
ds_read_b64_tr_b16 v[60:61], v11 offset:12416
v_add_f32 v146, v146, v155
v_mfma_f32_16x16x32_bf16 v[88:91], a[224:227], v[200:203], v[88:91]
v_exp_f32 v156, v76
v_mfma_f32_16x16x32_bf16 v[88:91], a[228:231], v[216:219], v[88:91]
ds_read_b64_tr_b16 v[62:63], v11 offset:13952
v_cvt_pk_bf16_f32 v105, v154, v155
v_mfma_f32_16x16x32_bf16 v[88:91], a[232:235], v[232:235], v[88:91]
v_add_f32 v147, v151, v156
v_mfma_f32_16x16x32_bf16 v[88:91], a[236:239], v[248:251], v[88:91]
v_exp_f32 v157, v77
v_mfma_f32_16x16x32_bf16 v[92:95], a[216:219], v[172:175], v[140:143]
v_add_f32 v147, v147, v157
v_cvt_pk_bf16_f32 v108, v156, v157
v_mfma_f32_16x16x32_bf16 v[92:95], a[220:223], v[188:191], v[92:95]
v_exp_f32 v158, v78
v_mfma_f32_16x16x32_bf16 v[92:95], a[224:227], v[204:207], v[92:95]
v_add_f32 v147, v147, v158
v_mfma_f32_16x16x32_bf16 v[92:95], a[228:231], v[220:223], v[92:95]
buffer_load_dwordx4 v27, s[20:23], s53 offen offset:2048 nt lds
v_mfma_f32_16x16x32_bf16 v[92:95], a[232:235], v[236:239], v[92:95]
s_add_u32 s4, s4, 1
v_exp_f32 v159, v79
v_mfma_f32_16x16x32_bf16 v[92:95], a[236:239], v[252:255], v[92:95]
s_waitcnt lgkmcnt(10)
v_add_f32 v147, v147, v159
v_cvt_pk_bf16_f32 v109, v158, v159
v_mfma_f32_16x16x32_bf16 a[0:3], v[40:43], v[112:115], a[0:3]
s_bitcmp0_b32 s5, s4
v_exp_f32 v152, v80
KF_pg8:
s_cbranch_execz KF_pg12
v_mfma_f32_16x16x32_bf16 a[4:7], v[40:43], v[116:119], a[4:7]
s_cselect_b32 s28, s6, 73728
v_add_f32 v144, v144, v152
v_mfma_f32_16x16x32_bf16 a[8:11], v[40:43], v[120:123], a[8:11]
s_cselect_b32 s30, 12288, 0
v_exp_f32 v153, v81
v_mfma_f32_16x16x32_bf16 a[12:15], v[40:43], v[124:127], a[12:15]
s_waitcnt lgkmcnt(8)
ds_read_b64_tr_b16 v[40:41], v12 offset:12416
v_add_f32 v144, v144, v153
v_mfma_f32_16x16x32_bf16 a[16:19], v[44:47], v[112:115], a[16:19]
s_cselect_b32 s53, s42, 1073741824
ds_read_b64_tr_b16 v[42:43], v12 offset:13952
v_cvt_pk_bf16_f32 v98, v152, v153
v_mfma_f32_16x16x32_bf16 a[20:23], v[44:47], v[116:119], a[20:23]
s_addc_u32 s1, s1, 0
v_exp_f32 v154, v82
v_mfma_f32_16x16x32_bf16 a[24:27], v[44:47], v[120:123], a[24:27]
s_cmp_eq_u32 s1, 30
v_add_f32 v144, v144, v154
v_mfma_f32_16x16x32_bf16 a[28:31], v[44:47], v[124:127], a[28:31]
s_waitcnt lgkmcnt(8)
v_exp_f32 v155, v83
v_mfma_f32_16x16x32_bf16 a[32:35], v[48:51], v[112:115], a[32:35]
s_cselect_b32 s1, 0, s1
ds_read_b64_tr_b16 v[44:45], v13 offset:12416
v_add_f32 v144, v144, v155
v_mfma_f32_16x16x32_bf16 a[36:39], v[48:51], v[116:119], a[36:39]
s_cmp_ge_u32 s1, 10
ds_read_b64_tr_b16 v[46:47], v13 offset:13952
v_cvt_pk_bf16_f32 v99, v154, v155
v_mfma_f32_16x16x32_bf16 a[40:43], v[48:51], v[120:123], a[40:43]
s_cselect_b32 s3, s52, 0
v_exp_f32 v156, v84
v_mfma_f32_16x16x32_bf16 a[44:47], v[48:51], v[124:127], a[44:47]
s_waitcnt lgkmcnt(8)
ds_read_b64_tr_b16 v[48:49], v10 offset:12544
v_add_f32 v145, v145, v156
v_mfma_f32_16x16x32_bf16 a[48:51], v[52:55], v[112:115], a[48:51]
s_cmp_ge_u32 s1, 20
v_exp_f32 v157, v85
v_mfma_f32_16x16x32_bf16 a[52:55], v[52:55], v[116:119], a[52:55]
s_cselect_b32 s3, s45, s3
ds_read_b64_tr_b16 v[50:51], v10 offset:14080
v_add_f32 v145, v145, v157
v_mfma_f32_16x16x32_bf16 a[56:59], v[52:55], v[120:123], a[56:59]
s_mul_i32 s42, s1, 3072
v_exp_f32 v158, v86
v_mfma_f32_16x16x32_bf16 a[60:63], v[52:55], v[124:127], a[60:63]
s_waitcnt lgkmcnt(8)
ds_read_b64_tr_b16 v[52:53], v11 offset:12544
v_cvt_pk_bf16_f32 v102, v156, v157
v_mfma_f32_16x16x32_bf16 a[64:67], v[56:59], v[112:115], a[64:67]
s_add_u32 s42, s42, s3
ds_read_b64_tr_b16 v[54:55], v11 offset:14080
v_add_f32 v145, v145, v158
v_mfma_f32_16x16x32_bf16 a[68:71], v[56:59], v[116:119], a[68:71]
s_add_u32 s6, s6, s30
v_exp_f32 v159, v87
v_mfma_f32_16x16x32_bf16 a[72:75], v[56:59], v[120:123], a[72:75]
s_cmp_eq_u32 s6, 73728
v_add_f32 v145, v145, v159
v_cvt_pk_bf16_f32 v103, v158, v159
v_mfma_f32_16x16x32_bf16 a[76:79], v[56:59], v[124:127], a[76:79]
s_waitcnt lgkmcnt(8)
v_exp_f32 v152, v88
v_mfma_f32_16x16x32_bf16 a[80:83], v[60:63], v[112:115], a[80:83]
s_cselect_b32 s6, 0, s6
ds_read_b64_tr_b16 v[56:57], v12 offset:12544
v_add_f32 v146, v146, v152
v_mfma_f32_16x16x32_bf16 a[84:87], v[60:63], v[116:119], a[84:87]
s_cmp_eq_u32 s30, 0
ds_read_b64_tr_b16 v[58:59], v12 offset:14080
v_mfma_f32_16x16x32_bf16 a[88:91], v[60:63], v[120:123], a[88:91]
s_cselect_b32 s7, 147456, s6
v_exp_f32 v153, v89
v_mfma_f32_16x16x32_bf16 a[92:95], v[60:63], v[124:127], a[92:95]
s_waitcnt lgkmcnt(8)
ds_read_b64_tr_b16 v[60:61], v13 offset:12544
ds_read_b64_tr_b16 v[62:63], v13 offset:14080
v_mfma_f32_16x16x32_bf16 a[96:99], v[40:43], v[112:115], a[96:99]
s_cselect_b32 s29, 1073741824, s42
v_exp_f32 v154, v90
v_mfma_f32_16x16x32_bf16 a[100:103], v[40:43], v[116:119], a[100:103]
v_add_f32 v146, v146, v153
v_cvt_pk_bf16_f32 v106, v152, v153
v_mfma_f32_16x16x32_bf16 a[104:107], v[40:43], v[120:123], a[104:107]
v_exp_f32 v155, v91
v_mfma_f32_16x16x32_bf16 a[108:111], v[40:43], v[124:127], a[108:111]
s_waitcnt lgkmcnt(8)
v_add_f32 v146, v146, v154
v_add_f32 v146, v146, v155
v_mfma_f32_16x16x32_bf16 a[112:115], v[44:47], v[112:115], a[112:115]
v_cvt_pk_bf16_f32 v107, v154, v155
v_mfma_f32_16x16x32_bf16 a[116:119], v[44:47], v[116:119], a[116:119]
v_exp_f32 v156, v92
v_mfma_f32_16x16x32_bf16 a[120:123], v[44:47], v[120:123], a[120:123]
v_add_f32 v147, v147, v156
v_mfma_f32_16x16x32_bf16 a[124:127], v[44:47], v[124:127], a[124:127]
s_waitcnt lgkmcnt(6)
v_exp_f32 v157, v93
v_mfma_f32_16x16x32_bf16 a[128:131], v[48:51], v[112:115], a[128:131]
s_waitcnt vmcnt(6) lgkmcnt(0)
v_add_f32 v147, v147, v157
v_cvt_pk_bf16_f32 v110, v156, v157
v_mfma_f32_16x16x32_bf16 a[132:135], v[48:51], v[116:119], a[132:135]
s_barrier
v_mfma_f32_16x16x32_bf16 a[136:139], v[48:51], v[120:123], a[136:139]
v_exp_f32 v158, v94
v_mfma_f32_16x16x32_bf16 a[140:143], v[48:51], v[124:127], a[140:143]
ds_read_b128 a[192:195], v8 offset:36864
v_add_f32 v147, v147, v158
v_mfma_f32_16x16x32_bf16 a[144:147], v[52:55], v[112:115], a[144:147]
v_exp_f32 v159, v95
v_mfma_f32_16x16x32_bf16 a[148:151], v[52:55], v[116:119], a[148:151]
ds_read_b128 a[196:199], v9 offset:36864
v_add_f32 v147, v147, v159
v_mfma_f32_16x16x32_bf16 a[152:155], v[52:55], v[120:123], a[152:155]
ds_read_b128 a[200:203], v8 offset:36992
v_cvt_pk_bf16_f32 v111, v158, v159
v_mfma_f32_16x16x32_bf16 a[156:159], v[52:55], v[124:127], a[156:159]
ds_read_b128 a[204:207], v9 offset:36992
ds_read_b128 a[208:211], v8 offset:37120
v_mfma_f32_16x16x32_bf16 a[160:163], v[56:59], v[112:115], a[160:163]
ds_read_b128 a[212:215], v9 offset:37120
v_mfma_f32_16x16x32_bf16 a[164:167], v[56:59], v[116:119], a[164:167]
v_mfma_f32_16x16x32_bf16 a[168:171], v[56:59], v[120:123], a[168:171]
v_mfma_f32_16x16x32_bf16 a[172:175], v[56:59], v[124:127], a[172:175]
v_mfma_f32_16x16x32_bf16 a[176:179], v[60:63], v[112:115], a[176:179]
v_max3_f32 v1, v144, v145, v146
v_max_f32 v1, v1, v147
v_mfma_f32_16x16x32_bf16 a[180:183], v[60:63], v[116:119], a[180:183]
v_cmp_nge_f32 vcc, s44, v1
v_mfma_f32_16x16x32_bf16 a[184:187], v[60:63], v[120:123], a[184:187]
s_waitcnt lgkmcnt(3)
v_mfma_f32_16x16x32_bf16 a[188:191], v[60:63], v[124:127], a[188:191]
s_cbranch_vccnz KF_fxp25
KF_bkp25:
v_mfma_f32_16x16x32_bf16 v[64:67], a[192:195], v[160:163], v[128:131]
s_add_u32 m0, s37, s7
ds_read_b128 a[216:219], v8 offset:38400
v_mfma_f32_16x16x32_bf16 v[64:67], a[196:199], v[176:179], v[64:67]
ds_read_b128 a[220:223], v9 offset:38400
v_mfma_f32_16x16x32_bf16 v[64:67], a[200:203], v[192:195], v[64:67]
s_waitcnt lgkmcnt(2)
ds_read_b128 a[224:227], v8 offset:38528
v_mfma_f32_16x16x32_bf16 v[64:67], a[204:207], v[208:211], v[64:67]
ds_read_b128 a[228:231], v9 offset:38528
v_mfma_f32_16x16x32_bf16 v[64:67], a[208:211], v[224:227], v[64:67]
buffer_load_dwordx4 v22, s[16:19], s29 offen nt lds
v_mfma_f32_16x16x32_bf16 v[64:67], a[212:215], v[240:243], v[64:67]
ds_read_b128 a[232:235], v8 offset:38656
ds_read_b128 a[236:239], v9 offset:38656
v_mfma_f32_16x16x32_bf16 v[68:71], a[192:195], v[164:167], v[132:135]
buffer_load_dwordx4 v23, s[16:19], s29 offen offset:1024 nt lds
v_mfma_f32_16x16x32_bf16 v[68:71], a[196:199], v[180:183], v[68:71]
ds_read_b64_tr_b16 v[40:41], v10 offset:24576
v_mfma_f32_16x16x32_bf16 v[68:71], a[200:203], v[196:199], v[68:71]
buffer_load_dwordx4 v24, s[16:19], s29 offen offset:2048 nt lds
v_mfma_f32_16x16x32_bf16 v[68:71], a[204:207], v[212:215], v[68:71]
s_add_u32 m0, s31, s28
ds_read_b64_tr_b16 v[42:43], v10 offset:26112
v_mfma_f32_16x16x32_bf16 v[68:71], a[208:211], v[228:231], v[68:71]
v_exp_f32 v152, v64
v_mfma_f32_16x16x32_bf16 v[68:71], a[212:215], v[244:247], v[68:71]
v_add_f32 v148, v144, v152
v_mfma_f32_16x16x32_bf16 v[72:75], a[192:195], v[168:171], v[136:139]
v_exp_f32 v153, v65
v_mfma_f32_16x16x32_bf16 v[72:75], a[196:199], v[184:187], v[72:75]
ds_read_b64_tr_b16 v[44:45], v11 offset:24576
v_add_f32 v148, v148, v153
v_mfma_f32_16x16x32_bf16 v[72:75], a[200:203], v[200:203], v[72:75]
v_exp_f32 v154, v66
v_mfma_f32_16x16x32_bf16 v[72:75], a[204:207], v[216:219], v[72:75]
ds_read_b64_tr_b16 v[46:47], v11 offset:26112
v_cvt_pk_bf16_f32 v112, v152, v153
v_mfma_f32_16x16x32_bf16 v[72:75], a[208:211], v[232:235], v[72:75]
v_add_f32 v148, v148, v154
v_mfma_f32_16x16x32_bf16 v[72:75], a[212:215], v[248:251], v[72:75]
v_exp_f32 v155, v67
v_mfma_f32_16x16x32_bf16 v[76:79], a[192:195], v[172:175], v[140:143]
ds_read_b64_tr_b16 v[48:49], v12 offset:24576
v_add_f32 v148, v148, v155
v_mfma_f32_16x16x32_bf16 v[76:79], a[196:199], v[188:191], v[76:79]
v_exp_f32 v156, v68
v_mfma_f32_16x16x32_bf16 v[76:79], a[200:203], v[204:207], v[76:79]
v_cvt_pk_bf16_f32 v113, v154, v155
v_add_f32 v149, v145, v156
v_mfma_f32_16x16x32_bf16 v[76:79], a[204:207], v[220:223], v[76:79]
buffer_load_dwordx4 v25, s[20:23], s53 offen nt lds
v_mfma_f32_16x16x32_bf16 v[76:79], a[208:211], v[236:239], v[76:79]
v_exp_f32 v157, v69
v_mfma_f32_16x16x32_bf16 v[76:79], a[212:215], v[252:255], v[76:79]
s_waitcnt lgkmcnt(8)
ds_read_b64_tr_b16 v[50:51], v12 offset:26112
v_add_f32 v149, v149, v157
v_mfma_f32_16x16x32_bf16 v[80:83], a[216:219], v[160:163], v[128:131]
v_exp_f32 v158, v70
v_mfma_f32_16x16x32_bf16 v[80:83], a[220:223], v[176:179], v[80:83]
ds_read_b64_tr_b16 v[52:53], v13 offset:24576
v_cvt_pk_bf16_f32 v116, v156, v157
v_mfma_f32_16x16x32_bf16 v[80:83], a[224:227], v[192:195], v[80:83]
s_waitcnt lgkmcnt(7)
v_exp_f32 v159, v71
v_mfma_f32_16x16x32_bf16 v[80:83], a[228:231], v[208:211], v[80:83]
ds_read_b64_tr_b16 v[54:55], v13 offset:26112
v_add_f32 v149, v149, v158
v_mfma_f32_16x16x32_bf16 v[80:83], a[232:235], v[224:227], v[80:83]
v_add_f32 v149, v149, v159
v_cvt_pk_bf16_f32 v117, v158, v159
v_mfma_f32_16x16x32_bf16 v[80:83], a[236:239], v[240:243], v[80:83]
v_exp_f32 v152, v72
v_mfma_f32_16x16x32_bf16 v[84:87], a[216:219], v[164:167], v[132:135]
ds_read_b64_tr_b16 v[56:57], v10 offset:24704
v_add_f32 v150, v146, v152
v_mfma_f32_16x16x32_bf16 v[84:87], a[220:223], v[180:183], v[84:87]
v_exp_f32 v153, v73
v_mfma_f32_16x16x32_bf16 v[84:87], a[224:227], v[196:199], v[84:87]
v_add_f32 v150, v150, v153
v_cvt_pk_bf16_f32 v120, v152, v153
v_mfma_f32_16x16x32_bf16 v[84:87], a[228:231], v[212:215], v[84:87]
buffer_load_dwordx4 v26, s[20:23], s53 offen offset:1024 nt lds
v_mfma_f32_16x16x32_bf16 v[84:87], a[232:235], v[228:231], v[84:87]
v_exp_f32 v154, v74
v_mfma_f32_16x16x32_bf16 v[84:87], a[236:239], v[244:247], v[84:87]
ds_read_b64_tr_b16 v[58:59], v10 offset:26240
v_add_f32 v150, v150, v154
v_mfma_f32_16x16x32_bf16 v[88:91], a[216:219], v[168:171], v[136:139]
v_exp_f32 v155, v75
v_mfma_f32_16x16x32_bf16 v[88:91], a[220:223], v[184:187], v[88:91]
ds_read_b64_tr_b16 v[60:61], v11 offset:24704
v_add_f32 v150, v150, v155
v_mfma_f32_16x16x32_bf16 v[88:91], a[224:227], v[200:203], v[88:91]
v_exp_f32 v156, v76
v_mfma_f32_16x16x32_bf16 v[88:91], a[228:231], v[216:219], v[88:91]
ds_read_b64_tr_b16 v[62:63], v11 offset:26240
v_cvt_pk_bf16_f32 v121, v154, v155
v_mfma_f32_16x16x32_bf16 v[88:91], a[232:235], v[232:235], v[88:91]
v_add_f32 v151, v147, v156
v_mfma_f32_16x16x32_bf16 v[88:91], a[236:239], v[248:251], v[88:91]
v_exp_f32 v157, v77
v_mfma_f32_16x16x32_bf16 v[92:95], a[216:219], v[172:175], v[140:143]
v_add_f32 v151, v151, v157
v_cvt_pk_bf16_f32 v124, v156, v157
v_mfma_f32_16x16x32_bf16 v[92:95], a[220:223], v[188:191], v[92:95]
v_exp_f32 v158, v78
v_mfma_f32_16x16x32_bf16 v[92:95], a[224:227], v[204:207], v[92:95]
v_add_f32 v151, v151, v158
v_mfma_f32_16x16x32_bf16 v[92:95], a[228:231], v[220:223], v[92:95]
buffer_load_dwordx4 v27, s[20:23], s53 offen offset:2048 nt lds
v_mfma_f32_16x16x32_bf16 v[92:95], a[232:235], v[236:239], v[92:95]
s_add_u32 s4, s4, 1
v_exp_f32 v159, v79
v_mfma_f32_16x16x32_bf16 v[92:95], a[236:239], v[252:255], v[92:95]
s_waitcnt lgkmcnt(10)
v_add_f32 v151, v151, v159
v_cvt_pk_bf16_f32 v125, v158, v159
v_mfma_f32_16x16x32_bf16 a[0:3], v[40:43], v[96:99], a[0:3]
s_bitcmp0_b32 s5, s4
v_exp_f32 v152, v80
v_mfma_f32_16x16x32_bf16 a[4:7], v[40:43], v[100:103], a[4:7]
s_cselect_b32 s28, s6, 73728
v_add_f32 v148, v148, v152
v_mfma_f32_16x16x32_bf16 a[8:11], v[40:43], v[104:107], a[8:11]
s_cselect_b32 s30, 12288, 0
v_exp_f32 v153, v81
v_mfma_f32_16x16x32_bf16 a[12:15], v[40:43], v[108:111], a[12:15]
s_waitcnt lgkmcnt(8)
ds_read_b64_tr_b16 v[40:41], v12 offset:24704
v_add_f32 v148, v148, v153
v_mfma_f32_16x16x32_bf16 a[16:19], v[44:47], v[96:99], a[16:19]
s_cselect_b32 s53, s42, 1073741824
ds_read_b64_tr_b16 v[42:43], v12 offset:26240
v_cvt_pk_bf16_f32 v114, v152, v153
v_mfma_f32_16x16x32_bf16 a[20:23], v[44:47], v[100:103], a[20:23]
s_addc_u32 s1, s1, 0
v_exp_f32 v154, v82
v_mfma_f32_16x16x32_bf16 a[24:27], v[44:47], v[104:107], a[24:27]
s_cmp_eq_u32 s1, 30
v_add_f32 v148, v148, v154
v_mfma_f32_16x16x32_bf16 a[28:31], v[44:47], v[108:111], a[28:31]
s_waitcnt lgkmcnt(8)
v_exp_f32 v155, v83
v_mfma_f32_16x16x32_bf16 a[32:35], v[48:51], v[96:99], a[32:35]
s_mov_b32 s55, 0
ds_read_b64_tr_b16 v[44:45], v13 offset:24704
v_add_f32 v148, v148, v155
v_mfma_f32_16x16x32_bf16 a[36:39], v[48:51], v[100:103], a[36:39]
buffer_load_dword v4, v5, s[64:67], s55 offen
v_mfma_f32_16x16x32_bf16 a[40:43], v[48:51], v[104:107], a[40:43]
s_cselect_b32 s1, 0, s1
v_exp_f32 v156, v84
v_mfma_f32_16x16x32_bf16 a[44:47], v[48:51], v[108:111], a[44:47]
s_waitcnt lgkmcnt(7)
ds_read_b64_tr_b16 v[46:47], v13 offset:26240
v_cvt_pk_bf16_f32 v115, v154, v155
v_mfma_f32_16x16x32_bf16 a[48:51], v[52:55], v[96:99], a[48:51]
s_cmp_ge_u32 s1, 10
v_exp_f32 v157, v85
v_mfma_f32_16x16x32_bf16 a[52:55], v[52:55], v[100:103], a[52:55]
s_cselect_b32 s3, s52, 0
ds_read_b64_tr_b16 v[48:49], v10 offset:24832
v_add_f32 v149, v149, v156
v_mfma_f32_16x16x32_bf16 a[56:59], v[52:55], v[104:107], a[56:59]
s_cmp_ge_u32 s1, 20
v_exp_f32 v158, v86
v_mfma_f32_16x16x32_bf16 a[60:63], v[52:55], v[108:111], a[60:63]
s_waitcnt lgkmcnt(7)
ds_read_b64_tr_b16 v[50:51], v10 offset:26368
v_add_f32 v149, v149, v157
v_mfma_f32_16x16x32_bf16 a[64:67], v[56:59], v[96:99], a[64:67]
s_cselect_b32 s3, s45, s3
ds_read_b64_tr_b16 v[52:53], v11 offset:24832
v_cvt_pk_bf16_f32 v118, v156, v157
v_mfma_f32_16x16x32_bf16 a[68:71], v[56:59], v[100:103], a[68:71]
s_mul_i32 s42, s1, 3072
v_exp_f32 v159, v87
v_mfma_f32_16x16x32_bf16 a[72:75], v[56:59], v[104:107], a[72:75]
s_add_u32 s42, s42, s3
ds_read_b64_tr_b16 v[54:55], v11 offset:26368
v_add_f32 v149, v149, v158
v_mfma_f32_16x16x32_bf16 a[76:79], v[56:59], v[108:111], a[76:79]
s_waitcnt lgkmcnt(8)
v_exp_f32 v152, v88
v_mfma_f32_16x16x32_bf16 a[80:83], v[60:63], v[96:99], a[80:83]
s_add_u32 s6, s6, s30
ds_read_b64_tr_b16 v[56:57], v12 offset:24832
v_add_f32 v149, v149, v159
v_mfma_f32_16x16x32_bf16 a[84:87], v[60:63], v[100:103], a[84:87]
s_cmp_eq_u32 s6, 73728
ds_read_b64_tr_b16 v[58:59], v12 offset:26368
v_cvt_pk_bf16_f32 v119, v158, v159
v_mfma_f32_16x16x32_bf16 a[88:91], v[60:63], v[104:107], a[88:91]
s_cselect_b32 s6, 0, s6
v_exp_f32 v153, v89
v_mfma_f32_16x16x32_bf16 a[92:95], v[60:63], v[108:111], a[92:95]
s_waitcnt lgkmcnt(8)
ds_read_b64_tr_b16 v[60:61], v13 offset:24832
v_add_f32 v150, v150, v152
v_mfma_f32_16x16x32_bf16 a[96:99], v[40:43], v[96:99], a[96:99]
s_cmp_eq_u32 s30, 0
v_exp_f32 v154, v90
v_mfma_f32_16x16x32_bf16 a[100:103], v[40:43], v[100:103], a[100:103]
s_cselect_b32 s7, 147456, s6
ds_read_b64_tr_b16 v[62:63], v13 offset:26368
v_add_f32 v150, v150, v153
v_mfma_f32_16x16x32_bf16 a[104:107], v[40:43], v[104:107], a[104:107]
s_cselect_b32 s29, 1073741824, s42
v_exp_f32 v155, v91
v_mfma_f32_16x16x32_bf16 a[108:111], v[40:43], v[108:111], a[108:111]
s_waitcnt lgkmcnt(8)
v_cvt_pk_bf16_f32 v122, v152, v153
v_add_f32 v150, v150, v154
v_mfma_f32_16x16x32_bf16 a[112:115], v[44:47], v[96:99], a[112:115]
v_add_f32 v150, v150, v155
v_cvt_pk_bf16_f32 v123, v154, v155
v_mfma_f32_16x16x32_bf16 a[116:119], v[44:47], v[100:103], a[116:119]
v_exp_f32 v156, v92
v_mfma_f32_16x16x32_bf16 a[120:123], v[44:47], v[104:107], a[120:123]
v_add_f32 v151, v151, v156
v_mfma_f32_16x16x32_bf16 a[124:127], v[44:47], v[108:111], a[124:127]
s_waitcnt lgkmcnt(6)
v_exp_f32 v157, v93
v_mfma_f32_16x16x32_bf16 a[128:131], v[48:51], v[96:99], a[128:131]
s_waitcnt vmcnt(7) lgkmcnt(0)
v_add_f32 v151, v151, v157
v_cvt_pk_bf16_f32 v126, v156, v157
v_mfma_f32_16x16x32_bf16 a[132:135], v[48:51], v[100:103], a[132:135]
s_barrier
v_mfma_f32_16x16x32_bf16 a[136:139], v[48:51], v[104:107], a[136:139]
v_exp_f32 v158, v94
v_mfma_f32_16x16x32_bf16 a[140:143], v[48:51], v[108:111], a[140:143]
ds_read_b128 a[192:195], v8 offset:49152
v_add_f32 v151, v151, v158
v_mfma_f32_16x16x32_bf16 a[144:147], v[52:55], v[96:99], a[144:147]
v_exp_f32 v159, v95
v_mfma_f32_16x16x32_bf16 a[148:151], v[52:55], v[100:103], a[148:151]
ds_read_b128 a[196:199], v9 offset:49152
v_add_f32 v151, v151, v159
v_mfma_f32_16x16x32_bf16 a[152:155], v[52:55], v[104:107], a[152:155]
ds_read_b128 a[200:203], v8 offset:49280
v_cvt_pk_bf16_f32 v127, v158, v159
v_mfma_f32_16x16x32_bf16 a[156:159], v[52:55], v[108:111], a[156:159]
ds_read_b128 a[204:207], v9 offset:49280
ds_read_b128 a[208:211], v8 offset:49408
v_mfma_f32_16x16x32_bf16 a[160:163], v[56:59], v[96:99], a[160:163]
ds_read_b128 a[212:215], v9 offset:49408
v_mfma_f32_16x16x32_bf16 a[164:167], v[56:59], v[100:103], a[164:167]
v_mfma_f32_16x16x32_bf16 a[168:171], v[56:59], v[104:107], a[168:171]
v_mfma_f32_16x16x32_bf16 a[172:175], v[56:59], v[108:111], a[172:175]
v_mfma_f32_16x16x32_bf16 a[176:179], v[60:63], v[96:99], a[176:179]
v_max3_f32 v1, v148, v149, v150
v_max_f32 v1, v1, v151
v_mfma_f32_16x16x32_bf16 a[180:183], v[60:63], v[100:103], a[180:183]
v_cmp_nge_f32 vcc, s44, v1
v_mfma_f32_16x16x32_bf16 a[184:187], v[60:63], v[104:107], a[184:187]
s_waitcnt lgkmcnt(3)
v_mfma_f32_16x16x32_bf16 a[188:191], v[60:63], v[108:111], a[188:191]
s_cbranch_vccnz KF_fxp26
KF_bkp26:
v_mfma_f32_16x16x32_bf16 v[64:67], a[192:195], v[160:163], v[128:131]
s_add_u32 m0, s37, s7
ds_read_b128 a[216:219], v8 offset:50688
v_mfma_f32_16x16x32_bf16 v[64:67], a[196:199], v[176:179], v[64:67]
ds_read_b128 a[220:223], v9 offset:50688
v_mfma_f32_16x16x32_bf16 v[64:67], a[200:203], v[192:195], v[64:67]
s_waitcnt lgkmcnt(2)
ds_read_b128 a[224:227], v8 offset:50816
v_mfma_f32_16x16x32_bf16 v[64:67], a[204:207], v[208:211], v[64:67]
ds_read_b128 a[228:231], v9 offset:50816
v_mfma_f32_16x16x32_bf16 v[64:67], a[208:211], v[224:227], v[64:67]
buffer_load_dwordx4 v22, s[16:19], s29 offen nt lds
v_mfma_f32_16x16x32_bf16 v[64:67], a[212:215], v[240:243], v[64:67]
ds_read_b128 a[232:235], v8 offset:50944
ds_read_b128 a[236:239], v9 offset:50944
v_mfma_f32_16x16x32_bf16 v[68:71], a[192:195], v[164:167], v[132:135]
buffer_load_dwordx4 v23, s[16:19], s29 offen offset:1024 nt lds
v_mfma_f32_16x16x32_bf16 v[68:71], a[196:199], v[180:183], v[68:71]
ds_read_b64_tr_b16 v[40:41], v10 offset:36864
v_mfma_f32_16x16x32_bf16 v[68:71], a[200:203], v[196:199], v[68:71]
buffer_load_dwordx4 v24, s[16:19], s29 offen offset:2048 nt lds
v_mfma_f32_16x16x32_bf16 v[68:71], a[204:207], v[212:215], v[68:71]
s_add_u32 m0, s31, s28
ds_read_b64_tr_b16 v[42:43], v10 offset:38400
v_mfma_f32_16x16x32_bf16 v[68:71], a[208:211], v[228:231], v[68:71]
v_exp_f32 v152, v64
v_mfma_f32_16x16x32_bf16 v[68:71], a[212:215], v[244:247], v[68:71]
v_add_f32 v144, v148, v152
v_mfma_f32_16x16x32_bf16 v[72:75], a[192:195], v[168:171], v[136:139]
v_exp_f32 v153, v65
v_mfma_f32_16x16x32_bf16 v[72:75], a[196:199], v[184:187], v[72:75]
ds_read_b64_tr_b16 v[44:45], v11 offset:36864
v_add_f32 v144, v144, v153
v_mfma_f32_16x16x32_bf16 v[72:75], a[200:203], v[200:203], v[72:75]
v_exp_f32 v154, v66
v_mfma_f32_16x16x32_bf16 v[72:75], a[204:207], v[216:219], v[72:75]
ds_read_b64_tr_b16 v[46:47], v11 offset:38400
v_cvt_pk_bf16_f32 v96, v152, v153
v_mfma_f32_16x16x32_bf16 v[72:75], a[208:211], v[232:235], v[72:75]
v_add_f32 v144, v144, v154
v_mfma_f32_16x16x32_bf16 v[72:75], a[212:215], v[248:251], v[72:75]
v_exp_f32 v155, v67
v_mfma_f32_16x16x32_bf16 v[76:79], a[192:195], v[172:175], v[140:143]
ds_read_b64_tr_b16 v[48:49], v12 offset:36864
v_add_f32 v144, v144, v155
v_mfma_f32_16x16x32_bf16 v[76:79], a[196:199], v[188:191], v[76:79]
v_exp_f32 v156, v68
v_mfma_f32_16x16x32_bf16 v[76:79], a[200:203], v[204:207], v[76:79]
v_cvt_pk_bf16_f32 v97, v154, v155
v_add_f32 v145, v149, v156
v_mfma_f32_16x16x32_bf16 v[76:79], a[204:207], v[220:223], v[76:79]
buffer_load_dwordx4 v25, s[20:23], s53 offen nt lds
v_mfma_f32_16x16x32_bf16 v[76:79], a[208:211], v[236:239], v[76:79]
v_exp_f32 v157, v69
v_mfma_f32_16x16x32_bf16 v[76:79], a[212:215], v[252:255], v[76:79]
s_waitcnt lgkmcnt(8)
ds_read_b64_tr_b16 v[50:51], v12 offset:38400
v_add_f32 v145, v145, v157
v_mfma_f32_16x16x32_bf16 v[80:83], a[216:219], v[160:163], v[128:131]
v_exp_f32 v158, v70
v_mfma_f32_16x16x32_bf16 v[80:83], a[220:223], v[176:179], v[80:83]
ds_read_b64_tr_b16 v[52:53], v13 offset:36864
v_cvt_pk_bf16_f32 v100, v156, v157
v_mfma_f32_16x16x32_bf16 v[80:83], a[224:227], v[192:195], v[80:83]
s_waitcnt lgkmcnt(7)
v_exp_f32 v159, v71
v_mfma_f32_16x16x32_bf16 v[80:83], a[228:231], v[208:211], v[80:83]
ds_read_b64_tr_b16 v[54:55], v13 offset:38400
v_add_f32 v145, v145, v158
v_mfma_f32_16x16x32_bf16 v[80:83], a[232:235], v[224:227], v[80:83]
v_add_f32 v145, v145, v159
v_cvt_pk_bf16_f32 v101, v158, v159
v_mfma_f32_16x16x32_bf16 v[80:83], a[236:239], v[240:243], v[80:83]
v_exp_f32 v152, v72
v_mfma_f32_16x16x32_bf16 v[84:87], a[216:219], v[164:167], v[132:135]
ds_read_b64_tr_b16 v[56:57], v10 offset:36992
v_add_f32 v146, v150, v152
v_mfma_f32_16x16x32_bf16 v[84:87], a[220:223], v[180:183], v[84:87]
v_exp_f32 v153, v73
v_mfma_f32_16x16x32_bf16 v[84:87], a[224:227], v[196:199], v[84:87]
v_add_f32 v146, v146, v153
v_cvt_pk_bf16_f32 v104, v152, v153
v_mfma_f32_16x16x32_bf16 v[84:87], a[228:231], v[212:215], v[84:87]
buffer_load_dwordx4 v26, s[20:23], s53 offen offset:1024 nt lds
v_mfma_f32_16x16x32_bf16 v[84:87], a[232:235], v[228:231], v[84:87]
v_exp_f32 v154, v74
v_mfma_f32_16x16x32_bf16 v[84:87], a[236:239], v[244:247], v[84:87]
ds_read_b64_tr_b16 v[58:59], v10 offset:38528
v_add_f32 v146, v146, v154
v_mfma_f32_16x16x32_bf16 v[88:91], a[216:219], v[168:171], v[136:139]
v_exp_f32 v155, v75
v_mfma_f32_16x16x32_bf16 v[88:91], a[220:223], v[184:187], v[88:91]
ds_read_b64_tr_b16 v[60:61], v11 offset:36992
v_add_f32 v146, v146, v155
v_mfma_f32_16x16x32_bf16 v[88:91], a[224:227], v[200:203], v[88:91]
v_exp_f32 v156, v76
v_mfma_f32_16x16x32_bf16 v[88:91], a[228:231], v[216:219], v[88:91]
ds_read_b64_tr_b16 v[62:63], v11 offset:38528
v_cvt_pk_bf16_f32 v105, v154, v155
v_mfma_f32_16x16x32_bf16 v[88:91], a[232:235], v[232:235], v[88:91]
v_add_f32 v147, v151, v156
v_mfma_f32_16x16x32_bf16 v[88:91], a[236:239], v[248:251], v[88:91]
v_exp_f32 v157, v77
v_mfma_f32_16x16x32_bf16 v[92:95], a[216:219], v[172:175], v[140:143]
v_add_f32 v147, v147, v157
v_cvt_pk_bf16_f32 v108, v156, v157
v_mfma_f32_16x16x32_bf16 v[92:95], a[220:223], v[188:191], v[92:95]
v_exp_f32 v158, v78
v_mfma_f32_16x16x32_bf16 v[92:95], a[224:227], v[204:207], v[92:95]
v_add_f32 v147, v147, v158
v_mfma_f32_16x16x32_bf16 v[92:95], a[228:231], v[220:223], v[92:95]
buffer_load_dwordx4 v27, s[20:23], s53 offen offset:2048 nt lds
v_mfma_f32_16x16x32_bf16 v[92:95], a[232:235], v[236:239], v[92:95]
s_add_u32 s4, s4, 1
v_exp_f32 v159, v79
v_mfma_f32_16x16x32_bf16 v[92:95], a[236:239], v[252:255], v[92:95]
s_waitcnt lgkmcnt(10)
v_add_f32 v147, v147, v159
v_cvt_pk_bf16_f32 v109, v158, v159
v_mfma_f32_16x16x32_bf16 a[0:3], v[40:43], v[112:115], a[0:3]
s_bitcmp0_b32 s5, s4
v_exp_f32 v152, v80
v_mfma_f32_16x16x32_bf16 a[4:7], v[40:43], v[116:119], a[4:7]
s_cselect_b32 s28, s6, 73728
v_add_f32 v144, v144, v152
v_mfma_f32_16x16x32_bf16 a[8:11], v[40:43], v[120:123], a[8:11]
s_cselect_b32 s30, 12288, 0
v_exp_f32 v153, v81
v_mfma_f32_16x16x32_bf16 a[12:15], v[40:43], v[124:127], a[12:15]
s_waitcnt lgkmcnt(8)
ds_read_b64_tr_b16 v[40:41], v12 offset:36992
v_add_f32 v144, v144, v153
v_mfma_f32_16x16x32_bf16 a[16:19], v[44:47], v[112:115], a[16:19]
s_cselect_b32 s53, s42, 1073741824
ds_read_b64_tr_b16 v[42:43], v12 offset:38528
v_cvt_pk_bf16_f32 v98, v152, v153
v_mfma_f32_16x16x32_bf16 a[20:23], v[44:47], v[116:119], a[20:23]
s_addc_u32 s1, s1, 0
v_exp_f32 v154, v82
v_mfma_f32_16x16x32_bf16 a[24:27], v[44:47], v[120:123], a[24:27]
s_cmp_eq_u32 s1, 30
v_add_f32 v144, v144, v154
v_mfma_f32_16x16x32_bf16 a[28:31], v[44:47], v[124:127], a[28:31]
s_waitcnt lgkmcnt(8)
v_exp_f32 v155, v83
v_mfma_f32_16x16x32_bf16 a[32:35], v[48:51], v[112:115], a[32:35]
s_cselect_b32 s1, 0, s1
ds_read_b64_tr_b16 v[44:45], v13 offset:36992
v_add_f32 v144, v144, v155
v_mfma_f32_16x16x32_bf16 a[36:39], v[48:51], v[116:119], a[36:39]
s_cmp_ge_u32 s1, 10
ds_read_b64_tr_b16 v[46:47], v13 offset:38528
v_cvt_pk_bf16_f32 v99, v154, v155
v_mfma_f32_16x16x32_bf16 a[40:43], v[48:51], v[120:123], a[40:43]
s_cselect_b32 s3, s52, 0
v_exp_f32 v156, v84
v_mfma_f32_16x16x32_bf16 a[44:47], v[48:51], v[124:127], a[44:47]
s_waitcnt lgkmcnt(8)
ds_read_b64_tr_b16 v[48:49], v10 offset:37120
v_add_f32 v145, v145, v156
v_mfma_f32_16x16x32_bf16 a[48:51], v[52:55], v[112:115], a[48:51]
s_cmp_ge_u32 s1, 20
v_exp_f32 v157, v85
v_mfma_f32_16x16x32_bf16 a[52:55], v[52:55], v[116:119], a[52:55]
s_cselect_b32 s3, s45, s3
ds_read_b64_tr_b16 v[50:51], v10 offset:38656
v_add_f32 v145, v145, v157
v_mfma_f32_16x16x32_bf16 a[56:59], v[52:55], v[120:123], a[56:59]
s_mul_i32 s42, s1, 3072
v_exp_f32 v158, v86
v_mfma_f32_16x16x32_bf16 a[60:63], v[52:55], v[124:127], a[60:63]
s_waitcnt lgkmcnt(8)
ds_read_b64_tr_b16 v[52:53], v11 offset:37120
v_cvt_pk_bf16_f32 v102, v156, v157
v_mfma_f32_16x16x32_bf16 a[64:67], v[56:59], v[112:115], a[64:67]
s_add_u32 s42, s42, s3
ds_read_b64_tr_b16 v[54:55], v11 offset:38656
v_add_f32 v145, v145, v158
v_mfma_f32_16x16x32_bf16 a[68:71], v[56:59], v[116:119], a[68:71]
s_add_u32 s6, s6, s30
v_exp_f32 v159, v87
v_mfma_f32_16x16x32_bf16 a[72:75], v[56:59], v[120:123], a[72:75]
s_cmp_eq_u32 s6, 73728
v_add_f32 v145, v145, v159
v_cvt_pk_bf16_f32 v103, v158, v159
v_mfma_f32_16x16x32_bf16 a[76:79], v[56:59], v[124:127], a[76:79]
s_waitcnt lgkmcnt(8)
v_exp_f32 v152, v88
v_mfma_f32_16x16x32_bf16 a[80:83], v[60:63], v[112:115], a[80:83]
s_cselect_b32 s6, 0, s6
ds_read_b64_tr_b16 v[56:57], v12 offset:37120
v_add_f32 v146, v146, v152
v_mfma_f32_16x16x32_bf16 a[84:87], v[60:63], v[116:119], a[84:87]
s_cmp_eq_u32 s30, 0
ds_read_b64_tr_b16 v[58:59], v12 offset:38656
v_mfma_f32_16x16x32_bf16 a[88:91], v[60:63], v[120:123], a[88:91]
s_cselect_b32 s7, 147456, s6
v_exp_f32 v153, v89
v_mfma_f32_16x16x32_bf16 a[92:95], v[60:63], v[124:127], a[92:95]
s_waitcnt lgkmcnt(8)
ds_read_b64_tr_b16 v[60:61], v13 offset:37120
ds_read_b64_tr_b16 v[62:63], v13 offset:38656
v_mfma_f32_16x16x32_bf16 a[96:99], v[40:43], v[112:115], a[96:99]
s_cselect_b32 s29, 1073741824, s42
v_exp_f32 v154, v90
v_mfma_f32_16x16x32_bf16 a[100:103], v[40:43], v[116:119], a[100:103]
v_add_f32 v146, v146, v153
v_cvt_pk_bf16_f32 v106, v152, v153
v_mfma_f32_16x16x32_bf16 a[104:107], v[40:43], v[120:123], a[104:107]
v_exp_f32 v155, v91
v_mfma_f32_16x16x32_bf16 a[108:111], v[40:43], v[124:127], a[108:111]
s_waitcnt lgkmcnt(8)
v_add_f32 v146, v146, v154
v_add_f32 v146, v146, v155
v_mfma_f32_16x16x32_bf16 a[112:115], v[44:47], v[112:115], a[112:115]
v_cvt_pk_bf16_f32 v107, v154, v155
v_mfma_f32_16x16x32_bf16 a[116:119], v[44:47], v[116:119], a[116:119]
v_exp_f32 v156, v92
v_mfma_f32_16x16x32_bf16 a[120:123], v[44:47], v[120:123], a[120:123]
v_add_f32 v147, v147, v156
v_mfma_f32_16x16x32_bf16 a[124:127], v[44:47], v[124:127], a[124:127]
s_waitcnt lgkmcnt(6)
v_exp_f32 v157, v93
v_mfma_f32_16x16x32_bf16 a[128:131], v[48:51], v[112:115], a[128:131]
s_waitcnt vmcnt(7) lgkmcnt(0)
v_add_f32 v147, v147, v157
v_cvt_pk_bf16_f32 v110, v156, v157
v_mfma_f32_16x16x32_bf16 a[132:135], v[48:51], v[116:119], a[132:135]
s_barrier
v_mfma_f32_16x16x32_bf16 a[136:139], v[48:51], v[120:123], a[136:139]
s_add_u32 m0, s37, 24576
v_exp_f32 v158, v94
v_mfma_f32_16x16x32_bf16 a[140:143], v[48:51], v[124:127], a[140:143]
s_add_u32 s40, s76, 0
ds_read_b128 a[192:195], v8 offset:61440
v_add_f32 v147, v147, v158
v_mfma_f32_16x16x32_bf16 a[144:147], v[52:55], v[112:115], a[144:147]
v_exp_f32 v159, v95
v_mfma_f32_16x16x32_bf16 a[148:151], v[52:55], v[116:119], a[148:151]
ds_read_b128 a[196:199], v9 offset:61440
v_add_f32 v147, v147, v159
v_mfma_f32_16x16x32_bf16 a[152:155], v[52:55], v[120:123], a[152:155]
KF_pg9:
s_cbranch_execz KF_pg13
ds_read_b128 a[200:203], v8 offset:61568
v_cvt_pk_bf16_f32 v111, v158, v159
v_mfma_f32_16x16x32_bf16 a[156:159], v[52:55], v[124:127], a[156:159]
buffer_load_dwordx4 v28, s[64:67], s40 offen lds
v_mfma_f32_16x16x32_bf16 a[160:163], v[56:59], v[112:115], a[160:163]
ds_read_b128 a[204:207], v9 offset:61568
ds_read_b128 a[208:211], v8 offset:61696
v_mfma_f32_16x16x32_bf16 a[164:167], v[56:59], v[116:119], a[164:167]
buffer_load_dwordx4 v29, s[64:67], s40 offen offset:1024 lds
v_mfma_f32_16x16x32_bf16 a[168:171], v[56:59], v[120:123], a[168:171]
ds_read_b128 a[212:215], v9 offset:61696
v_mfma_f32_16x16x32_bf16 a[172:175], v[56:59], v[124:127], a[172:175]
buffer_load_dwordx4 v30, s[64:67], s40 offen offset:2048 lds
v_mfma_f32_16x16x32_bf16 a[176:179], v[60:63], v[112:115], a[176:179]
v_max3_f32 v1, v144, v145, v146
v_max_f32 v1, v1, v147
v_mfma_f32_16x16x32_bf16 a[180:183], v[60:63], v[116:119], a[180:183]
v_cmp_nge_f32 vcc, s44, v1
v_mfma_f32_16x16x32_bf16 a[184:187], v[60:63], v[120:123], a[184:187]
s_waitcnt lgkmcnt(3)
v_mfma_f32_16x16x32_bf16 a[188:191], v[60:63], v[124:127], a[188:191]
s_cbranch_vccnz KF_fxp27
KF_bkp27:
v_mfma_f32_16x16x32_bf16 v[64:67], a[192:195], v[160:163], v[128:131]
s_add_u32 m0, s37, s7
ds_read_b128 a[216:219], v8 offset:62976
v_mov_b32 v6, 0
v_mfma_f32_16x16x32_bf16 v[64:67], a[196:199], v[176:179], v[64:67]
ds_read_b128 a[220:223], v9 offset:62976
v_mfma_f32_16x16x32_bf16 v[64:67], a[200:203], v[192:195], v[64:67]
s_waitcnt lgkmcnt(2)
ds_read_b128 a[224:227], v8 offset:63104
v_mfma_f32_16x16x32_bf16 v[64:67], a[204:207], v[208:211], v[64:67]
ds_read_b128 a[228:231], v9 offset:63104
v_mfma_f32_16x16x32_bf16 v[64:67], a[208:211], v[224:227], v[64:67]
buffer_load_dwordx4 v22, s[16:19], s29 offen nt lds
v_mfma_f32_16x16x32_bf16 v[64:67], a[212:215], v[240:243], v[64:67]
ds_read_b128 a[232:235], v8 offset:63232
ds_read_b128 a[236:239], v9 offset:63232
v_mfma_f32_16x16x32_bf16 v[68:71], a[192:195], v[164:167], v[132:135]
buffer_load_dwordx4 v23, s[16:19], s29 offen offset:1024 nt lds
v_mfma_f32_16x16x32_bf16 v[68:71], a[196:199], v[180:183], v[68:71]
ds_read_b64_tr_b16 v[40:41], v10 offset:49152
v_mfma_f32_16x16x32_bf16 v[68:71], a[200:203], v[196:199], v[68:71]
buffer_load_dwordx4 v24, s[16:19], s29 offen offset:2048 nt lds
v_mfma_f32_16x16x32_bf16 v[68:71], a[204:207], v[212:215], v[68:71]
s_add_u32 m0, s31, s28
ds_read_b64_tr_b16 v[42:43], v10 offset:50688
v_mfma_f32_16x16x32_bf16 v[68:71], a[208:211], v[228:231], v[68:71]
v_exp_f32 v152, v64
v_mfma_f32_16x16x32_bf16 v[68:71], a[212:215], v[244:247], v[68:71]
v_add_f32 v148, v144, v152
v_mfma_f32_16x16x32_bf16 v[72:75], a[192:195], v[168:171], v[136:139]
v_exp_f32 v153, v65
v_mfma_f32_16x16x32_bf16 v[72:75], a[196:199], v[184:187], v[72:75]
ds_read_b64_tr_b16 v[44:45], v11 offset:49152
v_add_f32 v148, v148, v153
v_mfma_f32_16x16x32_bf16 v[72:75], a[200:203], v[200:203], v[72:75]
v_exp_f32 v154, v66
v_mfma_f32_16x16x32_bf16 v[72:75], a[204:207], v[216:219], v[72:75]
ds_read_b64_tr_b16 v[46:47], v11 offset:50688
v_cvt_pk_bf16_f32 v112, v152, v153
v_mfma_f32_16x16x32_bf16 v[72:75], a[208:211], v[232:235], v[72:75]
v_add_f32 v148, v148, v154
v_mfma_f32_16x16x32_bf16 v[72:75], a[212:215], v[248:251], v[72:75]
v_exp_f32 v155, v67
v_mfma_f32_16x16x32_bf16 v[76:79], a[192:195], v[172:175], v[140:143]
ds_read_b64_tr_b16 v[48:49], v12 offset:49152
v_add_f32 v148, v148, v155
v_mfma_f32_16x16x32_bf16 v[76:79], a[196:199], v[188:191], v[76:79]
v_exp_f32 v156, v68
v_mfma_f32_16x16x32_bf16 v[76:79], a[200:203], v[204:207], v[76:79]
v_cvt_pk_bf16_f32 v113, v154, v155
v_add_f32 v149, v145, v156
v_mfma_f32_16x16x32_bf16 v[76:79], a[204:207], v[220:223], v[76:79]
buffer_load_dwordx4 v25, s[20:23], s53 offen nt lds
v_mfma_f32_16x16x32_bf16 v[76:79], a[208:211], v[236:239], v[76:79]
v_exp_f32 v157, v69
v_mfma_f32_16x16x32_bf16 v[76:79], a[212:215], v[252:255], v[76:79]
s_waitcnt lgkmcnt(8)
ds_read_b64_tr_b16 v[50:51], v12 offset:50688
v_add_f32 v149, v149, v157
v_mfma_f32_16x16x32_bf16 v[80:83], a[216:219], v[160:163], v[128:131]
v_exp_f32 v158, v70
v_mfma_f32_16x16x32_bf16 v[80:83], a[220:223], v[176:179], v[80:83]
ds_read_b64_tr_b16 v[52:53], v13 offset:49152
v_cvt_pk_bf16_f32 v116, v156, v157
v_mfma_f32_16x16x32_bf16 v[80:83], a[224:227], v[192:195], v[80:83]
s_waitcnt lgkmcnt(7)
v_exp_f32 v159, v71
v_mfma_f32_16x16x32_bf16 v[80:83], a[228:231], v[208:211], v[80:83]
ds_read_b64_tr_b16 v[54:55], v13 offset:50688
v_add_f32 v149, v149, v158
v_mfma_f32_16x16x32_bf16 v[80:83], a[232:235], v[224:227], v[80:83]
v_add_f32 v149, v149, v159
v_cvt_pk_bf16_f32 v117, v158, v159
v_mfma_f32_16x16x32_bf16 v[80:83], a[236:239], v[240:243], v[80:83]
v_exp_f32 v152, v72
v_mfma_f32_16x16x32_bf16 v[84:87], a[216:219], v[164:167], v[132:135]
ds_read_b64_tr_b16 v[56:57], v10 offset:49280
v_add_f32 v150, v146, v152
v_mfma_f32_16x16x32_bf16 v[84:87], a[220:223], v[180:183], v[84:87]
v_exp_f32 v153, v73
v_mfma_f32_16x16x32_bf16 v[84:87], a[224:227], v[196:199], v[84:87]
v_add_f32 v150, v150, v153
v_cvt_pk_bf16_f32 v120, v152, v153
v_mfma_f32_16x16x32_bf16 v[84:87], a[228:231], v[212:215], v[84:87]
buffer_load_dwordx4 v26, s[20:23], s53 offen offset:1024 nt lds
v_mfma_f32_16x16x32_bf16 v[84:87], a[232:235], v[228:231], v[84:87]
v_exp_f32 v154, v74
v_mfma_f32_16x16x32_bf16 v[84:87], a[236:239], v[244:247], v[84:87]
ds_read_b64_tr_b16 v[58:59], v10 offset:50816
v_add_f32 v150, v150, v154
v_mfma_f32_16x16x32_bf16 v[88:91], a[216:219], v[168:171], v[136:139]
v_exp_f32 v155, v75
v_mfma_f32_16x16x32_bf16 v[88:91], a[220:223], v[184:187], v[88:91]
ds_read_b64_tr_b16 v[60:61], v11 offset:49280
v_add_f32 v150, v150, v155
v_mfma_f32_16x16x32_bf16 v[88:91], a[224:227], v[200:203], v[88:91]
v_exp_f32 v156, v76
v_mfma_f32_16x16x32_bf16 v[88:91], a[228:231], v[216:219], v[88:91]
ds_read_b64_tr_b16 v[62:63], v11 offset:50816
v_cvt_pk_bf16_f32 v121, v154, v155
v_mfma_f32_16x16x32_bf16 v[88:91], a[232:235], v[232:235], v[88:91]
v_add_f32 v151, v147, v156
v_mfma_f32_16x16x32_bf16 v[88:91], a[236:239], v[248:251], v[88:91]
v_exp_f32 v157, v77
v_mfma_f32_16x16x32_bf16 v[92:95], a[216:219], v[172:175], v[140:143]
v_add_f32 v151, v151, v157
v_cvt_pk_bf16_f32 v124, v156, v157
v_mfma_f32_16x16x32_bf16 v[92:95], a[220:223], v[188:191], v[92:95]
v_exp_f32 v158, v78
v_mfma_f32_16x16x32_bf16 v[92:95], a[224:227], v[204:207], v[92:95]
v_add_f32 v151, v151, v158
v_mfma_f32_16x16x32_bf16 v[92:95], a[228:231], v[220:223], v[92:95]
buffer_load_dwordx4 v27, s[20:23], s53 offen offset:2048 nt lds
v_mfma_f32_16x16x32_bf16 v[92:95], a[232:235], v[236:239], v[92:95]
s_add_u32 m0, s37, 98304
v_exp_f32 v159, v79
v_mfma_f32_16x16x32_bf16 v[92:95], a[236:239], v[252:255], v[92:95]
s_waitcnt lgkmcnt(10)
v_add_f32 v151, v151, v159
v_cvt_pk_bf16_f32 v125, v158, v159
v_mfma_f32_16x16x32_bf16 a[0:3], v[40:43], v[96:99], a[0:3]
s_add_u32 s40, s76, 40960
v_exp_f32 v152, v80
v_mfma_f32_16x16x32_bf16 a[4:7], v[40:43], v[100:103], a[4:7]
v_add_f32 v148, v148, v152
v_mfma_f32_16x16x32_bf16 a[8:11], v[40:43], v[104:107], a[8:11]
v_exp_f32 v153, v81
v_mfma_f32_16x16x32_bf16 a[12:15], v[40:43], v[108:111], a[12:15]
s_waitcnt lgkmcnt(8)
ds_read_b64_tr_b16 v[40:41], v12 offset:49280
v_add_f32 v148, v148, v153
v_mfma_f32_16x16x32_bf16 a[16:19], v[44:47], v[96:99], a[16:19]
ds_read_b64_tr_b16 v[42:43], v12 offset:50816
v_cvt_pk_bf16_f32 v114, v152, v153
v_mfma_f32_16x16x32_bf16 a[20:23], v[44:47], v[100:103], a[20:23]
v_exp_f32 v154, v82
v_mfma_f32_16x16x32_bf16 a[24:27], v[44:47], v[104:107], a[24:27]
v_add_f32 v148, v148, v154
v_mfma_f32_16x16x32_bf16 a[28:31], v[44:47], v[108:111], a[28:31]
s_waitcnt lgkmcnt(8)
v_exp_f32 v155, v83
v_mfma_f32_16x16x32_bf16 a[32:35], v[48:51], v[96:99], a[32:35]
ds_read_b64_tr_b16 v[44:45], v13 offset:49280
v_add_f32 v148, v148, v155
v_mfma_f32_16x16x32_bf16 a[36:39], v[48:51], v[100:103], a[36:39]
buffer_load_dwordx4 v28, s[64:67], s40 offen lds
v_mfma_f32_16x16x32_bf16 a[40:43], v[48:51], v[104:107], a[40:43]
v_exp_f32 v156, v84
v_mfma_f32_16x16x32_bf16 a[44:47], v[48:51], v[108:111], a[44:47]
s_waitcnt lgkmcnt(7)
ds_read_b64_tr_b16 v[46:47], v13 offset:50816
v_cvt_pk_bf16_f32 v115, v154, v155
v_mfma_f32_16x16x32_bf16 a[48:51], v[52:55], v[96:99], a[48:51]
v_exp_f32 v157, v85
v_mfma_f32_16x16x32_bf16 a[52:55], v[52:55], v[100:103], a[52:55]
ds_read_b64_tr_b16 v[48:49], v10 offset:49408
v_add_f32 v149, v149, v156
v_mfma_f32_16x16x32_bf16 a[56:59], v[52:55], v[104:107], a[56:59]
v_exp_f32 v158, v86
v_mfma_f32_16x16x32_bf16 a[60:63], v[52:55], v[108:111], a[60:63]
s_waitcnt lgkmcnt(7)
ds_read_b64_tr_b16 v[50:51], v10 offset:50944
v_add_f32 v149, v149, v157
v_mfma_f32_16x16x32_bf16 a[64:67], v[56:59], v[96:99], a[64:67]
ds_read_b64_tr_b16 v[52:53], v11 offset:49408
v_cvt_pk_bf16_f32 v118, v156, v157
v_mfma_f32_16x16x32_bf16 a[68:71], v[56:59], v[100:103], a[68:71]
v_exp_f32 v159, v87
v_mfma_f32_16x16x32_bf16 a[72:75], v[56:59], v[104:107], a[72:75]
ds_read_b64_tr_b16 v[54:55], v11 offset:50944
v_add_f32 v149, v149, v158
v_mfma_f32_16x16x32_bf16 a[76:79], v[56:59], v[108:111], a[76:79]
s_waitcnt lgkmcnt(8)
v_exp_f32 v152, v88
v_mfma_f32_16x16x32_bf16 a[80:83], v[60:63], v[96:99], a[80:83]
ds_read_b64_tr_b16 v[56:57], v12 offset:49408
v_add_f32 v149, v149, v159
v_mfma_f32_16x16x32_bf16 a[84:87], v[60:63], v[100:103], a[84:87]
buffer_load_dwordx4 v29, s[64:67], s40 offen offset:1024 lds
v_mfma_f32_16x16x32_bf16 a[88:91], v[60:63], v[104:107], a[88:91]
v_exp_f32 v153, v89
v_mfma_f32_16x16x32_bf16 a[92:95], v[60:63], v[108:111], a[92:95]
s_waitcnt lgkmcnt(7)
v_cvt_pk_bf16_f32 v119, v158, v159
v_add_f32 v150, v150, v152
v_mfma_f32_16x16x32_bf16 a[96:99], v[40:43], v[96:99], a[96:99]
v_exp_f32 v154, v90
v_mfma_f32_16x16x32_bf16 a[100:103], v[40:43], v[100:103], a[100:103]
ds_read_b64_tr_b16 v[58:59], v12 offset:50944
ds_read_b64_tr_b16 v[60:61], v13 offset:49408
v_mfma_f32_16x16x32_bf16 a[104:107], v[40:43], v[104:107], a[104:107]
v_exp_f32 v155, v91
v_mfma_f32_16x16x32_bf16 a[108:111], v[40:43], v[108:111], a[108:111]
s_waitcnt lgkmcnt(7)
ds_read_b64_tr_b16 v[62:63], v13 offset:50944
v_add_f32 v150, v150, v153
v_mfma_f32_16x16x32_bf16 a[112:115], v[44:47], v[96:99], a[112:115]
v_cvt_pk_bf16_f32 v122, v152, v153
v_add_f32 v150, v150, v154
v_mfma_f32_16x16x32_bf16 a[116:119], v[44:47], v[100:103], a[116:119]
v_exp_f32 v156, v92
v_mfma_f32_16x16x32_bf16 a[120:123], v[44:47], v[104:107], a[120:123]
v_add_f32 v150, v150, v155
v_cvt_pk_bf16_f32 v123, v154, v155
v_mfma_f32_16x16x32_bf16 a[124:127], v[44:47], v[108:111], a[124:127]
s_waitcnt lgkmcnt(6)
v_exp_f32 v157, v93
v_mfma_f32_16x16x32_bf16 a[128:131], v[48:51], v[96:99], a[128:131]
s_waitcnt vmcnt(11) lgkmcnt(0)
v_add_f32 v151, v151, v156
v_add_f32 v151, v151, v157
v_mfma_f32_16x16x32_bf16 a[132:135], v[48:51], v[100:103], a[132:135]
s_barrier
v_cvt_pk_bf16_f32 v126, v156, v157
v_mfma_f32_16x16x32_bf16 a[136:139], v[48:51], v[104:107], a[136:139]
v_exp_f32 v158, v94
v_mfma_f32_16x16x32_bf16 a[140:143], v[48:51], v[108:111], a[140:143]
ds_read_b128 a[192:195], v8 offset:0
v_add_f32 v151, v151, v158
v_mfma_f32_16x16x32_bf16 a[144:147], v[52:55], v[96:99], a[144:147]
v_exp_f32 v159, v95
v_mfma_f32_16x16x32_bf16 a[148:151], v[52:55], v[100:103], a[148:151]
ds_read_b128 a[196:199], v9 offset:0
v_add_f32 v151, v151, v159
v_mfma_f32_16x16x32_bf16 a[152:155], v[52:55], v[104:107], a[152:155]
ds_read_b128 a[200:203], v8 offset:128
v_cvt_pk_bf16_f32 v127, v158, v159
v_mfma_f32_16x16x32_bf16 a[156:159], v[52:55], v[108:111], a[156:159]
ds_read_b128 a[204:207], v9 offset:128
ds_read_b128 a[208:211], v8 offset:256
v_mfma_f32_16x16x32_bf16 a[160:163], v[56:59], v[96:99], a[160:163]
ds_read_b128 a[212:215], v9 offset:256
v_mfma_f32_16x16x32_bf16 a[164:167], v[56:59], v[100:103], a[164:167]
v_mfma_f32_16x16x32_bf16 a[168:171], v[56:59], v[104:107], a[168:171]
buffer_load_dwordx4 v30, s[64:67], s40 offen offset:2048 lds
v_mfma_f32_16x16x32_bf16 a[172:175], v[56:59], v[108:111], a[172:175]
v_mfma_f32_16x16x32_bf16 a[176:179], v[60:63], v[96:99], a[176:179]
v_max3_f32 v1, v148, v149, v150
v_max_f32 v1, v1, v151
v_mfma_f32_16x16x32_bf16 a[180:183], v[60:63], v[100:103], a[180:183]
v_cmp_nge_f32 vcc, s44, v1
v_mfma_f32_16x16x32_bf16 a[184:187], v[60:63], v[104:107], a[184:187]
s_waitcnt lgkmcnt(3)
v_mfma_f32_16x16x32_bf16 a[188:191], v[60:63], v[108:111], a[188:191]
s_cbranch_vccnz KF_fxp28
KF_bkp28:
v_mfma_f32_16x16x32_bf16 v[64:67], a[192:195], v[160:163], v[128:131]
s_add_u32 m0, s37, 86016
ds_read_b128 a[216:219], v8 offset:1536
v_mov_b32 v23, v5
v_mfma_f32_16x16x32_bf16 v[64:67], a[196:199], v[176:179], v[64:67]
ds_read_b128 a[220:223], v9 offset:1536
v_mfma_f32_16x16x32_bf16 v[64:67], a[200:203], v[192:195], v[64:67]
s_waitcnt lgkmcnt(2)
ds_read_b128 a[224:227], v8 offset:1664
v_mfma_f32_16x16x32_bf16 v[64:67], a[204:207], v[208:211], v[64:67]
ds_read_b128 a[228:231], v9 offset:1664
v_mfma_f32_16x16x32_bf16 v[64:67], a[208:211], v[224:227], v[64:67]
buffer_load_dwordx4 v25, s[20:23], s42 offen nt lds
v_mfma_f32_16x16x32_bf16 v[64:67], a[212:215], v[240:243], v[64:67]
ds_read_b128 a[232:235], v8 offset:1792
ds_read_b128 a[236:239], v9 offset:1792
v_mfma_f32_16x16x32_bf16 v[68:71], a[192:195], v[164:167], v[132:135]
buffer_load_dwordx4 v26, s[20:23], s42 offen offset:1024 nt lds
v_mfma_f32_16x16x32_bf16 v[68:71], a[196:199], v[180:183], v[68:71]
ds_read_b64_tr_b16 v[40:41], v10 offset:61440
v_mfma_f32_16x16x32_bf16 v[68:71], a[200:203], v[196:199], v[68:71]
buffer_load_dwordx4 v27, s[20:23], s42 offen offset:2048 nt lds
v_mfma_f32_16x16x32_bf16 v[68:71], a[204:207], v[212:215], v[68:71]
s_add_u32 m0, s37, 36864
ds_read_b64_tr_b16 v[42:43], v10 offset:62976
v_mfma_f32_16x16x32_bf16 v[68:71], a[208:211], v[228:231], v[68:71]
s_add_u32 s40, s76, 81920
v_exp_f32 v152, v64
v_mfma_f32_16x16x32_bf16 v[68:71], a[212:215], v[244:247], v[68:71]
v_add_f32 v144, v148, v152
v_mfma_f32_16x16x32_bf16 v[72:75], a[192:195], v[168:171], v[136:139]
v_exp_f32 v153, v65
v_mfma_f32_16x16x32_bf16 v[72:75], a[196:199], v[184:187], v[72:75]
ds_read_b64_tr_b16 v[44:45], v11 offset:61440
v_add_f32 v144, v144, v153
v_mfma_f32_16x16x32_bf16 v[72:75], a[200:203], v[200:203], v[72:75]
v_exp_f32 v154, v66
v_mfma_f32_16x16x32_bf16 v[72:75], a[204:207], v[216:219], v[72:75]
ds_read_b64_tr_b16 v[46:47], v11 offset:62976
v_cvt_pk_bf16_f32 v96, v152, v153
v_mfma_f32_16x16x32_bf16 v[72:75], a[208:211], v[232:235], v[72:75]
v_add_f32 v144, v144, v154
v_mfma_f32_16x16x32_bf16 v[72:75], a[212:215], v[248:251], v[72:75]
v_exp_f32 v155, v67
v_mfma_f32_16x16x32_bf16 v[76:79], a[192:195], v[172:175], v[140:143]
ds_read_b64_tr_b16 v[48:49], v12 offset:61440
v_add_f32 v144, v144, v155
v_mfma_f32_16x16x32_bf16 v[76:79], a[196:199], v[188:191], v[76:79]
v_exp_f32 v156, v68
v_mfma_f32_16x16x32_bf16 v[76:79], a[200:203], v[204:207], v[76:79]
v_cvt_pk_bf16_f32 v97, v154, v155
v_add_f32 v145, v149, v156
v_mfma_f32_16x16x32_bf16 v[76:79], a[204:207], v[220:223], v[76:79]
buffer_load_dwordx4 v28, s[64:67], s40 offen lds
v_mfma_f32_16x16x32_bf16 v[76:79], a[208:211], v[236:239], v[76:79]
v_exp_f32 v157, v69
v_mfma_f32_16x16x32_bf16 v[76:79], a[212:215], v[252:255], v[76:79]
s_waitcnt lgkmcnt(8)
ds_read_b64_tr_b16 v[50:51], v12 offset:62976
v_add_f32 v145, v145, v157
v_mfma_f32_16x16x32_bf16 v[80:83], a[216:219], v[160:163], v[128:131]
v_exp_f32 v158, v70
v_mfma_f32_16x16x32_bf16 v[80:83], a[220:223], v[176:179], v[80:83]
ds_read_b64_tr_b16 v[52:53], v13 offset:61440
v_cvt_pk_bf16_f32 v100, v156, v157
v_mfma_f32_16x16x32_bf16 v[80:83], a[224:227], v[192:195], v[80:83]
s_waitcnt lgkmcnt(7)
v_exp_f32 v159, v71
v_mfma_f32_16x16x32_bf16 v[80:83], a[228:231], v[208:211], v[80:83]
ds_read_b64_tr_b16 v[54:55], v13 offset:62976
v_add_f32 v145, v145, v158
v_mfma_f32_16x16x32_bf16 v[80:83], a[232:235], v[224:227], v[80:83]
v_add_f32 v145, v145, v159
v_cvt_pk_bf16_f32 v101, v158, v159
v_mfma_f32_16x16x32_bf16 v[80:83], a[236:239], v[240:243], v[80:83]
v_exp_f32 v152, v72
v_mfma_f32_16x16x32_bf16 v[84:87], a[216:219], v[164:167], v[132:135]
ds_read_b64_tr_b16 v[56:57], v10 offset:61568
v_add_f32 v146, v150, v152
v_mfma_f32_16x16x32_bf16 v[84:87], a[220:223], v[180:183], v[84:87]
v_exp_f32 v153, v73
v_mfma_f32_16x16x32_bf16 v[84:87], a[224:227], v[196:199], v[84:87]
v_add_f32 v146, v146, v153
v_cvt_pk_bf16_f32 v104, v152, v153
v_mfma_f32_16x16x32_bf16 v[84:87], a[228:231], v[212:215], v[84:87]
buffer_load_dwordx4 v29, s[64:67], s40 offen offset:1024 lds
v_mfma_f32_16x16x32_bf16 v[84:87], a[232:235], v[228:231], v[84:87]
v_exp_f32 v154, v74
v_mfma_f32_16x16x32_bf16 v[84:87], a[236:239], v[244:247], v[84:87]
ds_read_b64_tr_b16 v[58:59], v10 offset:63104
v_add_f32 v146, v146, v154
v_mfma_f32_16x16x32_bf16 v[88:91], a[216:219], v[168:171], v[136:139]
v_exp_f32 v155, v75
v_mfma_f32_16x16x32_bf16 v[88:91], a[220:223], v[184:187], v[88:91]
ds_read_b64_tr_b16 v[60:61], v11 offset:61568
v_add_f32 v146, v146, v155
v_mfma_f32_16x16x32_bf16 v[88:91], a[224:227], v[200:203], v[88:91]
v_exp_f32 v156, v76
v_mfma_f32_16x16x32_bf16 v[88:91], a[228:231], v[216:219], v[88:91]
ds_read_b64_tr_b16 v[62:63], v11 offset:63104
v_cvt_pk_bf16_f32 v105, v154, v155
v_mfma_f32_16x16x32_bf16 v[88:91], a[232:235], v[232:235], v[88:91]
v_add_f32 v147, v151, v156
v_mfma_f32_16x16x32_bf16 v[88:91], a[236:239], v[248:251], v[88:91]
v_exp_f32 v157, v77
v_mfma_f32_16x16x32_bf16 v[92:95], a[216:219], v[172:175], v[140:143]
v_add_f32 v147, v147, v157
v_cvt_pk_bf16_f32 v108, v156, v157
v_mfma_f32_16x16x32_bf16 v[92:95], a[220:223], v[188:191], v[92:95]
v_exp_f32 v158, v78
v_mfma_f32_16x16x32_bf16 v[92:95], a[224:227], v[204:207], v[92:95]
v_add_f32 v147, v147, v158
v_mfma_f32_16x16x32_bf16 v[92:95], a[228:231], v[220:223], v[92:95]
buffer_load_dwordx4 v30, s[64:67], s40 offen offset:2048 lds
v_mfma_f32_16x16x32_bf16 v[92:95], a[232:235], v[236:239], v[92:95]
s_add_u32 m0, s37, 110592
v_exp_f32 v159, v79
v_mfma_f32_16x16x32_bf16 v[92:95], a[236:239], v[252:255], v[92:95]
s_waitcnt lgkmcnt(10)
v_add_f32 v147, v147, v159
v_cvt_pk_bf16_f32 v109, v158, v159
v_mfma_f32_16x16x32_bf16 a[0:3], v[40:43], v[112:115], a[0:3]
s_add_u32 s40, s76, 122880
v_exp_f32 v152, v80
v_mfma_f32_16x16x32_bf16 a[4:7], v[40:43], v[116:119], a[4:7]
v_add_f32 v144, v144, v152
v_mfma_f32_16x16x32_bf16 a[8:11], v[40:43], v[120:123], a[8:11]
v_exp_f32 v153, v81
v_mfma_f32_16x16x32_bf16 a[12:15], v[40:43], v[124:127], a[12:15]
s_waitcnt lgkmcnt(8)
ds_read_b64_tr_b16 v[40:41], v12 offset:61568
v_add_f32 v144, v144, v153
v_mfma_f32_16x16x32_bf16 a[16:19], v[44:47], v[112:115], a[16:19]
ds_read_b64_tr_b16 v[42:43], v12 offset:63104
v_cvt_pk_bf16_f32 v98, v152, v153
v_mfma_f32_16x16x32_bf16 a[20:23], v[44:47], v[116:119], a[20:23]
v_exp_f32 v154, v82
v_mfma_f32_16x16x32_bf16 a[24:27], v[44:47], v[120:123], a[24:27]
v_add_f32 v144, v144, v154
v_mfma_f32_16x16x32_bf16 a[28:31], v[44:47], v[124:127], a[28:31]
s_waitcnt lgkmcnt(8)
v_exp_f32 v155, v83
v_mfma_f32_16x16x32_bf16 a[32:35], v[48:51], v[112:115], a[32:35]
ds_read_b64_tr_b16 v[44:45], v13 offset:61568
v_add_f32 v144, v144, v155
v_mfma_f32_16x16x32_bf16 a[36:39], v[48:51], v[116:119], a[36:39]
buffer_load_dwordx4 v28, s[64:67], s40 offen lds
v_mfma_f32_16x16x32_bf16 a[40:43], v[48:51], v[120:123], a[40:43]
v_exp_f32 v156, v84
v_mfma_f32_16x16x32_bf16 a[44:47], v[48:51], v[124:127], a[44:47]
s_waitcnt lgkmcnt(7)
ds_read_b64_tr_b16 v[46:47], v13 offset:63104
v_cvt_pk_bf16_f32 v99, v154, v155
v_mfma_f32_16x16x32_bf16 a[48:51], v[52:55], v[112:115], a[48:51]
v_exp_f32 v157, v85
v_mfma_f32_16x16x32_bf16 a[52:55], v[52:55], v[116:119], a[52:55]
ds_read_b64_tr_b16 v[48:49], v10 offset:61696
v_add_f32 v145, v145, v156
v_mfma_f32_16x16x32_bf16 a[56:59], v[52:55], v[120:123], a[56:59]
v_exp_f32 v158, v86
v_mfma_f32_16x16x32_bf16 a[60:63], v[52:55], v[124:127], a[60:63]
s_waitcnt lgkmcnt(7)
ds_read_b64_tr_b16 v[50:51], v10 offset:63232
v_add_f32 v145, v145, v157
v_mfma_f32_16x16x32_bf16 a[64:67], v[56:59], v[112:115], a[64:67]
ds_read_b64_tr_b16 v[52:53], v11 offset:61696
v_cvt_pk_bf16_f32 v102, v156, v157
v_mfma_f32_16x16x32_bf16 a[68:71], v[56:59], v[116:119], a[68:71]
v_exp_f32 v159, v87
v_mfma_f32_16x16x32_bf16 a[72:75], v[56:59], v[120:123], a[72:75]
ds_read_b64_tr_b16 v[54:55], v11 offset:63232
v_add_f32 v145, v145, v158
v_mfma_f32_16x16x32_bf16 a[76:79], v[56:59], v[124:127], a[76:79]
s_waitcnt lgkmcnt(8)
v_exp_f32 v152, v88
v_mfma_f32_16x16x32_bf16 a[80:83], v[60:63], v[112:115], a[80:83]
ds_read_b64_tr_b16 v[56:57], v12 offset:61696
v_add_f32 v145, v145, v159
v_mfma_f32_16x16x32_bf16 a[84:87], v[60:63], v[116:119], a[84:87]
buffer_load_dwordx4 v29, s[64:67], s40 offen offset:1024 lds
v_mfma_f32_16x16x32_bf16 a[88:91], v[60:63], v[120:123], a[88:91]
v_exp_f32 v153, v89
v_mfma_f32_16x16x32_bf16 a[92:95], v[60:63], v[124:127], a[92:95]
s_waitcnt lgkmcnt(7)
v_cvt_pk_bf16_f32 v103, v158, v159
v_add_f32 v146, v146, v152
v_mfma_f32_16x16x32_bf16 a[96:99], v[40:43], v[112:115], a[96:99]
v_exp_f32 v154, v90
v_mfma_f32_16x16x32_bf16 a[100:103], v[40:43], v[116:119], a[100:103]
ds_read_b64_tr_b16 v[58:59], v12 offset:63232
ds_read_b64_tr_b16 v[60:61], v13 offset:61696
v_mfma_f32_16x16x32_bf16 a[104:107], v[40:43], v[120:123], a[104:107]
v_exp_f32 v155, v91
v_mfma_f32_16x16x32_bf16 a[108:111], v[40:43], v[124:127], a[108:111]
s_waitcnt lgkmcnt(7)
ds_read_b64_tr_b16 v[62:63], v13 offset:63232
v_add_f32 v146, v146, v153
v_mfma_f32_16x16x32_bf16 a[112:115], v[44:47], v[112:115], a[112:115]
v_cvt_pk_bf16_f32 v106, v152, v153
v_add_f32 v146, v146, v154
v_mfma_f32_16x16x32_bf16 a[116:119], v[44:47], v[116:119], a[116:119]
v_exp_f32 v156, v92
v_mfma_f32_16x16x32_bf16 a[120:123], v[44:47], v[120:123], a[120:123]
v_add_f32 v146, v146, v155
v_cvt_pk_bf16_f32 v107, v154, v155
v_mfma_f32_16x16x32_bf16 a[124:127], v[44:47], v[124:127], a[124:127]
s_waitcnt lgkmcnt(6)
v_exp_f32 v157, v93
v_mfma_f32_16x16x32_bf16 a[128:131], v[48:51], v[112:115], a[128:131]
s_waitcnt vmcnt(11) lgkmcnt(0)
v_add_f32 v147, v147, v156
v_add_f32 v147, v147, v157
v_mfma_f32_16x16x32_bf16 a[132:135], v[48:51], v[116:119], a[132:135]
s_barrier
v_cvt_pk_bf16_f32 v110, v156, v157
v_mfma_f32_16x16x32_bf16 a[136:139], v[48:51], v[120:123], a[136:139]
v_exp_f32 v158, v94
v_mfma_f32_16x16x32_bf16 a[140:143], v[48:51], v[124:127], a[140:143]
ds_read_b128 a[192:195], v8 offset:12288
v_add_f32 v147, v147, v158
v_mfma_f32_16x16x32_bf16 a[144:147], v[52:55], v[112:115], a[144:147]
v_exp_f32 v159, v95
v_mfma_f32_16x16x32_bf16 a[148:151], v[52:55], v[116:119], a[148:151]
ds_read_b128 a[196:199], v9 offset:12288
v_add_f32 v147, v147, v159
v_mfma_f32_16x16x32_bf16 a[152:155], v[52:55], v[120:123], a[152:155]
ds_read_b128 a[200:203], v8 offset:12416
v_cvt_pk_bf16_f32 v111, v158, v159
v_mfma_f32_16x16x32_bf16 a[156:159], v[52:55], v[124:127], a[156:159]
ds_read_b128 a[204:207], v9 offset:12416
ds_read_b128 a[208:211], v8 offset:12544
v_mfma_f32_16x16x32_bf16 a[160:163], v[56:59], v[112:115], a[160:163]
ds_read_b128 a[212:215], v9 offset:12544
v_mfma_f32_16x16x32_bf16 a[164:167], v[56:59], v[116:119], a[164:167]
v_mfma_f32_16x16x32_bf16 a[168:171], v[56:59], v[120:123], a[168:171]
buffer_load_dwordx4 v30, s[64:67], s40 offen offset:2048 lds
v_mfma_f32_16x16x32_bf16 a[172:175], v[56:59], v[124:127], a[172:175]
v_mfma_f32_16x16x32_bf16 a[176:179], v[60:63], v[112:115], a[176:179]
v_max3_f32 v1, v144, v145, v146
v_max_f32 v1, v1, v147
v_mfma_f32_16x16x32_bf16 a[180:183], v[60:63], v[116:119], a[180:183]
s_waitcnt lgkmcnt(3)
v_cmp_nge_f32 vcc, s44, v1
v_mfma_f32_16x16x32_bf16 a[184:187], v[60:63], v[120:123], a[184:187]
buffer_load_dword v5, v6, s[60:63], 0 offen sc1
v_mfma_f32_16x16x32_bf16 a[188:191], v[60:63], v[124:127], a[188:191]
s_cbranch_vccnz KF_fxp29
KF_bkp29:
v_mfma_f32_16x16x32_bf16 v[64:67], a[192:195], v[160:163], v[128:131]
s_add_u32 m0, s37, 49152
ds_read_b128 a[216:219], v8 offset:13824
v_mfma_f32_16x16x32_bf16 v[64:67], a[196:199], v[176:179], v[64:67]
s_add_u32 s40, s76, 163840
ds_read_b128 a[220:223], v9 offset:13824
v_mfma_f32_16x16x32_bf16 v[64:67], a[200:203], v[192:195], v[64:67]
s_waitcnt lgkmcnt(2)
ds_read_b128 a[224:227], v8 offset:13952
v_mfma_f32_16x16x32_bf16 v[64:67], a[204:207], v[208:211], v[64:67]
ds_read_b128 a[228:231], v9 offset:13952
v_mfma_f32_16x16x32_bf16 v[64:67], a[208:211], v[224:227], v[64:67]
buffer_load_dwordx4 v28, s[64:67], s40 offen lds
v_mfma_f32_16x16x32_bf16 v[64:67], a[212:215], v[240:243], v[64:67]
ds_read_b128 a[232:235], v8 offset:14080
ds_read_b128 a[236:239], v9 offset:14080
v_mfma_f32_16x16x32_bf16 v[68:71], a[192:195], v[164:167], v[132:135]
buffer_load_dwordx4 v29, s[64:67], s40 offen offset:1024 lds
v_mfma_f32_16x16x32_bf16 v[68:71], a[196:199], v[180:183], v[68:71]
ds_read_b64_tr_b16 v[40:41], v10 offset:0
v_mfma_f32_16x16x32_bf16 v[68:71], a[200:203], v[196:199], v[68:71]
buffer_load_dwordx4 v30, s[64:67], s40 offen offset:2048 lds
v_mfma_f32_16x16x32_bf16 v[68:71], a[204:207], v[212:215], v[68:71]
s_add_u32 m0, s37, 122880
ds_read_b64_tr_b16 v[42:43], v10 offset:1536
v_mfma_f32_16x16x32_bf16 v[68:71], a[208:211], v[228:231], v[68:71]
s_add_u32 s40, s76, 204800
v_exp_f32 v152, v64
v_mfma_f32_16x16x32_bf16 v[68:71], a[212:215], v[244:247], v[68:71]
v_add_f32 v148, v144, v152
v_mfma_f32_16x16x32_bf16 v[72:75], a[192:195], v[168:171], v[136:139]
v_exp_f32 v153, v65
v_mfma_f32_16x16x32_bf16 v[72:75], a[196:199], v[184:187], v[72:75]
ds_read_b64_tr_b16 v[44:45], v11 offset:0
v_add_f32 v148, v148, v153
v_mfma_f32_16x16x32_bf16 v[72:75], a[200:203], v[200:203], v[72:75]
v_exp_f32 v154, v66
v_mfma_f32_16x16x32_bf16 v[72:75], a[204:207], v[216:219], v[72:75]
ds_read_b64_tr_b16 v[46:47], v11 offset:1536
v_cvt_pk_bf16_f32 v112, v152, v153
v_mfma_f32_16x16x32_bf16 v[72:75], a[208:211], v[232:235], v[72:75]
v_add_f32 v148, v148, v154
v_mfma_f32_16x16x32_bf16 v[72:75], a[212:215], v[248:251], v[72:75]
v_exp_f32 v155, v67
v_mfma_f32_16x16x32_bf16 v[76:79], a[192:195], v[172:175], v[140:143]
ds_read_b64_tr_b16 v[48:49], v12 offset:0
v_add_f32 v148, v148, v155
v_mfma_f32_16x16x32_bf16 v[76:79], a[196:199], v[188:191], v[76:79]
v_exp_f32 v156, v68
v_mfma_f32_16x16x32_bf16 v[76:79], a[200:203], v[204:207], v[76:79]
v_cvt_pk_bf16_f32 v113, v154, v155
v_add_f32 v149, v145, v156
v_mfma_f32_16x16x32_bf16 v[76:79], a[204:207], v[220:223], v[76:79]
buffer_load_dwordx4 v28, s[64:67], s40 offen lds
v_mfma_f32_16x16x32_bf16 v[76:79], a[208:211], v[236:239], v[76:79]
v_exp_f32 v157, v69
v_mfma_f32_16x16x32_bf16 v[76:79], a[212:215], v[252:255], v[76:79]
s_waitcnt lgkmcnt(8)
ds_read_b64_tr_b16 v[50:51], v12 offset:1536
v_add_f32 v149, v149, v157
v_mfma_f32_16x16x32_bf16 v[80:83], a[216:219], v[160:163], v[128:131]
v_exp_f32 v158, v70
v_mfma_f32_16x16x32_bf16 v[80:83], a[220:223], v[176:179], v[80:83]
ds_read_b64_tr_b16 v[52:53], v13 offset:0
v_cvt_pk_bf16_f32 v116, v156, v157
v_mfma_f32_16x16x32_bf16 v[80:83], a[224:227], v[192:195], v[80:83]
s_waitcnt lgkmcnt(7)
v_exp_f32 v159, v71
v_mfma_f32_16x16x32_bf16 v[80:83], a[228:231], v[208:211], v[80:83]
ds_read_b64_tr_b16 v[54:55], v13 offset:1536
v_add_f32 v149, v149, v158
v_mfma_f32_16x16x32_bf16 v[80:83], a[232:235], v[224:227], v[80:83]
v_add_f32 v149, v149, v159
v_cvt_pk_bf16_f32 v117, v158, v159
v_mfma_f32_16x16x32_bf16 v[80:83], a[236:239], v[240:243], v[80:83]
v_exp_f32 v152, v72
v_mfma_f32_16x16x32_bf16 v[84:87], a[216:219], v[164:167], v[132:135]
ds_read_b64_tr_b16 v[56:57], v10 offset:128
v_add_f32 v150, v146, v152
v_mfma_f32_16x16x32_bf16 v[84:87], a[220:223], v[180:183], v[84:87]
v_exp_f32 v153, v73
v_mfma_f32_16x16x32_bf16 v[84:87], a[224:227], v[196:199], v[84:87]
v_add_f32 v150, v150, v153
v_cvt_pk_bf16_f32 v120, v152, v153
v_mfma_f32_16x16x32_bf16 v[84:87], a[228:231], v[212:215], v[84:87]
buffer_load_dwordx4 v29, s[64:67], s40 offen offset:1024 lds
v_mfma_f32_16x16x32_bf16 v[84:87], a[232:235], v[228:231], v[84:87]
v_exp_f32 v154, v74
v_mfma_f32_16x16x32_bf16 v[84:87], a[236:239], v[244:247], v[84:87]
ds_read_b64_tr_b16 v[58:59], v10 offset:1664
v_add_f32 v150, v150, v154
v_mfma_f32_16x16x32_bf16 v[88:91], a[216:219], v[168:171], v[136:139]
v_exp_f32 v155, v75
v_mfma_f32_16x16x32_bf16 v[88:91], a[220:223], v[184:187], v[88:91]
ds_read_b64_tr_b16 v[60:61], v11 offset:128
v_add_f32 v150, v150, v155
v_mfma_f32_16x16x32_bf16 v[88:91], a[224:227], v[200:203], v[88:91]
KF_pg10:
s_cbranch_execz KF_pg14
v_exp_f32 v156, v76
v_mfma_f32_16x16x32_bf16 v[88:91], a[228:231], v[216:219], v[88:91]
ds_read_b64_tr_b16 v[62:63], v11 offset:1664
v_cvt_pk_bf16_f32 v121, v154, v155
v_mfma_f32_16x16x32_bf16 v[88:91], a[232:235], v[232:235], v[88:91]
v_add_f32 v151, v147, v156
v_mfma_f32_16x16x32_bf16 v[88:91], a[236:239], v[248:251], v[88:91]
v_exp_f32 v157, v77
v_mfma_f32_16x16x32_bf16 v[92:95], a[216:219], v[172:175], v[140:143]
v_add_f32 v151, v151, v157
v_cvt_pk_bf16_f32 v124, v156, v157
v_mfma_f32_16x16x32_bf16 v[92:95], a[220:223], v[188:191], v[92:95]
v_exp_f32 v158, v78
v_mfma_f32_16x16x32_bf16 v[92:95], a[224:227], v[204:207], v[92:95]
v_add_f32 v151, v151, v158
v_mfma_f32_16x16x32_bf16 v[92:95], a[228:231], v[220:223], v[92:95]
buffer_load_dwordx4 v30, s[64:67], s40 offen offset:2048 lds
v_mfma_f32_16x16x32_bf16 v[92:95], a[232:235], v[236:239], v[92:95]
s_add_u32 m0, s37, 61440
v_exp_f32 v159, v79
v_mfma_f32_16x16x32_bf16 v[92:95], a[236:239], v[252:255], v[92:95]
s_waitcnt lgkmcnt(10)
v_add_f32 v151, v151, v159
v_cvt_pk_bf16_f32 v125, v158, v159
v_mfma_f32_16x16x32_bf16 a[0:3], v[40:43], v[96:99], a[0:3]
s_add_u32 s40, s77, 0
v_exp_f32 v152, v80
v_mfma_f32_16x16x32_bf16 a[4:7], v[40:43], v[100:103], a[4:7]
v_add_f32 v148, v148, v152
v_mfma_f32_16x16x32_bf16 a[8:11], v[40:43], v[104:107], a[8:11]
v_exp_f32 v153, v81
v_mfma_f32_16x16x32_bf16 a[12:15], v[40:43], v[108:111], a[12:15]
s_waitcnt lgkmcnt(8)
ds_read_b64_tr_b16 v[40:41], v12 offset:128
v_add_f32 v148, v148, v153
v_mfma_f32_16x16x32_bf16 a[16:19], v[44:47], v[96:99], a[16:19]
ds_read_b64_tr_b16 v[42:43], v12 offset:1664
v_cvt_pk_bf16_f32 v114, v152, v153
v_mfma_f32_16x16x32_bf16 a[20:23], v[44:47], v[100:103], a[20:23]
v_exp_f32 v154, v82
v_mfma_f32_16x16x32_bf16 a[24:27], v[44:47], v[104:107], a[24:27]
v_add_f32 v148, v148, v154
v_mfma_f32_16x16x32_bf16 a[28:31], v[44:47], v[108:111], a[28:31]
s_waitcnt lgkmcnt(8)
v_exp_f32 v155, v83
v_mfma_f32_16x16x32_bf16 a[32:35], v[48:51], v[96:99], a[32:35]
ds_read_b64_tr_b16 v[44:45], v13 offset:128
v_add_f32 v148, v148, v155
v_mfma_f32_16x16x32_bf16 a[36:39], v[48:51], v[100:103], a[36:39]
buffer_load_dwordx4 v28, s[64:67], s40 offen lds
v_mfma_f32_16x16x32_bf16 a[40:43], v[48:51], v[104:107], a[40:43]
v_exp_f32 v156, v84
v_mfma_f32_16x16x32_bf16 a[44:47], v[48:51], v[108:111], a[44:47]
s_waitcnt lgkmcnt(7)
ds_read_b64_tr_b16 v[46:47], v13 offset:1664
v_cvt_pk_bf16_f32 v115, v154, v155
v_mfma_f32_16x16x32_bf16 a[48:51], v[52:55], v[96:99], a[48:51]
v_exp_f32 v157, v85
v_mfma_f32_16x16x32_bf16 a[52:55], v[52:55], v[100:103], a[52:55]
ds_read_b64_tr_b16 v[48:49], v10 offset:256
v_add_f32 v149, v149, v156
v_mfma_f32_16x16x32_bf16 a[56:59], v[52:55], v[104:107], a[56:59]
v_exp_f32 v158, v86
v_mfma_f32_16x16x32_bf16 a[60:63], v[52:55], v[108:111], a[60:63]
s_waitcnt lgkmcnt(7)
ds_read_b64_tr_b16 v[50:51], v10 offset:1792
v_add_f32 v149, v149, v157
v_mfma_f32_16x16x32_bf16 a[64:67], v[56:59], v[96:99], a[64:67]
ds_read_b64_tr_b16 v[52:53], v11 offset:256
v_cvt_pk_bf16_f32 v118, v156, v157
v_mfma_f32_16x16x32_bf16 a[68:71], v[56:59], v[100:103], a[68:71]
v_exp_f32 v159, v87
v_mfma_f32_16x16x32_bf16 a[72:75], v[56:59], v[104:107], a[72:75]
s_waitcnt vmcnt(7)
v_cmp_gt_u32 vcc, 32, v5
v_add_f32 v149, v149, v158
v_mfma_f32_16x16x32_bf16 a[76:79], v[56:59], v[108:111], a[76:79]
s_waitcnt lgkmcnt(7)
v_exp_f32 v152, v88
v_mfma_f32_16x16x32_bf16 a[80:83], v[60:63], v[96:99], a[80:83]
ds_read_b64_tr_b16 v[54:55], v11 offset:1792
v_add_f32 v149, v149, v159
v_mfma_f32_16x16x32_bf16 a[84:87], v[60:63], v[100:103], a[84:87]
buffer_load_dwordx4 v29, s[64:67], s40 offen offset:1024 lds
v_mfma_f32_16x16x32_bf16 a[88:91], v[60:63], v[104:107], a[88:91]
s_cbranch_vccnz KF_slc
KF_rtc:
v_exp_f32 v153, v89
v_mfma_f32_16x16x32_bf16 a[92:95], v[60:63], v[108:111], a[92:95]
s_waitcnt lgkmcnt(6)
v_cvt_pk_bf16_f32 v119, v158, v159
v_add_f32 v150, v150, v152
v_mfma_f32_16x16x32_bf16 a[96:99], v[40:43], v[96:99], a[96:99]
v_exp_f32 v154, v90
v_mfma_f32_16x16x32_bf16 a[100:103], v[40:43], v[100:103], a[100:103]
ds_read_b64_tr_b16 v[56:57], v12 offset:256
ds_read_b64_tr_b16 v[58:59], v12 offset:1792
v_mfma_f32_16x16x32_bf16 a[104:107], v[40:43], v[104:107], a[104:107]
v_exp_f32 v155, v91
v_mfma_f32_16x16x32_bf16 a[108:111], v[40:43], v[108:111], a[108:111]
s_waitcnt lgkmcnt(6)
ds_read_b64_tr_b16 v[60:61], v13 offset:256
ds_read_b64_tr_b16 v[62:63], v13 offset:1792
v_mfma_f32_16x16x32_bf16 a[112:115], v[44:47], v[96:99], a[112:115]
v_add_f32 v150, v150, v153
v_cvt_pk_bf16_f32 v122, v152, v153
v_mfma_f32_16x16x32_bf16 a[116:119], v[44:47], v[100:103], a[116:119]
v_exp_f32 v156, v92
v_mfma_f32_16x16x32_bf16 a[120:123], v[44:47], v[104:107], a[120:123]
v_add_f32 v150, v150, v154
v_add_f32 v150, v150, v155
v_mfma_f32_16x16x32_bf16 a[124:127], v[44:47], v[108:111], a[124:127]
s_waitcnt lgkmcnt(6)
v_exp_f32 v157, v93
v_mfma_f32_16x16x32_bf16 a[128:131], v[48:51], v[96:99], a[128:131]
s_waitcnt lgkmcnt(0)
v_cvt_pk_bf16_f32 v123, v154, v155
v_add_f32 v151, v151, v156
v_mfma_f32_16x16x32_bf16 a[132:135], v[48:51], v[100:103], a[132:135]
s_barrier
v_add_f32 v151, v151, v157
v_cvt_pk_bf16_f32 v126, v156, v157
v_mfma_f32_16x16x32_bf16 a[136:139], v[48:51], v[104:107], a[136:139]
v_exp_f32 v158, v94
v_mfma_f32_16x16x32_bf16 a[140:143], v[48:51], v[108:111], a[140:143]
ds_read_b64_tr_b16 v[40:41], v10 offset:12288
v_add_f32 v151, v151, v158
v_mfma_f32_16x16x32_bf16 a[144:147], v[52:55], v[96:99], a[144:147]
v_exp_f32 v159, v95
v_mfma_f32_16x16x32_bf16 a[148:151], v[52:55], v[100:103], a[148:151]
ds_read_b64_tr_b16 v[42:43], v10 offset:13824
v_add_f32 v151, v151, v159
v_mfma_f32_16x16x32_bf16 a[152:155], v[52:55], v[104:107], a[152:155]
ds_read_b64_tr_b16 v[44:45], v11 offset:12288
v_cvt_pk_bf16_f32 v127, v158, v159
v_mfma_f32_16x16x32_bf16 a[156:159], v[52:55], v[108:111], a[156:159]
ds_read_b64_tr_b16 v[46:47], v11 offset:13824
ds_read_b64_tr_b16 v[48:49], v12 offset:12288
v_mfma_f32_16x16x32_bf16 a[160:163], v[56:59], v[96:99], a[160:163]
ds_read_b64_tr_b16 v[50:51], v12 offset:13824
ds_read_b64_tr_b16 v[52:53], v13 offset:12288
v_mfma_f32_16x16x32_bf16 a[164:167], v[56:59], v[100:103], a[164:167]
ds_read_b64_tr_b16 v[54:55], v13 offset:13824
v_mfma_f32_16x16x32_bf16 a[168:171], v[56:59], v[104:107], a[168:171]
buffer_load_dwordx4 v30, s[64:67], s40 offen offset:2048 lds
v_mfma_f32_16x16x32_bf16 a[172:175], v[56:59], v[108:111], a[172:175]
v_mfma_f32_16x16x32_bf16 a[176:179], v[60:63], v[96:99], a[176:179]
v_max3_f32 v1, v148, v149, v150
v_max_f32 v1, v1, v151
v_mfma_f32_16x16x32_bf16 a[180:183], v[60:63], v[100:103], a[180:183]
v_cmp_nge_f32 vcc, s44, v1
v_mfma_f32_16x16x32_bf16 a[184:187], v[60:63], v[104:107], a[184:187]
s_waitcnt lgkmcnt(6)
v_mfma_f32_16x16x32_bf16 a[188:191], v[60:63], v[108:111], a[188:191]
s_cbranch_vccnz KF_fxp30
KF_bkp30:
v_mfma_f32_16x16x32_bf16 a[0:3], v[40:43], v[112:115], a[0:3]
ds_read_b64_tr_b16 v[56:57], v10 offset:12416
ds_read_b64_tr_b16 v[58:59], v10 offset:13952
v_mfma_f32_16x16x32_bf16 a[4:7], v[40:43], v[116:119], a[4:7]
s_add_u32 s40, s78, 0
v_mov_b32 v152, v148
v_mov_b32 v153, v149
v_mfma_f32_16x16x32_bf16 a[8:11], v[40:43], v[120:123], a[8:11]
s_add_u32 m0, s37, 135168
ds_read_b64_tr_b16 v[60:61], v11 offset:12416
ds_read_b64_tr_b16 v[62:63], v11 offset:13952
v_mfma_f32_16x16x32_bf16 a[12:15], v[40:43], v[124:127], a[12:15]
s_waitcnt lgkmcnt(8)
ds_read_b64_tr_b16 v[40:41], v12 offset:12416
ds_read_b64_tr_b16 v[42:43], v12 offset:13952
v_mfma_f32_16x16x32_bf16 a[16:19], v[44:47], v[112:115], a[16:19]
buffer_load_dwordx4 v28, s[64:67], s40 offen lds
v_mfma_f32_16x16x32_bf16 a[20:23], v[44:47], v[116:119], a[20:23]
v_mov_b32 v154, v150
v_mov_b32 v155, v151
v_mfma_f32_16x16x32_bf16 a[24:27], v[44:47], v[120:123], a[24:27]
v_permlane32_swap_b32 v152, v148
v_permlane32_swap_b32 v153, v149
v_mfma_f32_16x16x32_bf16 a[28:31], v[44:47], v[124:127], a[28:31]
s_waitcnt lgkmcnt(8)
ds_read_b64_tr_b16 v[44:45], v13 offset:12416
ds_read_b64_tr_b16 v[46:47], v13 offset:13952
v_mfma_f32_16x16x32_bf16 a[32:35], v[48:51], v[112:115], a[32:35]
v_permlane32_swap_b32 v154, v150
v_permlane32_swap_b32 v155, v151
v_mfma_f32_16x16x32_bf16 a[36:39], v[48:51], v[116:119], a[36:39]
v_add_f32 v148, v148, v152
v_add_f32 v149, v149, v153
v_mfma_f32_16x16x32_bf16 a[40:43], v[48:51], v[120:123], a[40:43]
v_add_f32 v150, v150, v154
v_add_f32 v151, v151, v155
v_mfma_f32_16x16x32_bf16 a[44:47], v[48:51], v[124:127], a[44:47]
s_waitcnt lgkmcnt(8)
ds_read_b64_tr_b16 v[48:49], v10 offset:12544
ds_read_b64_tr_b16 v[50:51], v10 offset:14080
v_mfma_f32_16x16x32_bf16 a[48:51], v[52:55], v[112:115], a[48:51]
buffer_load_dwordx4 v29, s[64:67], s40 offen offset:1024 lds
v_mfma_f32_16x16x32_bf16 a[52:55], v[52:55], v[116:119], a[52:55]
v_mov_b32 v152, v148
v_mov_b32 v153, v149
v_mfma_f32_16x16x32_bf16 a[56:59], v[52:55], v[120:123], a[56:59]
v_mov_b32 v154, v150
v_mov_b32 v155, v151
v_mfma_f32_16x16x32_bf16 a[60:63], v[52:55], v[124:127], a[60:63]
s_waitcnt lgkmcnt(8)
ds_read_b64_tr_b16 v[52:53], v11 offset:12544
ds_read_b64_tr_b16 v[54:55], v11 offset:14080
v_mfma_f32_16x16x32_bf16 a[64:67], v[56:59], v[112:115], a[64:67]
v_permlane16_swap_b32 v152, v148
v_permlane16_swap_b32 v153, v149
v_mfma_f32_16x16x32_bf16 a[68:71], v[56:59], v[116:119], a[68:71]
v_permlane16_swap_b32 v154, v150
v_permlane16_swap_b32 v155, v151
v_mfma_f32_16x16x32_bf16 a[72:75], v[56:59], v[120:123], a[72:75]
v_add_f32 v148, v148, v152
v_add_f32 v149, v149, v153
v_mfma_f32_16x16x32_bf16 a[76:79], v[56:59], v[124:127], a[76:79]
s_waitcnt lgkmcnt(8)
ds_read_b64_tr_b16 v[56:57], v12 offset:12544
ds_read_b64_tr_b16 v[58:59], v12 offset:14080
v_mfma_f32_16x16x32_bf16 a[80:83], v[60:63], v[112:115], a[80:83]
buffer_load_dwordx4 v30, s[64:67], s40 offen offset:2048 lds
v_mfma_f32_16x16x32_bf16 a[84:87], v[60:63], v[116:119], a[84:87]
v_add_f32 v150, v150, v154
v_add_f32 v151, v151, v155
v_mfma_f32_16x16x32_bf16 a[88:91], v[60:63], v[120:123], a[88:91]
v_rcp_f32 v2, v148
v_mfma_f32_16x16x32_bf16 a[92:95], v[60:63], v[124:127], a[92:95]
s_waitcnt lgkmcnt(8)
ds_read_b64_tr_b16 v[60:61], v13 offset:12544
ds_read_b64_tr_b16 v[62:63], v13 offset:14080
v_mfma_f32_16x16x32_bf16 a[96:99], v[40:43], v[112:115], a[96:99]
v_rcp_f32 v3, v149
v_rcp_f32 v8, v150
v_rcp_f32 v9, v151
v_mfma_f32_16x16x32_bf16 a[100:103], v[40:43], v[116:119], a[100:103]
v_accvgpr_read_b32 v160, a0
v_accvgpr_read_b32 v161, a1
v_mfma_f32_16x16x32_bf16 a[104:107], v[40:43], v[120:123], a[104:107]
s_add_u32 s40, s79, 0
v_accvgpr_read_b32 v162, a2
v_accvgpr_read_b32 v163, a3
v_mfma_f32_16x16x32_bf16 a[108:111], v[40:43], v[124:127], a[108:111]
s_waitcnt lgkmcnt(8)
v_mul_f32 v160, v2, v160
v_mul_f32 v161, v2, v161
v_mfma_f32_16x16x32_bf16 a[112:115], v[44:47], v[112:115], a[112:115]
s_add_u32 m0, s37, 0
v_mul_f32 v162, v2, v162
v_mul_f32 v163, v2, v163
v_mfma_f32_16x16x32_bf16 a[116:119], v[44:47], v[116:119], a[116:119]
buffer_load_dwordx4 v28, s[64:67], s40 offen lds
v_mfma_f32_16x16x32_bf16 a[120:123], v[44:47], v[120:123], a[120:123]
v_cvt_pk_bf16_f32 v160, v160, v161
v_cvt_pk_bf16_f32 v161, v162, v163
v_mfma_f32_16x16x32_bf16 a[124:127], v[44:47], v[124:127], a[124:127]
s_waitcnt lgkmcnt(6)
v_accvgpr_read_b32 v162, a16
v_accvgpr_read_b32 v163, a17
v_mfma_f32_16x16x32_bf16 a[128:131], v[48:51], v[112:115], a[128:131]
s_waitcnt lgkmcnt(0)
v_accvgpr_read_b32 v22, a18
v_accvgpr_read_b32 v23, a19
v_mfma_f32_16x16x32_bf16 a[132:135], v[48:51], v[116:119], a[132:135]
s_barrier
v_mul_f32 v162, v2, v162
v_mul_f32 v163, v2, v163
v_mfma_f32_16x16x32_bf16 a[136:139], v[48:51], v[120:123], a[136:139]
ds_read_b64_tr_b16 v[40:41], v14 offset:24576
ds_read_b64_tr_b16 v[42:43], v14 offset:27648
v_mfma_f32_16x16x32_bf16 a[140:143], v[48:51], v[124:127], a[140:143]
ds_read_b64_tr_b16 v[44:45], v16 offset:24576
ds_read_b64_tr_b16 v[46:47], v16 offset:27648
v_mfma_f32_16x16x32_bf16 a[144:147], v[52:55], v[112:115], a[144:147]
s_add_u32 s41, s80, 4096
v_mul_f32 v22, v2, v22
v_mul_f32 v23, v2, v23
v_mfma_f32_16x16x32_bf16 a[148:151], v[52:55], v[116:119], a[148:151]
v_cvt_pk_bf16_f32 v162, v162, v163
v_cvt_pk_bf16_f32 v163, v22, v23
v_mfma_f32_16x16x32_bf16 a[152:155], v[52:55], v[120:123], a[152:155]
buffer_load_dwordx4 v29, s[64:67], s40 offen offset:1024 lds
v_mfma_f32_16x16x32_bf16 a[156:159], v[52:55], v[124:127], a[156:159]
v_accvgpr_read_b32 v164, a4
v_accvgpr_read_b32 v165, a5
v_mfma_f32_16x16x32_bf16 a[160:163], v[56:59], v[112:115], a[160:163]
ds_read_b64_tr_b16 v[48:49], v15 offset:24576
ds_read_b64_tr_b16 v[50:51], v15 offset:27648
v_mfma_f32_16x16x32_bf16 a[164:167], v[56:59], v[116:119], a[164:167]
ds_read_b64_tr_b16 v[52:53], v17 offset:24576
ds_read_b64_tr_b16 v[54:55], v17 offset:27648
v_mfma_f32_16x16x32_bf16 a[168:171], v[56:59], v[120:123], a[168:171]
v_accvgpr_read_b32 v166, a6
v_accvgpr_read_b32 v167, a7
v_mfma_f32_16x16x32_bf16 a[172:175], v[56:59], v[124:127], a[172:175]
v_mul_f32 v164, v3, v164
v_mul_f32 v165, v3, v165
v_mfma_f32_16x16x32_bf16 a[176:179], v[60:63], v[112:115], a[176:179]
buffer_store_dwordx4 v[160:163], v18, s[24:27], s80 offen sc1
v_mfma_f32_16x16x32_bf16 a[180:183], v[60:63], v[116:119], a[180:183]
v_mul_f32 v166, v3, v166
v_mul_f32 v167, v3, v167
v_mfma_f32_16x16x32_bf16 a[184:187], v[60:63], v[120:123], a[184:187]
v_cvt_pk_bf16_f32 v164, v164, v165
v_cvt_pk_bf16_f32 v165, v166, v167
v_mfma_f32_16x16x32_bf16 a[188:191], v[60:63], v[124:127], a[188:191]
s_waitcnt lgkmcnt(4)
v_accvgpr_read_b32 v166, a20
v_accvgpr_read_b32 v167, a21
v_accvgpr_read_b32 v24, a22
v_accvgpr_read_b32 v25, a23
v_pk_mul_f32 v[166:167], v[166:167], v[2:3] op_sel:[0,1] op_sel_hi:[1,1]
v_pk_mul_f32 v[24:25], v[24:25], v[2:3] op_sel:[0,1] op_sel_hi:[1,1]
v_cvt_pk_bf16_f32 v166, v166, v167
v_cvt_pk_bf16_f32 v167, v24, v25
v_accvgpr_read_b32 v168, a8
v_accvgpr_read_b32 v169, a9
v_accvgpr_read_b32 v170, a10
v_accvgpr_read_b32 v171, a11
v_pk_mul_f32 v[168:169], v[168:169], v[8:9] op_sel_hi:[1,0]
v_pk_mul_f32 v[170:171], v[170:171], v[8:9] op_sel_hi:[1,0]
v_cvt_pk_bf16_f32 v168, v168, v169
v_cvt_pk_bf16_f32 v169, v170, v171
v_accvgpr_read_b32 v170, a24
v_accvgpr_read_b32 v171, a25
v_accvgpr_read_b32 v26, a26
v_accvgpr_read_b32 v27, a27
v_pk_mul_f32 v[170:171], v[170:171], v[8:9] op_sel_hi:[1,0]
v_pk_mul_f32 v[26:27], v[26:27], v[8:9] op_sel_hi:[1,0]
v_cvt_pk_bf16_f32 v170, v170, v171
v_cvt_pk_bf16_f32 v171, v26, v27
v_accvgpr_read_b32 v172, a12
v_accvgpr_read_b32 v173, a13
v_accvgpr_read_b32 v174, a14
v_accvgpr_read_b32 v175, a15
v_pk_mul_f32 v[172:173], v[172:173], v[8:9] op_sel:[0,1] op_sel_hi:[1,1]
v_pk_mul_f32 v[174:175], v[174:175], v[8:9] op_sel:[0,1] op_sel_hi:[1,1]
v_cvt_pk_bf16_f32 v172, v172, v173
v_cvt_pk_bf16_f32 v173, v174, v175
v_accvgpr_read_b32 v174, a28
v_accvgpr_read_b32 v175, a29
v_accvgpr_read_b32 v22, a30
v_accvgpr_read_b32 v23, a31
v_pk_mul_f32 v[174:175], v[174:175], v[8:9] op_sel:[0,1] op_sel_hi:[1,1]
v_pk_mul_f32 v[22:23], v[22:23], v[8:9] op_sel:[0,1] op_sel_hi:[1,1]
v_cvt_pk_bf16_f32 v174, v174, v175
v_cvt_pk_bf16_f32 v175, v22, v23
v_accvgpr_read_b32 v176, a32
v_accvgpr_read_b32 v177, a33
v_accvgpr_read_b32 v178, a34
v_accvgpr_read_b32 v179, a35
v_pk_mul_f32 v[176:177], v[176:177], v[2:3] op_sel_hi:[1,0]
v_pk_mul_f32 v[178:179], v[178:179], v[2:3] op_sel_hi:[1,0]
v_cvt_pk_bf16_f32 v176, v176, v177
v_cvt_pk_bf16_f32 v177, v178, v179
v_accvgpr_read_b32 v178, a48
v_accvgpr_read_b32 v179, a49
v_accvgpr_read_b32 v24, a50
v_accvgpr_read_b32 v25, a51
v_pk_mul_f32 v[178:179], v[178:179], v[2:3] op_sel_hi:[1,0]
v_pk_mul_f32 v[24:25], v[24:25], v[2:3] op_sel_hi:[1,0]
v_cvt_pk_bf16_f32 v178, v178, v179
v_cvt_pk_bf16_f32 v179, v24, v25
v_mfma_f32_16x16x32_bf16 a[192:195], v[40:43], v[160:163], 0
ds_read_b64_tr_b16 v[56:57], v14 offset:24640
v_accvgpr_read_b32 v180, a36
v_mfma_f32_16x16x32_bf16 a[192:195], v[44:47], v[176:179], a[192:195]
buffer_store_dwordx4 v[164:167], v19, s[24:27], s80 offen sc1
v_accvgpr_read_b32 v181, a37
v_accvgpr_read_b32 v182, a38
v_accvgpr_read_b32 v183, a39
v_pk_mul_f32 v[180:181], v[180:181], v[2:3] op_sel:[0,1] op_sel_hi:[1,1]
v_pk_mul_f32 v[182:183], v[182:183], v[2:3] op_sel:[0,1] op_sel_hi:[1,1]
v_cvt_pk_bf16_f32 v180, v180, v181
v_cvt_pk_bf16_f32 v181, v182, v183
v_accvgpr_read_b32 v182, a52
v_accvgpr_read_b32 v183, a53
v_accvgpr_read_b32 v26, a54
v_accvgpr_read_b32 v27, a55
v_pk_mul_f32 v[182:183], v[182:183], v[2:3] op_sel:[0,1] op_sel_hi:[1,1]
v_pk_mul_f32 v[26:27], v[26:27], v[2:3] op_sel:[0,1] op_sel_hi:[1,1]
v_cvt_pk_bf16_f32 v182, v182, v183
v_cvt_pk_bf16_f32 v183, v26, v27
v_mfma_f32_16x16x32_bf16 a[196:199], v[40:43], v[164:167], 0
ds_read_b64_tr_b16 v[58:59], v14 offset:27712
v_accvgpr_read_b32 v184, a40
v_mfma_f32_16x16x32_bf16 a[196:199], v[44:47], v[180:183], a[196:199]
buffer_load_dwordx4 v30, s[64:67], s40 offen offset:2048 lds
v_accvgpr_read_b32 v185, a41
v_accvgpr_read_b32 v186, a42
v_accvgpr_read_b32 v187, a43
v_pk_mul_f32 v[184:185], v[184:185], v[8:9] op_sel_hi:[1,0]
v_pk_mul_f32 v[186:187], v[186:187], v[8:9] op_sel_hi:[1,0]
v_cvt_pk_bf16_f32 v184, v184, v185
v_cvt_pk_bf16_f32 v185, v186, v187
v_accvgpr_read_b32 v186, a56
v_accvgpr_read_b32 v187, a57
v_accvgpr_read_b32 v22, a58
v_accvgpr_read_b32 v23, a59
v_pk_mul_f32 v[186:187], v[186:187], v[8:9] op_sel_hi:[1,0]
v_pk_mul_f32 v[22:23], v[22:23], v[8:9] op_sel_hi:[1,0]
v_cvt_pk_bf16_f32 v186, v186, v187
v_cvt_pk_bf16_f32 v187, v22, v23
v_mfma_f32_16x16x32_bf16 a[200:203], v[40:43], v[168:171], 0
ds_read_b64_tr_b16 v[60:61], v16 offset:24640
v_accvgpr_read_b32 v188, a44
v_mfma_f32_16x16x32_bf16 a[200:203], v[44:47], v[184:187], a[200:203]
buffer_store_dwordx4 v[168:171], v20, s[24:27], s80 offen sc1
v_accvgpr_read_b32 v189, a45
v_accvgpr_read_b32 v190, a46
v_accvgpr_read_b32 v191, a47
v_pk_mul_f32 v[188:189], v[188:189], v[8:9] op_sel:[0,1] op_sel_hi:[1,1]
v_pk_mul_f32 v[190:191], v[190:191], v[8:9] op_sel:[0,1] op_sel_hi:[1,1]
v_cvt_pk_bf16_f32 v188, v188, v189
v_cvt_pk_bf16_f32 v189, v190, v191
v_accvgpr_read_b32 v190, a60
v_accvgpr_read_b32 v191, a61
v_accvgpr_read_b32 v24, a62
v_accvgpr_read_b32 v25, a63
v_pk_mul_f32 v[190:191], v[190:191], v[8:9] op_sel:[0,1] op_sel_hi:[1,1]
v_pk_mul_f32 v[24:25], v[24:25], v[8:9] op_sel:[0,1] op_sel_hi:[1,1]
v_cvt_pk_bf16_f32 v190, v190, v191
v_cvt_pk_bf16_f32 v191, v24, v25
v_mfma_f32_16x16x32_bf16 a[204:207], v[40:43], v[172:175], 0
ds_read_b64_tr_b16 v[62:63], v16 offset:27712
v_accvgpr_read_b32 v192, a64
v_mfma_f32_16x16x32_bf16 a[204:207], v[44:47], v[188:191], a[204:207]
s_waitcnt lgkmcnt(4)
v_accvgpr_read_b32 v193, a65
v_accvgpr_read_b32 v194, a66
v_mfma_f32_16x16x32_bf16 a[208:211], v[48:51], v[160:163], 0
s_add_u32 s40, s77, 40960
ds_read_b64_tr_b16 v[40:41], v15 offset:24640
v_accvgpr_read_b32 v195, a67
v_mfma_f32_16x16x32_bf16 a[208:211], v[52:55], v[176:179], a[208:211]
buffer_store_dwordx4 v[172:175], v21, s[24:27], s80 offen sc1
v_mfma_f32_16x16x32_bf16 a[212:215], v[48:51], v[164:167], 0
s_add_u32 m0, s37, 73728
ds_read_b64_tr_b16 v[42:43], v15 offset:27712
v_mul_f32 v192, v2, v192
v_mfma_f32_16x16x32_bf16 a[212:215], v[52:55], v[180:183], a[212:215]
buffer_load_dwordx4 v28, s[64:67], s40 offen lds
v_mfma_f32_16x16x32_bf16 a[216:219], v[48:51], v[168:171], 0
ds_read_b64_tr_b16 v[44:45], v17 offset:24640
v_mul_f32 v193, v2, v193
v_mfma_f32_16x16x32_bf16 a[216:219], v[52:55], v[184:187], a[216:219]
v_mul_f32 v194, v2, v194
v_mul_f32 v195, v2, v195
v_mfma_f32_16x16x32_bf16 a[220:223], v[48:51], v[172:175], 0
ds_read_b64_tr_b16 v[46:47], v17 offset:27712
v_cvt_pk_bf16_f32 v192, v192, v193
v_mfma_f32_16x16x32_bf16 a[220:223], v[52:55], v[188:191], a[220:223]
s_waitcnt lgkmcnt(4)
v_cvt_pk_bf16_f32 v193, v194, v195
v_accvgpr_read_b32 v194, a80
v_mfma_f32_16x16x32_bf16 a[224:227], v[56:59], v[160:163], 0
ds_read_b64_tr_b16 v[48:49], v14 offset:24704
v_accvgpr_read_b32 v195, a81
v_mfma_f32_16x16x32_bf16 a[224:227], v[60:63], v[176:179], a[224:227]
buffer_load_dwordx4 v29, s[64:67], s40 offen offset:1024 lds
v_mfma_f32_16x16x32_bf16 a[228:231], v[56:59], v[164:167], 0
ds_read_b64_tr_b16 v[50:51], v14 offset:27776
v_accvgpr_read_b32 v26, a82
v_mfma_f32_16x16x32_bf16 a[228:231], v[60:63], v[180:183], a[228:231]
v_accvgpr_read_b32 v27, a83
v_mul_f32 v194, v2, v194
v_mfma_f32_16x16x32_bf16 a[232:235], v[56:59], v[168:171], 0
ds_read_b64_tr_b16 v[52:53], v16 offset:24704
v_mul_f32 v195, v2, v195
v_mfma_f32_16x16x32_bf16 a[232:235], v[60:63], v[184:187], a[232:235]
v_mul_f32 v26, v2, v26
v_mul_f32 v27, v2, v27
v_mfma_f32_16x16x32_bf16 a[236:239], v[56:59], v[172:175], 0
ds_read_b64_tr_b16 v[54:55], v16 offset:27776
v_cvt_pk_bf16_f32 v194, v194, v195
v_mfma_f32_16x16x32_bf16 a[236:239], v[60:63], v[188:191], a[236:239]
s_waitcnt lgkmcnt(4)
v_cvt_pk_bf16_f32 v195, v26, v27
v_accvgpr_read_b32 v196, a68
v_mfma_f32_16x16x32_bf16 a[240:243], v[40:43], v[160:163], 0
ds_read_b64_tr_b16 v[56:57], v15 offset:24704
v_accvgpr_read_b32 v197, a69
v_mfma_f32_16x16x32_bf16 a[240:243], v[44:47], v[176:179], a[240:243]
buffer_store_dwordx4 v[176:179], v18, s[24:27], s80 offen offset:1024 sc1
v_mfma_f32_16x16x32_bf16 a[244:247], v[40:43], v[164:167], 0
ds_read_b64_tr_b16 v[58:59], v15 offset:27776
v_accvgpr_read_b32 v198, a70
v_mfma_f32_16x16x32_bf16 a[244:247], v[44:47], v[180:183], a[244:247]
buffer_load_dwordx4 v30, s[64:67], s40 offen offset:2048 lds
v_mfma_f32_16x16x32_bf16 a[248:251], v[40:43], v[168:171], 0
ds_read_b64_tr_b16 v[60:61], v17 offset:24704
v_accvgpr_read_b32 v199, a71
v_mfma_f32_16x16x32_bf16 a[248:251], v[44:47], v[184:187], a[248:251]
v_mul_f32 v196, v3, v196
v_mul_f32 v197, v3, v197
v_mfma_f32_16x16x32_bf16 a[252:255], v[40:43], v[172:175], 0
ds_read_b64_tr_b16 v[62:63], v17 offset:27776
v_mul_f32 v198, v3, v198
v_mfma_f32_16x16x32_bf16 a[252:255], v[44:47], v[188:191], a[252:255]
s_waitcnt lgkmcnt(4)
v_mul_f32 v199, v3, v199
v_cvt_pk_bf16_f32 v196, v196, v197
v_mfma_f32_16x16x32_bf16 v[64:67], v[48:51], v[160:163], 0
ds_read_b64_tr_b16 v[40:41], v14 offset:24768
v_cvt_pk_bf16_f32 v197, v198, v199
v_mfma_f32_16x16x32_bf16 v[64:67], v[52:55], v[176:179], v[64:67]
s_add_u32 s40, s78, 40960
v_accvgpr_read_b32 v198, a84
v_accvgpr_read_b32 v199, a85
v_mfma_f32_16x16x32_bf16 v[68:71], v[48:51], v[164:167], 0
s_add_u32 m0, s37, 12288
ds_read_b64_tr_b16 v[42:43], v14 offset:27840
v_accvgpr_read_b32 v22, a86
v_mfma_f32_16x16x32_bf16 v[68:71], v[52:55], v[180:183], v[68:71]
buffer_load_dwordx4 v28, s[64:67], s40 offen lds
v_mfma_f32_16x16x32_bf16 v[72:75], v[48:51], v[168:171], 0
ds_read_b64_tr_b16 v[44:45], v16 offset:24768
v_accvgpr_read_b32 v23, a87
v_mfma_f32_16x16x32_bf16 v[72:75], v[52:55], v[184:187], v[72:75]
buffer_store_dwordx4 v[180:183], v19, s[24:27], s80 offen offset:1024 sc1
v_mfma_f32_16x16x32_bf16 v[76:79], v[48:51], v[172:175], 0
ds_read_b64_tr_b16 v[46:47], v16 offset:27840
v_mul_f32 v198, v3, v198
v_mfma_f32_16x16x32_bf16 v[76:79], v[52:55], v[188:191], v[76:79]
s_waitcnt lgkmcnt(4)
v_mul_f32 v199, v3, v199
v_mul_f32 v22, v3, v22
v_mfma_f32_16x16x32_bf16 v[80:83], v[56:59], v[160:163], 0
ds_read_b64_tr_b16 v[48:49], v15 offset:24768
v_mul_f32 v23, v3, v23
v_mfma_f32_16x16x32_bf16 v[80:83], v[60:63], v[176:179], v[80:83]
v_cvt_pk_bf16_f32 v198, v198, v199
v_cvt_pk_bf16_f32 v199, v22, v23
v_mfma_f32_16x16x32_bf16 v[84:87], v[56:59], v[164:167], 0
ds_read_b64_tr_b16 v[50:51], v15 offset:27840
v_accvgpr_read_b32 v200, a72
v_mfma_f32_16x16x32_bf16 v[84:87], v[60:63], v[180:183], v[84:87]
v_accvgpr_read_b32 v201, a73
v_accvgpr_read_b32 v202, a74
v_mfma_f32_16x16x32_bf16 v[88:91], v[56:59], v[168:171], 0
ds_read_b64_tr_b16 v[52:53], v17 offset:24768
v_accvgpr_read_b32 v203, a75
v_mfma_f32_16x16x32_bf16 v[88:91], v[60:63], v[184:187], v[88:91]
buffer_load_dwordx4 v29, s[64:67], s40 offen offset:1024 lds
v_mfma_f32_16x16x32_bf16 v[92:95], v[56:59], v[172:175], 0
ds_read_b64_tr_b16 v[54:55], v17 offset:27840
v_mul_f32 v200, v8, v200
v_mfma_f32_16x16x32_bf16 v[92:95], v[60:63], v[188:191], v[92:95]
s_waitcnt lgkmcnt(4)
v_mul_f32 v201, v8, v201
v_mul_f32 v202, v8, v202
v_mfma_f32_16x16x32_bf16 v[96:99], v[40:43], v[160:163], 0
ds_read_b64_tr_b16 v[56:57], v14 offset:24832
v_mul_f32 v203, v8, v203
v_mfma_f32_16x16x32_bf16 v[96:99], v[44:47], v[176:179], v[96:99]
v_cvt_pk_bf16_f32 v200, v200, v201
v_cvt_pk_bf16_f32 v201, v202, v203
v_mfma_f32_16x16x32_bf16 v[100:103], v[40:43], v[164:167], 0
ds_read_b64_tr_b16 v[58:59], v14 offset:27904
v_accvgpr_read_b32 v202, a88
v_mfma_f32_16x16x32_bf16 v[100:103], v[44:47], v[180:183], v[100:103]
buffer_store_dwordx4 v[184:187], v20, s[24:27], s80 offen offset:1024 sc1
v_mfma_f32_16x16x32_bf16 v[104:107], v[40:43], v[168:171], 0
ds_read_b64_tr_b16 v[60:61], v16 offset:24832
v_accvgpr_read_b32 v203, a89
v_mfma_f32_16x16x32_bf16 v[104:107], v[44:47], v[184:187], v[104:107]
buffer_load_dwordx4 v30, s[64:67], s40 offen offset:2048 lds
v_mfma_f32_16x16x32_bf16 v[108:111], v[40:43], v[172:175], 0
ds_read_b64_tr_b16 v[62:63], v16 offset:27904
v_accvgpr_read_b32 v24, a90
v_mfma_f32_16x16x32_bf16 v[108:111], v[44:47], v[188:191], v[108:111]
s_waitcnt lgkmcnt(4)
v_accvgpr_read_b32 v25, a91
v_mul_f32 v202, v8, v202
v_mfma_f32_16x16x32_bf16 v[112:115], v[48:51], v[160:163], 0
ds_read_b64_tr_b16 v[40:41], v15 offset:24832
v_mul_f32 v203, v8, v203
v_mfma_f32_16x16x32_bf16 v[112:115], v[52:55], v[176:179], v[112:115]
ds_read_b64_tr_b16 v[42:43], v15 offset:27904
v_mul_f32 v24, v8, v24
v_mfma_f32_16x16x32_bf16 v[116:119], v[48:51], v[164:167], 0
s_add_u32 s40, s79, 40960
ds_read_b64_tr_b16 v[44:45], v17 offset:24832
KF_pg11:
s_cbranch_execz KF_pg15
v_mul_f32 v25, v8, v25
v_mfma_f32_16x16x32_bf16 v[116:119], v[52:55], v[180:183], v[116:119]
s_add_u32 m0, s37, 86016
ds_read_b64_tr_b16 v[46:47], v17 offset:27904
v_cvt_pk_bf16_f32 v202, v202, v203
v_mfma_f32_16x16x32_bf16 v[120:123], v[48:51], v[168:171], 0
s_waitcnt vmcnt(9)
v_mov_b32 v7, 1
v_cvt_pk_bf16_f32 v203, v24, v25
v_mfma_f32_16x16x32_bf16 v[120:123], v[52:55], v[184:187], v[120:123]
buffer_store_dword v7, v35, s[56:59], 0 offen sc1
v_mfma_f32_16x16x32_bf16 v[124:127], v[48:51], v[172:175], 0
buffer_load_dwordx4 v28, s[64:67], s40 offen lds
v_mfma_f32_16x16x32_bf16 v[124:127], v[52:55], v[188:191], v[124:127]
s_waitcnt lgkmcnt(4)
v_accvgpr_read_b32 v204, a76
v_accvgpr_read_b32 v205, a77
v_mfma_f32_16x16x32_bf16 v[128:131], v[56:59], v[160:163], 0
s_waitcnt lgkmcnt(0)
v_accvgpr_read_b32 v206, a78
v_accvgpr_read_b32 v207, a79
v_mfma_f32_16x16x32_bf16 v[128:131], v[60:63], v[176:179], v[128:131]
s_barrier
v_mul_f32 v204, v9, v204
v_mul_f32 v205, v9, v205
v_mfma_f32_16x16x32_bf16 v[132:135], v[56:59], v[164:167], 0
ds_read_b64_tr_b16 v[48:49], v14 offset:36864
v_mul_f32 v206, v9, v206
v_mfma_f32_16x16x32_bf16 v[132:135], v[60:63], v[180:183], v[132:135]
ds_read_b64_tr_b16 v[50:51], v14 offset:39936
v_mul_f32 v207, v9, v207
v_mfma_f32_16x16x32_bf16 v[136:139], v[56:59], v[168:171], 0
ds_read_b64_tr_b16 v[52:53], v16 offset:36864
v_cvt_pk_bf16_f32 v204, v204, v205
v_mfma_f32_16x16x32_bf16 v[136:139], v[60:63], v[184:187], v[136:139]
ds_read_b64_tr_b16 v[54:55], v16 offset:39936
v_cvt_pk_bf16_f32 v205, v206, v207
v_mfma_f32_16x16x32_bf16 v[140:143], v[56:59], v[172:175], 0
buffer_store_dwordx4 v[188:191], v21, s[24:27], s80 offen offset:1024 sc1
v_mfma_f32_16x16x32_bf16 v[140:143], v[60:63], v[188:191], v[140:143]
v_accvgpr_read_b32 v206, a92
v_accvgpr_read_b32 v207, a93
v_mfma_f32_16x16x32_bf16 v[144:147], v[40:43], v[160:163], 0
ds_read_b64_tr_b16 v[56:57], v15 offset:36864
v_accvgpr_read_b32 v26, a94
v_mfma_f32_16x16x32_bf16 v[144:147], v[44:47], v[176:179], v[144:147]
buffer_load_dwordx4 v29, s[64:67], s40 offen offset:1024 lds
v_mfma_f32_16x16x32_bf16 v[148:151], v[40:43], v[164:167], 0
ds_read_b64_tr_b16 v[58:59], v15 offset:39936
v_accvgpr_read_b32 v27, a95
v_mfma_f32_16x16x32_bf16 v[148:151], v[44:47], v[180:183], v[148:151]
v_mul_f32 v206, v9, v206
v_mul_f32 v207, v9, v207
v_mfma_f32_16x16x32_bf16 v[152:155], v[40:43], v[168:171], 0
ds_read_b64_tr_b16 v[60:61], v17 offset:36864
v_mul_f32 v26, v9, v26
v_mfma_f32_16x16x32_bf16 v[152:155], v[44:47], v[184:187], v[152:155]
v_mul_f32 v27, v9, v27
v_cvt_pk_bf16_f32 v206, v206, v207
v_mfma_f32_16x16x32_bf16 v[156:159], v[40:43], v[172:175], 0
ds_read_b64_tr_b16 v[62:63], v17 offset:39936
v_cvt_pk_bf16_f32 v207, v26, v27
v_mfma_f32_16x16x32_bf16 v[156:159], v[44:47], v[188:191], v[156:159]
s_waitcnt lgkmcnt(4)
v_accvgpr_read_b32 v208, a96
v_accvgpr_read_b32 v209, a97
v_accvgpr_read_b32 v210, a98
v_accvgpr_read_b32 v211, a99
v_pk_mul_f32 v[208:209], v[208:209], v[2:3] op_sel_hi:[1,0]
v_pk_mul_f32 v[210:211], v[210:211], v[2:3] op_sel_hi:[1,0]
v_cvt_pk_bf16_f32 v208, v208, v209
v_cvt_pk_bf16_f32 v209, v210, v211
v_accvgpr_read_b32 v210, a112
v_accvgpr_read_b32 v211, a113
v_accvgpr_read_b32 v22, a114
v_accvgpr_read_b32 v23, a115
v_pk_mul_f32 v[210:211], v[210:211], v[2:3] op_sel_hi:[1,0]
v_pk_mul_f32 v[22:23], v[22:23], v[2:3] op_sel_hi:[1,0]
v_cvt_pk_bf16_f32 v210, v210, v211
v_cvt_pk_bf16_f32 v211, v22, v23
v_mfma_f32_16x16x32_bf16 a[192:195], v[48:51], v[192:195], a[192:195]
ds_read_b64_tr_b16 v[40:41], v14 offset:36928
v_accvgpr_read_b32 v212, a100
v_mfma_f32_16x16x32_bf16 a[192:195], v[52:55], v[208:211], a[192:195]
buffer_store_dwordx4 v[192:195], v18, s[24:27], s80 offen offset:2048 sc1
v_accvgpr_read_b32 v213, a101
v_accvgpr_read_b32 v214, a102
v_accvgpr_read_b32 v215, a103
v_pk_mul_f32 v[212:213], v[212:213], v[2:3] op_sel:[0,1] op_sel_hi:[1,1]
v_pk_mul_f32 v[214:215], v[214:215], v[2:3] op_sel:[0,1] op_sel_hi:[1,1]
v_cvt_pk_bf16_f32 v212, v212, v213
v_cvt_pk_bf16_f32 v213, v214, v215
v_accvgpr_read_b32 v214, a116
v_accvgpr_read_b32 v215, a117
v_accvgpr_read_b32 v24, a118
v_accvgpr_read_b32 v25, a119
v_pk_mul_f32 v[214:215], v[214:215], v[2:3] op_sel:[0,1] op_sel_hi:[1,1]
v_pk_mul_f32 v[24:25], v[24:25], v[2:3] op_sel:[0,1] op_sel_hi:[1,1]
v_cvt_pk_bf16_f32 v214, v214, v215
v_cvt_pk_bf16_f32 v215, v24, v25
v_mfma_f32_16x16x32_bf16 a[196:199], v[48:51], v[196:199], a[196:199]
ds_read_b64_tr_b16 v[42:43], v14 offset:40000
v_accvgpr_read_b32 v216, a104
v_mfma_f32_16x16x32_bf16 a[196:199], v[52:55], v[212:215], a[196:199]
buffer_load_dwordx4 v30, s[64:67], s40 offen offset:2048 lds
v_accvgpr_read_b32 v217, a105
v_accvgpr_read_b32 v218, a106
v_accvgpr_read_b32 v219, a107
v_pk_mul_f32 v[216:217], v[216:217], v[8:9] op_sel_hi:[1,0]
v_pk_mul_f32 v[218:219], v[218:219], v[8:9] op_sel_hi:[1,0]
v_cvt_pk_bf16_f32 v216, v216, v217
v_cvt_pk_bf16_f32 v217, v218, v219
v_accvgpr_read_b32 v218, a120
v_accvgpr_read_b32 v219, a121
v_accvgpr_read_b32 v26, a122
v_accvgpr_read_b32 v27, a123
v_pk_mul_f32 v[218:219], v[218:219], v[8:9] op_sel_hi:[1,0]
v_pk_mul_f32 v[26:27], v[26:27], v[8:9] op_sel_hi:[1,0]
v_cvt_pk_bf16_f32 v218, v218, v219
v_cvt_pk_bf16_f32 v219, v26, v27
v_mfma_f32_16x16x32_bf16 a[200:203], v[48:51], v[200:203], a[200:203]
ds_read_b64_tr_b16 v[44:45], v16 offset:36928
v_accvgpr_read_b32 v220, a108
v_mfma_f32_16x16x32_bf16 a[200:203], v[52:55], v[216:219], a[200:203]
v_accvgpr_read_b32 v221, a109
v_accvgpr_read_b32 v222, a110
v_accvgpr_read_b32 v223, a111
v_pk_mul_f32 v[220:221], v[220:221], v[8:9] op_sel:[0,1] op_sel_hi:[1,1]
v_pk_mul_f32 v[222:223], v[222:223], v[8:9] op_sel:[0,1] op_sel_hi:[1,1]
v_cvt_pk_bf16_f32 v220, v220, v221
v_cvt_pk_bf16_f32 v221, v222, v223
v_accvgpr_read_b32 v222, a124
v_accvgpr_read_b32 v223, a125
v_accvgpr_read_b32 v22, a126
v_accvgpr_read_b32 v23, a127
v_pk_mul_f32 v[222:223], v[222:223], v[8:9] op_sel:[0,1] op_sel_hi:[1,1]
v_pk_mul_f32 v[22:23], v[22:23], v[8:9] op_sel:[0,1] op_sel_hi:[1,1]
v_cvt_pk_bf16_f32 v222, v222, v223
v_cvt_pk_bf16_f32 v223, v22, v23
v_mfma_f32_16x16x32_bf16 a[204:207], v[48:51], v[204:207], a[204:207]
s_add_u32 s40, s77, 81920
ds_read_b64_tr_b16 v[46:47], v16 offset:40000
v_accvgpr_read_b32 v224, a128
v_mfma_f32_16x16x32_bf16 a[204:207], v[52:55], v[220:223], a[204:207]
s_waitcnt lgkmcnt(4)
v_accvgpr_read_b32 v225, a129
v_accvgpr_read_b32 v226, a130
v_mfma_f32_16x16x32_bf16 a[208:211], v[56:59], v[192:195], a[208:211]
s_add_u32 m0, s37, 24576
ds_read_b64_tr_b16 v[48:49], v15 offset:36928
v_accvgpr_read_b32 v227, a131
v_mfma_f32_16x16x32_bf16 a[208:211], v[60:63], v[208:211], a[208:211]
buffer_load_dwordx4 v28, s[64:67], s40 offen lds
v_mfma_f32_16x16x32_bf16 a[212:215], v[56:59], v[196:199], a[212:215]
ds_read_b64_tr_b16 v[50:51], v15 offset:40000
v_mul_f32 v224, v2, v224
v_mfma_f32_16x16x32_bf16 a[212:215], v[60:63], v[212:215], a[212:215]
v_mul_f32 v225, v2, v225
v_mul_f32 v226, v2, v226
v_mfma_f32_16x16x32_bf16 a[216:219], v[56:59], v[200:203], a[216:219]
ds_read_b64_tr_b16 v[52:53], v17 offset:36928
v_mul_f32 v227, v2, v227
v_mfma_f32_16x16x32_bf16 a[216:219], v[60:63], v[216:219], a[216:219]
buffer_store_dwordx4 v[196:199], v19, s[24:27], s80 offen offset:2048 sc1
v_mfma_f32_16x16x32_bf16 a[220:223], v[56:59], v[204:207], a[220:223]
ds_read_b64_tr_b16 v[54:55], v17 offset:40000
v_cvt_pk_bf16_f32 v224, v224, v225
v_mfma_f32_16x16x32_bf16 a[220:223], v[60:63], v[220:223], a[220:223]
s_waitcnt lgkmcnt(4)
v_cvt_pk_bf16_f32 v225, v226, v227
v_accvgpr_read_b32 v226, a144
v_mfma_f32_16x16x32_bf16 a[224:227], v[40:43], v[192:195], a[224:227]
ds_read_b64_tr_b16 v[56:57], v14 offset:36992
v_accvgpr_read_b32 v227, a145
v_mfma_f32_16x16x32_bf16 a[224:227], v[44:47], v[208:211], a[224:227]
v_accvgpr_read_b32 v24, a146
v_accvgpr_read_b32 v25, a147
v_mfma_f32_16x16x32_bf16 a[228:231], v[40:43], v[196:199], a[228:231]
ds_read_b64_tr_b16 v[58:59], v14 offset:40064
v_mul_f32 v226, v2, v226
v_mfma_f32_16x16x32_bf16 a[228:231], v[44:47], v[212:215], a[228:231]
buffer_load_dwordx4 v29, s[64:67], s40 offen offset:1024 lds
v_mfma_f32_16x16x32_bf16 a[232:235], v[40:43], v[200:203], a[232:235]
ds_read_b64_tr_b16 v[60:61], v16 offset:36992
v_mul_f32 v227, v2, v227
v_mfma_f32_16x16x32_bf16 a[232:235], v[44:47], v[216:219], a[232:235]
v_mul_f32 v24, v2, v24
v_mul_f32 v25, v2, v25
v_mfma_f32_16x16x32_bf16 a[236:239], v[40:43], v[204:207], a[236:239]
ds_read_b64_tr_b16 v[62:63], v16 offset:40064
v_cvt_pk_bf16_f32 v226, v226, v227
v_mfma_f32_16x16x32_bf16 a[236:239], v[44:47], v[220:223], a[236:239]
s_waitcnt lgkmcnt(4)
v_cvt_pk_bf16_f32 v227, v24, v25
v_accvgpr_read_b32 v228, a132
v_mfma_f32_16x16x32_bf16 a[240:243], v[48:51], v[192:195], a[240:243]
ds_read_b64_tr_b16 v[40:41], v15 offset:36992
v_accvgpr_read_b32 v229, a133
v_mfma_f32_16x16x32_bf16 a[240:243], v[52:55], v[208:211], a[240:243]
v_accvgpr_read_b32 v230, a134
v_accvgpr_read_b32 v231, a135
v_mfma_f32_16x16x32_bf16 a[244:247], v[48:51], v[196:199], a[244:247]
ds_read_b64_tr_b16 v[42:43], v15 offset:40064
v_mul_f32 v228, v3, v228
v_mfma_f32_16x16x32_bf16 a[244:247], v[52:55], v[212:215], a[244:247]
buffer_store_dwordx4 v[200:203], v20, s[24:27], s80 offen offset:2048 sc1
v_mfma_f32_16x16x32_bf16 a[248:251], v[48:51], v[200:203], a[248:251]
ds_read_b64_tr_b16 v[44:45], v17 offset:36992
v_mul_f32 v229, v3, v229
v_mfma_f32_16x16x32_bf16 a[248:251], v[52:55], v[216:219], a[248:251]
buffer_load_dwordx4 v30, s[64:67], s40 offen offset:2048 lds
v_mfma_f32_16x16x32_bf16 a[252:255], v[48:51], v[204:207], a[252:255]
ds_read_b64_tr_b16 v[46:47], v17 offset:40064
v_mul_f32 v230, v3, v230
v_mfma_f32_16x16x32_bf16 a[252:255], v[52:55], v[220:223], a[252:255]
s_waitcnt lgkmcnt(4)
v_mul_f32 v231, v3, v231
v_cvt_pk_bf16_f32 v228, v228, v229
v_mfma_f32_16x16x32_bf16 v[64:67], v[56:59], v[192:195], v[64:67]
ds_read_b64_tr_b16 v[48:49], v14 offset:37056
v_cvt_pk_bf16_f32 v229, v230, v231
v_mfma_f32_16x16x32_bf16 v[64:67], v[60:63], v[208:211], v[64:67]
v_accvgpr_read_b32 v230, a148
v_accvgpr_read_b32 v231, a149
v_mfma_f32_16x16x32_bf16 v[68:71], v[56:59], v[196:199], v[68:71]
ds_read_b64_tr_b16 v[50:51], v14 offset:40128
v_accvgpr_read_b32 v26, a150
v_mfma_f32_16x16x32_bf16 v[68:71], v[60:63], v[212:215], v[68:71]
s_add_u32 s40, s78, 81920
v_accvgpr_read_b32 v27, a151
v_mul_f32 v230, v3, v230
v_mfma_f32_16x16x32_bf16 v[72:75], v[56:59], v[200:203], v[72:75]
s_add_u32 m0, s37, 98304
ds_read_b64_tr_b16 v[52:53], v16 offset:37056
v_mul_f32 v231, v3, v231
v_mfma_f32_16x16x32_bf16 v[72:75], v[60:63], v[216:219], v[72:75]
buffer_load_dwordx4 v28, s[64:67], s40 offen lds
v_mfma_f32_16x16x32_bf16 v[76:79], v[56:59], v[204:207], v[76:79]
ds_read_b64_tr_b16 v[54:55], v16 offset:40128
v_mul_f32 v26, v3, v26
v_mfma_f32_16x16x32_bf16 v[76:79], v[60:63], v[220:223], v[76:79]
s_waitcnt lgkmcnt(4)
v_mul_f32 v27, v3, v27
v_cvt_pk_bf16_f32 v230, v230, v231
v_mfma_f32_16x16x32_bf16 v[80:83], v[40:43], v[192:195], v[80:83]
ds_read_b64_tr_b16 v[56:57], v15 offset:37056
v_cvt_pk_bf16_f32 v231, v26, v27
v_mfma_f32_16x16x32_bf16 v[80:83], v[44:47], v[208:211], v[80:83]
buffer_store_dwordx4 v[204:207], v21, s[24:27], s80 offen offset:2048 sc1
v_mfma_f32_16x16x32_bf16 v[84:87], v[40:43], v[196:199], v[84:87]
ds_read_b64_tr_b16 v[58:59], v15 offset:40128
v_accvgpr_read_b32 v232, a136
v_mfma_f32_16x16x32_bf16 v[84:87], v[44:47], v[212:215], v[84:87]
v_accvgpr_read_b32 v233, a137
v_accvgpr_read_b32 v234, a138
v_mfma_f32_16x16x32_bf16 v[88:91], v[40:43], v[200:203], v[88:91]
ds_read_b64_tr_b16 v[60:61], v17 offset:37056
v_accvgpr_read_b32 v235, a139
v_mfma_f32_16x16x32_bf16 v[88:91], v[44:47], v[216:219], v[88:91]
buffer_load_dwordx4 v29, s[64:67], s40 offen offset:1024 lds
v_mfma_f32_16x16x32_bf16 v[92:95], v[40:43], v[204:207], v[92:95]
ds_read_b64_tr_b16 v[62:63], v17 offset:40128
v_mul_f32 v232, v8, v232
v_mfma_f32_16x16x32_bf16 v[92:95], v[44:47], v[220:223], v[92:95]
s_waitcnt lgkmcnt(4)
v_mul_f32 v233, v8, v233
v_mul_f32 v234, v8, v234
v_mfma_f32_16x16x32_bf16 v[96:99], v[48:51], v[192:195], v[96:99]
ds_read_b64_tr_b16 v[40:41], v14 offset:37120
v_mul_f32 v235, v8, v235
v_mfma_f32_16x16x32_bf16 v[96:99], v[52:55], v[208:211], v[96:99]
buffer_load_dword v5, v36, s[56:59], 0 offen offset:4 sc1
v_mfma_f32_16x16x32_bf16 v[100:103], v[48:51], v[196:199], v[100:103]
ds_read_b64_tr_b16 v[42:43], v14 offset:40192
v_cvt_pk_bf16_f32 v232, v232, v233
v_mfma_f32_16x16x32_bf16 v[100:103], v[52:55], v[212:215], v[100:103]
v_cvt_pk_bf16_f32 v233, v234, v235
v_accvgpr_read_b32 v234, a152
v_mfma_f32_16x16x32_bf16 v[104:107], v[48:51], v[200:203], v[104:107]
ds_read_b64_tr_b16 v[44:45], v16 offset:37120
v_accvgpr_read_b32 v235, a153
v_mfma_f32_16x16x32_bf16 v[104:107], v[52:55], v[216:219], v[104:107]
v_accvgpr_read_b32 v22, a154
v_accvgpr_read_b32 v23, a155
v_mfma_f32_16x16x32_bf16 v[108:111], v[48:51], v[204:207], v[108:111]
ds_read_b64_tr_b16 v[46:47], v16 offset:40192
v_mul_f32 v234, v8, v234
v_mfma_f32_16x16x32_bf16 v[108:111], v[52:55], v[220:223], v[108:111]
s_waitcnt lgkmcnt(4)
v_mul_f32 v235, v8, v235
v_mul_f32 v22, v8, v22
v_mfma_f32_16x16x32_bf16 v[112:115], v[56:59], v[192:195], v[112:115]
ds_read_b64_tr_b16 v[48:49], v15 offset:37120
v_mul_f32 v23, v8, v23
v_mfma_f32_16x16x32_bf16 v[112:115], v[60:63], v[208:211], v[112:115]
ds_read_b64_tr_b16 v[50:51], v15 offset:40192
v_cvt_pk_bf16_f32 v234, v234, v235
v_mfma_f32_16x16x32_bf16 v[116:119], v[56:59], v[196:199], v[116:119]
ds_read_b64_tr_b16 v[52:53], v17 offset:37120
v_cvt_pk_bf16_f32 v235, v22, v23
v_mfma_f32_16x16x32_bf16 v[116:119], v[60:63], v[212:215], v[116:119]
ds_read_b64_tr_b16 v[54:55], v17 offset:40192
v_accvgpr_read_b32 v236, a140
v_mfma_f32_16x16x32_bf16 v[120:123], v[56:59], v[200:203], v[120:123]
buffer_store_dwordx4 v[208:211], v18, s[24:27], s80 offen offset:3072 sc1
v_mfma_f32_16x16x32_bf16 v[120:123], v[60:63], v[216:219], v[120:123]
buffer_load_dwordx4 v30, s[64:67], s40 offen offset:2048 lds
v_mfma_f32_16x16x32_bf16 v[124:127], v[56:59], v[204:207], v[124:127]
v_accvgpr_read_b32 v237, a141
v_accvgpr_read_b32 v238, a142
v_mfma_f32_16x16x32_bf16 v[124:127], v[60:63], v[220:223], v[124:127]
s_waitcnt lgkmcnt(4)
v_accvgpr_read_b32 v239, a143
v_mul_f32 v236, v9, v236
v_mfma_f32_16x16x32_bf16 v[128:131], v[40:43], v[192:195], v[128:131]
s_waitcnt lgkmcnt(0)
v_mul_f32 v237, v9, v237
v_mul_f32 v238, v9, v238
v_mfma_f32_16x16x32_bf16 v[128:131], v[44:47], v[208:211], v[128:131]
s_barrier
v_mul_f32 v239, v9, v239
v_cvt_pk_bf16_f32 v236, v236, v237
v_mfma_f32_16x16x32_bf16 v[132:135], v[40:43], v[196:199], v[132:135]
ds_read_b64_tr_b16 v[56:57], v14 offset:49152
v_cvt_pk_bf16_f32 v237, v238, v239
v_mfma_f32_16x16x32_bf16 v[132:135], v[44:47], v[212:215], v[132:135]
ds_read_b64_tr_b16 v[58:59], v14 offset:52224
v_accvgpr_read_b32 v238, a156
v_mfma_f32_16x16x32_bf16 v[136:139], v[40:43], v[200:203], v[136:139]
ds_read_b64_tr_b16 v[60:61], v16 offset:49152
v_accvgpr_read_b32 v239, a157
v_mfma_f32_16x16x32_bf16 v[136:139], v[44:47], v[216:219], v[136:139]
ds_read_b64_tr_b16 v[62:63], v16 offset:52224
v_accvgpr_read_b32 v24, a158
v_mfma_f32_16x16x32_bf16 v[140:143], v[40:43], v[204:207], v[140:143]
buffer_store_dwordx4 v[212:215], v19, s[24:27], s80 offen offset:3072 sc1
v_mfma_f32_16x16x32_bf16 v[140:143], v[44:47], v[220:223], v[140:143]
s_add_u32 s40, s79, 81920
v_accvgpr_read_b32 v25, a159
v_mul_f32 v238, v9, v238
v_mfma_f32_16x16x32_bf16 v[144:147], v[48:51], v[192:195], v[144:147]
s_add_u32 m0, s37, 36864
ds_read_b64_tr_b16 v[40:41], v15 offset:49152
v_mul_f32 v239, v9, v239
v_mfma_f32_16x16x32_bf16 v[144:147], v[52:55], v[208:211], v[144:147]
buffer_load_dwordx4 v28, s[64:67], s40 offen lds
v_mfma_f32_16x16x32_bf16 v[148:151], v[48:51], v[196:199], v[148:151]
ds_read_b64_tr_b16 v[42:43], v15 offset:52224
v_mul_f32 v24, v9, v24
v_mfma_f32_16x16x32_bf16 v[148:151], v[52:55], v[212:215], v[148:151]
v_mul_f32 v25, v9, v25
v_cvt_pk_bf16_f32 v238, v238, v239
v_mfma_f32_16x16x32_bf16 v[152:155], v[48:51], v[200:203], v[152:155]
ds_read_b64_tr_b16 v[44:45], v17 offset:49152
v_cvt_pk_bf16_f32 v239, v24, v25
v_mfma_f32_16x16x32_bf16 v[152:155], v[52:55], v[216:219], v[152:155]
buffer_load_dwordx4 v29, s[64:67], s40 offen offset:1024 lds
v_mfma_f32_16x16x32_bf16 v[156:159], v[48:51], v[204:207], v[156:159]
ds_read_b64_tr_b16 v[46:47], v17 offset:52224
v_accvgpr_read_b32 v240, a160
v_mfma_f32_16x16x32_bf16 v[156:159], v[52:55], v[220:223], v[156:159]
s_waitcnt lgkmcnt(4)
v_accvgpr_read_b32 v241, a161
v_accvgpr_read_b32 v242, a162
v_accvgpr_read_b32 v243, a163
v_pk_mul_f32 v[240:241], v[240:241], v[2:3] op_sel_hi:[1,0]
v_pk_mul_f32 v[242:243], v[242:243], v[2:3] op_sel_hi:[1,0]
v_cvt_pk_bf16_f32 v240, v240, v241
v_cvt_pk_bf16_f32 v241, v242, v243
v_accvgpr_read_b32 v242, a176
v_accvgpr_read_b32 v243, a177
v_accvgpr_read_b32 v26, a178
v_accvgpr_read_b32 v27, a179
v_pk_mul_f32 v[242:243], v[242:243], v[2:3] op_sel_hi:[1,0]
v_pk_mul_f32 v[26:27], v[26:27], v[2:3] op_sel_hi:[1,0]
v_cvt_pk_bf16_f32 v242, v242, v243
v_cvt_pk_bf16_f32 v243, v26, v27
v_mfma_f32_16x16x32_bf16 a[192:195], v[56:59], v[224:227], a[192:195]
ds_read_b64_tr_b16 v[48:49], v14 offset:49216
v_accvgpr_read_b32 v244, a164
v_mfma_f32_16x16x32_bf16 a[192:195], v[60:63], v[240:243], a[192:195]
v_accvgpr_read_b32 v245, a165
v_accvgpr_read_b32 v246, a166
v_accvgpr_read_b32 v247, a167
v_pk_mul_f32 v[244:245], v[244:245], v[2:3] op_sel:[0,1] op_sel_hi:[1,1]
v_pk_mul_f32 v[246:247], v[246:247], v[2:3] op_sel:[0,1] op_sel_hi:[1,1]
v_cvt_pk_bf16_f32 v244, v244, v245
v_cvt_pk_bf16_f32 v245, v246, v247
v_accvgpr_read_b32 v246, a180
v_accvgpr_read_b32 v247, a181
v_accvgpr_read_b32 v22, a182
v_accvgpr_read_b32 v23, a183
v_pk_mul_f32 v[246:247], v[246:247], v[2:3] op_sel:[0,1] op_sel_hi:[1,1]
v_pk_mul_f32 v[22:23], v[22:23], v[2:3] op_sel:[0,1] op_sel_hi:[1,1]
v_cvt_pk_bf16_f32 v246, v246, v247
v_cvt_pk_bf16_f32 v247, v22, v23
v_mfma_f32_16x16x32_bf16 a[196:199], v[56:59], v[228:231], a[196:199]
ds_read_b64_tr_b16 v[50:51], v14 offset:52288
v_accvgpr_read_b32 v248, a168
v_mfma_f32_16x16x32_bf16 a[196:199], v[60:63], v[244:247], a[196:199]
buffer_store_dwordx4 v[216:219], v20, s[24:27], s80 offen offset:3072 sc1
v_accvgpr_read_b32 v249, a169
v_accvgpr_read_b32 v250, a170
v_accvgpr_read_b32 v251, a171
v_pk_mul_f32 v[248:249], v[248:249], v[8:9] op_sel_hi:[1,0]
v_pk_mul_f32 v[250:251], v[250:251], v[8:9] op_sel_hi:[1,0]
v_cvt_pk_bf16_f32 v248, v248, v249
v_cvt_pk_bf16_f32 v249, v250, v251
v_accvgpr_read_b32 v250, a184
v_accvgpr_read_b32 v251, a185
v_accvgpr_read_b32 v24, a186
v_accvgpr_read_b32 v25, a187
v_pk_mul_f32 v[250:251], v[250:251], v[8:9] op_sel_hi:[1,0]
v_pk_mul_f32 v[24:25], v[24:25], v[8:9] op_sel_hi:[1,0]
v_cvt_pk_bf16_f32 v250, v250, v251
v_cvt_pk_bf16_f32 v251, v24, v25
v_mfma_f32_16x16x32_bf16 a[200:203], v[56:59], v[232:235], a[200:203]
ds_read_b64_tr_b16 v[52:53], v16 offset:49216
v_accvgpr_read_b32 v252, a172
v_mfma_f32_16x16x32_bf16 a[200:203], v[60:63], v[248:251], a[200:203]
v_accvgpr_read_b32 v253, a173
v_accvgpr_read_b32 v254, a174
v_accvgpr_read_b32 v255, a175
v_pk_mul_f32 v[252:253], v[252:253], v[8:9] op_sel:[0,1] op_sel_hi:[1,1]
v_pk_mul_f32 v[254:255], v[254:255], v[8:9] op_sel:[0,1] op_sel_hi:[1,1]
v_cvt_pk_bf16_f32 v252, v252, v253
v_cvt_pk_bf16_f32 v253, v254, v255
v_accvgpr_read_b32 v254, a188
v_accvgpr_read_b32 v255, a189
v_accvgpr_read_b32 v26, a190
v_accvgpr_read_b32 v27, a191
v_pk_mul_f32 v[254:255], v[254:255], v[8:9] op_sel:[0,1] op_sel_hi:[1,1]
v_pk_mul_f32 v[26:27], v[26:27], v[8:9] op_sel:[0,1] op_sel_hi:[1,1]
v_cvt_pk_bf16_f32 v254, v254, v255
v_cvt_pk_bf16_f32 v255, v26, v27
v_mfma_f32_16x16x32_bf16 a[204:207], v[56:59], v[236:239], a[204:207]
ds_read_b64_tr_b16 v[54:55], v16 offset:52288
v_mfma_f32_16x16x32_bf16 a[204:207], v[60:63], v[252:255], a[204:207]
s_waitcnt lgkmcnt(4)
v_mfma_f32_16x16x32_bf16 a[208:211], v[40:43], v[224:227], a[208:211]
ds_read_b64_tr_b16 v[56:57], v15 offset:49216
v_mfma_f32_16x16x32_bf16 a[208:211], v[44:47], v[240:243], a[208:211]
buffer_load_dwordx4 v30, s[64:67], s40 offen offset:2048 lds
v_mfma_f32_16x16x32_bf16 a[212:215], v[40:43], v[228:231], a[212:215]
ds_read_b64_tr_b16 v[58:59], v15 offset:52288
v_mfma_f32_16x16x32_bf16 a[212:215], v[44:47], v[244:247], a[212:215]
s_waitcnt vmcnt(7)
v_cmp_gt_u32 vcc, 1, v5
v_mfma_f32_16x16x32_bf16 a[216:219], v[40:43], v[232:235], a[216:219]
ds_read_b64_tr_b16 v[60:61], v17 offset:49216
v_mfma_f32_16x16x32_bf16 a[216:219], v[44:47], v[248:251], a[216:219]
s_cbranch_vccnz KF_slo0
KF_rto0:
v_mfma_f32_16x16x32_bf16 a[220:223], v[40:43], v[236:239], a[220:223]
ds_read_b64_tr_b16 v[62:63], v17 offset:52288
v_mfma_f32_16x16x32_bf16 a[220:223], v[44:47], v[252:255], a[220:223]
s_waitcnt lgkmcnt(4)
v_mfma_f32_16x16x32_bf16 a[224:227], v[48:51], v[224:227], a[224:227]
ds_read_b64_tr_b16 v[40:41], v14 offset:49280
v_mfma_f32_16x16x32_bf16 a[224:227], v[52:55], v[240:243], a[224:227]
buffer_store_dwordx4 v[220:223], v21, s[24:27], s80 offen offset:3072 sc1
v_mfma_f32_16x16x32_bf16 a[228:231], v[48:51], v[228:231], a[228:231]
ds_read_b64_tr_b16 v[42:43], v14 offset:52352
v_mfma_f32_16x16x32_bf16 a[228:231], v[52:55], v[244:247], a[228:231]
v_mov_b32 v7, 2
v_mfma_f32_16x16x32_bf16 a[232:235], v[48:51], v[232:235], a[232:235]
ds_read_b64_tr_b16 v[44:45], v16 offset:49280
v_mfma_f32_16x16x32_bf16 a[232:235], v[52:55], v[248:251], a[232:235]
buffer_store_dword v7, v35, s[56:59], 0 offen sc1
v_mfma_f32_16x16x32_bf16 a[236:239], v[48:51], v[236:239], a[236:239]
ds_read_b64_tr_b16 v[46:47], v16 offset:52352
v_mfma_f32_16x16x32_bf16 a[236:239], v[52:55], v[252:255], a[236:239]
s_waitcnt lgkmcnt(4)
v_mfma_f32_16x16x32_bf16 a[240:243], v[56:59], v[224:227], a[240:243]
ds_read_b64_tr_b16 v[48:49], v15 offset:49280
v_mfma_f32_16x16x32_bf16 a[240:243], v[60:63], v[240:243], a[240:243]
buffer_load_dwordx4 a[0:3], v18, s[24:27], s81 offen sc1
v_mfma_f32_16x16x32_bf16 a[244:247], v[56:59], v[228:231], a[244:247]
ds_read_b64_tr_b16 v[50:51], v15 offset:52352
v_mfma_f32_16x16x32_bf16 a[244:247], v[60:63], v[244:247], a[244:247]
buffer_load_dwordx4 a[4:7], v19, s[24:27], s81 offen sc1
v_mfma_f32_16x16x32_bf16 a[248:251], v[56:59], v[232:235], a[248:251]
ds_read_b64_tr_b16 v[52:53], v17 offset:49280
v_mfma_f32_16x16x32_bf16 a[248:251], v[60:63], v[248:251], a[248:251]
buffer_load_dwordx4 a[8:11], v20, s[24:27], s81 offen sc1
v_mfma_f32_16x16x32_bf16 a[252:255], v[56:59], v[236:239], a[252:255]
ds_read_b64_tr_b16 v[54:55], v17 offset:52352
v_mfma_f32_16x16x32_bf16 a[252:255], v[60:63], v[252:255], a[252:255]
s_waitcnt lgkmcnt(4)
v_mfma_f32_16x16x32_bf16 v[64:67], v[40:43], v[224:227], v[64:67]
ds_read_b64_tr_b16 v[56:57], v14 offset:49344
v_mfma_f32_16x16x32_bf16 v[64:67], v[44:47], v[240:243], v[64:67]
buffer_store_dwordx4 v[224:227], v18, s[24:27], s41 offen sc1
v_mfma_f32_16x16x32_bf16 v[68:71], v[40:43], v[228:231], v[68:71]
ds_read_b64_tr_b16 v[58:59], v14 offset:52416
v_mfma_f32_16x16x32_bf16 v[68:71], v[44:47], v[244:247], v[68:71]
buffer_load_dwordx4 a[12:15], v21, s[24:27], s81 offen sc1
v_mfma_f32_16x16x32_bf16 v[72:75], v[40:43], v[232:235], v[72:75]
ds_read_b64_tr_b16 v[60:61], v16 offset:49344
v_mfma_f32_16x16x32_bf16 v[72:75], v[44:47], v[248:251], v[72:75]
v_mfma_f32_16x16x32_bf16 v[76:79], v[40:43], v[236:239], v[76:79]
ds_read_b64_tr_b16 v[62:63], v16 offset:52416
v_mfma_f32_16x16x32_bf16 v[76:79], v[44:47], v[252:255], v[76:79]
s_waitcnt lgkmcnt(4)
v_mfma_f32_16x16x32_bf16 v[80:83], v[48:51], v[224:227], v[80:83]
ds_read_b64_tr_b16 v[40:41], v15 offset:49344
v_mfma_f32_16x16x32_bf16 v[80:83], v[52:55], v[240:243], v[80:83]
buffer_load_dwordx4 a[16:19], v18, s[24:27], s82 offen sc1
v_mfma_f32_16x16x32_bf16 v[84:87], v[48:51], v[228:231], v[84:87]
ds_read_b64_tr_b16 v[42:43], v15 offset:52416
v_mfma_f32_16x16x32_bf16 v[84:87], v[52:55], v[244:247], v[84:87]
v_mfma_f32_16x16x32_bf16 v[88:91], v[48:51], v[232:235], v[88:91]
ds_read_b64_tr_b16 v[44:45], v17 offset:49344
v_mfma_f32_16x16x32_bf16 v[88:91], v[52:55], v[248:251], v[88:91]
buffer_store_dwordx4 v[228:231], v19, s[24:27], s41 offen sc1
v_mfma_f32_16x16x32_bf16 v[92:95], v[48:51], v[236:239], v[92:95]
ds_read_b64_tr_b16 v[46:47], v17 offset:52416
v_mfma_f32_16x16x32_bf16 v[92:95], v[52:55], v[252:255], v[92:95]
s_waitcnt lgkmcnt(4)
v_mfma_f32_16x16x32_bf16 v[96:99], v[56:59], v[224:227], v[96:99]
ds_read_b64_tr_b16 v[48:49], v14 offset:49408
v_mfma_f32_16x16x32_bf16 v[96:99], v[60:63], v[240:243], v[96:99]
buffer_load_dwordx4 a[20:23], v19, s[24:27], s82 offen sc1
v_mfma_f32_16x16x32_bf16 v[100:103], v[56:59], v[228:231], v[100:103]
ds_read_b64_tr_b16 v[50:51], v14 offset:52480
v_mfma_f32_16x16x32_bf16 v[100:103], v[60:63], v[244:247], v[100:103]
v_mfma_f32_16x16x32_bf16 v[104:107], v[56:59], v[232:235], v[104:107]
ds_read_b64_tr_b16 v[52:53], v16 offset:49408
v_mfma_f32_16x16x32_bf16 v[104:107], v[60:63], v[248:251], v[104:107]
buffer_load_dwordx4 a[24:27], v20, s[24:27], s82 offen sc1
v_mfma_f32_16x16x32_bf16 v[108:111], v[56:59], v[236:239], v[108:111]
ds_read_b64_tr_b16 v[54:55], v16 offset:52480
v_mfma_f32_16x16x32_bf16 v[108:111], v[60:63], v[252:255], v[108:111]
s_waitcnt lgkmcnt(4)
v_mfma_f32_16x16x32_bf16 v[112:115], v[40:43], v[224:227], v[112:115]
ds_read_b64_tr_b16 v[56:57], v15 offset:49408
v_mfma_f32_16x16x32_bf16 v[112:115], v[44:47], v[240:243], v[112:115]
ds_read_b64_tr_b16 v[58:59], v15 offset:52480
v_mfma_f32_16x16x32_bf16 v[116:119], v[40:43], v[228:231], v[116:119]
ds_read_b64_tr_b16 v[60:61], v17 offset:49408
v_mfma_f32_16x16x32_bf16 v[116:119], v[44:47], v[244:247], v[116:119]
ds_read_b64_tr_b16 v[62:63], v17 offset:52480
v_mfma_f32_16x16x32_bf16 v[120:123], v[40:43], v[232:235], v[120:123]
buffer_store_dwordx4 v[232:235], v20, s[24:27], s41 offen sc1
v_mfma_f32_16x16x32_bf16 v[120:123], v[44:47], v[248:251], v[120:123]
buffer_load_dword v5, v36, s[56:59], 0 offen offset:4 sc1
v_mfma_f32_16x16x32_bf16 v[124:127], v[40:43], v[236:239], v[124:127]
buffer_load_dwordx4 a[28:31], v21, s[24:27], s82 offen sc1
v_mfma_f32_16x16x32_bf16 v[124:127], v[44:47], v[252:255], v[124:127]
s_waitcnt lgkmcnt(4)
v_mfma_f32_16x16x32_bf16 v[128:131], v[48:51], v[224:227], v[128:131]
s_waitcnt lgkmcnt(0)
v_mfma_f32_16x16x32_bf16 v[128:131], v[52:55], v[240:243], v[128:131]
s_barrier
v_mfma_f32_16x16x32_bf16 v[132:135], v[48:51], v[228:231], v[132:135]
KF_pg12:
s_cbranch_execz KF_tret
ds_read_b64_tr_b16 v[40:41], v14 offset:61440
v_mfma_f32_16x16x32_bf16 v[132:135], v[52:55], v[244:247], v[132:135]
ds_read_b64_tr_b16 v[42:43], v14 offset:64512
v_mfma_f32_16x16x32_bf16 v[136:139], v[48:51], v[232:235], v[136:139]
ds_read_b64_tr_b16 v[44:45], v16 offset:61440
v_mfma_f32_16x16x32_bf16 v[136:139], v[52:55], v[248:251], v[136:139]
ds_read_b64_tr_b16 v[46:47], v16 offset:64512
v_mfma_f32_16x16x32_bf16 v[140:143], v[48:51], v[236:239], v[140:143]
buffer_load_dwordx4 a[32:35], v18, s[24:27], s83 offen sc1
v_mfma_f32_16x16x32_bf16 v[140:143], v[52:55], v[252:255], v[140:143]
v_mfma_f32_16x16x32_bf16 v[144:147], v[56:59], v[224:227], v[144:147]
ds_read_b64_tr_b16 v[48:49], v15 offset:61440
v_mfma_f32_16x16x32_bf16 v[144:147], v[60:63], v[240:243], v[144:147]
buffer_store_dwordx4 v[236:239], v21, s[24:27], s41 offen sc1
v_mfma_f32_16x16x32_bf16 v[148:151], v[56:59], v[228:231], v[148:151]
ds_read_b64_tr_b16 v[50:51], v15 offset:64512
v_mfma_f32_16x16x32_bf16 v[148:151], v[60:63], v[244:247], v[148:151]
buffer_load_dwordx4 a[36:39], v19, s[24:27], s83 offen sc1
v_mfma_f32_16x16x32_bf16 v[152:155], v[56:59], v[232:235], v[152:155]
ds_read_b64_tr_b16 v[52:53], v17 offset:61440
v_mfma_f32_16x16x32_bf16 v[152:155], v[60:63], v[248:251], v[152:155]
buffer_load_dwordx4 a[40:43], v20, s[24:27], s83 offen sc1
v_mfma_f32_16x16x32_bf16 v[156:159], v[56:59], v[236:239], v[156:159]
ds_read_b64_tr_b16 v[54:55], v17 offset:64512
v_mfma_f32_16x16x32_bf16 v[156:159], v[60:63], v[252:255], v[156:159]
s_waitcnt vmcnt(4) lgkmcnt(4)
v_mfma_f32_16x16x32_bf16 a[192:195], v[40:43], a[0:3], a[192:195]
ds_read_b64_tr_b16 v[56:57], v14 offset:61504
v_mfma_f32_16x16x32_bf16 a[192:195], v[44:47], a[16:19], a[192:195]
buffer_load_dwordx4 a[44:47], v21, s[24:27], s83 offen sc1
v_mfma_f32_16x16x32_bf16 a[196:199], v[40:43], a[4:7], a[196:199]
ds_read_b64_tr_b16 v[58:59], v14 offset:64576
v_mfma_f32_16x16x32_bf16 a[196:199], v[44:47], a[20:23], a[196:199]
v_mfma_f32_16x16x32_bf16 a[200:203], v[40:43], a[8:11], a[200:203]
ds_read_b64_tr_b16 v[60:61], v16 offset:61504
v_mfma_f32_16x16x32_bf16 a[200:203], v[44:47], a[24:27], a[200:203]
v_mfma_f32_16x16x32_bf16 a[204:207], v[40:43], a[12:15], a[204:207]
ds_read_b64_tr_b16 v[62:63], v16 offset:64576
v_mfma_f32_16x16x32_bf16 a[204:207], v[44:47], a[28:31], a[204:207]
s_waitcnt lgkmcnt(4)
v_mfma_f32_16x16x32_bf16 a[208:211], v[48:51], a[0:3], a[208:211]
s_add_u32 s40, s77, 122880
ds_read_b64_tr_b16 v[40:41], v15 offset:61504
v_mfma_f32_16x16x32_bf16 a[208:211], v[52:55], a[16:19], a[208:211]
buffer_store_dwordx4 v[240:243], v18, s[24:27], s41 offen offset:1024 sc1
v_mfma_f32_16x16x32_bf16 a[212:215], v[48:51], a[4:7], a[212:215]
s_add_u32 m0, s37, 110592
ds_read_b64_tr_b16 v[42:43], v15 offset:64576
v_mfma_f32_16x16x32_bf16 a[212:215], v[52:55], a[20:23], a[212:215]
buffer_load_dwordx4 v28, s[64:67], s40 offen lds
v_mfma_f32_16x16x32_bf16 a[216:219], v[48:51], a[8:11], a[216:219]
ds_read_b64_tr_b16 v[44:45], v17 offset:61504
v_mfma_f32_16x16x32_bf16 a[216:219], v[52:55], a[24:27], a[216:219]
v_mfma_f32_16x16x32_bf16 a[220:223], v[48:51], a[12:15], a[220:223]
ds_read_b64_tr_b16 v[46:47], v17 offset:64576
v_mfma_f32_16x16x32_bf16 a[220:223], v[52:55], a[28:31], a[220:223]
s_waitcnt lgkmcnt(4)
v_mfma_f32_16x16x32_bf16 a[224:227], v[56:59], a[0:3], a[224:227]
ds_read_b64_tr_b16 v[48:49], v14 offset:61568
v_mfma_f32_16x16x32_bf16 a[224:227], v[60:63], a[16:19], a[224:227]
buffer_load_dwordx4 v29, s[64:67], s40 offen offset:1024 lds
v_mfma_f32_16x16x32_bf16 a[228:231], v[56:59], a[4:7], a[228:231]
ds_read_b64_tr_b16 v[50:51], v14 offset:64640
v_mfma_f32_16x16x32_bf16 a[228:231], v[60:63], a[20:23], a[228:231]
buffer_load_dwordx4 v30, s[64:67], s40 offen offset:2048 lds
v_mfma_f32_16x16x32_bf16 a[232:235], v[56:59], a[8:11], a[232:235]
ds_read_b64_tr_b16 v[52:53], v16 offset:61568
v_mfma_f32_16x16x32_bf16 a[232:235], v[60:63], a[24:27], a[232:235]
buffer_store_dwordx4 v[244:247], v19, s[24:27], s41 offen offset:1024 sc1
v_mfma_f32_16x16x32_bf16 a[236:239], v[56:59], a[12:15], a[236:239]
ds_read_b64_tr_b16 v[54:55], v16 offset:64640
v_mfma_f32_16x16x32_bf16 a[236:239], v[60:63], a[28:31], a[236:239]
s_waitcnt lgkmcnt(4)
v_mfma_f32_16x16x32_bf16 a[240:243], v[40:43], a[0:3], a[240:243]
ds_read_b64_tr_b16 v[56:57], v15 offset:61568
v_mfma_f32_16x16x32_bf16 a[240:243], v[44:47], a[16:19], a[240:243]
s_add_u32 s40, s78, 122880
v_mfma_f32_16x16x32_bf16 a[244:247], v[40:43], a[4:7], a[244:247]
s_add_u32 m0, s37, 49152
ds_read_b64_tr_b16 v[58:59], v15 offset:64640
v_mfma_f32_16x16x32_bf16 a[244:247], v[44:47], a[20:23], a[244:247]
buffer_load_dwordx4 v28, s[64:67], s40 offen lds
v_mfma_f32_16x16x32_bf16 a[248:251], v[40:43], a[8:11], a[248:251]
ds_read_b64_tr_b16 v[60:61], v17 offset:61568
v_mfma_f32_16x16x32_bf16 a[248:251], v[44:47], a[24:27], a[248:251]
v_mfma_f32_16x16x32_bf16 a[252:255], v[40:43], a[12:15], a[252:255]
ds_read_b64_tr_b16 v[62:63], v17 offset:64640
v_mfma_f32_16x16x32_bf16 a[252:255], v[44:47], a[28:31], a[252:255]
s_waitcnt lgkmcnt(4)
v_mfma_f32_16x16x32_bf16 v[64:67], v[48:51], a[0:3], v[64:67]
ds_read_b64_tr_b16 v[40:41], v14 offset:61632
v_mfma_f32_16x16x32_bf16 v[64:67], v[52:55], a[16:19], v[64:67]
buffer_load_dwordx4 v29, s[64:67], s40 offen offset:1024 lds
v_mfma_f32_16x16x32_bf16 v[68:71], v[48:51], a[4:7], v[68:71]
ds_read_b64_tr_b16 v[42:43], v14 offset:64704
v_mfma_f32_16x16x32_bf16 v[68:71], v[52:55], a[20:23], v[68:71]
buffer_store_dwordx4 v[248:251], v20, s[24:27], s41 offen offset:1024 sc1
v_mfma_f32_16x16x32_bf16 v[72:75], v[48:51], a[8:11], v[72:75]
ds_read_b64_tr_b16 v[44:45], v16 offset:61632
v_mfma_f32_16x16x32_bf16 v[72:75], v[52:55], a[24:27], v[72:75]
v_mfma_f32_16x16x32_bf16 v[76:79], v[48:51], a[12:15], v[76:79]
ds_read_b64_tr_b16 v[46:47], v16 offset:64704
v_mfma_f32_16x16x32_bf16 v[76:79], v[52:55], a[28:31], v[76:79]
s_waitcnt lgkmcnt(4)
v_mfma_f32_16x16x32_bf16 v[80:83], v[56:59], a[0:3], v[80:83]
ds_read_b64_tr_b16 v[48:49], v15 offset:61632
v_mfma_f32_16x16x32_bf16 v[80:83], v[60:63], a[16:19], v[80:83]
v_cmp_gt_u32 vcc, 2, v5
v_mfma_f32_16x16x32_bf16 v[84:87], v[56:59], a[4:7], v[84:87]
ds_read_b64_tr_b16 v[50:51], v15 offset:64704
v_mfma_f32_16x16x32_bf16 v[84:87], v[60:63], a[20:23], v[84:87]
s_cbranch_vccnz KF_slo1
KF_rto1:
v_mfma_f32_16x16x32_bf16 v[88:91], v[56:59], a[8:11], v[88:91]
ds_read_b64_tr_b16 v[52:53], v17 offset:61632
v_mfma_f32_16x16x32_bf16 v[88:91], v[60:63], a[24:27], v[88:91]
buffer_load_dwordx4 v30, s[64:67], s40 offen offset:2048 lds
v_mfma_f32_16x16x32_bf16 v[92:95], v[56:59], a[12:15], v[92:95]
ds_read_b64_tr_b16 v[54:55], v17 offset:64704
v_mfma_f32_16x16x32_bf16 v[92:95], v[60:63], a[28:31], v[92:95]
s_waitcnt lgkmcnt(4)
v_mfma_f32_16x16x32_bf16 v[96:99], v[40:43], a[0:3], v[96:99]
ds_read_b64_tr_b16 v[56:57], v14 offset:61696
v_mfma_f32_16x16x32_bf16 v[96:99], v[44:47], a[16:19], v[96:99]
buffer_store_dwordx4 v[252:255], v21, s[24:27], s41 offen offset:1024 sc1
v_mfma_f32_16x16x32_bf16 v[100:103], v[40:43], a[4:7], v[100:103]
ds_read_b64_tr_b16 v[58:59], v14 offset:64768
v_mfma_f32_16x16x32_bf16 v[100:103], v[44:47], a[20:23], v[100:103]
buffer_load_dwordx4 a[48:51], v18, s[24:27], s81 offen offset:1024 sc1
v_mfma_f32_16x16x32_bf16 v[104:107], v[40:43], a[8:11], v[104:107]
ds_read_b64_tr_b16 v[60:61], v16 offset:61696
v_mfma_f32_16x16x32_bf16 v[104:107], v[44:47], a[24:27], v[104:107]
buffer_load_dwordx4 a[52:55], v19, s[24:27], s81 offen offset:1024 sc1
v_mfma_f32_16x16x32_bf16 v[108:111], v[40:43], a[12:15], v[108:111]
ds_read_b64_tr_b16 v[62:63], v16 offset:64768
v_mfma_f32_16x16x32_bf16 v[108:111], v[44:47], a[28:31], v[108:111]
s_waitcnt lgkmcnt(4)
v_mfma_f32_16x16x32_bf16 v[112:115], v[48:51], a[0:3], v[112:115]
ds_read_b64_tr_b16 v[40:41], v15 offset:61696
v_mfma_f32_16x16x32_bf16 v[112:115], v[52:55], a[16:19], v[112:115]
ds_read_b64_tr_b16 v[42:43], v15 offset:64768
v_mfma_f32_16x16x32_bf16 v[116:119], v[48:51], a[4:7], v[116:119]
ds_read_b64_tr_b16 v[44:45], v17 offset:61696
v_mfma_f32_16x16x32_bf16 v[116:119], v[52:55], a[20:23], v[116:119]
ds_read_b64_tr_b16 v[46:47], v17 offset:64768
v_mfma_f32_16x16x32_bf16 v[120:123], v[48:51], a[8:11], v[120:123]
buffer_load_dwordx4 a[56:59], v20, s[24:27], s81 offen offset:1024 sc1
v_mfma_f32_16x16x32_bf16 v[120:123], v[52:55], a[24:27], v[120:123]
buffer_load_dwordx4 a[60:63], v21, s[24:27], s81 offen offset:1024 sc1
v_mfma_f32_16x16x32_bf16 v[124:127], v[48:51], a[12:15], v[124:127]
v_mfma_f32_16x16x32_bf16 v[124:127], v[52:55], a[28:31], v[124:127]
s_waitcnt lgkmcnt(4)
v_mfma_f32_16x16x32_bf16 v[128:131], v[56:59], a[0:3], v[128:131]
s_waitcnt lgkmcnt(0)
v_mfma_f32_16x16x32_bf16 v[128:131], v[60:63], a[16:19], v[128:131]
s_barrier
v_mfma_f32_16x16x32_bf16 v[132:135], v[56:59], a[4:7], v[132:135]
ds_read_b64_tr_b16 v[48:49], v14 offset:0
v_mfma_f32_16x16x32_bf16 v[132:135], v[60:63], a[20:23], v[132:135]
ds_read_b64_tr_b16 v[50:51], v14 offset:3072
v_mfma_f32_16x16x32_bf16 v[136:139], v[56:59], a[8:11], v[136:139]
ds_read_b64_tr_b16 v[52:53], v16 offset:0
v_mfma_f32_16x16x32_bf16 v[136:139], v[60:63], a[24:27], v[136:139]
ds_read_b64_tr_b16 v[54:55], v16 offset:3072
v_mfma_f32_16x16x32_bf16 v[140:143], v[56:59], a[12:15], v[140:143]
buffer_load_dwordx4 a[64:67], v18, s[24:27], s82 offen offset:1024 sc1
v_mfma_f32_16x16x32_bf16 v[140:143], v[60:63], a[28:31], v[140:143]
v_mfma_f32_16x16x32_bf16 v[144:147], v[40:43], a[0:3], v[144:147]
ds_read_b64_tr_b16 v[56:57], v15 offset:0
v_mfma_f32_16x16x32_bf16 v[144:147], v[44:47], a[16:19], v[144:147]
buffer_load_dwordx4 a[68:71], v19, s[24:27], s82 offen offset:1024 sc1
v_mfma_f32_16x16x32_bf16 v[148:151], v[40:43], a[4:7], v[148:151]
ds_read_b64_tr_b16 v[58:59], v15 offset:3072
v_mfma_f32_16x16x32_bf16 v[148:151], v[44:47], a[20:23], v[148:151]
buffer_load_dwordx4 a[72:75], v20, s[24:27], s82 offen offset:1024 sc1
v_mfma_f32_16x16x32_bf16 v[152:155], v[40:43], a[8:11], v[152:155]
ds_read_b64_tr_b16 v[60:61], v17 offset:0
v_mfma_f32_16x16x32_bf16 v[152:155], v[44:47], a[24:27], v[152:155]
buffer_load_dwordx4 a[76:79], v21, s[24:27], s82 offen offset:1024 sc1
v_mfma_f32_16x16x32_bf16 v[156:159], v[40:43], a[12:15], v[156:159]
ds_read_b64_tr_b16 v[62:63], v17 offset:3072
v_mfma_f32_16x16x32_bf16 v[156:159], v[44:47], a[28:31], v[156:159]
s_waitcnt vmcnt(4) lgkmcnt(4)
v_mfma_f32_16x16x32_bf16 a[192:195], v[48:51], a[32:35], a[192:195]
ds_read_b64_tr_b16 v[40:41], v14 offset:64
v_mfma_f32_16x16x32_bf16 a[192:195], v[52:55], a[48:51], a[192:195]
buffer_load_dwordx4 a[80:83], v18, s[24:27], s83 offen offset:1024 sc1
v_mfma_f32_16x16x32_bf16 a[196:199], v[48:51], a[36:39], a[196:199]
ds_read_b64_tr_b16 v[42:43], v14 offset:3136
v_mfma_f32_16x16x32_bf16 a[196:199], v[52:55], a[52:55], a[196:199]
v_mfma_f32_16x16x32_bf16 a[200:203], v[48:51], a[40:43], a[200:203]
ds_read_b64_tr_b16 v[44:45], v16 offset:64
v_mfma_f32_16x16x32_bf16 a[200:203], v[52:55], a[56:59], a[200:203]
buffer_load_dwordx4 a[84:87], v19, s[24:27], s83 offen offset:1024 sc1
v_mfma_f32_16x16x32_bf16 a[204:207], v[48:51], a[44:47], a[204:207]
ds_read_b64_tr_b16 v[46:47], v16 offset:3136
v_mfma_f32_16x16x32_bf16 a[204:207], v[52:55], a[60:63], a[204:207]
s_waitcnt lgkmcnt(4)
v_mfma_f32_16x16x32_bf16 a[208:211], v[56:59], a[32:35], a[208:211]
ds_read_b64_tr_b16 v[48:49], v15 offset:64
v_mfma_f32_16x16x32_bf16 a[208:211], v[60:63], a[48:51], a[208:211]
v_mfma_f32_16x16x32_bf16 a[212:215], v[56:59], a[36:39], a[212:215]
ds_read_b64_tr_b16 v[50:51], v15 offset:3136
v_mfma_f32_16x16x32_bf16 a[212:215], v[60:63], a[52:55], a[212:215]
buffer_load_dwordx4 a[88:91], v20, s[24:27], s83 offen offset:1024 sc1
v_mfma_f32_16x16x32_bf16 a[216:219], v[56:59], a[40:43], a[216:219]
ds_read_b64_tr_b16 v[52:53], v17 offset:64
v_mfma_f32_16x16x32_bf16 a[216:219], v[60:63], a[56:59], a[216:219]
v_mfma_f32_16x16x32_bf16 a[220:223], v[56:59], a[44:47], a[220:223]
ds_read_b64_tr_b16 v[54:55], v17 offset:3136
v_mfma_f32_16x16x32_bf16 a[220:223], v[60:63], a[60:63], a[220:223]
s_waitcnt lgkmcnt(4)
v_mfma_f32_16x16x32_bf16 a[224:227], v[40:43], a[32:35], a[224:227]
ds_read_b64_tr_b16 v[56:57], v14 offset:128
v_mfma_f32_16x16x32_bf16 a[224:227], v[44:47], a[48:51], a[224:227]
buffer_load_dwordx4 a[92:95], v21, s[24:27], s83 offen offset:1024 sc1
v_mfma_f32_16x16x32_bf16 a[228:231], v[40:43], a[36:39], a[228:231]
ds_read_b64_tr_b16 v[58:59], v14 offset:3200
v_mfma_f32_16x16x32_bf16 a[228:231], v[44:47], a[52:55], a[228:231]
buffer_load_dwordx4 a[96:99], v18, s[24:27], s81 offen offset:2048 sc1
v_mfma_f32_16x16x32_bf16 a[232:235], v[40:43], a[40:43], a[232:235]
ds_read_b64_tr_b16 v[60:61], v16 offset:128
v_mfma_f32_16x16x32_bf16 a[232:235], v[44:47], a[56:59], a[232:235]
v_mfma_f32_16x16x32_bf16 a[236:239], v[40:43], a[44:47], a[236:239]
ds_read_b64_tr_b16 v[62:63], v16 offset:3200
v_mfma_f32_16x16x32_bf16 a[236:239], v[44:47], a[60:63], a[236:239]
s_waitcnt lgkmcnt(4)
v_mfma_f32_16x16x32_bf16 a[240:243], v[48:51], a[32:35], a[240:243]
ds_read_b64_tr_b16 v[40:41], v15 offset:128
v_mfma_f32_16x16x32_bf16 a[240:243], v[52:55], a[48:51], a[240:243]
buffer_load_dwordx4 a[100:103], v19, s[24:27], s81 offen offset:2048 sc1
v_mfma_f32_16x16x32_bf16 a[244:247], v[48:51], a[36:39], a[244:247]
ds_read_b64_tr_b16 v[42:43], v15 offset:3200
v_mfma_f32_16x16x32_bf16 a[244:247], v[52:55], a[52:55], a[244:247]
buffer_load_dwordx4 a[104:107], v20, s[24:27], s81 offen offset:2048 sc1
v_mfma_f32_16x16x32_bf16 a[248:251], v[48:51], a[40:43], a[248:251]
ds_read_b64_tr_b16 v[44:45], v17 offset:128
v_mfma_f32_16x16x32_bf16 a[248:251], v[52:55], a[56:59], a[248:251]
v_mfma_f32_16x16x32_bf16 a[252:255], v[48:51], a[44:47], a[252:255]
ds_read_b64_tr_b16 v[46:47], v17 offset:3200
v_mfma_f32_16x16x32_bf16 a[252:255], v[52:55], a[60:63], a[252:255]
s_waitcnt lgkmcnt(4)
v_mfma_f32_16x16x32_bf16 v[64:67], v[56:59], a[32:35], v[64:67]
ds_read_b64_tr_b16 v[48:49], v14 offset:192
v_mfma_f32_16x16x32_bf16 v[64:67], v[60:63], a[48:51], v[64:67]
buffer_load_dwordx4 a[108:111], v21, s[24:27], s81 offen offset:2048 sc1
v_mfma_f32_16x16x32_bf16 v[68:71], v[56:59], a[36:39], v[68:71]
ds_read_b64_tr_b16 v[50:51], v14 offset:3264
v_mfma_f32_16x16x32_bf16 v[68:71], v[60:63], a[52:55], v[68:71]
buffer_load_dwordx4 a[112:115], v18, s[24:27], s82 offen offset:2048 sc1
v_mfma_f32_16x16x32_bf16 v[72:75], v[56:59], a[40:43], v[72:75]
ds_read_b64_tr_b16 v[52:53], v16 offset:192
v_mfma_f32_16x16x32_bf16 v[72:75], v[60:63], a[56:59], v[72:75]
v_mfma_f32_16x16x32_bf16 v[76:79], v[56:59], a[44:47], v[76:79]
ds_read_b64_tr_b16 v[54:55], v16 offset:3264
v_mfma_f32_16x16x32_bf16 v[76:79], v[60:63], a[60:63], v[76:79]
s_waitcnt lgkmcnt(4)
v_mfma_f32_16x16x32_bf16 v[80:83], v[40:43], a[32:35], v[80:83]
ds_read_b64_tr_b16 v[56:57], v15 offset:192
v_mfma_f32_16x16x32_bf16 v[80:83], v[44:47], a[48:51], v[80:83]
v_mov_b32 v7, 3
v_mfma_f32_16x16x32_bf16 v[84:87], v[40:43], a[36:39], v[84:87]
ds_read_b64_tr_b16 v[58:59], v15 offset:3264
v_mfma_f32_16x16x32_bf16 v[84:87], v[44:47], a[52:55], v[84:87]
buffer_store_dword v7, v35, s[56:59], 0 offen sc1
v_mfma_f32_16x16x32_bf16 v[88:91], v[40:43], a[40:43], v[88:91]
ds_read_b64_tr_b16 v[60:61], v17 offset:192
v_mfma_f32_16x16x32_bf16 v[88:91], v[44:47], a[56:59], v[88:91]
buffer_load_dwordx4 a[116:119], v19, s[24:27], s82 offen offset:2048 sc1
v_mfma_f32_16x16x32_bf16 v[92:95], v[40:43], a[44:47], v[92:95]
ds_read_b64_tr_b16 v[62:63], v17 offset:3264
v_mfma_f32_16x16x32_bf16 v[92:95], v[44:47], a[60:63], v[92:95]
s_waitcnt lgkmcnt(4)
v_mfma_f32_16x16x32_bf16 v[96:99], v[48:51], a[32:35], v[96:99]
ds_read_b64_tr_b16 v[40:41], v14 offset:256
v_mfma_f32_16x16x32_bf16 v[96:99], v[52:55], a[48:51], v[96:99]
buffer_load_dwordx4 a[120:123], v20, s[24:27], s82 offen offset:2048 sc1
v_mfma_f32_16x16x32_bf16 v[100:103], v[48:51], a[36:39], v[100:103]
ds_read_b64_tr_b16 v[42:43], v14 offset:3328
v_mfma_f32_16x16x32_bf16 v[100:103], v[52:55], a[52:55], v[100:103]
v_mfma_f32_16x16x32_bf16 v[104:107], v[48:51], a[40:43], v[104:107]
ds_read_b64_tr_b16 v[44:45], v16 offset:256
v_mfma_f32_16x16x32_bf16 v[104:107], v[52:55], a[56:59], v[104:107]
buffer_load_dwordx4 a[124:127], v21, s[24:27], s82 offen offset:2048 sc1
v_mfma_f32_16x16x32_bf16 v[108:111], v[48:51], a[44:47], v[108:111]
ds_read_b64_tr_b16 v[46:47], v16 offset:3328
v_mfma_f32_16x16x32_bf16 v[108:111], v[52:55], a[60:63], v[108:111]
s_waitcnt lgkmcnt(4)
v_mfma_f32_16x16x32_bf16 v[112:115], v[56:59], a[32:35], v[112:115]
ds_read_b64_tr_b16 v[48:49], v15 offset:256
v_mfma_f32_16x16x32_bf16 v[112:115], v[60:63], a[48:51], v[112:115]
ds_read_b64_tr_b16 v[50:51], v15 offset:3328
v_mfma_f32_16x16x32_bf16 v[116:119], v[56:59], a[36:39], v[116:119]
ds_read_b64_tr_b16 v[52:53], v17 offset:256
v_mfma_f32_16x16x32_bf16 v[116:119], v[60:63], a[52:55], v[116:119]
ds_read_b64_tr_b16 v[54:55], v17 offset:3328
v_mfma_f32_16x16x32_bf16 v[120:123], v[56:59], a[40:43], v[120:123]
buffer_load_dwordx4 a[128:131], v18, s[24:27], s83 offen offset:2048 sc1
v_mfma_f32_16x16x32_bf16 v[120:123], v[60:63], a[56:59], v[120:123]
buffer_load_dwordx4 a[132:135], v19, s[24:27], s83 offen offset:2048 sc1
v_mfma_f32_16x16x32_bf16 v[124:127], v[56:59], a[44:47], v[124:127]
v_mfma_f32_16x16x32_bf16 v[124:127], v[60:63], a[60:63], v[124:127]
s_waitcnt lgkmcnt(4)
v_mfma_f32_16x16x32_bf16 v[128:131], v[40:43], a[32:35], v[128:131]
s_waitcnt lgkmcnt(0)
v_mfma_f32_16x16x32_bf16 v[128:131], v[44:47], a[48:51], v[128:131]
s_barrier
v_mfma_f32_16x16x32_bf16 v[132:135], v[40:43], a[36:39], v[132:135]
ds_read_b64_tr_b16 v[56:57], v14 offset:12288
v_mfma_f32_16x16x32_bf16 v[132:135], v[44:47], a[52:55], v[132:135]
ds_read_b64_tr_b16 v[58:59], v14 offset:15360
v_mfma_f32_16x16x32_bf16 v[136:139], v[40:43], a[40:43], v[136:139]
ds_read_b64_tr_b16 v[60:61], v16 offset:12288
v_mfma_f32_16x16x32_bf16 v[136:139], v[44:47], a[56:59], v[136:139]
ds_read_b64_tr_b16 v[62:63], v16 offset:15360
v_mfma_f32_16x16x32_bf16 v[140:143], v[40:43], a[44:47], v[140:143]
buffer_load_dwordx4 a[136:139], v20, s[24:27], s83 offen offset:2048 sc1
v_mfma_f32_16x16x32_bf16 v[140:143], v[44:47], a[60:63], v[140:143]
v_mfma_f32_16x16x32_bf16 v[144:147], v[48:51], a[32:35], v[144:147]
ds_read_b64_tr_b16 v[40:41], v15 offset:12288
v_mfma_f32_16x16x32_bf16 v[144:147], v[52:55], a[48:51], v[144:147]
buffer_load_dwordx4 a[140:143], v21, s[24:27], s83 offen offset:2048 sc1
v_mfma_f32_16x16x32_bf16 v[148:151], v[48:51], a[36:39], v[148:151]
ds_read_b64_tr_b16 v[42:43], v15 offset:15360
v_mfma_f32_16x16x32_bf16 v[148:151], v[52:55], a[52:55], v[148:151]
s_add_u32 s40, s79, 122880
v_mfma_f32_16x16x32_bf16 v[152:155], v[48:51], a[40:43], v[152:155]
s_add_u32 m0, s37, 122880
ds_read_b64_tr_b16 v[44:45], v17 offset:12288
v_mfma_f32_16x16x32_bf16 v[152:155], v[52:55], a[56:59], v[152:155]
buffer_load_dwordx4 v28, s[64:67], s40 offen lds
v_mfma_f32_16x16x32_bf16 v[156:159], v[48:51], a[44:47], v[156:159]
ds_read_b64_tr_b16 v[46:47], v17 offset:15360
v_mfma_f32_16x16x32_bf16 v[156:159], v[52:55], a[60:63], v[156:159]
s_waitcnt vmcnt(14) lgkmcnt(4)
v_mfma_f32_16x16x32_bf16 a[192:195], v[56:59], a[64:67], a[192:195]
ds_read_b64_tr_b16 v[48:49], v14 offset:12352
v_mfma_f32_16x16x32_bf16 a[192:195], v[60:63], a[80:83], a[192:195]
buffer_load_dwordx4 v29, s[64:67], s40 offen offset:1024 lds
v_mfma_f32_16x16x32_bf16 a[196:199], v[56:59], a[68:71], a[196:199]
ds_read_b64_tr_b16 v[50:51], v14 offset:15424
v_mfma_f32_16x16x32_bf16 a[196:199], v[60:63], a[84:87], a[196:199]
buffer_load_dwordx4 v30, s[64:67], s40 offen offset:2048 lds
v_mfma_f32_16x16x32_bf16 a[200:203], v[56:59], a[72:75], a[200:203]
ds_read_b64_tr_b16 v[52:53], v16 offset:12352
v_mfma_f32_16x16x32_bf16 a[200:203], v[60:63], a[88:91], a[200:203]
v_mfma_f32_16x16x32_bf16 a[204:207], v[56:59], a[76:79], a[204:207]
s_add_u32 s40, s77, 163840
ds_read_b64_tr_b16 v[54:55], v16 offset:15424
v_mfma_f32_16x16x32_bf16 a[204:207], v[60:63], a[92:95], a[204:207]
s_waitcnt lgkmcnt(4)
v_mfma_f32_16x16x32_bf16 a[208:211], v[40:43], a[64:67], a[208:211]
s_add_u32 m0, s37, 61440
ds_read_b64_tr_b16 v[56:57], v15 offset:12352
v_mfma_f32_16x16x32_bf16 a[208:211], v[44:47], a[80:83], a[208:211]
buffer_load_dwordx4 v28, s[64:67], s40 offen lds
v_mfma_f32_16x16x32_bf16 a[212:215], v[40:43], a[68:71], a[212:215]
ds_read_b64_tr_b16 v[58:59], v15 offset:15424
v_mfma_f32_16x16x32_bf16 a[212:215], v[44:47], a[84:87], a[212:215]
buffer_load_dwordx4 v29, s[64:67], s40 offen offset:1024 lds
v_mfma_f32_16x16x32_bf16 a[216:219], v[40:43], a[72:75], a[216:219]
ds_read_b64_tr_b16 v[60:61], v17 offset:12352
v_mfma_f32_16x16x32_bf16 a[216:219], v[44:47], a[88:91], a[216:219]
v_mfma_f32_16x16x32_bf16 a[220:223], v[40:43], a[76:79], a[220:223]
ds_read_b64_tr_b16 v[62:63], v17 offset:15424
v_mfma_f32_16x16x32_bf16 a[220:223], v[44:47], a[92:95], a[220:223]
s_waitcnt lgkmcnt(4)
v_mfma_f32_16x16x32_bf16 a[224:227], v[48:51], a[64:67], a[224:227]
ds_read_b64_tr_b16 v[40:41], v14 offset:12416
v_mfma_f32_16x16x32_bf16 a[224:227], v[52:55], a[80:83], a[224:227]
buffer_load_dwordx4 v30, s[64:67], s40 offen offset:2048 lds
v_mfma_f32_16x16x32_bf16 a[228:231], v[48:51], a[68:71], a[228:231]
ds_read_b64_tr_b16 v[42:43], v14 offset:15488
v_mfma_f32_16x16x32_bf16 a[228:231], v[52:55], a[84:87], a[228:231]
s_add_u32 s40, s78, 163840
v_mfma_f32_16x16x32_bf16 a[232:235], v[48:51], a[72:75], a[232:235]
s_add_u32 m0, s37, 135168
ds_read_b64_tr_b16 v[44:45], v16 offset:12416
v_mfma_f32_16x16x32_bf16 a[232:235], v[52:55], a[88:91], a[232:235]
buffer_load_dwordx4 v28, s[64:67], s40 offen lds
v_mfma_f32_16x16x32_bf16 a[236:239], v[48:51], a[76:79], a[236:239]
ds_read_b64_tr_b16 v[46:47], v16 offset:15488
v_mfma_f32_16x16x32_bf16 a[236:239], v[52:55], a[92:95], a[236:239]
s_waitcnt lgkmcnt(4)
v_mfma_f32_16x16x32_bf16 a[240:243], v[56:59], a[64:67], a[240:243]
ds_read_b64_tr_b16 v[48:49], v15 offset:12416
v_mfma_f32_16x16x32_bf16 a[240:243], v[60:63], a[80:83], a[240:243]
buffer_load_dword v5, v36, s[56:59], 0 offen offset:4 sc1
v_mfma_f32_16x16x32_bf16 a[244:247], v[56:59], a[68:71], a[244:247]
ds_read_b64_tr_b16 v[50:51], v15 offset:15488
v_mfma_f32_16x16x32_bf16 a[244:247], v[60:63], a[84:87], a[244:247]
buffer_load_dwordx4 v29, s[64:67], s40 offen offset:1024 lds
v_mfma_f32_16x16x32_bf16 a[248:251], v[56:59], a[72:75], a[248:251]
ds_read_b64_tr_b16 v[52:53], v17 offset:12416
v_mfma_f32_16x16x32_bf16 a[248:251], v[60:63], a[88:91], a[248:251]
v_mfma_f32_16x16x32_bf16 a[252:255], v[56:59], a[76:79], a[252:255]
ds_read_b64_tr_b16 v[54:55], v17 offset:15488
v_mfma_f32_16x16x32_bf16 a[252:255], v[60:63], a[92:95], a[252:255]
s_waitcnt lgkmcnt(4)
v_mfma_f32_16x16x32_bf16 v[64:67], v[40:43], a[64:67], v[64:67]
ds_read_b64_tr_b16 v[56:57], v14 offset:12480
v_mfma_f32_16x16x32_bf16 v[64:67], v[44:47], a[80:83], v[64:67]
buffer_load_dwordx4 v30, s[64:67], s40 offen offset:2048 lds
v_mfma_f32_16x16x32_bf16 v[68:71], v[40:43], a[68:71], v[68:71]
ds_read_b64_tr_b16 v[58:59], v14 offset:15552
v_mfma_f32_16x16x32_bf16 v[68:71], v[44:47], a[84:87], v[68:71]
s_add_u32 s40, s79, 163840
v_mfma_f32_16x16x32_bf16 v[72:75], v[40:43], a[72:75], v[72:75]
s_add_u32 m0, s37, 0
ds_read_b64_tr_b16 v[60:61], v16 offset:12480
v_mfma_f32_16x16x32_bf16 v[72:75], v[44:47], a[88:91], v[72:75]
buffer_load_dwordx4 v28, s[64:67], s40 offen lds
v_mfma_f32_16x16x32_bf16 v[76:79], v[40:43], a[76:79], v[76:79]
ds_read_b64_tr_b16 v[62:63], v16 offset:15552
v_mfma_f32_16x16x32_bf16 v[76:79], v[44:47], a[92:95], v[76:79]
s_waitcnt lgkmcnt(4)
v_mfma_f32_16x16x32_bf16 v[80:83], v[48:51], a[64:67], v[80:83]
ds_read_b64_tr_b16 v[40:41], v15 offset:12480
v_mfma_f32_16x16x32_bf16 v[80:83], v[52:55], a[80:83], v[80:83]
buffer_load_dwordx4 v29, s[64:67], s40 offen offset:1024 lds
v_mfma_f32_16x16x32_bf16 v[84:87], v[48:51], a[68:71], v[84:87]
ds_read_b64_tr_b16 v[42:43], v15 offset:15552
v_mfma_f32_16x16x32_bf16 v[84:87], v[52:55], a[84:87], v[84:87]
buffer_load_dwordx4 v30, s[64:67], s40 offen offset:2048 lds
v_mfma_f32_16x16x32_bf16 v[88:91], v[48:51], a[72:75], v[88:91]
ds_read_b64_tr_b16 v[44:45], v17 offset:12480
v_mfma_f32_16x16x32_bf16 v[88:91], v[52:55], a[88:91], v[88:91]
v_mfma_f32_16x16x32_bf16 v[92:95], v[48:51], a[76:79], v[92:95]
s_add_u32 s40, s77, 204800
ds_read_b64_tr_b16 v[46:47], v17 offset:15552
v_mfma_f32_16x16x32_bf16 v[92:95], v[52:55], a[92:95], v[92:95]
s_waitcnt lgkmcnt(4)
v_mfma_f32_16x16x32_bf16 v[96:99], v[56:59], a[64:67], v[96:99]
s_add_u32 m0, s37, 73728
ds_read_b64_tr_b16 v[48:49], v14 offset:12544
v_mfma_f32_16x16x32_bf16 v[96:99], v[60:63], a[80:83], v[96:99]
buffer_load_dwordx4 v28, s[64:67], s40 offen lds
v_mfma_f32_16x16x32_bf16 v[100:103], v[56:59], a[68:71], v[100:103]
ds_read_b64_tr_b16 v[50:51], v14 offset:15616
v_mfma_f32_16x16x32_bf16 v[100:103], v[60:63], a[84:87], v[100:103]
buffer_load_dwordx4 v29, s[64:67], s40 offen offset:1024 lds
v_mfma_f32_16x16x32_bf16 v[104:107], v[56:59], a[72:75], v[104:107]
ds_read_b64_tr_b16 v[52:53], v16 offset:12544
v_mfma_f32_16x16x32_bf16 v[104:107], v[60:63], a[88:91], v[104:107]
v_mfma_f32_16x16x32_bf16 v[108:111], v[56:59], a[76:79], v[108:111]
ds_read_b64_tr_b16 v[54:55], v16 offset:15616
v_mfma_f32_16x16x32_bf16 v[108:111], v[60:63], a[92:95], v[108:111]
s_waitcnt lgkmcnt(4)
v_mfma_f32_16x16x32_bf16 v[112:115], v[40:43], a[64:67], v[112:115]
ds_read_b64_tr_b16 v[56:57], v15 offset:12544
v_mfma_f32_16x16x32_bf16 v[112:115], v[44:47], a[80:83], v[112:115]
ds_read_b64_tr_b16 v[58:59], v15 offset:15616
v_mfma_f32_16x16x32_bf16 v[116:119], v[40:43], a[68:71], v[116:119]
ds_read_b64_tr_b16 v[60:61], v17 offset:12544
v_mfma_f32_16x16x32_bf16 v[116:119], v[44:47], a[84:87], v[116:119]
ds_read_b64_tr_b16 v[62:63], v17 offset:15616
v_mfma_f32_16x16x32_bf16 v[120:123], v[40:43], a[72:75], v[120:123]
buffer_load_dwordx4 v30, s[64:67], s40 offen offset:2048 lds
v_mfma_f32_16x16x32_bf16 v[120:123], v[44:47], a[88:91], v[120:123]
v_mfma_f32_16x16x32_bf16 v[124:127], v[40:43], a[76:79], v[124:127]
v_mfma_f32_16x16x32_bf16 v[124:127], v[44:47], a[92:95], v[124:127]
s_waitcnt lgkmcnt(4)
v_mfma_f32_16x16x32_bf16 v[128:131], v[48:51], a[64:67], v[128:131]
s_waitcnt lgkmcnt(0)
v_mfma_f32_16x16x32_bf16 v[128:131], v[52:55], a[80:83], v[128:131]
s_barrier
v_mfma_f32_16x16x32_bf16 v[132:135], v[48:51], a[68:71], v[132:135]
ds_read_b64_tr_b16 v[40:41], v14 offset:24576
v_mfma_f32_16x16x32_bf16 v[132:135], v[52:55], a[84:87], v[132:135]
ds_read_b64_tr_b16 v[42:43], v14 offset:27648
v_mfma_f32_16x16x32_bf16 v[136:139], v[48:51], a[72:75], v[136:139]
s_add_u32 s40, s78, 204800
ds_read_b64_tr_b16 v[44:45], v16 offset:24576
v_mfma_f32_16x16x32_bf16 v[136:139], v[52:55], a[88:91], v[136:139]
s_add_u32 m0, s37, 12288
ds_read_b64_tr_b16 v[46:47], v16 offset:27648
v_mfma_f32_16x16x32_bf16 v[140:143], v[48:51], a[76:79], v[140:143]
buffer_load_dwordx4 v28, s[64:67], s40 offen lds
v_mfma_f32_16x16x32_bf16 v[140:143], v[52:55], a[92:95], v[140:143]
v_mfma_f32_16x16x32_bf16 v[144:147], v[56:59], a[64:67], v[144:147]
ds_read_b64_tr_b16 v[48:49], v15 offset:24576
v_mfma_f32_16x16x32_bf16 v[144:147], v[60:63], a[80:83], v[144:147]
buffer_load_dwordx4 v29, s[64:67], s40 offen offset:1024 lds
v_mfma_f32_16x16x32_bf16 v[148:151], v[56:59], a[68:71], v[148:151]
ds_read_b64_tr_b16 v[50:51], v15 offset:27648
v_mfma_f32_16x16x32_bf16 v[148:151], v[60:63], a[84:87], v[148:151]
v_mfma_f32_16x16x32_bf16 v[152:155], v[56:59], a[72:75], v[152:155]
ds_read_b64_tr_b16 v[52:53], v17 offset:24576
v_mfma_f32_16x16x32_bf16 v[152:155], v[60:63], a[88:91], v[152:155]
buffer_load_dwordx4 v30, s[64:67], s40 offen offset:2048 lds
v_mfma_f32_16x16x32_bf16 v[156:159], v[56:59], a[76:79], v[156:159]
s_add_u32 s40, s79, 204800
ds_read_b64_tr_b16 v[54:55], v17 offset:27648
v_mfma_f32_16x16x32_bf16 v[156:159], v[60:63], a[92:95], v[156:159]
s_waitcnt vmcnt(23) lgkmcnt(4)
v_mfma_f32_16x16x32_bf16 a[192:195], v[40:43], a[96:99], a[192:195]
s_add_u32 m0, s37, 86016
ds_read_b64_tr_b16 v[56:57], v14 offset:24640
v_mfma_f32_16x16x32_bf16 a[192:195], v[44:47], a[112:115], a[192:195]
buffer_load_dwordx4 v28, s[64:67], s40 offen lds
v_mfma_f32_16x16x32_bf16 a[196:199], v[40:43], a[100:103], a[196:199]
ds_read_b64_tr_b16 v[58:59], v14 offset:27712
v_mfma_f32_16x16x32_bf16 a[196:199], v[44:47], a[116:119], a[196:199]
s_xor_b32 s3, s47, 7168
s_cselect_b64 s[22:23], 0, -1
s_cselect_b32 s3, s3, 1073741824
v_mfma_f32_16x16x32_bf16 a[200:203], v[40:43], a[104:107], a[200:203]
ds_read_b64_tr_b16 v[60:61], v16 offset:24640
v_add_u32 v13, s3, v34
v_mfma_f32_16x16x32_bf16 a[200:203], v[44:47], a[120:123], a[200:203]
buffer_load_dwordx4 v29, s[64:67], s40 offen offset:1024 lds
v_mfma_f32_16x16x32_bf16 a[204:207], v[40:43], a[108:111], a[204:207]
ds_read_b64_tr_b16 v[62:63], v16 offset:27712
v_mfma_f32_16x16x32_bf16 a[204:207], v[44:47], a[124:127], a[204:207]
s_waitcnt lgkmcnt(4)
s_xor_b32 s3, s47, 6144
s_cselect_b64 s[20:21], 0, -1
s_cselect_b32 s3, s3, 1073741824
v_mfma_f32_16x16x32_bf16 a[208:211], v[48:51], a[96:99], a[208:211]
ds_read_b64_tr_b16 v[40:41], v15 offset:24640
v_add_u32 v12, s3, v33
v_mfma_f32_16x16x32_bf16 a[208:211], v[52:55], a[112:115], a[208:211]
buffer_load_dwordx4 v30, s[64:67], s40 offen offset:2048 lds
v_mfma_f32_16x16x32_bf16 a[212:215], v[48:51], a[100:103], a[212:215]
ds_read_b64_tr_b16 v[42:43], v15 offset:27712
v_mfma_f32_16x16x32_bf16 a[212:215], v[52:55], a[116:119], a[212:215]
s_xor_b32 s3, s47, 5120
s_cselect_b64 s[18:19], 0, -1
s_cselect_b32 s3, s3, 1073741824
v_mfma_f32_16x16x32_bf16 a[216:219], v[48:51], a[104:107], a[216:219]
KF_pg13:
s_cbranch_execz KF_tret
ds_read_b64_tr_b16 v[44:45], v17 offset:24640
v_add_u32 v11, s3, v32
v_mfma_f32_16x16x32_bf16 a[216:219], v[52:55], a[120:123], a[216:219]
s_waitcnt vmcnt(14)
v_cmp_gt_u32 vcc, 3, v5
v_mfma_f32_16x16x32_bf16 a[220:223], v[48:51], a[108:111], a[220:223]
ds_read_b64_tr_b16 v[46:47], v17 offset:27712
v_mfma_f32_16x16x32_bf16 a[220:223], v[52:55], a[124:127], a[220:223]
s_waitcnt lgkmcnt(4)
s_xor_b32 s3, s47, 4096
s_cselect_b64 s[16:17], 0, -1
s_cselect_b32 s3, s3, 1073741824
v_mfma_f32_16x16x32_bf16 a[224:227], v[56:59], a[96:99], a[224:227]
ds_read_b64_tr_b16 v[48:49], v14 offset:24704
v_add_u32 v10, s3, v31
v_mfma_f32_16x16x32_bf16 a[224:227], v[60:63], a[112:115], a[224:227]
s_cbranch_vccnz KF_slo2
KF_rto2:
s_xor_b32 s3, s47, 3072
s_cselect_b64 s[14:15], 0, -1
s_cselect_b32 s3, s3, 1073741824
v_mfma_f32_16x16x32_bf16 a[228:231], v[56:59], a[100:103], a[228:231]
ds_read_b64_tr_b16 v[50:51], v14 offset:27776
v_add_u32 v34, s3, v34
v_mfma_f32_16x16x32_bf16 a[228:231], v[60:63], a[116:119], a[228:231]
buffer_load_dwordx4 a[144:147], v18, s[24:27], s81 offen offset:3072 sc1
v_mfma_f32_16x16x32_bf16 a[232:235], v[56:59], a[104:107], a[232:235]
ds_read_b64_tr_b16 v[52:53], v16 offset:24704
v_mfma_f32_16x16x32_bf16 a[232:235], v[60:63], a[120:123], a[232:235]
s_xor_b32 s3, s47, 2048
s_cselect_b64 s[12:13], 0, -1
s_cselect_b32 s3, s3, 1073741824
v_mfma_f32_16x16x32_bf16 a[236:239], v[56:59], a[108:111], a[236:239]
ds_read_b64_tr_b16 v[54:55], v16 offset:27776
v_add_u32 v33, s3, v33
v_mfma_f32_16x16x32_bf16 a[236:239], v[60:63], a[124:127], a[236:239]
s_waitcnt lgkmcnt(4)
s_xor_b32 s3, s47, 1024
s_cselect_b64 s[10:11], 0, -1
s_cselect_b32 s3, s3, 1073741824
v_mfma_f32_16x16x32_bf16 a[240:243], v[40:43], a[96:99], a[240:243]
ds_read_b64_tr_b16 v[56:57], v15 offset:24704
v_add_u32 v32, s3, v32
v_mfma_f32_16x16x32_bf16 a[240:243], v[44:47], a[112:115], a[240:243]
buffer_load_dwordx4 a[148:151], v19, s[24:27], s81 offen offset:3072 sc1
v_mfma_f32_16x16x32_bf16 a[244:247], v[40:43], a[100:103], a[244:247]
ds_read_b64_tr_b16 v[58:59], v15 offset:27776
v_mfma_f32_16x16x32_bf16 a[244:247], v[44:47], a[116:119], a[244:247]
buffer_load_dwordx4 a[152:155], v20, s[24:27], s81 offen offset:3072 sc1
v_mfma_f32_16x16x32_bf16 a[248:251], v[40:43], a[104:107], a[248:251]
ds_read_b64_tr_b16 v[60:61], v17 offset:24704
v_mfma_f32_16x16x32_bf16 a[248:251], v[44:47], a[120:123], a[248:251]
s_xor_b32 s3, s47, 0
s_cselect_b64 s[8:9], 0, -1
s_cselect_b32 s3, s3, 1073741824
v_mfma_f32_16x16x32_bf16 a[252:255], v[40:43], a[108:111], a[252:255]
ds_read_b64_tr_b16 v[62:63], v17 offset:27776
v_add_u32 v31, s3, v31
v_mfma_f32_16x16x32_bf16 a[252:255], v[44:47], a[124:127], a[252:255]
s_waitcnt lgkmcnt(4)
v_mfma_f32_16x16x32_bf16 v[64:67], v[48:51], a[96:99], v[64:67]
ds_read_b64_tr_b16 v[40:41], v14 offset:24768
v_mfma_f32_16x16x32_bf16 v[64:67], v[52:55], a[112:115], v[64:67]
buffer_load_dwordx4 a[156:159], v21, s[24:27], s81 offen offset:3072 sc1
v_mfma_f32_16x16x32_bf16 v[68:71], v[48:51], a[100:103], v[68:71]
ds_read_b64_tr_b16 v[42:43], v14 offset:27840
v_mfma_f32_16x16x32_bf16 v[68:71], v[52:55], a[116:119], v[68:71]
buffer_load_dwordx4 a[160:163], v18, s[24:27], s82 offen offset:3072 sc1
v_mfma_f32_16x16x32_bf16 v[72:75], v[48:51], a[104:107], v[72:75]
ds_read_b64_tr_b16 v[44:45], v16 offset:24768
v_mfma_f32_16x16x32_bf16 v[72:75], v[52:55], a[120:123], v[72:75]
v_mfma_f32_16x16x32_bf16 v[76:79], v[48:51], a[108:111], v[76:79]
ds_read_b64_tr_b16 v[46:47], v16 offset:27840
v_mfma_f32_16x16x32_bf16 v[76:79], v[52:55], a[124:127], v[76:79]
s_waitcnt lgkmcnt(4)
v_mfma_f32_16x16x32_bf16 v[80:83], v[56:59], a[96:99], v[80:83]
ds_read_b64_tr_b16 v[48:49], v15 offset:24768
v_mfma_f32_16x16x32_bf16 v[80:83], v[60:63], a[112:115], v[80:83]
buffer_load_dwordx4 a[164:167], v19, s[24:27], s82 offen offset:3072 sc1
v_mfma_f32_16x16x32_bf16 v[84:87], v[56:59], a[100:103], v[84:87]
ds_read_b64_tr_b16 v[50:51], v15 offset:27840
v_mfma_f32_16x16x32_bf16 v[84:87], v[60:63], a[116:119], v[84:87]
buffer_load_dwordx4 a[168:171], v20, s[24:27], s82 offen offset:3072 sc1
v_mfma_f32_16x16x32_bf16 v[88:91], v[56:59], a[104:107], v[88:91]
ds_read_b64_tr_b16 v[52:53], v17 offset:24768
v_mfma_f32_16x16x32_bf16 v[88:91], v[60:63], a[120:123], v[88:91]
v_mfma_f32_16x16x32_bf16 v[92:95], v[56:59], a[108:111], v[92:95]
ds_read_b64_tr_b16 v[54:55], v17 offset:27840
v_mfma_f32_16x16x32_bf16 v[92:95], v[60:63], a[124:127], v[92:95]
s_waitcnt lgkmcnt(4)
v_mfma_f32_16x16x32_bf16 v[96:99], v[40:43], a[96:99], v[96:99]
ds_read_b64_tr_b16 v[56:57], v14 offset:24832
v_mfma_f32_16x16x32_bf16 v[96:99], v[44:47], a[112:115], v[96:99]
buffer_load_dwordx4 a[172:175], v21, s[24:27], s82 offen offset:3072 sc1
v_mfma_f32_16x16x32_bf16 v[100:103], v[40:43], a[100:103], v[100:103]
ds_read_b64_tr_b16 v[58:59], v14 offset:27904
v_mfma_f32_16x16x32_bf16 v[100:103], v[44:47], a[116:119], v[100:103]
buffer_load_dwordx4 a[176:179], v18, s[24:27], s83 offen offset:3072 sc1
v_mfma_f32_16x16x32_bf16 v[104:107], v[40:43], a[104:107], v[104:107]
ds_read_b64_tr_b16 v[60:61], v16 offset:24832
v_mfma_f32_16x16x32_bf16 v[104:107], v[44:47], a[120:123], v[104:107]
v_mfma_f32_16x16x32_bf16 v[108:111], v[40:43], a[108:111], v[108:111]
ds_read_b64_tr_b16 v[62:63], v16 offset:27904
v_mfma_f32_16x16x32_bf16 v[108:111], v[44:47], a[124:127], v[108:111]
s_waitcnt lgkmcnt(4)
v_mfma_f32_16x16x32_bf16 v[112:115], v[48:51], a[96:99], v[112:115]
ds_read_b64_tr_b16 v[40:41], v15 offset:24832
v_mfma_f32_16x16x32_bf16 v[112:115], v[52:55], a[112:115], v[112:115]
ds_read_b64_tr_b16 v[42:43], v15 offset:27904
v_mfma_f32_16x16x32_bf16 v[116:119], v[48:51], a[100:103], v[116:119]
ds_read_b64_tr_b16 v[44:45], v17 offset:24832
v_mfma_f32_16x16x32_bf16 v[116:119], v[52:55], a[116:119], v[116:119]
ds_read_b64_tr_b16 v[46:47], v17 offset:27904
v_mfma_f32_16x16x32_bf16 v[120:123], v[48:51], a[104:107], v[120:123]
buffer_load_dwordx4 a[180:183], v19, s[24:27], s83 offen offset:3072 sc1
v_mfma_f32_16x16x32_bf16 v[120:123], v[52:55], a[120:123], v[120:123]
buffer_load_dwordx4 a[184:187], v20, s[24:27], s83 offen offset:3072 sc1
v_mfma_f32_16x16x32_bf16 v[124:127], v[48:51], a[108:111], v[124:127]
v_mfma_f32_16x16x32_bf16 v[124:127], v[52:55], a[124:127], v[124:127]
s_waitcnt lgkmcnt(4)
v_mfma_f32_16x16x32_bf16 v[128:131], v[56:59], a[96:99], v[128:131]
s_waitcnt lgkmcnt(0)
v_mfma_f32_16x16x32_bf16 v[128:131], v[60:63], a[112:115], v[128:131]
s_barrier
v_mfma_f32_16x16x32_bf16 v[132:135], v[56:59], a[100:103], v[132:135]
ds_read_b64_tr_b16 v[48:49], v14 offset:36864
v_mfma_f32_16x16x32_bf16 v[132:135], v[60:63], a[116:119], v[132:135]
ds_read_b64_tr_b16 v[50:51], v14 offset:39936
v_mfma_f32_16x16x32_bf16 v[136:139], v[56:59], a[104:107], v[136:139]
ds_read_b64_tr_b16 v[52:53], v16 offset:36864
v_mfma_f32_16x16x32_bf16 v[136:139], v[60:63], a[120:123], v[136:139]
ds_read_b64_tr_b16 v[54:55], v16 offset:39936
v_mfma_f32_16x16x32_bf16 v[140:143], v[56:59], a[108:111], v[140:143]
buffer_load_dwordx4 a[188:191], v21, s[24:27], s83 offen offset:3072 sc1
v_mfma_f32_16x16x32_bf16 v[140:143], v[60:63], a[124:127], v[140:143]
v_mfma_f32_16x16x32_bf16 v[144:147], v[40:43], a[96:99], v[144:147]
s_add_u32 s42, s81, 4096
ds_read_b64_tr_b16 v[56:57], v15 offset:36864
v_mfma_f32_16x16x32_bf16 v[144:147], v[44:47], a[112:115], v[144:147]
buffer_load_dwordx4 v[160:163], v18, s[24:27], s42 offen sc1
v_mfma_f32_16x16x32_bf16 v[148:151], v[40:43], a[100:103], v[148:151]
ds_read_b64_tr_b16 v[58:59], v15 offset:39936
v_mfma_f32_16x16x32_bf16 v[148:151], v[44:47], a[116:119], v[148:151]
v_mfma_f32_16x16x32_bf16 v[152:155], v[40:43], a[104:107], v[152:155]
ds_read_b64_tr_b16 v[60:61], v17 offset:36864
v_mfma_f32_16x16x32_bf16 v[152:155], v[44:47], a[120:123], v[152:155]
buffer_load_dwordx4 v[164:167], v19, s[24:27], s42 offen sc1
v_mfma_f32_16x16x32_bf16 v[156:159], v[40:43], a[108:111], v[156:159]
ds_read_b64_tr_b16 v[62:63], v17 offset:39936
v_mfma_f32_16x16x32_bf16 v[156:159], v[44:47], a[124:127], v[156:159]
s_waitcnt vmcnt(10) lgkmcnt(4)
v_mfma_f32_16x16x32_bf16 a[192:195], v[48:51], a[128:131], a[192:195]
ds_read_b64_tr_b16 v[40:41], v14 offset:36928
v_mfma_f32_16x16x32_bf16 a[192:195], v[52:55], a[144:147], a[192:195]
buffer_load_dwordx4 v[168:171], v20, s[24:27], s42 offen sc1
v_mfma_f32_16x16x32_bf16 a[196:199], v[48:51], a[132:135], a[196:199]
ds_read_b64_tr_b16 v[42:43], v14 offset:40000
v_mfma_f32_16x16x32_bf16 a[196:199], v[52:55], a[148:151], a[196:199]
v_mfma_f32_16x16x32_bf16 a[200:203], v[48:51], a[136:139], a[200:203]
ds_read_b64_tr_b16 v[44:45], v16 offset:36928
v_mfma_f32_16x16x32_bf16 a[200:203], v[52:55], a[152:155], a[200:203]
buffer_load_dwordx4 v[172:175], v21, s[24:27], s42 offen sc1
v_mfma_f32_16x16x32_bf16 a[204:207], v[48:51], a[140:143], a[204:207]
ds_read_b64_tr_b16 v[46:47], v16 offset:40000
v_mfma_f32_16x16x32_bf16 a[204:207], v[52:55], a[156:159], a[204:207]
s_waitcnt lgkmcnt(4)
v_mfma_f32_16x16x32_bf16 a[208:211], v[56:59], a[128:131], a[208:211]
s_add_u32 s42, s82, 4096
ds_read_b64_tr_b16 v[48:49], v15 offset:36928
v_mfma_f32_16x16x32_bf16 a[208:211], v[60:63], a[144:147], a[208:211]
buffer_load_dwordx4 v[176:179], v18, s[24:27], s42 offen sc1
v_mfma_f32_16x16x32_bf16 a[212:215], v[56:59], a[132:135], a[212:215]
ds_read_b64_tr_b16 v[50:51], v15 offset:40000
v_mfma_f32_16x16x32_bf16 a[212:215], v[60:63], a[148:151], a[212:215]
v_mfma_f32_16x16x32_bf16 a[216:219], v[56:59], a[136:139], a[216:219]
ds_read_b64_tr_b16 v[52:53], v17 offset:36928
v_mfma_f32_16x16x32_bf16 a[216:219], v[60:63], a[152:155], a[216:219]
buffer_load_dwordx4 v[180:183], v19, s[24:27], s42 offen sc1
v_mfma_f32_16x16x32_bf16 a[220:223], v[56:59], a[140:143], a[220:223]
ds_read_b64_tr_b16 v[54:55], v17 offset:40000
v_mfma_f32_16x16x32_bf16 a[220:223], v[60:63], a[156:159], a[220:223]
s_waitcnt lgkmcnt(4)
v_mfma_f32_16x16x32_bf16 a[224:227], v[40:43], a[128:131], a[224:227]
ds_read_b64_tr_b16 v[56:57], v14 offset:36992
v_mfma_f32_16x16x32_bf16 a[224:227], v[44:47], a[144:147], a[224:227]
buffer_load_dwordx4 v[184:187], v20, s[24:27], s42 offen sc1
v_mfma_f32_16x16x32_bf16 a[228:231], v[40:43], a[132:135], a[228:231]
ds_read_b64_tr_b16 v[58:59], v14 offset:40064
v_mfma_f32_16x16x32_bf16 a[228:231], v[44:47], a[148:151], a[228:231]
v_mfma_f32_16x16x32_bf16 a[232:235], v[40:43], a[136:139], a[232:235]
ds_read_b64_tr_b16 v[60:61], v16 offset:36992
v_mfma_f32_16x16x32_bf16 a[232:235], v[44:47], a[152:155], a[232:235]
v_mfma_f32_16x16x32_bf16 a[236:239], v[40:43], a[140:143], a[236:239]
ds_read_b64_tr_b16 v[62:63], v16 offset:40064
v_mfma_f32_16x16x32_bf16 a[236:239], v[44:47], a[156:159], a[236:239]
s_waitcnt lgkmcnt(4)
v_mfma_f32_16x16x32_bf16 a[240:243], v[48:51], a[128:131], a[240:243]
ds_read_b64_tr_b16 v[40:41], v15 offset:36992
v_mfma_f32_16x16x32_bf16 a[240:243], v[52:55], a[144:147], a[240:243]
buffer_load_dwordx4 v[188:191], v21, s[24:27], s42 offen sc1
v_mfma_f32_16x16x32_bf16 a[244:247], v[48:51], a[132:135], a[244:247]
ds_read_b64_tr_b16 v[42:43], v15 offset:40064
v_mfma_f32_16x16x32_bf16 a[244:247], v[52:55], a[148:151], a[244:247]
v_mfma_f32_16x16x32_bf16 a[248:251], v[48:51], a[136:139], a[248:251]
s_add_u32 s42, s83, 4096
ds_read_b64_tr_b16 v[44:45], v17 offset:36992
v_mfma_f32_16x16x32_bf16 a[248:251], v[52:55], a[152:155], a[248:251]
buffer_load_dwordx4 v[192:195], v18, s[24:27], s42 offen sc1
v_mfma_f32_16x16x32_bf16 a[252:255], v[48:51], a[140:143], a[252:255]
ds_read_b64_tr_b16 v[46:47], v17 offset:40064
v_mfma_f32_16x16x32_bf16 a[252:255], v[52:55], a[156:159], a[252:255]
s_waitcnt lgkmcnt(4)
v_mfma_f32_16x16x32_bf16 v[64:67], v[56:59], a[128:131], v[64:67]
ds_read_b64_tr_b16 v[48:49], v14 offset:37056
v_mfma_f32_16x16x32_bf16 v[64:67], v[60:63], a[144:147], v[64:67]
buffer_load_dwordx4 v[196:199], v19, s[24:27], s42 offen sc1
v_mfma_f32_16x16x32_bf16 v[68:71], v[56:59], a[132:135], v[68:71]
ds_read_b64_tr_b16 v[50:51], v14 offset:40128
v_mfma_f32_16x16x32_bf16 v[68:71], v[60:63], a[148:151], v[68:71]
buffer_load_dwordx4 v[200:203], v20, s[24:27], s42 offen sc1
v_mfma_f32_16x16x32_bf16 v[72:75], v[56:59], a[136:139], v[72:75]
ds_read_b64_tr_b16 v[52:53], v16 offset:37056
v_mfma_f32_16x16x32_bf16 v[72:75], v[60:63], a[152:155], v[72:75]
v_mfma_f32_16x16x32_bf16 v[76:79], v[56:59], a[140:143], v[76:79]
ds_read_b64_tr_b16 v[54:55], v16 offset:40128
v_mfma_f32_16x16x32_bf16 v[76:79], v[60:63], a[156:159], v[76:79]
s_waitcnt lgkmcnt(4)
v_mfma_f32_16x16x32_bf16 v[80:83], v[40:43], a[128:131], v[80:83]
ds_read_b64_tr_b16 v[56:57], v15 offset:37056
v_mfma_f32_16x16x32_bf16 v[80:83], v[44:47], a[144:147], v[80:83]
buffer_load_dwordx4 v[204:207], v21, s[24:27], s42 offen sc1
v_mfma_f32_16x16x32_bf16 v[84:87], v[40:43], a[132:135], v[84:87]
ds_read_b64_tr_b16 v[58:59], v15 offset:40128
v_mfma_f32_16x16x32_bf16 v[84:87], v[44:47], a[148:151], v[84:87]
v_mfma_f32_16x16x32_bf16 v[88:91], v[40:43], a[136:139], v[88:91]
s_add_u32 s42, s81, 4096
ds_read_b64_tr_b16 v[60:61], v17 offset:37056
v_mfma_f32_16x16x32_bf16 v[88:91], v[44:47], a[152:155], v[88:91]
buffer_load_dwordx4 v[208:211], v18, s[24:27], s42 offen offset:1024 sc1
v_mfma_f32_16x16x32_bf16 v[92:95], v[40:43], a[140:143], v[92:95]
ds_read_b64_tr_b16 v[62:63], v17 offset:40128
v_mfma_f32_16x16x32_bf16 v[92:95], v[44:47], a[156:159], v[92:95]
s_waitcnt lgkmcnt(4)
v_mfma_f32_16x16x32_bf16 v[96:99], v[48:51], a[128:131], v[96:99]
ds_read_b64_tr_b16 v[40:41], v14 offset:37120
v_mfma_f32_16x16x32_bf16 v[96:99], v[52:55], a[144:147], v[96:99]
buffer_load_dwordx4 v[212:215], v19, s[24:27], s42 offen offset:1024 sc1
v_mfma_f32_16x16x32_bf16 v[100:103], v[48:51], a[132:135], v[100:103]
ds_read_b64_tr_b16 v[42:43], v14 offset:40192
v_mfma_f32_16x16x32_bf16 v[100:103], v[52:55], a[148:151], v[100:103]
buffer_load_dwordx4 v[216:219], v20, s[24:27], s42 offen offset:1024 sc1
v_mfma_f32_16x16x32_bf16 v[104:107], v[48:51], a[136:139], v[104:107]
ds_read_b64_tr_b16 v[44:45], v16 offset:37120
v_mfma_f32_16x16x32_bf16 v[104:107], v[52:55], a[152:155], v[104:107]
v_mfma_f32_16x16x32_bf16 v[108:111], v[48:51], a[140:143], v[108:111]
ds_read_b64_tr_b16 v[46:47], v16 offset:40192
v_mfma_f32_16x16x32_bf16 v[108:111], v[52:55], a[156:159], v[108:111]
s_waitcnt lgkmcnt(4)
v_mfma_f32_16x16x32_bf16 v[112:115], v[56:59], a[128:131], v[112:115]
ds_read_b64_tr_b16 v[48:49], v15 offset:37120
v_mfma_f32_16x16x32_bf16 v[112:115], v[60:63], a[144:147], v[112:115]
ds_read_b64_tr_b16 v[50:51], v15 offset:40192
v_mfma_f32_16x16x32_bf16 v[116:119], v[56:59], a[132:135], v[116:119]
ds_read_b64_tr_b16 v[52:53], v17 offset:37120
v_mfma_f32_16x16x32_bf16 v[116:119], v[60:63], a[148:151], v[116:119]
ds_read_b64_tr_b16 v[54:55], v17 offset:40192
v_mfma_f32_16x16x32_bf16 v[120:123], v[56:59], a[136:139], v[120:123]
buffer_load_dwordx4 v[220:223], v21, s[24:27], s42 offen offset:1024 sc1
v_mfma_f32_16x16x32_bf16 v[120:123], v[60:63], a[152:155], v[120:123]
v_mfma_f32_16x16x32_bf16 v[124:127], v[56:59], a[140:143], v[124:127]
v_mfma_f32_16x16x32_bf16 v[124:127], v[60:63], a[156:159], v[124:127]
s_waitcnt lgkmcnt(4)
v_mfma_f32_16x16x32_bf16 v[128:131], v[40:43], a[128:131], v[128:131]
s_waitcnt lgkmcnt(0)
v_mfma_f32_16x16x32_bf16 v[128:131], v[44:47], a[144:147], v[128:131]
s_barrier
v_mfma_f32_16x16x32_bf16 v[132:135], v[40:43], a[132:135], v[132:135]
ds_read_b64_tr_b16 v[56:57], v14 offset:49152
v_mfma_f32_16x16x32_bf16 v[132:135], v[44:47], a[148:151], v[132:135]
ds_read_b64_tr_b16 v[58:59], v14 offset:52224
v_mfma_f32_16x16x32_bf16 v[136:139], v[40:43], a[136:139], v[136:139]
ds_read_b64_tr_b16 v[60:61], v16 offset:49152
v_mfma_f32_16x16x32_bf16 v[136:139], v[44:47], a[152:155], v[136:139]
s_add_u32 s42, s82, 4096
ds_read_b64_tr_b16 v[62:63], v16 offset:52224
v_mfma_f32_16x16x32_bf16 v[140:143], v[40:43], a[140:143], v[140:143]
buffer_load_dwordx4 v[224:227], v18, s[24:27], s42 offen offset:1024 sc1
v_mfma_f32_16x16x32_bf16 v[140:143], v[44:47], a[156:159], v[140:143]
v_mfma_f32_16x16x32_bf16 v[144:147], v[48:51], a[128:131], v[144:147]
ds_read_b64_tr_b16 v[40:41], v15 offset:49152
v_mfma_f32_16x16x32_bf16 v[144:147], v[52:55], a[144:147], v[144:147]
buffer_load_dwordx4 v[228:231], v19, s[24:27], s42 offen offset:1024 sc1
v_mfma_f32_16x16x32_bf16 v[148:151], v[48:51], a[132:135], v[148:151]
ds_read_b64_tr_b16 v[42:43], v15 offset:52224
v_mfma_f32_16x16x32_bf16 v[148:151], v[52:55], a[148:151], v[148:151]
buffer_load_dwordx4 v[232:235], v20, s[24:27], s42 offen offset:1024 sc1
v_mfma_f32_16x16x32_bf16 v[152:155], v[48:51], a[136:139], v[152:155]
ds_read_b64_tr_b16 v[44:45], v17 offset:49152
v_mfma_f32_16x16x32_bf16 v[152:155], v[52:55], a[152:155], v[152:155]
buffer_load_dwordx4 v[236:239], v21, s[24:27], s42 offen offset:1024 sc1
v_mfma_f32_16x16x32_bf16 v[156:159], v[48:51], a[140:143], v[156:159]
ds_read_b64_tr_b16 v[46:47], v17 offset:52224
v_mfma_f32_16x16x32_bf16 v[156:159], v[52:55], a[156:159], v[156:159]
s_waitcnt vmcnt(20) lgkmcnt(4)
v_mfma_f32_16x16x32_bf16 a[192:195], v[56:59], a[160:163], a[192:195]
s_add_u32 s42, s83, 4096
ds_read_b64_tr_b16 v[48:49], v14 offset:49216
v_mfma_f32_16x16x32_bf16 a[192:195], v[60:63], a[176:179], a[192:195]
buffer_load_dwordx4 v[240:243], v18, s[24:27], s42 offen offset:1024 sc1
v_mfma_f32_16x16x32_bf16 a[196:199], v[56:59], a[164:167], a[196:199]
ds_read_b64_tr_b16 v[50:51], v14 offset:52288
v_mfma_f32_16x16x32_bf16 a[196:199], v[60:63], a[180:183], a[196:199]
v_mfma_f32_16x16x32_bf16 a[200:203], v[56:59], a[168:171], a[200:203]
ds_read_b64_tr_b16 v[52:53], v16 offset:49216
v_mfma_f32_16x16x32_bf16 a[200:203], v[60:63], a[184:187], a[200:203]
buffer_load_dwordx4 v[244:247], v19, s[24:27], s42 offen offset:1024 sc1
v_mfma_f32_16x16x32_bf16 a[204:207], v[56:59], a[172:175], a[204:207]
ds_read_b64_tr_b16 v[54:55], v16 offset:52288
v_mfma_f32_16x16x32_bf16 a[204:207], v[60:63], a[188:191], a[204:207]
s_waitcnt lgkmcnt(4)
v_mfma_f32_16x16x32_bf16 a[208:211], v[40:43], a[160:163], a[208:211]
ds_read_b64_tr_b16 v[56:57], v15 offset:49216
v_mfma_f32_16x16x32_bf16 a[208:211], v[44:47], a[176:179], a[208:211]
buffer_load_dwordx4 v[248:251], v20, s[24:27], s42 offen offset:1024 sc1
v_mfma_f32_16x16x32_bf16 a[212:215], v[40:43], a[164:167], a[212:215]
ds_read_b64_tr_b16 v[58:59], v15 offset:52288
v_mfma_f32_16x16x32_bf16 a[212:215], v[44:47], a[180:183], a[212:215]
v_mfma_f32_16x16x32_bf16 a[216:219], v[40:43], a[168:171], a[216:219]
ds_read_b64_tr_b16 v[60:61], v17 offset:49216
v_mfma_f32_16x16x32_bf16 a[216:219], v[44:47], a[184:187], a[216:219]
buffer_load_dwordx4 v[252:255], v21, s[24:27], s42 offen offset:1024 sc1
v_mfma_f32_16x16x32_bf16 a[220:223], v[40:43], a[172:175], a[220:223]
ds_read_b64_tr_b16 v[62:63], v17 offset:52288
v_mfma_f32_16x16x32_bf16 a[220:223], v[44:47], a[188:191], a[220:223]
s_waitcnt lgkmcnt(4)
v_mfma_f32_16x16x32_bf16 a[224:227], v[48:51], a[160:163], a[224:227]
ds_read_b64_tr_b16 v[40:41], v14 offset:49280
v_mfma_f32_16x16x32_bf16 a[224:227], v[52:55], a[176:179], a[224:227]
v_mfma_f32_16x16x32_bf16 a[228:231], v[48:51], a[164:167], a[228:231]
ds_read_b64_tr_b16 v[42:43], v14 offset:52352
v_mfma_f32_16x16x32_bf16 a[228:231], v[52:55], a[180:183], a[228:231]
v_mfma_f32_16x16x32_bf16 a[232:235], v[48:51], a[168:171], a[232:235]
ds_read_b64_tr_b16 v[44:45], v16 offset:49280
v_mfma_f32_16x16x32_bf16 a[232:235], v[52:55], a[184:187], a[232:235]
v_mfma_f32_16x16x32_bf16 a[236:239], v[48:51], a[172:175], a[236:239]
ds_read_b64_tr_b16 v[46:47], v16 offset:52352
v_mfma_f32_16x16x32_bf16 a[236:239], v[52:55], a[188:191], a[236:239]
s_waitcnt lgkmcnt(4)
v_mfma_f32_16x16x32_bf16 a[240:243], v[56:59], a[160:163], a[240:243]
ds_read_b64_tr_b16 v[48:49], v15 offset:49280
v_mfma_f32_16x16x32_bf16 a[240:243], v[60:63], a[176:179], a[240:243]
v_mfma_f32_16x16x32_bf16 a[244:247], v[56:59], a[164:167], a[244:247]
ds_read_b64_tr_b16 v[50:51], v15 offset:52352
v_mfma_f32_16x16x32_bf16 a[244:247], v[60:63], a[180:183], a[244:247]
v_mfma_f32_16x16x32_bf16 a[248:251], v[56:59], a[168:171], a[248:251]
ds_read_b64_tr_b16 v[52:53], v17 offset:49280
v_mfma_f32_16x16x32_bf16 a[248:251], v[60:63], a[184:187], a[248:251]
v_mfma_f32_16x16x32_bf16 a[252:255], v[56:59], a[172:175], a[252:255]
ds_read_b64_tr_b16 v[54:55], v17 offset:52352
v_mfma_f32_16x16x32_bf16 a[252:255], v[60:63], a[188:191], a[252:255]
s_waitcnt lgkmcnt(4)
v_mfma_f32_16x16x32_bf16 v[64:67], v[40:43], a[160:163], v[64:67]
ds_read_b64_tr_b16 v[56:57], v14 offset:49344
v_mfma_f32_16x16x32_bf16 v[64:67], v[44:47], a[176:179], v[64:67]
v_mfma_f32_16x16x32_bf16 v[68:71], v[40:43], a[164:167], v[68:71]
ds_read_b64_tr_b16 v[58:59], v14 offset:52416
v_mfma_f32_16x16x32_bf16 v[68:71], v[44:47], a[180:183], v[68:71]
v_mfma_f32_16x16x32_bf16 v[72:75], v[40:43], a[168:171], v[72:75]
ds_read_b64_tr_b16 v[60:61], v16 offset:49344
v_mfma_f32_16x16x32_bf16 v[72:75], v[44:47], a[184:187], v[72:75]
v_mfma_f32_16x16x32_bf16 v[76:79], v[40:43], a[172:175], v[76:79]
ds_read_b64_tr_b16 v[62:63], v16 offset:52416
v_mfma_f32_16x16x32_bf16 v[76:79], v[44:47], a[188:191], v[76:79]
s_waitcnt lgkmcnt(4)
v_mfma_f32_16x16x32_bf16 v[80:83], v[48:51], a[160:163], v[80:83]
ds_read_b64_tr_b16 v[40:41], v15 offset:49344
v_mfma_f32_16x16x32_bf16 v[80:83], v[52:55], a[176:179], v[80:83]
v_mfma_f32_16x16x32_bf16 v[84:87], v[48:51], a[164:167], v[84:87]
ds_read_b64_tr_b16 v[42:43], v15 offset:52416
v_mfma_f32_16x16x32_bf16 v[84:87], v[52:55], a[180:183], v[84:87]
v_mfma_f32_16x16x32_bf16 v[88:91], v[48:51], a[168:171], v[88:91]
ds_read_b64_tr_b16 v[44:45], v17 offset:49344
v_mfma_f32_16x16x32_bf16 v[88:91], v[52:55], a[184:187], v[88:91]
v_mfma_f32_16x16x32_bf16 v[92:95], v[48:51], a[172:175], v[92:95]
ds_read_b64_tr_b16 v[46:47], v17 offset:52416
v_mfma_f32_16x16x32_bf16 v[92:95], v[52:55], a[188:191], v[92:95]
s_waitcnt lgkmcnt(4)
v_mfma_f32_16x16x32_bf16 v[96:99], v[56:59], a[160:163], v[96:99]
ds_read_b64_tr_b16 v[48:49], v14 offset:49408
v_mfma_f32_16x16x32_bf16 v[96:99], v[60:63], a[176:179], v[96:99]
v_mfma_f32_16x16x32_bf16 v[100:103], v[56:59], a[164:167], v[100:103]
ds_read_b64_tr_b16 v[50:51], v14 offset:52480
v_mfma_f32_16x16x32_bf16 v[100:103], v[60:63], a[180:183], v[100:103]
v_mfma_f32_16x16x32_bf16 v[104:107], v[56:59], a[168:171], v[104:107]
ds_read_b64_tr_b16 v[52:53], v16 offset:49408
v_mfma_f32_16x16x32_bf16 v[104:107], v[60:63], a[184:187], v[104:107]
v_mfma_f32_16x16x32_bf16 v[108:111], v[56:59], a[172:175], v[108:111]
ds_read_b64_tr_b16 v[54:55], v16 offset:52480
v_mfma_f32_16x16x32_bf16 v[108:111], v[60:63], a[188:191], v[108:111]
s_waitcnt lgkmcnt(4)
v_mfma_f32_16x16x32_bf16 v[112:115], v[40:43], a[160:163], v[112:115]
ds_read_b64_tr_b16 v[56:57], v15 offset:49408
v_mfma_f32_16x16x32_bf16 v[112:115], v[44:47], a[176:179], v[112:115]
ds_read_b64_tr_b16 v[58:59], v15 offset:52480
v_mfma_f32_16x16x32_bf16 v[116:119], v[40:43], a[164:167], v[116:119]
ds_read_b64_tr_b16 v[60:61], v17 offset:49408
v_mfma_f32_16x16x32_bf16 v[116:119], v[44:47], a[180:183], v[116:119]
ds_read_b64_tr_b16 v[62:63], v17 offset:52480
v_mfma_f32_16x16x32_bf16 v[120:123], v[40:43], a[168:171], v[120:123]
v_mfma_f32_16x16x32_bf16 v[120:123], v[44:47], a[184:187], v[120:123]
v_mfma_f32_16x16x32_bf16 v[124:127], v[40:43], a[172:175], v[124:127]
v_mfma_f32_16x16x32_bf16 v[124:127], v[44:47], a[188:191], v[124:127]
s_waitcnt lgkmcnt(4)
v_mfma_f32_16x16x32_bf16 v[128:131], v[48:51], a[160:163], v[128:131]
s_waitcnt lgkmcnt(0)
v_mfma_f32_16x16x32_bf16 v[128:131], v[52:55], a[176:179], v[128:131]
s_barrier
v_mfma_f32_16x16x32_bf16 v[132:135], v[48:51], a[164:167], v[132:135]
ds_read_b64_tr_b16 a[0:1], v14 offset:61440
ds_read_b64_tr_b16 a[2:3], v14 offset:64512
v_mfma_f32_16x16x32_bf16 v[132:135], v[52:55], a[180:183], v[132:135]
ds_read_b64_tr_b16 a[4:5], v16 offset:61440
ds_read_b64_tr_b16 a[6:7], v16 offset:64512
v_mfma_f32_16x16x32_bf16 v[136:139], v[48:51], a[168:171], v[136:139]
ds_read_b64_tr_b16 a[8:9], v14 offset:0
ds_read_b64_tr_b16 a[10:11], v14 offset:3072
v_mfma_f32_16x16x32_bf16 v[136:139], v[52:55], a[184:187], v[136:139]
ds_read_b64_tr_b16 a[12:13], v16 offset:0
ds_read_b64_tr_b16 a[14:15], v16 offset:3072
v_mfma_f32_16x16x32_bf16 v[140:143], v[48:51], a[172:175], v[140:143]
ds_read_b64_tr_b16 a[16:17], v14 offset:12288
ds_read_b64_tr_b16 a[18:19], v14 offset:15360
v_mfma_f32_16x16x32_bf16 v[140:143], v[52:55], a[188:191], v[140:143]
ds_read_b64_tr_b16 a[20:21], v16 offset:12288
ds_read_b64_tr_b16 a[22:23], v16 offset:15360
v_mfma_f32_16x16x32_bf16 v[144:147], v[56:59], a[160:163], v[144:147]
v_mfma_f32_16x16x32_bf16 v[144:147], v[60:63], a[176:179], v[144:147]
v_mfma_f32_16x16x32_bf16 v[148:151], v[56:59], a[164:167], v[148:151]
v_mfma_f32_16x16x32_bf16 v[148:151], v[60:63], a[180:183], v[148:151]
v_mfma_f32_16x16x32_bf16 v[152:155], v[56:59], a[168:171], v[152:155]
v_mfma_f32_16x16x32_bf16 v[152:155], v[60:63], a[184:187], v[152:155]
v_mfma_f32_16x16x32_bf16 v[156:159], v[56:59], a[172:175], v[156:159]
v_mfma_f32_16x16x32_bf16 v[156:159], v[60:63], a[188:191], v[156:159]
s_waitcnt vmcnt(0) lgkmcnt(8)
v_mfma_f32_16x16x32_bf16 a[192:195], a[0:3], v[160:163], a[192:195]
ds_read_b64_tr_b16 a[24:25], v15 offset:61440
v_and_b32 v2, 15, v0
v_mfma_f32_16x16x32_bf16 a[192:195], a[4:7], v[176:179], a[192:195]
s_waitcnt lgkmcnt(5)
ds_read_b64_tr_b16 a[26:27], v15 offset:64512
v_mul_u32_u24 v2, 1280, v2
v_mfma_f32_16x16x32_bf16 a[192:195], a[8:11], v[192:195], a[192:195]
ds_read_b64_tr_b16 a[28:29], v17 offset:61440
v_lshrrev_b32 v3, 5, v0
v_mfma_f32_16x16x32_bf16 a[192:195], a[12:15], v[208:211], a[192:195]
s_waitcnt lgkmcnt(3)
ds_read_b64_tr_b16 a[30:31], v17 offset:64512
v_bfe_u32 v4, v0, 4, 1
v_mfma_f32_16x16x32_bf16 a[192:195], a[16:19], v[224:227], a[192:195]
v_lshl_or_b32 v3, v4, 1, v3
v_lshl_add_u32 v2, v3, 4, v2
v_mfma_f32_16x16x32_bf16 a[192:195], a[20:23], v[240:243], a[192:195]
s_mov_b32 s40, 0
ds_read_b64_tr_b16 a[32:33], v15 offset:0
v_lshlrev_b32 v1, 4, v0
v_mfma_f32_16x16x32_bf16 a[196:199], a[0:3], v[164:167], a[196:199]
ds_read_b64_tr_b16 a[34:35], v15 offset:3072
v_add_u32 v3, 4096, v1
v_mfma_f32_16x16x32_bf16 a[196:199], a[4:7], v[180:183], a[196:199]
ds_read_b64_tr_b16 a[36:37], v17 offset:0
v_mfma_f32_16x16x32_bf16 a[196:199], a[8:11], v[196:199], a[196:199]
ds_read_b64_tr_b16 a[38:39], v17 offset:3072
v_mfma_f32_16x16x32_bf16 a[196:199], a[12:15], v[212:215], a[196:199]
v_mfma_f32_16x16x32_bf16 a[196:199], a[16:19], v[228:231], a[196:199]
ds_read_b64_tr_b16 a[40:41], v15 offset:12288
v_mfma_f32_16x16x32_bf16 a[196:199], a[20:23], v[244:247], a[196:199]
ds_read_b64_tr_b16 a[42:43], v15 offset:15360
v_mfma_f32_16x16x32_bf16 a[200:203], a[0:3], v[168:171], a[200:203]
ds_read_b64_tr_b16 a[44:45], v17 offset:12288
v_mfma_f32_16x16x32_bf16 a[200:203], a[4:7], v[184:187], a[200:203]
ds_read_b64_tr_b16 a[46:47], v17 offset:15360
v_mfma_f32_16x16x32_bf16 a[200:203], a[8:11], v[200:203], a[200:203]
v_mfma_f32_16x16x32_bf16 a[200:203], a[12:15], v[216:219], a[200:203]
ds_read_b64_tr_b16 a[48:49], v14 offset:61504
v_mfma_f32_16x16x32_bf16 a[200:203], a[16:19], v[232:235], a[200:203]
ds_read_b64_tr_b16 a[50:51], v14 offset:64576
v_mfma_f32_16x16x32_bf16 a[200:203], a[20:23], v[248:251], a[200:203]
ds_read_b64_tr_b16 a[52:53], v16 offset:61504
v_mfma_f32_16x16x32_bf16 a[204:207], a[0:3], v[172:175], a[204:207]
ds_read_b64_tr_b16 a[54:55], v16 offset:64576
v_mfma_f32_16x16x32_bf16 a[204:207], a[4:7], v[188:191], a[204:207]
v_mfma_f32_16x16x32_bf16 a[204:207], a[8:11], v[204:207], a[204:207]
ds_read_b64_tr_b16 a[56:57], v14 offset:64
v_mfma_f32_16x16x32_bf16 a[204:207], a[12:15], v[220:223], a[204:207]
ds_read_b64_tr_b16 a[58:59], v14 offset:3136
v_mfma_f32_16x16x32_bf16 a[204:207], a[16:19], v[236:239], a[204:207]
ds_read_b64_tr_b16 a[60:61], v16 offset:64
v_accvgpr_read_b32 v40, a192
v_mfma_f32_16x16x32_bf16 a[204:207], a[20:23], v[252:255], a[204:207]
s_waitcnt lgkmcnt(15)
ds_read_b64_tr_b16 a[62:63], v16 offset:3136
v_accvgpr_read_b32 v41, a193
v_mfma_f32_16x16x32_bf16 a[208:211], a[24:27], v[160:163], a[208:211]
v_accvgpr_read_b32 v42, a194
v_accvgpr_read_b32 v43, a195
v_mfma_f32_16x16x32_bf16 a[208:211], a[28:31], v[176:179], a[208:211]
s_waitcnt lgkmcnt(12)
ds_read_b64_tr_b16 a[64:65], v14 offset:12352
v_mfma_f32_16x16x32_bf16 a[208:211], a[32:35], v[192:195], a[208:211]
ds_read_b64_tr_b16 a[66:67], v14 offset:15424
v_mfma_f32_16x16x32_bf16 a[208:211], a[36:39], v[208:211], a[208:211]
s_waitcnt lgkmcnt(10)
ds_read_b64_tr_b16 a[68:69], v16 offset:12352
v_mfma_f32_16x16x32_bf16 a[208:211], a[40:43], v[224:227], a[208:211]
ds_read_b64_tr_b16 a[70:71], v16 offset:15424
v_mfma_f32_16x16x32_bf16 a[208:211], a[44:47], v[240:243], a[208:211]
v_mfma_f32_16x16x32_bf16 a[212:215], a[24:27], v[164:167], a[212:215]
ds_read_b64_tr_b16 a[72:73], v15 offset:61504
v_mfma_f32_16x16x32_bf16 a[212:215], a[28:31], v[180:183], a[212:215]
ds_read_b64_tr_b16 a[74:75], v15 offset:64576
v_mfma_f32_16x16x32_bf16 a[212:215], a[32:35], v[196:199], a[212:215]
ds_read_b64_tr_b16 a[76:77], v17 offset:61504
v_mfma_f32_16x16x32_bf16 a[212:215], a[36:39], v[212:215], a[212:215]
ds_read_b64_tr_b16 a[78:79], v17 offset:64576
v_mfma_f32_16x16x32_bf16 a[212:215], a[40:43], v[228:231], a[212:215]
v_accvgpr_read_b32 v44, a208
v_accvgpr_read_b32 v45, a209
v_mfma_f32_16x16x32_bf16 a[212:215], a[44:47], v[244:247], a[212:215]
ds_read_b64_tr_b16 a[80:81], v15 offset:64
v_accvgpr_read_b32 v46, a210
v_mfma_f32_16x16x32_bf16 a[216:219], a[24:27], v[168:171], a[216:219]
ds_read_b64_tr_b16 a[82:83], v15 offset:3136
v_accvgpr_read_b32 v47, a211
v_mfma_f32_16x16x32_bf16 a[216:219], a[28:31], v[184:187], a[216:219]
ds_read_b64_tr_b16 a[84:85], v17 offset:64
v_cvt_pk_bf16_f32 v40, v40, v41
v_mfma_f32_16x16x32_bf16 a[216:219], a[32:35], v[200:203], a[216:219]
ds_read_b64_tr_b16 a[86:87], v17 offset:3136
v_cvt_pk_bf16_f32 v41, v42, v43
v_mfma_f32_16x16x32_bf16 a[216:219], a[36:39], v[216:219], a[216:219]
v_cvt_pk_bf16_f32 v42, v44, v45
v_cvt_pk_bf16_f32 v43, v46, v47
v_mfma_f32_16x16x32_bf16 a[216:219], a[40:43], v[232:235], a[216:219]
KF_pg14:
s_cbranch_execz KF_tret
ds_read_b64_tr_b16 a[88:89], v15 offset:12352
v_mfma_f32_16x16x32_bf16 a[216:219], a[44:47], v[248:251], a[216:219]
ds_read_b64_tr_b16 a[90:91], v15 offset:15424
v_mfma_f32_16x16x32_bf16 a[220:223], a[24:27], v[172:175], a[220:223]
ds_read_b64_tr_b16 a[92:93], v17 offset:12352
v_mfma_f32_16x16x32_bf16 a[220:223], a[28:31], v[188:191], a[220:223]
ds_read_b64_tr_b16 a[94:95], v17 offset:15424
v_mfma_f32_16x16x32_bf16 a[220:223], a[32:35], v[204:207], a[220:223]
buffer_store_dwordx4 v[40:43], v31, s[68:71], s40 offen sc1
v_mfma_f32_16x16x32_bf16 a[220:223], a[36:39], v[220:223], a[220:223]
v_cndmask_b32 v56, v56, v40, s[8:9]
v_cndmask_b32 v57, v57, v41, s[8:9]
v_mfma_f32_16x16x32_bf16 a[220:223], a[40:43], v[236:239], a[220:223]
v_cndmask_b32 v58, v58, v42, s[8:9]
v_cndmask_b32 v59, v59, v43, s[8:9]
v_mfma_f32_16x16x32_bf16 a[220:223], a[44:47], v[252:255], a[220:223]
s_waitcnt lgkmcnt(15)
v_accvgpr_read_b32 v48, a196
v_accvgpr_read_b32 v49, a197
v_mfma_f32_16x16x32_bf16 a[224:227], a[48:51], v[160:163], a[224:227]
ds_read_b64_tr_b16 a[0:1], v14 offset:61568
v_accvgpr_read_b32 v50, a198
v_mfma_f32_16x16x32_bf16 a[224:227], a[52:55], v[176:179], a[224:227]
ds_read_b64_tr_b16 a[2:3], v14 offset:64640
v_accvgpr_read_b32 v51, a199
v_mfma_f32_16x16x32_bf16 a[224:227], a[56:59], v[192:195], a[224:227]
v_accvgpr_read_b32 v52, a212
v_accvgpr_read_b32 v53, a213
v_mfma_f32_16x16x32_bf16 a[224:227], a[60:63], v[208:211], a[224:227]
s_waitcnt lgkmcnt(14)
ds_read_b64_tr_b16 a[4:5], v16 offset:61568
v_accvgpr_read_b32 v54, a214
v_mfma_f32_16x16x32_bf16 a[224:227], a[64:67], v[224:227], a[224:227]
v_accvgpr_read_b32 v55, a215
v_cvt_pk_bf16_f32 v48, v48, v49
v_mfma_f32_16x16x32_bf16 a[224:227], a[68:71], v[240:243], a[224:227]
s_waitcnt lgkmcnt(11)
ds_read_b64_tr_b16 a[6:7], v16 offset:64640
v_cvt_pk_bf16_f32 v49, v50, v51
v_mfma_f32_16x16x32_bf16 a[240:243], a[72:75], v[160:163], a[240:243]
v_cvt_pk_bf16_f32 v50, v52, v53
v_cvt_pk_bf16_f32 v51, v54, v55
v_mfma_f32_16x16x32_bf16 a[240:243], a[76:79], v[176:179], a[240:243]
s_waitcnt lgkmcnt(8)
ds_read_b64_tr_b16 a[8:9], v14 offset:128
v_mfma_f32_16x16x32_bf16 a[240:243], a[80:83], v[192:195], a[240:243]
buffer_store_dwordx4 v[48:51], v32, s[68:71], s40 offen sc1
v_mfma_f32_16x16x32_bf16 a[240:243], a[84:87], v[208:211], a[240:243]
s_waitcnt lgkmcnt(5)
ds_read_b64_tr_b16 a[10:11], v14 offset:3200
v_cndmask_b32 v56, v56, v48, s[10:11]
v_mfma_f32_16x16x32_bf16 a[240:243], a[88:91], v[224:227], a[240:243]
v_cndmask_b32 v57, v57, v49, s[10:11]
v_cndmask_b32 v58, v58, v50, s[10:11]
v_mfma_f32_16x16x32_bf16 a[240:243], a[92:95], v[240:243], a[240:243]
ds_read_b64_tr_b16 a[12:13], v16 offset:128
v_cndmask_b32 v59, v59, v51, s[10:11]
v_mfma_f32_16x16x32_bf16 a[228:231], a[48:51], v[164:167], a[228:231]
v_accvgpr_read_b32 v40, a200
v_accvgpr_read_b32 v41, a201
v_mfma_f32_16x16x32_bf16 a[228:231], a[52:55], v[180:183], a[228:231]
ds_read_b64_tr_b16 a[14:15], v16 offset:3200
v_accvgpr_read_b32 v42, a202
v_mfma_f32_16x16x32_bf16 a[228:231], a[56:59], v[196:199], a[228:231]
v_accvgpr_read_b32 v43, a203
v_accvgpr_read_b32 v44, a216
v_mfma_f32_16x16x32_bf16 a[228:231], a[60:63], v[212:215], a[228:231]
ds_read_b64_tr_b16 a[16:17], v14 offset:12416
v_accvgpr_read_b32 v45, a217
v_mfma_f32_16x16x32_bf16 a[228:231], a[64:67], v[228:231], a[228:231]
ds_read_b64_tr_b16 a[18:19], v14 offset:15488
v_accvgpr_read_b32 v46, a218
v_mfma_f32_16x16x32_bf16 a[228:231], a[68:71], v[244:247], a[228:231]
v_accvgpr_read_b32 v47, a219
v_cvt_pk_bf16_f32 v40, v40, v41
v_mfma_f32_16x16x32_bf16 a[244:247], a[72:75], v[164:167], a[244:247]
ds_read_b64_tr_b16 a[20:21], v16 offset:12416
v_cvt_pk_bf16_f32 v41, v42, v43
v_mfma_f32_16x16x32_bf16 a[244:247], a[76:79], v[180:183], a[244:247]
v_cvt_pk_bf16_f32 v42, v44, v45
v_cvt_pk_bf16_f32 v43, v46, v47
v_mfma_f32_16x16x32_bf16 a[244:247], a[80:83], v[196:199], a[244:247]
ds_read_b64_tr_b16 a[22:23], v16 offset:15488
v_mfma_f32_16x16x32_bf16 a[244:247], a[84:87], v[212:215], a[244:247]
buffer_store_dwordx4 v[40:43], v33, s[68:71], s40 offen sc1
v_mfma_f32_16x16x32_bf16 a[244:247], a[88:91], v[228:231], a[244:247]
ds_read_b64_tr_b16 a[24:25], v15 offset:61568
v_cndmask_b32 v56, v56, v40, s[12:13]
v_mfma_f32_16x16x32_bf16 a[244:247], a[92:95], v[244:247], a[244:247]
v_cndmask_b32 v57, v57, v41, s[12:13]
v_cndmask_b32 v58, v58, v42, s[12:13]
v_mfma_f32_16x16x32_bf16 a[232:235], a[48:51], v[168:171], a[232:235]
ds_read_b64_tr_b16 a[26:27], v15 offset:64640
v_cndmask_b32 v59, v59, v43, s[12:13]
v_mfma_f32_16x16x32_bf16 a[232:235], a[52:55], v[184:187], a[232:235]
v_accvgpr_read_b32 v48, a204
v_accvgpr_read_b32 v49, a205
v_mfma_f32_16x16x32_bf16 a[232:235], a[56:59], v[200:203], a[232:235]
ds_read_b64_tr_b16 a[28:29], v17 offset:61568
v_accvgpr_read_b32 v50, a206
v_mfma_f32_16x16x32_bf16 a[232:235], a[60:63], v[216:219], a[232:235]
v_accvgpr_read_b32 v51, a207
v_accvgpr_read_b32 v52, a220
v_mfma_f32_16x16x32_bf16 a[232:235], a[64:67], v[232:235], a[232:235]
ds_read_b64_tr_b16 a[30:31], v17 offset:64640
v_accvgpr_read_b32 v53, a221
v_mfma_f32_16x16x32_bf16 a[232:235], a[68:71], v[248:251], a[232:235]
v_accvgpr_read_b32 v54, a222
v_accvgpr_read_b32 v55, a223
v_mfma_f32_16x16x32_bf16 a[248:251], a[72:75], v[168:171], a[248:251]
ds_read_b64_tr_b16 a[32:33], v15 offset:128
v_cvt_pk_bf16_f32 v48, v48, v49
v_mfma_f32_16x16x32_bf16 a[248:251], a[76:79], v[184:187], a[248:251]
ds_read_b64_tr_b16 a[34:35], v15 offset:3200
v_cvt_pk_bf16_f32 v49, v50, v51
v_mfma_f32_16x16x32_bf16 a[248:251], a[80:83], v[200:203], a[248:251]
v_cvt_pk_bf16_f32 v50, v52, v53
v_cvt_pk_bf16_f32 v51, v54, v55
v_mfma_f32_16x16x32_bf16 a[248:251], a[84:87], v[216:219], a[248:251]
ds_read_b64_tr_b16 a[36:37], v17 offset:128
v_mfma_f32_16x16x32_bf16 a[248:251], a[88:91], v[232:235], a[248:251]
buffer_store_dwordx4 v[48:51], v34, s[68:71], s40 offen sc1
v_mfma_f32_16x16x32_bf16 a[248:251], a[92:95], v[248:251], a[248:251]
ds_read_b64_tr_b16 a[38:39], v17 offset:3200
v_cndmask_b32 v56, v56, v48, s[14:15]
v_mfma_f32_16x16x32_bf16 a[236:239], a[48:51], v[172:175], a[236:239]
v_cndmask_b32 v57, v57, v49, s[14:15]
v_cndmask_b32 v58, v58, v50, s[14:15]
v_mfma_f32_16x16x32_bf16 a[236:239], a[52:55], v[188:191], a[236:239]
s_mov_b32 s40, 122880
ds_read_b64_tr_b16 a[40:41], v15 offset:12416
v_cndmask_b32 v59, v59, v51, s[14:15]
v_mfma_f32_16x16x32_bf16 a[236:239], a[56:59], v[204:207], a[236:239]
v_accvgpr_read_b32 v40, a224
v_accvgpr_read_b32 v41, a225
v_mfma_f32_16x16x32_bf16 a[236:239], a[60:63], v[220:223], a[236:239]
ds_read_b64_tr_b16 a[42:43], v15 offset:15488
v_accvgpr_read_b32 v42, a226
v_mfma_f32_16x16x32_bf16 a[236:239], a[64:67], v[236:239], a[236:239]
v_accvgpr_read_b32 v43, a227
v_accvgpr_read_b32 v44, a240
v_mfma_f32_16x16x32_bf16 a[236:239], a[68:71], v[252:255], a[236:239]
ds_read_b64_tr_b16 a[44:45], v17 offset:12416
v_accvgpr_read_b32 v45, a241
v_mfma_f32_16x16x32_bf16 a[252:255], a[72:75], v[172:175], a[252:255]
v_accvgpr_read_b32 v46, a242
v_accvgpr_read_b32 v47, a243
v_mfma_f32_16x16x32_bf16 a[252:255], a[76:79], v[188:191], a[252:255]
ds_read_b64_tr_b16 a[46:47], v17 offset:15488
v_cvt_pk_bf16_f32 v40, v40, v41
v_mfma_f32_16x16x32_bf16 a[252:255], a[80:83], v[204:207], a[252:255]
v_cvt_pk_bf16_f32 v41, v42, v43
v_cvt_pk_bf16_f32 v42, v44, v45
v_mfma_f32_16x16x32_bf16 a[252:255], a[84:87], v[220:223], a[252:255]
v_cvt_pk_bf16_f32 v43, v46, v47
v_mfma_f32_16x16x32_bf16 a[252:255], a[88:91], v[236:239], a[252:255]
buffer_store_dwordx4 v[40:43], v10, s[68:71], s40 offen sc1
v_mfma_f32_16x16x32_bf16 a[252:255], a[92:95], v[252:255], a[252:255]
s_waitcnt lgkmcnt(15)
v_cndmask_b32 v56, v56, v40, s[16:17]
v_cndmask_b32 v57, v57, v41, s[16:17]
v_mfma_f32_16x16x32_bf16 v[64:67], a[0:3], v[160:163], v[64:67]
ds_read_b64_tr_b16 a[48:49], v14 offset:61632
v_cndmask_b32 v58, v58, v42, s[16:17]
v_mfma_f32_16x16x32_bf16 v[64:67], a[4:7], v[176:179], v[64:67]
ds_read_b64_tr_b16 a[50:51], v14 offset:64704
v_cndmask_b32 v59, v59, v43, s[16:17]
v_mfma_f32_16x16x32_bf16 v[64:67], a[8:11], v[192:195], v[64:67]
v_accvgpr_read_b32 v48, a228
v_accvgpr_read_b32 v49, a229
v_mfma_f32_16x16x32_bf16 v[64:67], a[12:15], v[208:211], v[64:67]
s_waitcnt lgkmcnt(14)
ds_read_b64_tr_b16 a[52:53], v16 offset:61632
v_accvgpr_read_b32 v50, a230
v_mfma_f32_16x16x32_bf16 v[64:67], a[16:19], v[224:227], v[64:67]
v_accvgpr_read_b32 v51, a231
v_accvgpr_read_b32 v52, a244
v_mfma_f32_16x16x32_bf16 v[64:67], a[20:23], v[240:243], v[64:67]
s_waitcnt lgkmcnt(11)
ds_read_b64_tr_b16 a[54:55], v16 offset:64704
v_accvgpr_read_b32 v53, a245
v_mfma_f32_16x16x32_bf16 v[80:83], a[24:27], v[160:163], v[80:83]
v_accvgpr_read_b32 v54, a246
v_accvgpr_read_b32 v55, a247
v_mfma_f32_16x16x32_bf16 v[80:83], a[28:31], v[176:179], v[80:83]
s_waitcnt lgkmcnt(8)
ds_read_b64_tr_b16 a[56:57], v14 offset:192
v_cvt_pk_bf16_f32 v48, v48, v49
v_mfma_f32_16x16x32_bf16 v[80:83], a[32:35], v[192:195], v[80:83]
v_cvt_pk_bf16_f32 v49, v50, v51
v_cvt_pk_bf16_f32 v50, v52, v53
v_mfma_f32_16x16x32_bf16 v[80:83], a[36:39], v[208:211], v[80:83]
s_waitcnt lgkmcnt(5)
ds_read_b64_tr_b16 a[58:59], v14 offset:3264
v_cvt_pk_bf16_f32 v51, v54, v55
v_mfma_f32_16x16x32_bf16 v[80:83], a[40:43], v[224:227], v[80:83]
buffer_store_dwordx4 v[48:51], v11, s[68:71], s40 offen sc1
v_mfma_f32_16x16x32_bf16 v[80:83], a[44:47], v[240:243], v[80:83]
ds_read_b64_tr_b16 a[60:61], v16 offset:192
v_cndmask_b32 v56, v56, v48, s[18:19]
v_mfma_f32_16x16x32_bf16 v[68:71], a[0:3], v[164:167], v[68:71]
v_cndmask_b32 v57, v57, v49, s[18:19]
v_cndmask_b32 v58, v58, v50, s[18:19]
v_mfma_f32_16x16x32_bf16 v[68:71], a[4:7], v[180:183], v[68:71]
ds_read_b64_tr_b16 a[62:63], v16 offset:3264
v_cndmask_b32 v59, v59, v51, s[18:19]
v_mfma_f32_16x16x32_bf16 v[68:71], a[8:11], v[196:199], v[68:71]
v_accvgpr_read_b32 v40, a232
v_accvgpr_read_b32 v41, a233
v_mfma_f32_16x16x32_bf16 v[68:71], a[12:15], v[212:215], v[68:71]
ds_read_b64_tr_b16 a[64:65], v14 offset:12480
v_accvgpr_read_b32 v42, a234
v_mfma_f32_16x16x32_bf16 v[68:71], a[16:19], v[228:231], v[68:71]
ds_read_b64_tr_b16 a[66:67], v14 offset:15552
v_accvgpr_read_b32 v43, a235
v_mfma_f32_16x16x32_bf16 v[68:71], a[20:23], v[244:247], v[68:71]
v_accvgpr_read_b32 v44, a248
v_accvgpr_read_b32 v45, a249
v_mfma_f32_16x16x32_bf16 v[84:87], a[24:27], v[164:167], v[84:87]
ds_read_b64_tr_b16 a[68:69], v16 offset:12480
v_accvgpr_read_b32 v46, a250
v_mfma_f32_16x16x32_bf16 v[84:87], a[28:31], v[180:183], v[84:87]
v_accvgpr_read_b32 v47, a251
v_cvt_pk_bf16_f32 v40, v40, v41
v_mfma_f32_16x16x32_bf16 v[84:87], a[32:35], v[196:199], v[84:87]
ds_read_b64_tr_b16 a[70:71], v16 offset:15552
v_cvt_pk_bf16_f32 v41, v42, v43
v_mfma_f32_16x16x32_bf16 v[84:87], a[36:39], v[212:215], v[84:87]
v_cvt_pk_bf16_f32 v42, v44, v45
v_cvt_pk_bf16_f32 v43, v46, v47
v_mfma_f32_16x16x32_bf16 v[84:87], a[40:43], v[228:231], v[84:87]
ds_read_b64_tr_b16 a[72:73], v15 offset:61632
v_mfma_f32_16x16x32_bf16 v[84:87], a[44:47], v[244:247], v[84:87]
v_mfma_f32_16x16x32_bf16 v[72:75], a[0:3], v[168:171], v[72:75]
ds_read_b64_tr_b16 a[74:75], v15 offset:64704
v_mfma_f32_16x16x32_bf16 v[72:75], a[4:7], v[184:187], v[72:75]
buffer_store_dwordx4 v[40:43], v12, s[68:71], s40 offen sc1
v_mfma_f32_16x16x32_bf16 v[72:75], a[8:11], v[200:203], v[72:75]
ds_read_b64_tr_b16 a[76:77], v17 offset:61632
v_cndmask_b32 v56, v56, v40, s[20:21]
v_mfma_f32_16x16x32_bf16 v[72:75], a[12:15], v[216:219], v[72:75]
v_cndmask_b32 v57, v57, v41, s[20:21]
v_cndmask_b32 v58, v58, v42, s[20:21]
v_mfma_f32_16x16x32_bf16 v[72:75], a[16:19], v[232:235], v[72:75]
ds_read_b64_tr_b16 a[78:79], v17 offset:64704
v_cndmask_b32 v59, v59, v43, s[20:21]
v_mfma_f32_16x16x32_bf16 v[72:75], a[20:23], v[248:251], v[72:75]
v_accvgpr_read_b32 v48, a236
v_accvgpr_read_b32 v49, a237
v_mfma_f32_16x16x32_bf16 v[88:91], a[24:27], v[168:171], v[88:91]
ds_read_b64_tr_b16 a[80:81], v15 offset:192
v_accvgpr_read_b32 v50, a238
v_mfma_f32_16x16x32_bf16 v[88:91], a[28:31], v[184:187], v[88:91]
ds_read_b64_tr_b16 a[82:83], v15 offset:3264
v_accvgpr_read_b32 v51, a239
v_mfma_f32_16x16x32_bf16 v[88:91], a[32:35], v[200:203], v[88:91]
v_accvgpr_read_b32 v52, a252
v_accvgpr_read_b32 v53, a253
v_mfma_f32_16x16x32_bf16 v[88:91], a[36:39], v[216:219], v[88:91]
ds_read_b64_tr_b16 a[84:85], v17 offset:192
v_accvgpr_read_b32 v54, a254
v_mfma_f32_16x16x32_bf16 v[88:91], a[40:43], v[232:235], v[88:91]
v_accvgpr_read_b32 v55, a255
v_cvt_pk_bf16_f32 v48, v48, v49
v_mfma_f32_16x16x32_bf16 v[88:91], a[44:47], v[248:251], v[88:91]
ds_read_b64_tr_b16 a[86:87], v17 offset:3264
v_cvt_pk_bf16_f32 v49, v50, v51
v_mfma_f32_16x16x32_bf16 v[76:79], a[0:3], v[172:175], v[76:79]
v_cvt_pk_bf16_f32 v50, v52, v53
v_cvt_pk_bf16_f32 v51, v54, v55
v_mfma_f32_16x16x32_bf16 v[76:79], a[4:7], v[188:191], v[76:79]
ds_read_b64_tr_b16 a[88:89], v15 offset:12480
v_mfma_f32_16x16x32_bf16 v[76:79], a[8:11], v[204:207], v[76:79]
buffer_store_dwordx4 v[48:51], v13, s[68:71], s40 offen sc1
v_mfma_f32_16x16x32_bf16 v[76:79], a[12:15], v[220:223], v[76:79]
ds_read_b64_tr_b16 a[90:91], v15 offset:15552
v_cndmask_b32 v56, v56, v48, s[22:23]
v_mfma_f32_16x16x32_bf16 v[76:79], a[16:19], v[236:239], v[76:79]
v_cndmask_b32 v57, v57, v49, s[22:23]
v_cndmask_b32 v58, v58, v50, s[22:23]
v_mfma_f32_16x16x32_bf16 v[76:79], a[20:23], v[252:255], v[76:79]
s_mov_b32 s40, 245760
ds_read_b64_tr_b16 a[92:93], v17 offset:12480
v_cndmask_b32 v59, v59, v51, s[22:23]
v_mfma_f32_16x16x32_bf16 v[92:95], a[24:27], v[172:175], v[92:95]
v_cvt_pk_bf16_f32 v64, v64, v65
v_cvt_pk_bf16_f32 v65, v66, v67
v_mfma_f32_16x16x32_bf16 v[92:95], a[28:31], v[188:191], v[92:95]
ds_read_b64_tr_b16 a[94:95], v17 offset:15552
v_cvt_pk_bf16_f32 v66, v80, v81
v_mfma_f32_16x16x32_bf16 v[92:95], a[32:35], v[204:207], v[92:95]
v_cvt_pk_bf16_f32 v67, v82, v83
v_mfma_f32_16x16x32_bf16 v[92:95], a[36:39], v[220:223], v[92:95]
buffer_store_dwordx4 v[64:67], v31, s[68:71], s40 offen sc1
v_mfma_f32_16x16x32_bf16 v[92:95], a[40:43], v[236:239], v[92:95]
v_cvt_pk_bf16_f32 v68, v68, v69
v_cvt_pk_bf16_f32 v69, v70, v71
v_mfma_f32_16x16x32_bf16 v[92:95], a[44:47], v[252:255], v[92:95]
s_waitcnt lgkmcnt(15)
v_cvt_pk_bf16_f32 v70, v84, v85
v_cvt_pk_bf16_f32 v71, v86, v87
v_mfma_f32_16x16x32_bf16 v[96:99], a[48:51], v[160:163], v[96:99]
ds_read_b64_tr_b16 a[0:1], v14 offset:61696
v_mfma_f32_16x16x32_bf16 v[96:99], a[52:55], v[176:179], v[96:99]
ds_read_b64_tr_b16 a[2:3], v14 offset:64768
v_mfma_f32_16x16x32_bf16 v[96:99], a[56:59], v[192:195], v[96:99]
buffer_store_dwordx4 v[68:71], v32, s[68:71], s40 offen sc1
v_mfma_f32_16x16x32_bf16 v[96:99], a[60:63], v[208:211], v[96:99]
s_waitcnt lgkmcnt(14)
ds_read_b64_tr_b16 a[4:5], v16 offset:61696
v_cvt_pk_bf16_f32 v72, v72, v73
v_mfma_f32_16x16x32_bf16 v[96:99], a[64:67], v[224:227], v[96:99]
v_cvt_pk_bf16_f32 v73, v74, v75
v_cvt_pk_bf16_f32 v74, v88, v89
v_mfma_f32_16x16x32_bf16 v[96:99], a[68:71], v[240:243], v[96:99]
s_waitcnt lgkmcnt(11)
ds_read_b64_tr_b16 a[6:7], v16 offset:64768
v_cvt_pk_bf16_f32 v75, v90, v91
v_mfma_f32_16x16x32_bf16 v[112:115], a[72:75], v[160:163], v[112:115]
buffer_store_dwordx4 v[72:75], v33, s[68:71], s40 offen sc1
v_mfma_f32_16x16x32_bf16 v[112:115], a[76:79], v[176:179], v[112:115]
s_waitcnt lgkmcnt(8)
ds_read_b64_tr_b16 a[8:9], v14 offset:256
v_cvt_pk_bf16_f32 v76, v76, v77
v_mfma_f32_16x16x32_bf16 v[112:115], a[80:83], v[192:195], v[112:115]
v_cvt_pk_bf16_f32 v77, v78, v79
v_cvt_pk_bf16_f32 v78, v92, v93
v_mfma_f32_16x16x32_bf16 v[112:115], a[84:87], v[208:211], v[112:115]
s_waitcnt lgkmcnt(5)
ds_read_b64_tr_b16 a[10:11], v14 offset:3328
v_cvt_pk_bf16_f32 v79, v94, v95
v_mfma_f32_16x16x32_bf16 v[112:115], a[88:91], v[224:227], v[112:115]
buffer_store_dwordx4 v[76:79], v34, s[68:71], s40 offen sc1
v_mfma_f32_16x16x32_bf16 v[112:115], a[92:95], v[240:243], v[112:115]
s_mov_b32 s40, 368640
ds_read_b64_tr_b16 a[12:13], v16 offset:256
v_cvt_pk_bf16_f32 v96, v96, v97
v_mfma_f32_16x16x32_bf16 v[100:103], a[48:51], v[164:167], v[100:103]
v_cvt_pk_bf16_f32 v97, v98, v99
v_mfma_f32_16x16x32_bf16 v[100:103], a[52:55], v[180:183], v[100:103]
ds_read_b64_tr_b16 a[14:15], v16 offset:3328
v_mfma_f32_16x16x32_bf16 v[100:103], a[56:59], v[196:199], v[100:103]
v_mfma_f32_16x16x32_bf16 v[100:103], a[60:63], v[212:215], v[100:103]
ds_read_b64_tr_b16 a[16:17], v14 offset:12544
v_mfma_f32_16x16x32_bf16 v[100:103], a[64:67], v[228:231], v[100:103]
ds_read_b64_tr_b16 a[18:19], v14 offset:15616
v_cvt_pk_bf16_f32 v98, v112, v113
v_mfma_f32_16x16x32_bf16 v[100:103], a[68:71], v[244:247], v[100:103]
v_cvt_pk_bf16_f32 v99, v114, v115
v_mfma_f32_16x16x32_bf16 v[116:119], a[72:75], v[164:167], v[116:119]
ds_read_b64_tr_b16 a[20:21], v16 offset:12544
v_mfma_f32_16x16x32_bf16 v[116:119], a[76:79], v[180:183], v[116:119]
buffer_store_dwordx4 v[96:99], v10, s[68:71], s40 offen sc1
v_mfma_f32_16x16x32_bf16 v[116:119], a[80:83], v[196:199], v[116:119]
ds_read_b64_tr_b16 a[22:23], v16 offset:15616
v_mfma_f32_16x16x32_bf16 v[116:119], a[84:87], v[212:215], v[116:119]
v_mfma_f32_16x16x32_bf16 v[116:119], a[88:91], v[228:231], v[116:119]
ds_read_b64_tr_b16 a[24:25], v15 offset:61696
v_cvt_pk_bf16_f32 v100, v100, v101
v_mfma_f32_16x16x32_bf16 v[116:119], a[92:95], v[244:247], v[116:119]
v_cvt_pk_bf16_f32 v101, v102, v103
v_mfma_f32_16x16x32_bf16 v[104:107], a[48:51], v[168:171], v[104:107]
ds_read_b64_tr_b16 a[26:27], v15 offset:64768
v_mfma_f32_16x16x32_bf16 v[104:107], a[52:55], v[184:187], v[104:107]
v_mfma_f32_16x16x32_bf16 v[104:107], a[56:59], v[200:203], v[104:107]
ds_read_b64_tr_b16 a[28:29], v17 offset:61696
v_mfma_f32_16x16x32_bf16 v[104:107], a[60:63], v[216:219], v[104:107]
v_mfma_f32_16x16x32_bf16 v[104:107], a[64:67], v[232:235], v[104:107]
ds_read_b64_tr_b16 a[30:31], v17 offset:64768
v_cvt_pk_bf16_f32 v102, v116, v117
v_mfma_f32_16x16x32_bf16 v[104:107], a[68:71], v[248:251], v[104:107]
v_cvt_pk_bf16_f32 v103, v118, v119
v_mfma_f32_16x16x32_bf16 v[120:123], a[72:75], v[168:171], v[120:123]
ds_read_b64_tr_b16 a[32:33], v15 offset:256
v_mfma_f32_16x16x32_bf16 v[120:123], a[76:79], v[184:187], v[120:123]
ds_read_b64_tr_b16 a[34:35], v15 offset:3328
v_mfma_f32_16x16x32_bf16 v[120:123], a[80:83], v[200:203], v[120:123]
buffer_store_dwordx4 v[100:103], v11, s[68:71], s40 offen sc1
v_mfma_f32_16x16x32_bf16 v[120:123], a[84:87], v[216:219], v[120:123]
ds_read_b64_tr_b16 a[36:37], v17 offset:256
v_mfma_f32_16x16x32_bf16 v[120:123], a[88:91], v[232:235], v[120:123]
v_cvt_pk_bf16_f32 v104, v104, v105
v_cvt_pk_bf16_f32 v105, v106, v107
v_mfma_f32_16x16x32_bf16 v[120:123], a[92:95], v[248:251], v[120:123]
ds_read_b64_tr_b16 a[38:39], v17 offset:3328
v_mfma_f32_16x16x32_bf16 v[108:111], a[48:51], v[172:175], v[108:111]
s_waitcnt vmcnt(6)
v_mov_b32 v7, 1
v_mfma_f32_16x16x32_bf16 v[108:111], a[52:55], v[188:191], v[108:111]
s_barrier
ds_read_b64_tr_b16 a[40:41], v15 offset:12544
v_mfma_f32_16x16x32_bf16 v[108:111], a[56:59], v[204:207], v[108:111]
buffer_store_dwordx4 v[6:9], v37, s[56:59], 0 offen sc1
v_mfma_f32_16x16x32_bf16 v[108:111], a[60:63], v[220:223], v[108:111]
ds_read_b64_tr_b16 a[42:43], v15 offset:15616
v_mfma_f32_16x16x32_bf16 v[108:111], a[64:67], v[236:239], v[108:111]
v_cvt_pk_bf16_f32 v106, v120, v121
v_cvt_pk_bf16_f32 v107, v122, v123
v_mfma_f32_16x16x32_bf16 v[108:111], a[68:71], v[252:255], v[108:111]
ds_read_b64_tr_b16 a[44:45], v17 offset:12544
v_mfma_f32_16x16x32_bf16 v[124:127], a[72:75], v[172:175], v[124:127]
buffer_store_dwordx4 v[104:107], v12, s[68:71], s40 offen sc1
v_mfma_f32_16x16x32_bf16 v[124:127], a[76:79], v[188:191], v[124:127]
ds_read_b64_tr_b16 a[46:47], v17 offset:15616
v_mfma_f32_16x16x32_bf16 v[124:127], a[80:83], v[204:207], v[124:127]
v_mfma_f32_16x16x32_bf16 v[124:127], a[84:87], v[220:223], v[124:127]
v_mfma_f32_16x16x32_bf16 v[124:127], a[88:91], v[236:239], v[124:127]
v_cvt_pk_bf16_f32 v108, v108, v109
v_cvt_pk_bf16_f32 v109, v110, v111
v_mfma_f32_16x16x32_bf16 v[124:127], a[92:95], v[252:255], v[124:127]
s_waitcnt lgkmcnt(15)
v_mfma_f32_16x16x32_bf16 v[128:131], a[0:3], v[160:163], v[128:131]
v_mfma_f32_16x16x32_bf16 v[128:131], a[4:7], v[176:179], v[128:131]
v_mfma_f32_16x16x32_bf16 v[128:131], a[8:11], v[192:195], v[128:131]
v_mfma_f32_16x16x32_bf16 v[128:131], a[12:15], v[208:211], v[128:131]
s_waitcnt lgkmcnt(12)
v_mfma_f32_16x16x32_bf16 v[128:131], a[16:19], v[224:227], v[128:131]
s_waitcnt lgkmcnt(8)
v_cvt_pk_bf16_f32 v110, v124, v125
v_cvt_pk_bf16_f32 v111, v126, v127
v_mfma_f32_16x16x32_bf16 v[128:131], a[20:23], v[240:243], v[128:131]
buffer_store_dwordx4 v[108:111], v13, s[68:71], s40 offen sc1
v_mfma_f32_16x16x32_bf16 v[144:147], a[24:27], v[160:163], v[144:147]
s_mov_b32 s40, 491520
v_mfma_f32_16x16x32_bf16 v[144:147], a[28:31], v[176:179], v[144:147]
s_waitcnt lgkmcnt(4)
v_mfma_f32_16x16x32_bf16 v[144:147], a[32:35], v[192:195], v[144:147]
v_mfma_f32_16x16x32_bf16 v[144:147], a[36:39], v[208:211], v[144:147]
s_waitcnt lgkmcnt(0)
v_mfma_f32_16x16x32_bf16 v[144:147], a[40:43], v[224:227], v[144:147]
v_mfma_f32_16x16x32_bf16 v[144:147], a[44:47], v[240:243], v[144:147]
v_mfma_f32_16x16x32_bf16 v[132:135], a[0:3], v[164:167], v[132:135]
v_mfma_f32_16x16x32_bf16 v[132:135], a[4:7], v[180:183], v[132:135]
v_cvt_pk_bf16_f32 v128, v128, v129
v_cvt_pk_bf16_f32 v129, v130, v131
v_mfma_f32_16x16x32_bf16 v[132:135], a[8:11], v[196:199], v[132:135]
v_mfma_f32_16x16x32_bf16 v[132:135], a[12:15], v[212:215], v[132:135]
v_mfma_f32_16x16x32_bf16 v[132:135], a[16:19], v[228:231], v[132:135]
v_mfma_f32_16x16x32_bf16 v[132:135], a[20:23], v[244:247], v[132:135]
v_mfma_f32_16x16x32_bf16 v[148:151], a[24:27], v[164:167], v[148:151]
v_mfma_f32_16x16x32_bf16 v[148:151], a[28:31], v[180:183], v[148:151]
v_cvt_pk_bf16_f32 v130, v144, v145
v_cvt_pk_bf16_f32 v131, v146, v147
v_mfma_f32_16x16x32_bf16 v[148:151], a[32:35], v[196:199], v[148:151]
buffer_store_dwordx4 v[128:131], v31, s[68:71], s40 offen sc1
v_mfma_f32_16x16x32_bf16 v[148:151], a[36:39], v[212:215], v[148:151]
v_mfma_f32_16x16x32_bf16 v[148:151], a[40:43], v[228:231], v[148:151]
v_mfma_f32_16x16x32_bf16 v[148:151], a[44:47], v[244:247], v[148:151]
v_mfma_f32_16x16x32_bf16 v[136:139], a[0:3], v[168:171], v[136:139]
v_mfma_f32_16x16x32_bf16 v[136:139], a[4:7], v[184:187], v[136:139]
v_cvt_pk_bf16_f32 v132, v132, v133
v_cvt_pk_bf16_f32 v133, v134, v135
v_mfma_f32_16x16x32_bf16 v[136:139], a[8:11], v[200:203], v[136:139]
v_mfma_f32_16x16x32_bf16 v[136:139], a[12:15], v[216:219], v[136:139]
v_mfma_f32_16x16x32_bf16 v[136:139], a[16:19], v[232:235], v[136:139]
v_mfma_f32_16x16x32_bf16 v[136:139], a[20:23], v[248:251], v[136:139]
v_mfma_f32_16x16x32_bf16 v[152:155], a[24:27], v[168:171], v[152:155]
buffer_load_dword v5, v38, s[56:59], 0 offen offset:4 sc1
v_mfma_f32_16x16x32_bf16 v[152:155], a[28:31], v[184:187], v[152:155]
v_cvt_pk_bf16_f32 v134, v148, v149
v_cvt_pk_bf16_f32 v135, v150, v151
v_mfma_f32_16x16x32_bf16 v[152:155], a[32:35], v[200:203], v[152:155]
buffer_store_dwordx4 v[132:135], v32, s[68:71], s40 offen sc1
v_mfma_f32_16x16x32_bf16 v[152:155], a[36:39], v[216:219], v[152:155]
v_mfma_f32_16x16x32_bf16 v[152:155], a[40:43], v[232:235], v[152:155]
v_mfma_f32_16x16x32_bf16 v[152:155], a[44:47], v[248:251], v[152:155]
v_mfma_f32_16x16x32_bf16 v[140:143], a[0:3], v[172:175], v[140:143]
v_mfma_f32_16x16x32_bf16 v[140:143], a[4:7], v[188:191], v[140:143]
v_cvt_pk_bf16_f32 v136, v136, v137
v_cvt_pk_bf16_f32 v137, v138, v139
v_mfma_f32_16x16x32_bf16 v[140:143], a[8:11], v[204:207], v[140:143]
v_mfma_f32_16x16x32_bf16 v[140:143], a[12:15], v[220:223], v[140:143]
v_mfma_f32_16x16x32_bf16 v[140:143], a[16:19], v[236:239], v[140:143]
v_mfma_f32_16x16x32_bf16 v[140:143], a[20:23], v[252:255], v[140:143]
v_mfma_f32_16x16x32_bf16 v[156:159], a[24:27], v[172:175], v[156:159]
v_mfma_f32_16x16x32_bf16 v[156:159], a[28:31], v[188:191], v[156:159]
v_cvt_pk_bf16_f32 v138, v152, v153
v_cvt_pk_bf16_f32 v139, v154, v155
v_mfma_f32_16x16x32_bf16 v[156:159], a[32:35], v[204:207], v[156:159]
buffer_store_dwordx4 v[136:139], v33, s[68:71], s40 offen sc1
v_mfma_f32_16x16x32_bf16 v[156:159], a[36:39], v[220:223], v[156:159]
v_mfma_f32_16x16x32_bf16 v[156:159], a[40:43], v[236:239], v[156:159]
v_mfma_f32_16x16x32_bf16 v[156:159], a[44:47], v[252:255], v[156:159]
v_cvt_pk_bf16_f32 v140, v140, v141
v_cvt_pk_bf16_f32 v141, v142, v143
s_nop 5
v_cvt_pk_bf16_f32 v142, v156, v157
v_cvt_pk_bf16_f32 v143, v158, v159
buffer_store_dwordx4 v[140:143], v34, s[68:71], s40 offen sc1
v_mov_b32 v7, 2
v_cndmask_b32 v192, v192, v64, s[8:9]
v_cndmask_b32 v193, v193, v65, s[8:9]
v_cndmask_b32 v194, v194, v66, s[8:9]
v_cndmask_b32 v195, v195, v67, s[8:9]
v_cndmask_b32 v192, v192, v68, s[10:11]
v_cndmask_b32 v193, v193, v69, s[10:11]
v_cndmask_b32 v194, v194, v70, s[10:11]
v_cndmask_b32 v195, v195, v71, s[10:11]
v_cndmask_b32 v192, v192, v72, s[12:13]
v_cndmask_b32 v193, v193, v73, s[12:13]
v_cndmask_b32 v194, v194, v74, s[12:13]
v_cndmask_b32 v195, v195, v75, s[12:13]
v_cndmask_b32 v192, v192, v76, s[14:15]
v_cndmask_b32 v193, v193, v77, s[14:15]
v_cndmask_b32 v194, v194, v78, s[14:15]
v_cndmask_b32 v195, v195, v79, s[14:15]
v_cndmask_b32 v192, v192, v96, s[16:17]
v_cndmask_b32 v193, v193, v97, s[16:17]
v_cndmask_b32 v194, v194, v98, s[16:17]
v_cndmask_b32 v195, v195, v99, s[16:17]
v_cndmask_b32 v192, v192, v100, s[18:19]
v_cndmask_b32 v193, v193, v101, s[18:19]
v_cndmask_b32 v194, v194, v102, s[18:19]
v_cndmask_b32 v195, v195, v103, s[18:19]
v_cndmask_b32 v192, v192, v104, s[20:21]
v_cndmask_b32 v193, v193, v105, s[20:21]
v_cndmask_b32 v194, v194, v106, s[20:21]
v_cndmask_b32 v195, v195, v107, s[20:21]
v_cndmask_b32 v192, v192, v108, s[22:23]
v_cndmask_b32 v193, v193, v109, s[22:23]
v_cndmask_b32 v194, v194, v110, s[22:23]
v_cndmask_b32 v195, v195, v111, s[22:23]
v_cndmask_b32 v224, v224, v128, s[8:9]
KF_pg15:
s_cbranch_execz KF_tret
v_cndmask_b32 v225, v225, v129, s[8:9]
v_cndmask_b32 v226, v226, v130, s[8:9]
v_cndmask_b32 v227, v227, v131, s[8:9]
v_cndmask_b32 v224, v224, v132, s[10:11]
v_cndmask_b32 v225, v225, v133, s[10:11]
v_cndmask_b32 v226, v226, v134, s[10:11]
v_cndmask_b32 v227, v227, v135, s[10:11]
v_cndmask_b32 v224, v224, v136, s[12:13]
v_cndmask_b32 v225, v225, v137, s[12:13]
v_cndmask_b32 v226, v226, v138, s[12:13]
v_cndmask_b32 v227, v227, v139, s[12:13]
v_cndmask_b32 v224, v224, v140, s[14:15]
v_cndmask_b32 v225, v225, v141, s[14:15]
v_cndmask_b32 v226, v226, v142, s[14:15]
v_cndmask_b32 v227, v227, v143, s[14:15]
s_waitcnt vmcnt(0)
s_barrier
buffer_store_dwordx4 v[6:9], v37, s[56:59], 0 offen sc1
v_cmp_gt_u32 vcc, 1, v5
s_nop 0
s_cbranch_vccnz KF_slpA
KF_rtpA:
buffer_load_dwordx4 v[164:167], v1, s[68:71], s84 offen offset:1024 sc1
buffer_load_dwordx4 v[168:171], v1, s[68:71], s84 offen offset:2048 sc1
buffer_load_dwordx4 v[172:175], v1, s[68:71], s84 offen offset:3072 sc1
buffer_load_dwordx4 v[176:179], v3, s[68:71], s84 offen sc1
buffer_load_dwordx4 v[180:183], v3, s[68:71], s84 offen offset:1024 sc1
buffer_load_dwordx4 v[184:187], v3, s[68:71], s84 offen offset:2048 sc1
buffer_load_dwordx4 v[188:191], v3, s[68:71], s84 offen offset:3072 sc1
v_cmp_gt_u32 vcc, 2, v5
s_nop 0
s_cbranch_vccz KF_rtp2
s_waitcnt vmcnt(4)
buffer_load_dword v5, v38, s[56:59], 0 offen offset:4 sc1
s_waitcnt vmcnt(0)
v_cmp_gt_u32 vcc, 2, v5
s_nop 0
s_cbranch_vccnz KF_slp2
KF_rtp2:
buffer_load_dwordx4 v[196:199], v1, s[68:71], s85 offen offset:1024 sc1
buffer_load_dwordx4 v[200:203], v1, s[68:71], s85 offen offset:2048 sc1
buffer_load_dwordx4 v[204:207], v1, s[68:71], s85 offen offset:3072 sc1
buffer_load_dwordx4 v[208:211], v3, s[68:71], s85 offen sc1
buffer_load_dwordx4 v[212:215], v3, s[68:71], s85 offen offset:1024 sc1
buffer_load_dwordx4 v[216:219], v3, s[68:71], s85 offen offset:2048 sc1
buffer_load_dwordx4 v[220:223], v3, s[68:71], s85 offen offset:3072 sc1
buffer_load_dwordx4 v[228:231], v1, s[68:71], s86 offen offset:1024 sc1
buffer_load_dwordx4 v[232:235], v1, s[68:71], s86 offen offset:2048 sc1
buffer_load_dwordx4 v[236:239], v1, s[68:71], s86 offen offset:3072 sc1
buffer_load_dwordx4 v[240:243], v3, s[68:71], s86 offen sc1
buffer_load_dwordx4 v[244:247], v3, s[68:71], s86 offen offset:1024 sc1
buffer_load_dwordx4 v[248:251], v3, s[68:71], s86 offen offset:2048 sc1
buffer_load_dwordx4 v[252:255], v3, s[68:71], s86 offen offset:3072 sc1
v_lshlrev_b32 v64, 16, v56
v_and_b32 v65, 0xffff0000, v56
v_lshlrev_b32 v66, 16, v57
v_and_b32 v67, 0xffff0000, v57
v_lshlrev_b32 v68, 16, v58
v_and_b32 v69, 0xffff0000, v58
v_lshlrev_b32 v70, 16, v59
v_and_b32 v71, 0xffff0000, v59
s_waitcnt vmcnt(20)
v_lshlrev_b32 v120, 16, v164
v_and_b32 v121, 0xffff0000, v164
v_lshlrev_b32 v122, 16, v165
v_and_b32 v123, 0xffff0000, v165
v_lshlrev_b32 v124, 16, v166
v_and_b32 v125, 0xffff0000, v166
v_lshlrev_b32 v126, 16, v167
v_and_b32 v127, 0xffff0000, v167
v_pk_add_f32 v[64:65], v[64:65], v[120:121]
v_pk_add_f32 v[66:67], v[66:67], v[122:123]
v_pk_add_f32 v[68:69], v[68:69], v[124:125]
v_pk_add_f32 v[70:71], v[70:71], v[126:127]
s_waitcnt vmcnt(19)
v_lshlrev_b32 v112, 16, v168
v_and_b32 v113, 0xffff0000, v168
v_lshlrev_b32 v114, 16, v169
v_and_b32 v115, 0xffff0000, v169
v_lshlrev_b32 v116, 16, v170
v_and_b32 v117, 0xffff0000, v170
v_lshlrev_b32 v118, 16, v171
v_and_b32 v119, 0xffff0000, v171
v_pk_add_f32 v[64:65], v[64:65], v[112:113]
v_pk_add_f32 v[66:67], v[66:67], v[114:115]
v_pk_add_f32 v[68:69], v[68:69], v[116:117]
v_pk_add_f32 v[70:71], v[70:71], v[118:119]
s_waitcnt vmcnt(18)
v_lshlrev_b32 v120, 16, v172
v_and_b32 v121, 0xffff0000, v172
v_lshlrev_b32 v122, 16, v173
v_and_b32 v123, 0xffff0000, v173
v_lshlrev_b32 v124, 16, v174
v_and_b32 v125, 0xffff0000, v174
v_lshlrev_b32 v126, 16, v175
v_and_b32 v127, 0xffff0000, v175
v_pk_add_f32 v[64:65], v[64:65], v[120:121]
v_pk_add_f32 v[66:67], v[66:67], v[122:123]
v_pk_add_f32 v[68:69], v[68:69], v[124:125]
v_pk_add_f32 v[70:71], v[70:71], v[126:127]
s_waitcnt vmcnt(17)
v_lshlrev_b32 v112, 16, v176
v_and_b32 v113, 0xffff0000, v176
v_lshlrev_b32 v114, 16, v177
v_and_b32 v115, 0xffff0000, v177
v_lshlrev_b32 v116, 16, v178
v_and_b32 v117, 0xffff0000, v178
v_lshlrev_b32 v118, 16, v179
v_and_b32 v119, 0xffff0000, v179
v_pk_add_f32 v[64:65], v[64:65], v[112:113]
v_pk_add_f32 v[66:67], v[66:67], v[114:115]
v_pk_add_f32 v[68:69], v[68:69], v[116:117]
v_pk_add_f32 v[70:71], v[70:71], v[118:119]
s_waitcnt vmcnt(16)
v_lshlrev_b32 v120, 16, v180
v_and_b32 v121, 0xffff0000, v180
v_lshlrev_b32 v122, 16, v181
v_and_b32 v123, 0xffff0000, v181
v_lshlrev_b32 v124, 16, v182
v_and_b32 v125, 0xffff0000, v182
v_lshlrev_b32 v126, 16, v183
v_and_b32 v127, 0xffff0000, v183
v_pk_add_f32 v[64:65], v[64:65], v[120:121]
v_pk_add_f32 v[66:67], v[66:67], v[122:123]
v_pk_add_f32 v[68:69], v[68:69], v[124:125]
v_pk_add_f32 v[70:71], v[70:71], v[126:127]
s_waitcnt vmcnt(15)
v_lshlrev_b32 v112, 16, v184
v_and_b32 v113, 0xffff0000, v184
v_lshlrev_b32 v114, 16, v185
v_and_b32 v115, 0xffff0000, v185
v_lshlrev_b32 v116, 16, v186
v_and_b32 v117, 0xffff0000, v186
v_lshlrev_b32 v118, 16, v187
v_and_b32 v119, 0xffff0000, v187
v_pk_add_f32 v[64:65], v[64:65], v[112:113]
v_pk_add_f32 v[66:67], v[66:67], v[114:115]
v_pk_add_f32 v[68:69], v[68:69], v[116:117]
v_pk_add_f32 v[70:71], v[70:71], v[118:119]
s_waitcnt vmcnt(14)
v_lshlrev_b32 v120, 16, v188
v_and_b32 v121, 0xffff0000, v188
v_lshlrev_b32 v122, 16, v189
v_and_b32 v123, 0xffff0000, v189
v_lshlrev_b32 v124, 16, v190
v_and_b32 v125, 0xffff0000, v190
v_lshlrev_b32 v126, 16, v191
v_and_b32 v127, 0xffff0000, v191
v_pk_add_f32 v[64:65], v[64:65], v[120:121]
v_pk_add_f32 v[66:67], v[66:67], v[122:123]
v_pk_add_f32 v[68:69], v[68:69], v[124:125]
v_pk_add_f32 v[70:71], v[70:71], v[126:127]
v_cvt_pk_bf16_f32 v72, v64, v65
v_cvt_pk_bf16_f32 v73, v66, v67
v_cvt_pk_bf16_f32 v74, v68, v69
v_cvt_pk_bf16_f32 v75, v70, v71
s_nop 0
v_permlane16_swap_b32 v72, v74
v_permlane16_swap_b32 v73, v75
buffer_store_dwordx4 v[72:75], v2, s[72:75], s87 offen
v_lshlrev_b32 v80, 16, v192
v_and_b32 v81, 0xffff0000, v192
v_lshlrev_b32 v82, 16, v193
v_and_b32 v83, 0xffff0000, v193
v_lshlrev_b32 v84, 16, v194
v_and_b32 v85, 0xffff0000, v194
v_lshlrev_b32 v86, 16, v195
v_and_b32 v87, 0xffff0000, v195
s_waitcnt vmcnt(14)
v_lshlrev_b32 v120, 16, v196
v_and_b32 v121, 0xffff0000, v196
v_lshlrev_b32 v122, 16, v197
v_and_b32 v123, 0xffff0000, v197
v_lshlrev_b32 v124, 16, v198
v_and_b32 v125, 0xffff0000, v198
v_lshlrev_b32 v126, 16, v199
v_and_b32 v127, 0xffff0000, v199
v_pk_add_f32 v[80:81], v[80:81], v[120:121]
v_pk_add_f32 v[82:83], v[82:83], v[122:123]
v_pk_add_f32 v[84:85], v[84:85], v[124:125]
v_pk_add_f32 v[86:87], v[86:87], v[126:127]
s_waitcnt vmcnt(13)
v_lshlrev_b32 v112, 16, v200
v_and_b32 v113, 0xffff0000, v200
v_lshlrev_b32 v114, 16, v201
v_and_b32 v115, 0xffff0000, v201
v_lshlrev_b32 v116, 16, v202
v_and_b32 v117, 0xffff0000, v202
v_lshlrev_b32 v118, 16, v203
v_and_b32 v119, 0xffff0000, v203
v_pk_add_f32 v[80:81], v[80:81], v[112:113]
v_pk_add_f32 v[82:83], v[82:83], v[114:115]
v_pk_add_f32 v[84:85], v[84:85], v[116:117]
v_pk_add_f32 v[86:87], v[86:87], v[118:119]
s_waitcnt vmcnt(12)
v_lshlrev_b32 v120, 16, v204
v_and_b32 v121, 0xffff0000, v204
v_lshlrev_b32 v122, 16, v205
v_and_b32 v123, 0xffff0000, v205
v_lshlrev_b32 v124, 16, v206
v_and_b32 v125, 0xffff0000, v206
v_lshlrev_b32 v126, 16, v207
v_and_b32 v127, 0xffff0000, v207
v_pk_add_f32 v[80:81], v[80:81], v[120:121]
v_pk_add_f32 v[82:83], v[82:83], v[122:123]
v_pk_add_f32 v[84:85], v[84:85], v[124:125]
v_pk_add_f32 v[86:87], v[86:87], v[126:127]
s_waitcnt vmcnt(11)
v_lshlrev_b32 v112, 16, v208
v_and_b32 v113, 0xffff0000, v208
v_lshlrev_b32 v114, 16, v209
v_and_b32 v115, 0xffff0000, v209
v_lshlrev_b32 v116, 16, v210
v_and_b32 v117, 0xffff0000, v210
v_lshlrev_b32 v118, 16, v211
v_and_b32 v119, 0xffff0000, v211
v_pk_add_f32 v[80:81], v[80:81], v[112:113]
v_pk_add_f32 v[82:83], v[82:83], v[114:115]
v_pk_add_f32 v[84:85], v[84:85], v[116:117]
v_pk_add_f32 v[86:87], v[86:87], v[118:119]
s_waitcnt vmcnt(10)
v_lshlrev_b32 v120, 16, v212
v_and_b32 v121, 0xffff0000, v212
v_lshlrev_b32 v122, 16, v213
v_and_b32 v123, 0xffff0000, v213
v_lshlrev_b32 v124, 16, v214
v_and_b32 v125, 0xffff0000, v214
v_lshlrev_b32 v126, 16, v215
v_and_b32 v127, 0xffff0000, v215
v_pk_add_f32 v[80:81], v[80:81], v[120:121]
v_pk_add_f32 v[82:83], v[82:83], v[122:123]
v_pk_add_f32 v[84:85], v[84:85], v[124:125]
v_pk_add_f32 v[86:87], v[86:87], v[126:127]
s_waitcnt vmcnt(9)
v_lshlrev_b32 v112, 16, v216
v_and_b32 v113, 0xffff0000, v216
v_lshlrev_b32 v114, 16, v217
v_and_b32 v115, 0xffff0000, v217
v_lshlrev_b32 v116, 16, v218
v_and_b32 v117, 0xffff0000, v218
v_lshlrev_b32 v118, 16, v219
v_and_b32 v119, 0xffff0000, v219
v_pk_add_f32 v[80:81], v[80:81], v[112:113]
v_pk_add_f32 v[82:83], v[82:83], v[114:115]
v_pk_add_f32 v[84:85], v[84:85], v[116:117]
v_pk_add_f32 v[86:87], v[86:87], v[118:119]
s_waitcnt vmcnt(8)
v_lshlrev_b32 v120, 16, v220
v_and_b32 v121, 0xffff0000, v220
v_lshlrev_b32 v122, 16, v221
v_and_b32 v123, 0xffff0000, v221
v_lshlrev_b32 v124, 16, v222
v_and_b32 v125, 0xffff0000, v222
v_lshlrev_b32 v126, 16, v223
v_and_b32 v127, 0xffff0000, v223
v_pk_add_f32 v[80:81], v[80:81], v[120:121]
v_pk_add_f32 v[82:83], v[82:83], v[122:123]
v_pk_add_f32 v[84:85], v[84:85], v[124:125]
v_pk_add_f32 v[86:87], v[86:87], v[126:127]
v_cvt_pk_bf16_f32 v88, v80, v81
v_cvt_pk_bf16_f32 v89, v82, v83
v_cvt_pk_bf16_f32 v90, v84, v85
v_cvt_pk_bf16_f32 v91, v86, v87
s_nop 0
v_permlane16_swap_b32 v88, v90
v_permlane16_swap_b32 v89, v91
buffer_store_dwordx4 v[88:91], v2, s[72:75], s88 offen
v_lshlrev_b32 v96, 16, v224
v_and_b32 v97, 0xffff0000, v224
v_lshlrev_b32 v98, 16, v225
v_and_b32 v99, 0xffff0000, v225
v_lshlrev_b32 v100, 16, v226
v_and_b32 v101, 0xffff0000, v226
v_lshlrev_b32 v102, 16, v227
v_and_b32 v103, 0xffff0000, v227
s_waitcnt vmcnt(8)
v_lshlrev_b32 v120, 16, v228
v_and_b32 v121, 0xffff0000, v228
v_lshlrev_b32 v122, 16, v229
v_and_b32 v123, 0xffff0000, v229
v_lshlrev_b32 v124, 16, v230
v_and_b32 v125, 0xffff0000, v230
v_lshlrev_b32 v126, 16, v231
v_and_b32 v127, 0xffff0000, v231
v_pk_add_f32 v[96:97], v[96:97], v[120:121]
v_pk_add_f32 v[98:99], v[98:99], v[122:123]
v_pk_add_f32 v[100:101], v[100:101], v[124:125]
v_pk_add_f32 v[102:103], v[102:103], v[126:127]
s_waitcnt vmcnt(7)
v_lshlrev_b32 v112, 16, v232
v_and_b32 v113, 0xffff0000, v232
v_lshlrev_b32 v114, 16, v233
v_and_b32 v115, 0xffff0000, v233
v_lshlrev_b32 v116, 16, v234
v_and_b32 v117, 0xffff0000, v234
v_lshlrev_b32 v118, 16, v235
v_and_b32 v119, 0xffff0000, v235
v_pk_add_f32 v[96:97], v[96:97], v[112:113]
v_pk_add_f32 v[98:99], v[98:99], v[114:115]
v_pk_add_f32 v[100:101], v[100:101], v[116:117]
v_pk_add_f32 v[102:103], v[102:103], v[118:119]
s_waitcnt vmcnt(6)
v_lshlrev_b32 v120, 16, v236
v_and_b32 v121, 0xffff0000, v236
v_lshlrev_b32 v122, 16, v237
v_and_b32 v123, 0xffff0000, v237
v_lshlrev_b32 v124, 16, v238
v_and_b32 v125, 0xffff0000, v238
v_lshlrev_b32 v126, 16, v239
v_and_b32 v127, 0xffff0000, v239
v_pk_add_f32 v[96:97], v[96:97], v[120:121]
v_pk_add_f32 v[98:99], v[98:99], v[122:123]
v_pk_add_f32 v[100:101], v[100:101], v[124:125]
v_pk_add_f32 v[102:103], v[102:103], v[126:127]
s_waitcnt vmcnt(5)
v_lshlrev_b32 v112, 16, v240
v_and_b32 v113, 0xffff0000, v240
v_lshlrev_b32 v114, 16, v241
v_and_b32 v115, 0xffff0000, v241
v_lshlrev_b32 v116, 16, v242
v_and_b32 v117, 0xffff0000, v242
v_lshlrev_b32 v118, 16, v243
v_and_b32 v119, 0xffff0000, v243
v_pk_add_f32 v[96:97], v[96:97], v[112:113]
v_pk_add_f32 v[98:99], v[98:99], v[114:115]
v_pk_add_f32 v[100:101], v[100:101], v[116:117]
v_pk_add_f32 v[102:103], v[102:103], v[118:119]
s_waitcnt vmcnt(4)
v_lshlrev_b32 v120, 16, v244
v_and_b32 v121, 0xffff0000, v244
v_lshlrev_b32 v122, 16, v245
v_and_b32 v123, 0xffff0000, v245
v_lshlrev_b32 v124, 16, v246
v_and_b32 v125, 0xffff0000, v246
v_lshlrev_b32 v126, 16, v247
v_and_b32 v127, 0xffff0000, v247
v_pk_add_f32 v[96:97], v[96:97], v[120:121]
v_pk_add_f32 v[98:99], v[98:99], v[122:123]
v_pk_add_f32 v[100:101], v[100:101], v[124:125]
v_pk_add_f32 v[102:103], v[102:103], v[126:127]
s_waitcnt vmcnt(3)
v_lshlrev_b32 v112, 16, v248
v_and_b32 v113, 0xffff0000, v248
v_lshlrev_b32 v114, 16, v249
v_and_b32 v115, 0xffff0000, v249
v_lshlrev_b32 v116, 16, v250
v_and_b32 v117, 0xffff0000, v250
v_lshlrev_b32 v118, 16, v251
v_and_b32 v119, 0xffff0000, v251
v_pk_add_f32 v[96:97], v[96:97], v[112:113]
v_pk_add_f32 v[98:99], v[98:99], v[114:115]
v_pk_add_f32 v[100:101], v[100:101], v[116:117]
v_pk_add_f32 v[102:103], v[102:103], v[118:119]
s_waitcnt vmcnt(2)
v_lshlrev_b32 v120, 16, v252
v_and_b32 v121, 0xffff0000, v252
v_lshlrev_b32 v122, 16, v253
v_and_b32 v123, 0xffff0000, v253
v_lshlrev_b32 v124, 16, v254
v_and_b32 v125, 0xffff0000, v254
v_lshlrev_b32 v126, 16, v255
v_and_b32 v127, 0xffff0000, v255
v_pk_add_f32 v[96:97], v[96:97], v[120:121]
v_pk_add_f32 v[98:99], v[98:99], v[122:123]
v_pk_add_f32 v[100:101], v[100:101], v[124:125]
v_pk_add_f32 v[102:103], v[102:103], v[126:127]
v_cvt_pk_bf16_f32 v104, v96, v97
v_cvt_pk_bf16_f32 v105, v98, v99
v_cvt_pk_bf16_f32 v106, v100, v101
v_cvt_pk_bf16_f32 v107, v102, v103
s_nop 0
v_permlane16_swap_b32 v104, v106
v_permlane16_swap_b32 v105, v107
buffer_store_dwordx4 v[104:107], v2, s[72:75], s89 offen
KF_done:
s_endpgm
KF_slc:
s_mov_b32 s90, 0
KF_spc:
buffer_load_dword v5, v6, s[60:63], 0 offen sc1
s_waitcnt vmcnt(0)
v_cmp_gt_u32 vcc, 32, v5
s_add_u32 s90, s90, 1
s_cmp_gt_u32 s90, 0x40000
s_cbranch_scc1 KF_rtc
s_cbranch_vccnz KF_spc
s_branch KF_rtc
KF_slo0:
s_mov_b32 s90, 0
KF_spo0:
buffer_load_dword v5, v36, s[56:59], 0 offen offset:4 sc1
s_waitcnt vmcnt(0)
v_cmp_gt_u32 vcc, 1, v5
s_add_u32 s90, s90, 1
s_cmp_gt_u32 s90, 0x40000
s_cbranch_scc1 KF_rto0
s_cbranch_vccnz KF_spo0
s_branch KF_rto0
KF_slo1:
s_mov_b32 s90, 0
KF_spo1:
buffer_load_dword v5, v36, s[56:59], 0 offen offset:4 sc1
s_waitcnt vmcnt(0)
v_cmp_gt_u32 vcc, 2, v5
s_add_u32 s90, s90, 1
s_cmp_gt_u32 s90, 0x40000
s_cbranch_scc1 KF_rto1
s_cbranch_vccnz KF_spo1
s_branch KF_rto1
KF_slo2:
s_mov_b32 s90, 0
KF_spo2:
buffer_load_dword v5, v36, s[56:59], 0 offen offset:4 sc1
s_waitcnt vmcnt(0)
v_cmp_gt_u32 vcc, 3, v5
s_add_u32 s90, s90, 1
s_cmp_gt_u32 s90, 0x40000
s_cbranch_scc1 KF_rto2
s_cbranch_vccnz KF_spo2
s_branch KF_rto2
KF_slpA:
s_mov_b32 s90, 0
KF_sppA:
buffer_load_dword v5, v38, s[56:59], 0 offen offset:4 sc1
s_waitcnt vmcnt(0)
v_cmp_gt_u32 vcc, 1, v5
s_add_u32 s90, s90, 1
s_cmp_gt_u32 s90, 0x40000
s_cbranch_scc1 KF_rtpA
s_cbranch_vccnz KF_sppA
s_branch KF_rtpA
KF_slp2:
s_mov_b32 s90, 0
KF_spp2:
buffer_load_dword v5, v38, s[56:59], 0 offen offset:4 sc1
s_waitcnt vmcnt(0)
v_cmp_gt_u32 vcc, 2, v5
s_add_u32 s90, s90, 1
s_cmp_gt_u32 s90, 0x40000
s_cbranch_scc1 KF_rtp2
s_cbranch_vccnz KF_spp2
s_branch KF_rtp2
KF_fxp0:
s_call_b64 s[48:49], KF_fix1
s_branch KF_bkp0
KF_fx0:
s_call_b64 s[48:49], KF_fix0
s_branch KF_bk0
KF_fx1:
s_call_b64 s[48:49], KF_fix1
s_branch KF_bk1
KF_fx2:
s_call_b64 s[48:49], KF_fix0
s_branch KF_bk2
KF_fx3:
s_call_b64 s[48:49], KF_fix1
s_branch KF_bk3
KF_fx4:
s_call_b64 s[48:49], KF_fix0
s_branch KF_bk4
KF_fx5:
s_call_b64 s[48:49], KF_fix1
s_branch KF_bk5
KF_fxp25:
s_call_b64 s[48:49], KF_fix0
s_branch KF_bkp25
KF_fxp26:
s_call_b64 s[48:49], KF_fix1
s_branch KF_bkp26
KF_fxp27:
s_call_b64 s[48:49], KF_fix0
s_branch KF_bkp27
KF_fxp28:
s_call_b64 s[48:49], KF_fix1
s_branch KF_bkp28
KF_fxp29:
s_call_b64 s[48:49], KF_fix0
s_branch KF_bkp29
KF_fxp30:
s_call_b64 s[48:49], KF_fix1
s_branch KF_bkp30
KF_fix0:
s_waitcnt vmcnt(0)
s_nop 7
v_max3_f32 v1, v64, v65, v66
v_max3_f32 v1, v1, v67, v80
v_max3_f32 v1, v1, v81, v82
v_max_f32 v1, v1, v83
v_max3_f32 v2, v68, v69, v70
v_max3_f32 v2, v2, v71, v84
v_max3_f32 v2, v2, v85, v86
v_max_f32 v2, v2, v87
v_max3_f32 v3, v72, v73, v74
v_max3_f32 v3, v3, v75, v88
v_max3_f32 v3, v3, v89, v90
v_max_f32 v3, v3, v91
v_max3_f32 v4, v76, v77, v78
v_max3_f32 v4, v4, v79, v92
v_max3_f32 v4, v4, v93, v94
v_max_f32 v4, v4, v95
v_mov_b32 v152, v1
v_mov_b32 v153, v2
v_mov_b32 v154, v3
v_mov_b32 v155, v4
s_nop 0
v_permlane32_swap_b32 v152, v1
v_permlane32_swap_b32 v153, v2
v_permlane32_swap_b32 v154, v3
v_permlane32_swap_b32 v155, v4
v_max_f32 v1, v1, v152
v_max_f32 v2, v2, v153
v_max_f32 v3, v3, v154
v_max_f32 v4, v4, v155
v_mov_b32 v152, v1
v_mov_b32 v153, v2
v_mov_b32 v154, v3
v_mov_b32 v155, v4
s_nop 0
v_permlane16_swap_b32 v152, v1
v_permlane16_swap_b32 v153, v2
v_permlane16_swap_b32 v154, v3
v_permlane16_swap_b32 v155, v4
v_max_f32 v1, v1, v152
v_max_f32 v2, v2, v153
v_max_f32 v3, v3, v154
v_max_f32 v4, v4, v155
v_max_f32 v1, 0, v1
v_max_f32 v2, 0, v2
v_max_f32 v3, 0, v3
v_max_f32 v4, 0, v4
v_sub_f32 v152, v64, v1
v_sub_f32 v153, v65, v1
v_sub_f32 v154, v66, v1
v_sub_f32 v155, v67, v1
v_sub_f32 v156, v80, v1
v_sub_f32 v157, v81, v1
v_sub_f32 v158, v82, v1
v_sub_f32 v159, v83, v1
v_exp_f32 v152, v152
v_exp_f32 v153, v153
v_exp_f32 v154, v154
v_exp_f32 v155, v155
v_exp_f32 v156, v156
v_exp_f32 v157, v157
v_exp_f32 v158, v158
v_exp_f32 v159, v159
v_cvt_pk_bf16_f32 v96, v152, v153
v_cvt_pk_bf16_f32 v97, v154, v155
v_cvt_pk_bf16_f32 v98, v156, v157
v_cvt_pk_bf16_f32 v99, v158, v159
v_sub_f32 v152, v68, v2
v_sub_f32 v153, v69, v2
v_sub_f32 v154, v70, v2
v_sub_f32 v155, v71, v2
v_sub_f32 v156, v84, v2
v_sub_f32 v157, v85, v2
v_sub_f32 v158, v86, v2
v_sub_f32 v159, v87, v2
v_exp_f32 v152, v152
v_exp_f32 v153, v153
v_exp_f32 v154, v154
v_exp_f32 v155, v155
v_exp_f32 v156, v156
v_exp_f32 v157, v157
v_exp_f32 v158, v158
v_exp_f32 v159, v159
v_cvt_pk_bf16_f32 v100, v152, v153
v_cvt_pk_bf16_f32 v101, v154, v155
v_cvt_pk_bf16_f32 v102, v156, v157
v_cvt_pk_bf16_f32 v103, v158, v159
v_sub_f32 v152, v72, v3
v_sub_f32 v153, v73, v3
v_sub_f32 v154, v74, v3
v_sub_f32 v155, v75, v3
v_sub_f32 v156, v88, v3
v_sub_f32 v157, v89, v3
v_sub_f32 v158, v90, v3
v_sub_f32 v159, v91, v3
v_exp_f32 v152, v152
v_exp_f32 v153, v153
v_exp_f32 v154, v154
v_exp_f32 v155, v155
v_exp_f32 v156, v156
v_exp_f32 v157, v157
v_exp_f32 v158, v158
v_exp_f32 v159, v159
v_cvt_pk_bf16_f32 v104, v152, v153
v_cvt_pk_bf16_f32 v105, v154, v155
v_cvt_pk_bf16_f32 v106, v156, v157
v_cvt_pk_bf16_f32 v107, v158, v159
v_sub_f32 v152, v76, v4
v_sub_f32 v153, v77, v4
v_sub_f32 v154, v78, v4
v_sub_f32 v155, v79, v4
v_sub_f32 v156, v92, v4
v_sub_f32 v157, v93, v4
v_sub_f32 v158, v94, v4
v_sub_f32 v159, v95, v4
v_exp_f32 v152, v152
v_exp_f32 v153, v153
v_exp_f32 v154, v154
v_exp_f32 v155, v155
v_exp_f32 v156, v156
v_exp_f32 v157, v157
v_exp_f32 v158, v158
v_exp_f32 v159, v159
v_cvt_pk_bf16_f32 v108, v152, v153
v_cvt_pk_bf16_f32 v109, v154, v155
v_cvt_pk_bf16_f32 v110, v156, v157
v_cvt_pk_bf16_f32 v111, v158, v159
v_sub_f32 v128, v128, v1
v_sub_f32 v129, v129, v1
v_sub_f32 v130, v130, v1
v_sub_f32 v131, v131, v1
v_sub_f32 v132, v132, v2
v_sub_f32 v133, v133, v2
v_sub_f32 v134, v134, v2
v_sub_f32 v135, v135, v2
v_sub_f32 v136, v136, v3
v_sub_f32 v137, v137, v3
v_sub_f32 v138, v138, v3
v_sub_f32 v139, v139, v3
v_sub_f32 v140, v140, v4
v_sub_f32 v141, v141, v4
v_sub_f32 v142, v142, v4
v_sub_f32 v143, v143, v4
v_exp_f32 v1, -v1
v_exp_f32 v2, -v2
v_exp_f32 v3, -v3
v_exp_f32 v4, -v4
s_nop 0
v_mul_f32 v148, v148, v1
v_mul_f32 v149, v149, v2
v_mul_f32 v150, v150, v3
v_mul_f32 v151, v151, v4
s_nop 1
v_mfma_f32_16x16x32_bf16 v[144:147], a[240:243], v[96:99], v[148:151]
v_mfma_f32_16x16x32_bf16 v[144:147], a[244:247], v[100:103], v[144:147]
v_mfma_f32_16x16x32_bf16 v[144:147], a[248:251], v[104:107], v[144:147]
v_mfma_f32_16x16x32_bf16 v[144:147], a[252:255], v[108:111], v[144:147]
v_accvgpr_read_b32 v152, a0
v_accvgpr_read_b32 v153, a1
v_accvgpr_read_b32 v154, a2
v_accvgpr_read_b32 v155, a3
v_mul_f32 v152, v152, v1
v_mul_f32 v153, v153, v1
v_mul_f32 v154, v154, v1
v_mul_f32 v155, v155, v1
v_accvgpr_write_b32 a0, v152
v_accvgpr_write_b32 a1, v153
v_accvgpr_write_b32 a2, v154
v_accvgpr_write_b32 a3, v155
v_accvgpr_read_b32 v156, a4
v_accvgpr_read_b32 v157, a5
v_accvgpr_read_b32 v158, a6
v_accvgpr_read_b32 v159, a7
v_mul_f32 v156, v156, v2
v_mul_f32 v157, v157, v2
v_mul_f32 v158, v158, v2
v_mul_f32 v159, v159, v2
v_accvgpr_write_b32 a4, v156
v_accvgpr_write_b32 a5, v157
v_accvgpr_write_b32 a6, v158
v_accvgpr_write_b32 a7, v159
v_accvgpr_read_b32 v152, a8
v_accvgpr_read_b32 v153, a9
v_accvgpr_read_b32 v154, a10
v_accvgpr_read_b32 v155, a11
v_mul_f32 v152, v152, v3
v_mul_f32 v153, v153, v3
v_mul_f32 v154, v154, v3
v_mul_f32 v155, v155, v3
v_accvgpr_write_b32 a8, v152
v_accvgpr_write_b32 a9, v153
v_accvgpr_write_b32 a10, v154
v_accvgpr_write_b32 a11, v155
v_accvgpr_read_b32 v156, a12
v_accvgpr_read_b32 v157, a13
v_accvgpr_read_b32 v158, a14
v_accvgpr_read_b32 v159, a15
v_mul_f32 v156, v156, v4
v_mul_f32 v157, v157, v4
v_mul_f32 v158, v158, v4
v_mul_f32 v159, v159, v4
v_accvgpr_write_b32 a12, v156
v_accvgpr_write_b32 a13, v157
v_accvgpr_write_b32 a14, v158
v_accvgpr_write_b32 a15, v159
v_accvgpr_read_b32 v152, a16
v_accvgpr_read_b32 v153, a17
v_accvgpr_read_b32 v154, a18
v_accvgpr_read_b32 v155, a19
v_mul_f32 v152, v152, v1
v_mul_f32 v153, v153, v1
v_mul_f32 v154, v154, v1
v_mul_f32 v155, v155, v1
v_accvgpr_write_b32 a16, v152
v_accvgpr_write_b32 a17, v153
v_accvgpr_write_b32 a18, v154
v_accvgpr_write_b32 a19, v155
v_accvgpr_read_b32 v156, a20
v_accvgpr_read_b32 v157, a21
v_accvgpr_read_b32 v158, a22
v_accvgpr_read_b32 v159, a23
v_mul_f32 v156, v156, v2
v_mul_f32 v157, v157, v2
v_mul_f32 v158, v158, v2
v_mul_f32 v159, v159, v2
v_accvgpr_write_b32 a20, v156
v_accvgpr_write_b32 a21, v157
v_accvgpr_write_b32 a22, v158
v_accvgpr_write_b32 a23, v159
v_accvgpr_read_b32 v152, a24
v_accvgpr_read_b32 v153, a25
v_accvgpr_read_b32 v154, a26
v_accvgpr_read_b32 v155, a27
v_mul_f32 v152, v152, v3
v_mul_f32 v153, v153, v3
v_mul_f32 v154, v154, v3
v_mul_f32 v155, v155, v3
v_accvgpr_write_b32 a24, v152
v_accvgpr_write_b32 a25, v153
v_accvgpr_write_b32 a26, v154
v_accvgpr_write_b32 a27, v155
v_accvgpr_read_b32 v156, a28
v_accvgpr_read_b32 v157, a29
v_accvgpr_read_b32 v158, a30
v_accvgpr_read_b32 v159, a31
v_mul_f32 v156, v156, v4
v_mul_f32 v157, v157, v4
v_mul_f32 v158, v158, v4
v_mul_f32 v159, v159, v4
v_accvgpr_write_b32 a28, v156
v_accvgpr_write_b32 a29, v157
v_accvgpr_write_b32 a30, v158
v_accvgpr_write_b32 a31, v159
v_accvgpr_read_b32 v152, a32
v_accvgpr_read_b32 v153, a33
v_accvgpr_read_b32 v154, a34
v_accvgpr_read_b32 v155, a35
v_mul_f32 v152, v152, v1
v_mul_f32 v153, v153, v1
v_mul_f32 v154, v154, v1
v_mul_f32 v155, v155, v1
v_accvgpr_write_b32 a32, v152
v_accvgpr_write_b32 a33, v153
v_accvgpr_write_b32 a34, v154
v_accvgpr_write_b32 a35, v155
v_accvgpr_read_b32 v156, a36
v_accvgpr_read_b32 v157, a37
v_accvgpr_read_b32 v158, a38
v_accvgpr_read_b32 v159, a39
v_mul_f32 v156, v156, v2
v_mul_f32 v157, v157, v2
v_mul_f32 v158, v158, v2
v_mul_f32 v159, v159, v2
v_accvgpr_write_b32 a36, v156
v_accvgpr_write_b32 a37, v157
v_accvgpr_write_b32 a38, v158
v_accvgpr_write_b32 a39, v159
v_accvgpr_read_b32 v152, a40
v_accvgpr_read_b32 v153, a41
v_accvgpr_read_b32 v154, a42
v_accvgpr_read_b32 v155, a43
v_mul_f32 v152, v152, v3
v_mul_f32 v153, v153, v3
v_mul_f32 v154, v154, v3
v_mul_f32 v155, v155, v3
v_accvgpr_write_b32 a40, v152
v_accvgpr_write_b32 a41, v153
v_accvgpr_write_b32 a42, v154
v_accvgpr_write_b32 a43, v155
v_accvgpr_read_b32 v156, a44
v_accvgpr_read_b32 v157, a45
v_accvgpr_read_b32 v158, a46
v_accvgpr_read_b32 v159, a47
v_mul_f32 v156, v156, v4
v_mul_f32 v157, v157, v4
v_mul_f32 v158, v158, v4
v_mul_f32 v159, v159, v4
v_accvgpr_write_b32 a44, v156
v_accvgpr_write_b32 a45, v157
v_accvgpr_write_b32 a46, v158
v_accvgpr_write_b32 a47, v159
v_accvgpr_read_b32 v152, a48
v_accvgpr_read_b32 v153, a49
v_accvgpr_read_b32 v154, a50
v_accvgpr_read_b32 v155, a51
v_mul_f32 v152, v152, v1
v_mul_f32 v153, v153, v1
v_mul_f32 v154, v154, v1
v_mul_f32 v155, v155, v1
v_accvgpr_write_b32 a48, v152
v_accvgpr_write_b32 a49, v153
v_accvgpr_write_b32 a50, v154
v_accvgpr_write_b32 a51, v155
v_accvgpr_read_b32 v156, a52
v_accvgpr_read_b32 v157, a53
v_accvgpr_read_b32 v158, a54
v_accvgpr_read_b32 v159, a55
v_mul_f32 v156, v156, v2
v_mul_f32 v157, v157, v2
v_mul_f32 v158, v158, v2
v_mul_f32 v159, v159, v2
v_accvgpr_write_b32 a52, v156
v_accvgpr_write_b32 a53, v157
v_accvgpr_write_b32 a54, v158
v_accvgpr_write_b32 a55, v159
v_accvgpr_read_b32 v152, a56
v_accvgpr_read_b32 v153, a57
v_accvgpr_read_b32 v154, a58
v_accvgpr_read_b32 v155, a59
v_mul_f32 v152, v152, v3
v_mul_f32 v153, v153, v3
v_mul_f32 v154, v154, v3
v_mul_f32 v155, v155, v3
v_accvgpr_write_b32 a56, v152
v_accvgpr_write_b32 a57, v153
v_accvgpr_write_b32 a58, v154
v_accvgpr_write_b32 a59, v155
v_accvgpr_read_b32 v156, a60
v_accvgpr_read_b32 v157, a61
v_accvgpr_read_b32 v158, a62
v_accvgpr_read_b32 v159, a63
v_mul_f32 v156, v156, v4
v_mul_f32 v157, v157, v4
v_mul_f32 v158, v158, v4
v_mul_f32 v159, v159, v4
v_accvgpr_write_b32 a60, v156
v_accvgpr_write_b32 a61, v157
v_accvgpr_write_b32 a62, v158
v_accvgpr_write_b32 a63, v159
v_accvgpr_read_b32 v152, a64
v_accvgpr_read_b32 v153, a65
v_accvgpr_read_b32 v154, a66
v_accvgpr_read_b32 v155, a67
v_mul_f32 v152, v152, v1
v_mul_f32 v153, v153, v1
v_mul_f32 v154, v154, v1
v_mul_f32 v155, v155, v1
v_accvgpr_write_b32 a64, v152
v_accvgpr_write_b32 a65, v153
v_accvgpr_write_b32 a66, v154
v_accvgpr_write_b32 a67, v155
v_accvgpr_read_b32 v156, a68
v_accvgpr_read_b32 v157, a69
v_accvgpr_read_b32 v158, a70
v_accvgpr_read_b32 v159, a71
v_mul_f32 v156, v156, v2
v_mul_f32 v157, v157, v2
v_mul_f32 v158, v158, v2
v_mul_f32 v159, v159, v2
v_accvgpr_write_b32 a68, v156
v_accvgpr_write_b32 a69, v157
v_accvgpr_write_b32 a70, v158
v_accvgpr_write_b32 a71, v159
v_accvgpr_read_b32 v152, a72
v_accvgpr_read_b32 v153, a73
v_accvgpr_read_b32 v154, a74
v_accvgpr_read_b32 v155, a75
v_mul_f32 v152, v152, v3
v_mul_f32 v153, v153, v3
v_mul_f32 v154, v154, v3
v_mul_f32 v155, v155, v3
v_accvgpr_write_b32 a72, v152
v_accvgpr_write_b32 a73, v153
v_accvgpr_write_b32 a74, v154
v_accvgpr_write_b32 a75, v155
v_accvgpr_read_b32 v156, a76
v_accvgpr_read_b32 v157, a77
v_accvgpr_read_b32 v158, a78
v_accvgpr_read_b32 v159, a79
v_mul_f32 v156, v156, v4
v_mul_f32 v157, v157, v4
v_mul_f32 v158, v158, v4
v_mul_f32 v159, v159, v4
v_accvgpr_write_b32 a76, v156
v_accvgpr_write_b32 a77, v157
v_accvgpr_write_b32 a78, v158
v_accvgpr_write_b32 a79, v159
v_accvgpr_read_b32 v152, a80
v_accvgpr_read_b32 v153, a81
v_accvgpr_read_b32 v154, a82
v_accvgpr_read_b32 v155, a83
v_mul_f32 v152, v152, v1
v_mul_f32 v153, v153, v1
v_mul_f32 v154, v154, v1
v_mul_f32 v155, v155, v1
v_accvgpr_write_b32 a80, v152
v_accvgpr_write_b32 a81, v153
v_accvgpr_write_b32 a82, v154
v_accvgpr_write_b32 a83, v155
v_accvgpr_read_b32 v156, a84
v_accvgpr_read_b32 v157, a85
v_accvgpr_read_b32 v158, a86
v_accvgpr_read_b32 v159, a87
v_mul_f32 v156, v156, v2
v_mul_f32 v157, v157, v2
v_mul_f32 v158, v158, v2
v_mul_f32 v159, v159, v2
v_accvgpr_write_b32 a84, v156
v_accvgpr_write_b32 a85, v157
v_accvgpr_write_b32 a86, v158
v_accvgpr_write_b32 a87, v159
v_accvgpr_read_b32 v152, a88
v_accvgpr_read_b32 v153, a89
v_accvgpr_read_b32 v154, a90
v_accvgpr_read_b32 v155, a91
v_mul_f32 v152, v152, v3
v_mul_f32 v153, v153, v3
v_mul_f32 v154, v154, v3
v_mul_f32 v155, v155, v3
v_accvgpr_write_b32 a88, v152
v_accvgpr_write_b32 a89, v153
v_accvgpr_write_b32 a90, v154
v_accvgpr_write_b32 a91, v155
v_accvgpr_read_b32 v156, a92
v_accvgpr_read_b32 v157, a93
v_accvgpr_read_b32 v158, a94
v_accvgpr_read_b32 v159, a95
v_mul_f32 v156, v156, v4
v_mul_f32 v157, v157, v4
v_mul_f32 v158, v158, v4
v_mul_f32 v159, v159, v4
v_accvgpr_write_b32 a92, v156
v_accvgpr_write_b32 a93, v157
v_accvgpr_write_b32 a94, v158
v_accvgpr_write_b32 a95, v159
v_accvgpr_read_b32 v152, a96
v_accvgpr_read_b32 v153, a97
v_accvgpr_read_b32 v154, a98
v_accvgpr_read_b32 v155, a99
v_mul_f32 v152, v152, v1
v_mul_f32 v153, v153, v1
v_mul_f32 v154, v154, v1
v_mul_f32 v155, v155, v1
v_accvgpr_write_b32 a96, v152
v_accvgpr_write_b32 a97, v153
v_accvgpr_write_b32 a98, v154
v_accvgpr_write_b32 a99, v155
v_accvgpr_read_b32 v156, a100
v_accvgpr_read_b32 v157, a101
v_accvgpr_read_b32 v158, a102
v_accvgpr_read_b32 v159, a103
v_mul_f32 v156, v156, v2
v_mul_f32 v157, v157, v2
v_mul_f32 v158, v158, v2
v_mul_f32 v159, v159, v2
v_accvgpr_write_b32 a100, v156
v_accvgpr_write_b32 a101, v157
v_accvgpr_write_b32 a102, v158
v_accvgpr_write_b32 a103, v159
v_accvgpr_read_b32 v152, a104
v_accvgpr_read_b32 v153, a105
v_accvgpr_read_b32 v154, a106
v_accvgpr_read_b32 v155, a107
v_mul_f32 v152, v152, v3
v_mul_f32 v153, v153, v3
v_mul_f32 v154, v154, v3
v_mul_f32 v155, v155, v3
v_accvgpr_write_b32 a104, v152
v_accvgpr_write_b32 a105, v153
v_accvgpr_write_b32 a106, v154
v_accvgpr_write_b32 a107, v155
v_accvgpr_read_b32 v156, a108
v_accvgpr_read_b32 v157, a109
v_accvgpr_read_b32 v158, a110
v_accvgpr_read_b32 v159, a111
v_mul_f32 v156, v156, v4
v_mul_f32 v157, v157, v4
v_mul_f32 v158, v158, v4
v_mul_f32 v159, v159, v4
v_accvgpr_write_b32 a108, v156
v_accvgpr_write_b32 a109, v157
v_accvgpr_write_b32 a110, v158
v_accvgpr_write_b32 a111, v159
v_accvgpr_read_b32 v152, a112
v_accvgpr_read_b32 v153, a113
v_accvgpr_read_b32 v154, a114
v_accvgpr_read_b32 v155, a115
v_mul_f32 v152, v152, v1
v_mul_f32 v153, v153, v1
v_mul_f32 v154, v154, v1
v_mul_f32 v155, v155, v1
v_accvgpr_write_b32 a112, v152
v_accvgpr_write_b32 a113, v153
v_accvgpr_write_b32 a114, v154
v_accvgpr_write_b32 a115, v155
v_accvgpr_read_b32 v156, a116
v_accvgpr_read_b32 v157, a117
v_accvgpr_read_b32 v158, a118
v_accvgpr_read_b32 v159, a119
v_mul_f32 v156, v156, v2
v_mul_f32 v157, v157, v2
v_mul_f32 v158, v158, v2
v_mul_f32 v159, v159, v2
v_accvgpr_write_b32 a116, v156
v_accvgpr_write_b32 a117, v157
v_accvgpr_write_b32 a118, v158
v_accvgpr_write_b32 a119, v159
v_accvgpr_read_b32 v152, a120
v_accvgpr_read_b32 v153, a121
v_accvgpr_read_b32 v154, a122
v_accvgpr_read_b32 v155, a123
v_mul_f32 v152, v152, v3
v_mul_f32 v153, v153, v3
v_mul_f32 v154, v154, v3
v_mul_f32 v155, v155, v3
v_accvgpr_write_b32 a120, v152
v_accvgpr_write_b32 a121, v153
v_accvgpr_write_b32 a122, v154
v_accvgpr_write_b32 a123, v155
v_accvgpr_read_b32 v156, a124
v_accvgpr_read_b32 v157, a125
v_accvgpr_read_b32 v158, a126
v_accvgpr_read_b32 v159, a127
v_mul_f32 v156, v156, v4
v_mul_f32 v157, v157, v4
v_mul_f32 v158, v158, v4
v_mul_f32 v159, v159, v4
v_accvgpr_write_b32 a124, v156
v_accvgpr_write_b32 a125, v157
v_accvgpr_write_b32 a126, v158
v_accvgpr_write_b32 a127, v159
v_accvgpr_read_b32 v152, a128
v_accvgpr_read_b32 v153, a129
v_accvgpr_read_b32 v154, a130
v_accvgpr_read_b32 v155, a131
v_mul_f32 v152, v152, v1
v_mul_f32 v153, v153, v1
v_mul_f32 v154, v154, v1
v_mul_f32 v155, v155, v1
v_accvgpr_write_b32 a128, v152
v_accvgpr_write_b32 a129, v153
v_accvgpr_write_b32 a130, v154
v_accvgpr_write_b32 a131, v155
v_accvgpr_read_b32 v156, a132
v_accvgpr_read_b32 v157, a133
v_accvgpr_read_b32 v158, a134
v_accvgpr_read_b32 v159, a135
v_mul_f32 v156, v156, v2
v_mul_f32 v157, v157, v2
v_mul_f32 v158, v158, v2
v_mul_f32 v159, v159, v2
v_accvgpr_write_b32 a132, v156
v_accvgpr_write_b32 a133, v157
v_accvgpr_write_b32 a134, v158
v_accvgpr_write_b32 a135, v159
v_accvgpr_read_b32 v152, a136
v_accvgpr_read_b32 v153, a137
v_accvgpr_read_b32 v154, a138
v_accvgpr_read_b32 v155, a139
v_mul_f32 v152, v152, v3
v_mul_f32 v153, v153, v3
v_mul_f32 v154, v154, v3
v_mul_f32 v155, v155, v3
v_accvgpr_write_b32 a136, v152
v_accvgpr_write_b32 a137, v153
v_accvgpr_write_b32 a138, v154
v_accvgpr_write_b32 a139, v155
v_accvgpr_read_b32 v156, a140
v_accvgpr_read_b32 v157, a141
v_accvgpr_read_b32 v158, a142
v_accvgpr_read_b32 v159, a143
v_mul_f32 v156, v156, v4
v_mul_f32 v157, v157, v4
v_mul_f32 v158, v158, v4
v_mul_f32 v159, v159, v4
v_accvgpr_write_b32 a140, v156
v_accvgpr_write_b32 a141, v157
v_accvgpr_write_b32 a142, v158
v_accvgpr_write_b32 a143, v159
v_accvgpr_read_b32 v152, a144
v_accvgpr_read_b32 v153, a145
v_accvgpr_read_b32 v154, a146
v_accvgpr_read_b32 v155, a147
v_mul_f32 v152, v152, v1
v_mul_f32 v153, v153, v1
v_mul_f32 v154, v154, v1
v_mul_f32 v155, v155, v1
v_accvgpr_write_b32 a144, v152
v_accvgpr_write_b32 a145, v153
v_accvgpr_write_b32 a146, v154
v_accvgpr_write_b32 a147, v155
v_accvgpr_read_b32 v156, a148
v_accvgpr_read_b32 v157, a149
v_accvgpr_read_b32 v158, a150
v_accvgpr_read_b32 v159, a151
v_mul_f32 v156, v156, v2
v_mul_f32 v157, v157, v2
v_mul_f32 v158, v158, v2
v_mul_f32 v159, v159, v2
v_accvgpr_write_b32 a148, v156
v_accvgpr_write_b32 a149, v157
v_accvgpr_write_b32 a150, v158
v_accvgpr_write_b32 a151, v159
v_accvgpr_read_b32 v152, a152
v_accvgpr_read_b32 v153, a153
v_accvgpr_read_b32 v154, a154
v_accvgpr_read_b32 v155, a155
v_mul_f32 v152, v152, v3
v_mul_f32 v153, v153, v3
v_mul_f32 v154, v154, v3
v_mul_f32 v155, v155, v3
v_accvgpr_write_b32 a152, v152
v_accvgpr_write_b32 a153, v153
v_accvgpr_write_b32 a154, v154
v_accvgpr_write_b32 a155, v155
v_accvgpr_read_b32 v156, a156
v_accvgpr_read_b32 v157, a157
v_accvgpr_read_b32 v158, a158
v_accvgpr_read_b32 v159, a159
v_mul_f32 v156, v156, v4
v_mul_f32 v157, v157, v4
v_mul_f32 v158, v158, v4
v_mul_f32 v159, v159, v4
v_accvgpr_write_b32 a156, v156
v_accvgpr_write_b32 a157, v157
v_accvgpr_write_b32 a158, v158
v_accvgpr_write_b32 a159, v159
v_accvgpr_read_b32 v152, a160
v_accvgpr_read_b32 v153, a161
v_accvgpr_read_b32 v154, a162
v_accvgpr_read_b32 v155, a163
v_mul_f32 v152, v152, v1
v_mul_f32 v153, v153, v1
v_mul_f32 v154, v154, v1
v_mul_f32 v155, v155, v1
v_accvgpr_write_b32 a160, v152
v_accvgpr_write_b32 a161, v153
v_accvgpr_write_b32 a162, v154
v_accvgpr_write_b32 a163, v155
v_accvgpr_read_b32 v156, a164
v_accvgpr_read_b32 v157, a165
v_accvgpr_read_b32 v158, a166
v_accvgpr_read_b32 v159, a167
v_mul_f32 v156, v156, v2
v_mul_f32 v157, v157, v2
v_mul_f32 v158, v158, v2
v_mul_f32 v159, v159, v2
v_accvgpr_write_b32 a164, v156
v_accvgpr_write_b32 a165, v157
v_accvgpr_write_b32 a166, v158
v_accvgpr_write_b32 a167, v159
v_accvgpr_read_b32 v152, a168
v_accvgpr_read_b32 v153, a169
v_accvgpr_read_b32 v154, a170
v_accvgpr_read_b32 v155, a171
v_mul_f32 v152, v152, v3
v_mul_f32 v153, v153, v3
v_mul_f32 v154, v154, v3
v_mul_f32 v155, v155, v3
v_accvgpr_write_b32 a168, v152
v_accvgpr_write_b32 a169, v153
v_accvgpr_write_b32 a170, v154
v_accvgpr_write_b32 a171, v155
v_accvgpr_read_b32 v156, a172
v_accvgpr_read_b32 v157, a173
v_accvgpr_read_b32 v158, a174
v_accvgpr_read_b32 v159, a175
v_mul_f32 v156, v156, v4
v_mul_f32 v157, v157, v4
v_mul_f32 v158, v158, v4
v_mul_f32 v159, v159, v4
v_accvgpr_write_b32 a172, v156
v_accvgpr_write_b32 a173, v157
v_accvgpr_write_b32 a174, v158
v_accvgpr_write_b32 a175, v159
v_accvgpr_read_b32 v152, a176
v_accvgpr_read_b32 v153, a177
v_accvgpr_read_b32 v154, a178
v_accvgpr_read_b32 v155, a179
v_mul_f32 v152, v152, v1
v_mul_f32 v153, v153, v1
v_mul_f32 v154, v154, v1
v_mul_f32 v155, v155, v1
v_accvgpr_write_b32 a176, v152
v_accvgpr_write_b32 a177, v153
v_accvgpr_write_b32 a178, v154
v_accvgpr_write_b32 a179, v155
v_accvgpr_read_b32 v156, a180
v_accvgpr_read_b32 v157, a181
v_accvgpr_read_b32 v158, a182
v_accvgpr_read_b32 v159, a183
v_mul_f32 v156, v156, v2
v_mul_f32 v157, v157, v2
v_mul_f32 v158, v158, v2
v_mul_f32 v159, v159, v2
v_accvgpr_write_b32 a180, v156
v_accvgpr_write_b32 a181, v157
v_accvgpr_write_b32 a182, v158
v_accvgpr_write_b32 a183, v159
v_accvgpr_read_b32 v152, a184
v_accvgpr_read_b32 v153, a185
v_accvgpr_read_b32 v154, a186
v_accvgpr_read_b32 v155, a187
v_mul_f32 v152, v152, v3
v_mul_f32 v153, v153, v3
v_mul_f32 v154, v154, v3
v_mul_f32 v155, v155, v3
v_accvgpr_write_b32 a184, v152
v_accvgpr_write_b32 a185, v153
v_accvgpr_write_b32 a186, v154
v_accvgpr_write_b32 a187, v155
v_accvgpr_read_b32 v156, a188
v_accvgpr_read_b32 v157, a189
v_accvgpr_read_b32 v158, a190
v_accvgpr_read_b32 v159, a191
v_mul_f32 v156, v156, v4
v_mul_f32 v157, v157, v4
v_mul_f32 v158, v158, v4
v_mul_f32 v159, v159, v4
v_accvgpr_write_b32 a188, v156
v_accvgpr_write_b32 a189, v157
v_accvgpr_write_b32 a190, v158
v_accvgpr_write_b32 a191, v159
s_nop 1
s_setpc_b64 s[48:49]
KF_fix1:
s_waitcnt vmcnt(0)
s_nop 7
v_max3_f32 v1, v64, v65, v66
v_max3_f32 v1, v1, v67, v80
v_max3_f32 v1, v1, v81, v82
v_max_f32 v1, v1, v83
v_max3_f32 v2, v68, v69, v70
v_max3_f32 v2, v2, v71, v84
v_max3_f32 v2, v2, v85, v86
v_max_f32 v2, v2, v87
v_max3_f32 v3, v72, v73, v74
v_max3_f32 v3, v3, v75, v88
v_max3_f32 v3, v3, v89, v90
v_max_f32 v3, v3, v91
v_max3_f32 v4, v76, v77, v78
v_max3_f32 v4, v4, v79, v92
v_max3_f32 v4, v4, v93, v94
v_max_f32 v4, v4, v95
v_mov_b32 v152, v1
v_mov_b32 v153, v2
v_mov_b32 v154, v3
v_mov_b32 v155, v4
s_nop 0
v_permlane32_swap_b32 v152, v1
v_permlane32_swap_b32 v153, v2
v_permlane32_swap_b32 v154, v3
v_permlane32_swap_b32 v155, v4
v_max_f32 v1, v1, v152
v_max_f32 v2, v2, v153
v_max_f32 v3, v3, v154
v_max_f32 v4, v4, v155
v_mov_b32 v152, v1
v_mov_b32 v153, v2
v_mov_b32 v154, v3
v_mov_b32 v155, v4
s_nop 0
v_permlane16_swap_b32 v152, v1
v_permlane16_swap_b32 v153, v2
v_permlane16_swap_b32 v154, v3
v_permlane16_swap_b32 v155, v4
v_max_f32 v1, v1, v152
v_max_f32 v2, v2, v153
v_max_f32 v3, v3, v154
v_max_f32 v4, v4, v155
v_max_f32 v1, 0, v1
v_max_f32 v2, 0, v2
v_max_f32 v3, 0, v3
v_max_f32 v4, 0, v4
v_sub_f32 v152, v64, v1
v_sub_f32 v153, v65, v1
v_sub_f32 v154, v66, v1
v_sub_f32 v155, v67, v1
v_sub_f32 v156, v80, v1
v_sub_f32 v157, v81, v1
v_sub_f32 v158, v82, v1
v_sub_f32 v159, v83, v1
v_exp_f32 v152, v152
v_exp_f32 v153, v153
v_exp_f32 v154, v154
v_exp_f32 v155, v155
v_exp_f32 v156, v156
v_exp_f32 v157, v157
v_exp_f32 v158, v158
v_exp_f32 v159, v159
v_cvt_pk_bf16_f32 v112, v152, v153
v_cvt_pk_bf16_f32 v113, v154, v155
v_cvt_pk_bf16_f32 v114, v156, v157
v_cvt_pk_bf16_f32 v115, v158, v159
v_sub_f32 v152, v68, v2
v_sub_f32 v153, v69, v2
v_sub_f32 v154, v70, v2
v_sub_f32 v155, v71, v2
v_sub_f32 v156, v84, v2
v_sub_f32 v157, v85, v2
v_sub_f32 v158, v86, v2
v_sub_f32 v159, v87, v2
v_exp_f32 v152, v152
v_exp_f32 v153, v153
v_exp_f32 v154, v154
v_exp_f32 v155, v155
v_exp_f32 v156, v156
v_exp_f32 v157, v157
v_exp_f32 v158, v158
v_exp_f32 v159, v159
v_cvt_pk_bf16_f32 v116, v152, v153
v_cvt_pk_bf16_f32 v117, v154, v155
v_cvt_pk_bf16_f32 v118, v156, v157
v_cvt_pk_bf16_f32 v119, v158, v159
v_sub_f32 v152, v72, v3
v_sub_f32 v153, v73, v3
v_sub_f32 v154, v74, v3
v_sub_f32 v155, v75, v3
v_sub_f32 v156, v88, v3
v_sub_f32 v157, v89, v3
v_sub_f32 v158, v90, v3
v_sub_f32 v159, v91, v3
v_exp_f32 v152, v152
v_exp_f32 v153, v153
v_exp_f32 v154, v154
v_exp_f32 v155, v155
v_exp_f32 v156, v156
v_exp_f32 v157, v157
v_exp_f32 v158, v158
v_exp_f32 v159, v159
v_cvt_pk_bf16_f32 v120, v152, v153
v_cvt_pk_bf16_f32 v121, v154, v155
v_cvt_pk_bf16_f32 v122, v156, v157
v_cvt_pk_bf16_f32 v123, v158, v159
v_sub_f32 v152, v76, v4
v_sub_f32 v153, v77, v4
v_sub_f32 v154, v78, v4
v_sub_f32 v155, v79, v4
v_sub_f32 v156, v92, v4
v_sub_f32 v157, v93, v4
v_sub_f32 v158, v94, v4
v_sub_f32 v159, v95, v4
v_exp_f32 v152, v152
v_exp_f32 v153, v153
v_exp_f32 v154, v154
v_exp_f32 v155, v155
v_exp_f32 v156, v156
v_exp_f32 v157, v157
v_exp_f32 v158, v158
v_exp_f32 v159, v159
v_cvt_pk_bf16_f32 v124, v152, v153
v_cvt_pk_bf16_f32 v125, v154, v155
v_cvt_pk_bf16_f32 v126, v156, v157
v_cvt_pk_bf16_f32 v127, v158, v159
v_sub_f32 v128, v128, v1
v_sub_f32 v129, v129, v1
v_sub_f32 v130, v130, v1
v_sub_f32 v131, v131, v1
v_sub_f32 v132, v132, v2
v_sub_f32 v133, v133, v2
v_sub_f32 v134, v134, v2
v_sub_f32 v135, v135, v2
v_sub_f32 v136, v136, v3
v_sub_f32 v137, v137, v3
v_sub_f32 v138, v138, v3
v_sub_f32 v139, v139, v3
v_sub_f32 v140, v140, v4
v_sub_f32 v141, v141, v4
v_sub_f32 v142, v142, v4
v_sub_f32 v143, v143, v4
v_exp_f32 v1, -v1
v_exp_f32 v2, -v2
v_exp_f32 v3, -v3
v_exp_f32 v4, -v4
s_nop 0
v_mul_f32 v144, v144, v1
v_mul_f32 v145, v145, v2
v_mul_f32 v146, v146, v3
v_mul_f32 v147, v147, v4
s_nop 1
v_mfma_f32_16x16x32_bf16 v[148:151], a[240:243], v[112:115], v[144:147]
v_mfma_f32_16x16x32_bf16 v[148:151], a[244:247], v[116:119], v[148:151]
v_mfma_f32_16x16x32_bf16 v[148:151], a[248:251], v[120:123], v[148:151]
v_mfma_f32_16x16x32_bf16 v[148:151], a[252:255], v[124:127], v[148:151]
v_accvgpr_read_b32 v152, a0
v_accvgpr_read_b32 v153, a1
v_accvgpr_read_b32 v154, a2
v_accvgpr_read_b32 v155, a3
v_mul_f32 v152, v152, v1
v_mul_f32 v153, v153, v1
v_mul_f32 v154, v154, v1
v_mul_f32 v155, v155, v1
v_accvgpr_write_b32 a0, v152
v_accvgpr_write_b32 a1, v153
v_accvgpr_write_b32 a2, v154
v_accvgpr_write_b32 a3, v155
v_accvgpr_read_b32 v156, a4
v_accvgpr_read_b32 v157, a5
v_accvgpr_read_b32 v158, a6
v_accvgpr_read_b32 v159, a7
v_mul_f32 v156, v156, v2
v_mul_f32 v157, v157, v2
v_mul_f32 v158, v158, v2
v_mul_f32 v159, v159, v2
v_accvgpr_write_b32 a4, v156
v_accvgpr_write_b32 a5, v157
v_accvgpr_write_b32 a6, v158
v_accvgpr_write_b32 a7, v159
v_accvgpr_read_b32 v152, a8
v_accvgpr_read_b32 v153, a9
v_accvgpr_read_b32 v154, a10
v_accvgpr_read_b32 v155, a11
v_mul_f32 v152, v152, v3
v_mul_f32 v153, v153, v3
v_mul_f32 v154, v154, v3
v_mul_f32 v155, v155, v3
v_accvgpr_write_b32 a8, v152
v_accvgpr_write_b32 a9, v153
v_accvgpr_write_b32 a10, v154
v_accvgpr_write_b32 a11, v155
v_accvgpr_read_b32 v156, a12
v_accvgpr_read_b32 v157, a13
v_accvgpr_read_b32 v158, a14
v_accvgpr_read_b32 v159, a15
v_mul_f32 v156, v156, v4
v_mul_f32 v157, v157, v4
v_mul_f32 v158, v158, v4
v_mul_f32 v159, v159, v4
v_accvgpr_write_b32 a12, v156
v_accvgpr_write_b32 a13, v157
v_accvgpr_write_b32 a14, v158
v_accvgpr_write_b32 a15, v159
v_accvgpr_read_b32 v152, a16
v_accvgpr_read_b32 v153, a17
v_accvgpr_read_b32 v154, a18
v_accvgpr_read_b32 v155, a19
v_mul_f32 v152, v152, v1
v_mul_f32 v153, v153, v1
v_mul_f32 v154, v154, v1
v_mul_f32 v155, v155, v1
v_accvgpr_write_b32 a16, v152
v_accvgpr_write_b32 a17, v153
v_accvgpr_write_b32 a18, v154
v_accvgpr_write_b32 a19, v155
v_accvgpr_read_b32 v156, a20
v_accvgpr_read_b32 v157, a21
v_accvgpr_read_b32 v158, a22
v_accvgpr_read_b32 v159, a23
v_mul_f32 v156, v156, v2
v_mul_f32 v157, v157, v2
v_mul_f32 v158, v158, v2
v_mul_f32 v159, v159, v2
v_accvgpr_write_b32 a20, v156
v_accvgpr_write_b32 a21, v157
v_accvgpr_write_b32 a22, v158
v_accvgpr_write_b32 a23, v159
v_accvgpr_read_b32 v152, a24
v_accvgpr_read_b32 v153, a25
v_accvgpr_read_b32 v154, a26
v_accvgpr_read_b32 v155, a27
v_mul_f32 v152, v152, v3
v_mul_f32 v153, v153, v3
v_mul_f32 v154, v154, v3
v_mul_f32 v155, v155, v3
v_accvgpr_write_b32 a24, v152
v_accvgpr_write_b32 a25, v153
v_accvgpr_write_b32 a26, v154
v_accvgpr_write_b32 a27, v155
v_accvgpr_read_b32 v156, a28
v_accvgpr_read_b32 v157, a29
v_accvgpr_read_b32 v158, a30
v_accvgpr_read_b32 v159, a31
v_mul_f32 v156, v156, v4
v_mul_f32 v157, v157, v4
v_mul_f32 v158, v158, v4
v_mul_f32 v159, v159, v4
v_accvgpr_write_b32 a28, v156
v_accvgpr_write_b32 a29, v157
v_accvgpr_write_b32 a30, v158
v_accvgpr_write_b32 a31, v159
v_accvgpr_read_b32 v152, a32
v_accvgpr_read_b32 v153, a33
v_accvgpr_read_b32 v154, a34
v_accvgpr_read_b32 v155, a35
v_mul_f32 v152, v152, v1
v_mul_f32 v153, v153, v1
v_mul_f32 v154, v154, v1
v_mul_f32 v155, v155, v1
v_accvgpr_write_b32 a32, v152
v_accvgpr_write_b32 a33, v153
v_accvgpr_write_b32 a34, v154
v_accvgpr_write_b32 a35, v155
v_accvgpr_read_b32 v156, a36
v_accvgpr_read_b32 v157, a37
v_accvgpr_read_b32 v158, a38
v_accvgpr_read_b32 v159, a39
v_mul_f32 v156, v156, v2
v_mul_f32 v157, v157, v2
v_mul_f32 v158, v158, v2
v_mul_f32 v159, v159, v2
v_accvgpr_write_b32 a36, v156
v_accvgpr_write_b32 a37, v157
v_accvgpr_write_b32 a38, v158
v_accvgpr_write_b32 a39, v159
v_accvgpr_read_b32 v152, a40
v_accvgpr_read_b32 v153, a41
v_accvgpr_read_b32 v154, a42
v_accvgpr_read_b32 v155, a43
v_mul_f32 v152, v152, v3
v_mul_f32 v153, v153, v3
v_mul_f32 v154, v154, v3
v_mul_f32 v155, v155, v3
v_accvgpr_write_b32 a40, v152
v_accvgpr_write_b32 a41, v153
v_accvgpr_write_b32 a42, v154
v_accvgpr_write_b32 a43, v155
v_accvgpr_read_b32 v156, a44
v_accvgpr_read_b32 v157, a45
v_accvgpr_read_b32 v158, a46
v_accvgpr_read_b32 v159, a47
v_mul_f32 v156, v156, v4
v_mul_f32 v157, v157, v4
v_mul_f32 v158, v158, v4
v_mul_f32 v159, v159, v4
v_accvgpr_write_b32 a44, v156
v_accvgpr_write_b32 a45, v157
v_accvgpr_write_b32 a46, v158
v_accvgpr_write_b32 a47, v159
v_accvgpr_read_b32 v152, a48
v_accvgpr_read_b32 v153, a49
v_accvgpr_read_b32 v154, a50
v_accvgpr_read_b32 v155, a51
v_mul_f32 v152, v152, v1
v_mul_f32 v153, v153, v1
v_mul_f32 v154, v154, v1
v_mul_f32 v155, v155, v1
v_accvgpr_write_b32 a48, v152
v_accvgpr_write_b32 a49, v153
v_accvgpr_write_b32 a50, v154
v_accvgpr_write_b32 a51, v155
v_accvgpr_read_b32 v156, a52
v_accvgpr_read_b32 v157, a53
v_accvgpr_read_b32 v158, a54
v_accvgpr_read_b32 v159, a55
v_mul_f32 v156, v156, v2
v_mul_f32 v157, v157, v2
v_mul_f32 v158, v158, v2
v_mul_f32 v159, v159, v2
v_accvgpr_write_b32 a52, v156
v_accvgpr_write_b32 a53, v157
v_accvgpr_write_b32 a54, v158
v_accvgpr_write_b32 a55, v159
v_accvgpr_read_b32 v152, a56
v_accvgpr_read_b32 v153, a57
v_accvgpr_read_b32 v154, a58
v_accvgpr_read_b32 v155, a59
v_mul_f32 v152, v152, v3
v_mul_f32 v153, v153, v3
v_mul_f32 v154, v154, v3
v_mul_f32 v155, v155, v3
v_accvgpr_write_b32 a56, v152
v_accvgpr_write_b32 a57, v153
v_accvgpr_write_b32 a58, v154
v_accvgpr_write_b32 a59, v155
v_accvgpr_read_b32 v156, a60
v_accvgpr_read_b32 v157, a61
v_accvgpr_read_b32 v158, a62
v_accvgpr_read_b32 v159, a63
v_mul_f32 v156, v156, v4
v_mul_f32 v157, v157, v4
v_mul_f32 v158, v158, v4
v_mul_f32 v159, v159, v4
v_accvgpr_write_b32 a60, v156
v_accvgpr_write_b32 a61, v157
v_accvgpr_write_b32 a62, v158
v_accvgpr_write_b32 a63, v159
v_accvgpr_read_b32 v152, a64
v_accvgpr_read_b32 v153, a65
v_accvgpr_read_b32 v154, a66
v_accvgpr_read_b32 v155, a67
v_mul_f32 v152, v152, v1
v_mul_f32 v153, v153, v1
v_mul_f32 v154, v154, v1
v_mul_f32 v155, v155, v1
v_accvgpr_write_b32 a64, v152
v_accvgpr_write_b32 a65, v153
v_accvgpr_write_b32 a66, v154
v_accvgpr_write_b32 a67, v155
v_accvgpr_read_b32 v156, a68
v_accvgpr_read_b32 v157, a69
v_accvgpr_read_b32 v158, a70
v_accvgpr_read_b32 v159, a71
v_mul_f32 v156, v156, v2
v_mul_f32 v157, v157, v2
v_mul_f32 v158, v158, v2
v_mul_f32 v159, v159, v2
v_accvgpr_write_b32 a68, v156
v_accvgpr_write_b32 a69, v157
v_accvgpr_write_b32 a70, v158
v_accvgpr_write_b32 a71, v159
v_accvgpr_read_b32 v152, a72
v_accvgpr_read_b32 v153, a73
v_accvgpr_read_b32 v154, a74
v_accvgpr_read_b32 v155, a75
v_mul_f32 v152, v152, v3
v_mul_f32 v153, v153, v3
v_mul_f32 v154, v154, v3
v_mul_f32 v155, v155, v3
v_accvgpr_write_b32 a72, v152
v_accvgpr_write_b32 a73, v153
v_accvgpr_write_b32 a74, v154
v_accvgpr_write_b32 a75, v155
v_accvgpr_read_b32 v156, a76
v_accvgpr_read_b32 v157, a77
v_accvgpr_read_b32 v158, a78
v_accvgpr_read_b32 v159, a79
v_mul_f32 v156, v156, v4
v_mul_f32 v157, v157, v4
v_mul_f32 v158, v158, v4
v_mul_f32 v159, v159, v4
v_accvgpr_write_b32 a76, v156
v_accvgpr_write_b32 a77, v157
v_accvgpr_write_b32 a78, v158
v_accvgpr_write_b32 a79, v159
v_accvgpr_read_b32 v152, a80
v_accvgpr_read_b32 v153, a81
v_accvgpr_read_b32 v154, a82
v_accvgpr_read_b32 v155, a83
v_mul_f32 v152, v152, v1
v_mul_f32 v153, v153, v1
v_mul_f32 v154, v154, v1
v_mul_f32 v155, v155, v1
v_accvgpr_write_b32 a80, v152
v_accvgpr_write_b32 a81, v153
v_accvgpr_write_b32 a82, v154
v_accvgpr_write_b32 a83, v155
v_accvgpr_read_b32 v156, a84
v_accvgpr_read_b32 v157, a85
v_accvgpr_read_b32 v158, a86
v_accvgpr_read_b32 v159, a87
v_mul_f32 v156, v156, v2
v_mul_f32 v157, v157, v2
v_mul_f32 v158, v158, v2
v_mul_f32 v159, v159, v2
v_accvgpr_write_b32 a84, v156
v_accvgpr_write_b32 a85, v157
v_accvgpr_write_b32 a86, v158
v_accvgpr_write_b32 a87, v159
v_accvgpr_read_b32 v152, a88
v_accvgpr_read_b32 v153, a89
v_accvgpr_read_b32 v154, a90
v_accvgpr_read_b32 v155, a91
v_mul_f32 v152, v152, v3
v_mul_f32 v153, v153, v3
v_mul_f32 v154, v154, v3
v_mul_f32 v155, v155, v3
v_accvgpr_write_b32 a88, v152
v_accvgpr_write_b32 a89, v153
v_accvgpr_write_b32 a90, v154
v_accvgpr_write_b32 a91, v155
v_accvgpr_read_b32 v156, a92
v_accvgpr_read_b32 v157, a93
v_accvgpr_read_b32 v158, a94
v_accvgpr_read_b32 v159, a95
v_mul_f32 v156, v156, v4
v_mul_f32 v157, v157, v4
v_mul_f32 v158, v158, v4
v_mul_f32 v159, v159, v4
v_accvgpr_write_b32 a92, v156
v_accvgpr_write_b32 a93, v157
v_accvgpr_write_b32 a94, v158
v_accvgpr_write_b32 a95, v159
v_accvgpr_read_b32 v152, a96
v_accvgpr_read_b32 v153, a97
v_accvgpr_read_b32 v154, a98
v_accvgpr_read_b32 v155, a99
v_mul_f32 v152, v152, v1
v_mul_f32 v153, v153, v1
v_mul_f32 v154, v154, v1
v_mul_f32 v155, v155, v1
v_accvgpr_write_b32 a96, v152
v_accvgpr_write_b32 a97, v153
v_accvgpr_write_b32 a98, v154
v_accvgpr_write_b32 a99, v155
v_accvgpr_read_b32 v156, a100
v_accvgpr_read_b32 v157, a101
v_accvgpr_read_b32 v158, a102
v_accvgpr_read_b32 v159, a103
v_mul_f32 v156, v156, v2
v_mul_f32 v157, v157, v2
v_mul_f32 v158, v158, v2
v_mul_f32 v159, v159, v2
v_accvgpr_write_b32 a100, v156
v_accvgpr_write_b32 a101, v157
v_accvgpr_write_b32 a102, v158
v_accvgpr_write_b32 a103, v159
v_accvgpr_read_b32 v152, a104
v_accvgpr_read_b32 v153, a105
v_accvgpr_read_b32 v154, a106
v_accvgpr_read_b32 v155, a107
v_mul_f32 v152, v152, v3
v_mul_f32 v153, v153, v3
v_mul_f32 v154, v154, v3
v_mul_f32 v155, v155, v3
v_accvgpr_write_b32 a104, v152
v_accvgpr_write_b32 a105, v153
v_accvgpr_write_b32 a106, v154
v_accvgpr_write_b32 a107, v155
v_accvgpr_read_b32 v156, a108
v_accvgpr_read_b32 v157, a109
v_accvgpr_read_b32 v158, a110
v_accvgpr_read_b32 v159, a111
v_mul_f32 v156, v156, v4
v_mul_f32 v157, v157, v4
v_mul_f32 v158, v158, v4
v_mul_f32 v159, v159, v4
v_accvgpr_write_b32 a108, v156
v_accvgpr_write_b32 a109, v157
v_accvgpr_write_b32 a110, v158
v_accvgpr_write_b32 a111, v159
v_accvgpr_read_b32 v152, a112
v_accvgpr_read_b32 v153, a113
v_accvgpr_read_b32 v154, a114
v_accvgpr_read_b32 v155, a115
v_mul_f32 v152, v152, v1
v_mul_f32 v153, v153, v1
v_mul_f32 v154, v154, v1
v_mul_f32 v155, v155, v1
v_accvgpr_write_b32 a112, v152
v_accvgpr_write_b32 a113, v153
v_accvgpr_write_b32 a114, v154
v_accvgpr_write_b32 a115, v155
v_accvgpr_read_b32 v156, a116
v_accvgpr_read_b32 v157, a117
v_accvgpr_read_b32 v158, a118
v_accvgpr_read_b32 v159, a119
v_mul_f32 v156, v156, v2
v_mul_f32 v157, v157, v2
v_mul_f32 v158, v158, v2
v_mul_f32 v159, v159, v2
v_accvgpr_write_b32 a116, v156
v_accvgpr_write_b32 a117, v157
v_accvgpr_write_b32 a118, v158
v_accvgpr_write_b32 a119, v159
v_accvgpr_read_b32 v152, a120
v_accvgpr_read_b32 v153, a121
v_accvgpr_read_b32 v154, a122
v_accvgpr_read_b32 v155, a123
v_mul_f32 v152, v152, v3
v_mul_f32 v153, v153, v3
v_mul_f32 v154, v154, v3
v_mul_f32 v155, v155, v3
v_accvgpr_write_b32 a120, v152
v_accvgpr_write_b32 a121, v153
v_accvgpr_write_b32 a122, v154
v_accvgpr_write_b32 a123, v155
v_accvgpr_read_b32 v156, a124
v_accvgpr_read_b32 v157, a125
v_accvgpr_read_b32 v158, a126
v_accvgpr_read_b32 v159, a127
v_mul_f32 v156, v156, v4
v_mul_f32 v157, v157, v4
v_mul_f32 v158, v158, v4
v_mul_f32 v159, v159, v4
v_accvgpr_write_b32 a124, v156
v_accvgpr_write_b32 a125, v157
v_accvgpr_write_b32 a126, v158
v_accvgpr_write_b32 a127, v159
v_accvgpr_read_b32 v152, a128
v_accvgpr_read_b32 v153, a129
v_accvgpr_read_b32 v154, a130
v_accvgpr_read_b32 v155, a131
v_mul_f32 v152, v152, v1
v_mul_f32 v153, v153, v1
v_mul_f32 v154, v154, v1
v_mul_f32 v155, v155, v1
v_accvgpr_write_b32 a128, v152
v_accvgpr_write_b32 a129, v153
v_accvgpr_write_b32 a130, v154
v_accvgpr_write_b32 a131, v155
v_accvgpr_read_b32 v156, a132
v_accvgpr_read_b32 v157, a133
v_accvgpr_read_b32 v158, a134
v_accvgpr_read_b32 v159, a135
v_mul_f32 v156, v156, v2
v_mul_f32 v157, v157, v2
v_mul_f32 v158, v158, v2
v_mul_f32 v159, v159, v2
v_accvgpr_write_b32 a132, v156
v_accvgpr_write_b32 a133, v157
v_accvgpr_write_b32 a134, v158
v_accvgpr_write_b32 a135, v159
v_accvgpr_read_b32 v152, a136
v_accvgpr_read_b32 v153, a137
v_accvgpr_read_b32 v154, a138
v_accvgpr_read_b32 v155, a139
v_mul_f32 v152, v152, v3
v_mul_f32 v153, v153, v3
v_mul_f32 v154, v154, v3
v_mul_f32 v155, v155, v3
v_accvgpr_write_b32 a136, v152
v_accvgpr_write_b32 a137, v153
v_accvgpr_write_b32 a138, v154
v_accvgpr_write_b32 a139, v155
v_accvgpr_read_b32 v156, a140
v_accvgpr_read_b32 v157, a141
v_accvgpr_read_b32 v158, a142
v_accvgpr_read_b32 v159, a143
v_mul_f32 v156, v156, v4
v_mul_f32 v157, v157, v4
v_mul_f32 v158, v158, v4
v_mul_f32 v159, v159, v4
v_accvgpr_write_b32 a140, v156
v_accvgpr_write_b32 a141, v157
v_accvgpr_write_b32 a142, v158
v_accvgpr_write_b32 a143, v159
v_accvgpr_read_b32 v152, a144
v_accvgpr_read_b32 v153, a145
v_accvgpr_read_b32 v154, a146
v_accvgpr_read_b32 v155, a147
v_mul_f32 v152, v152, v1
v_mul_f32 v153, v153, v1
v_mul_f32 v154, v154, v1
v_mul_f32 v155, v155, v1
v_accvgpr_write_b32 a144, v152
v_accvgpr_write_b32 a145, v153
v_accvgpr_write_b32 a146, v154
v_accvgpr_write_b32 a147, v155
v_accvgpr_read_b32 v156, a148
v_accvgpr_read_b32 v157, a149
v_accvgpr_read_b32 v158, a150
v_accvgpr_read_b32 v159, a151
v_mul_f32 v156, v156, v2
v_mul_f32 v157, v157, v2
v_mul_f32 v158, v158, v2
v_mul_f32 v159, v159, v2
v_accvgpr_write_b32 a148, v156
v_accvgpr_write_b32 a149, v157
v_accvgpr_write_b32 a150, v158
v_accvgpr_write_b32 a151, v159
v_accvgpr_read_b32 v152, a152
v_accvgpr_read_b32 v153, a153
v_accvgpr_read_b32 v154, a154
v_accvgpr_read_b32 v155, a155
v_mul_f32 v152, v152, v3
v_mul_f32 v153, v153, v3
v_mul_f32 v154, v154, v3
v_mul_f32 v155, v155, v3
v_accvgpr_write_b32 a152, v152
v_accvgpr_write_b32 a153, v153
v_accvgpr_write_b32 a154, v154
v_accvgpr_write_b32 a155, v155
v_accvgpr_read_b32 v156, a156
v_accvgpr_read_b32 v157, a157
v_accvgpr_read_b32 v158, a158
v_accvgpr_read_b32 v159, a159
v_mul_f32 v156, v156, v4
v_mul_f32 v157, v157, v4
v_mul_f32 v158, v158, v4
v_mul_f32 v159, v159, v4
v_accvgpr_write_b32 a156, v156
v_accvgpr_write_b32 a157, v157
v_accvgpr_write_b32 a158, v158
v_accvgpr_write_b32 a159, v159
v_accvgpr_read_b32 v152, a160
v_accvgpr_read_b32 v153, a161
v_accvgpr_read_b32 v154, a162
v_accvgpr_read_b32 v155, a163
v_mul_f32 v152, v152, v1
v_mul_f32 v153, v153, v1
v_mul_f32 v154, v154, v1
v_mul_f32 v155, v155, v1
v_accvgpr_write_b32 a160, v152
v_accvgpr_write_b32 a161, v153
v_accvgpr_write_b32 a162, v154
v_accvgpr_write_b32 a163, v155
v_accvgpr_read_b32 v156, a164
v_accvgpr_read_b32 v157, a165
v_accvgpr_read_b32 v158, a166
v_accvgpr_read_b32 v159, a167
v_mul_f32 v156, v156, v2
v_mul_f32 v157, v157, v2
v_mul_f32 v158, v158, v2
v_mul_f32 v159, v159, v2
v_accvgpr_write_b32 a164, v156
v_accvgpr_write_b32 a165, v157
v_accvgpr_write_b32 a166, v158
v_accvgpr_write_b32 a167, v159
v_accvgpr_read_b32 v152, a168
v_accvgpr_read_b32 v153, a169
v_accvgpr_read_b32 v154, a170
v_accvgpr_read_b32 v155, a171
v_mul_f32 v152, v152, v3
v_mul_f32 v153, v153, v3
v_mul_f32 v154, v154, v3
v_mul_f32 v155, v155, v3
v_accvgpr_write_b32 a168, v152
v_accvgpr_write_b32 a169, v153
v_accvgpr_write_b32 a170, v154
v_accvgpr_write_b32 a171, v155
v_accvgpr_read_b32 v156, a172
v_accvgpr_read_b32 v157, a173
v_accvgpr_read_b32 v158, a174
v_accvgpr_read_b32 v159, a175
v_mul_f32 v156, v156, v4
v_mul_f32 v157, v157, v4
v_mul_f32 v158, v158, v4
v_mul_f32 v159, v159, v4
v_accvgpr_write_b32 a172, v156
v_accvgpr_write_b32 a173, v157
v_accvgpr_write_b32 a174, v158
v_accvgpr_write_b32 a175, v159
v_accvgpr_read_b32 v152, a176
v_accvgpr_read_b32 v153, a177
v_accvgpr_read_b32 v154, a178
v_accvgpr_read_b32 v155, a179
v_mul_f32 v152, v152, v1
v_mul_f32 v153, v153, v1
v_mul_f32 v154, v154, v1
v_mul_f32 v155, v155, v1
v_accvgpr_write_b32 a176, v152
v_accvgpr_write_b32 a177, v153
v_accvgpr_write_b32 a178, v154
v_accvgpr_write_b32 a179, v155
v_accvgpr_read_b32 v156, a180
v_accvgpr_read_b32 v157, a181
v_accvgpr_read_b32 v158, a182
v_accvgpr_read_b32 v159, a183
v_mul_f32 v156, v156, v2
v_mul_f32 v157, v157, v2
v_mul_f32 v158, v158, v2
v_mul_f32 v159, v159, v2
v_accvgpr_write_b32 a180, v156
v_accvgpr_write_b32 a181, v157
v_accvgpr_write_b32 a182, v158
v_accvgpr_write_b32 a183, v159
v_accvgpr_read_b32 v152, a184
v_accvgpr_read_b32 v153, a185
v_accvgpr_read_b32 v154, a186
v_accvgpr_read_b32 v155, a187
v_mul_f32 v152, v152, v3
v_mul_f32 v153, v153, v3
v_mul_f32 v154, v154, v3
v_mul_f32 v155, v155, v3
v_accvgpr_write_b32 a184, v152
v_accvgpr_write_b32 a185, v153
v_accvgpr_write_b32 a186, v154
v_accvgpr_write_b32 a187, v155
v_accvgpr_read_b32 v156, a188
v_accvgpr_read_b32 v157, a189
v_accvgpr_read_b32 v158, a190
v_accvgpr_read_b32 v159, a191
v_mul_f32 v156, v156, v4
v_mul_f32 v157, v157, v4
v_mul_f32 v158, v158, v4
v_mul_f32 v159, v159, v4
v_accvgpr_write_b32 a188, v156
v_accvgpr_write_b32 a189, v157
v_accvgpr_write_b32 a190, v158
v_accvgpr_write_b32 a191, v159
s_nop 1
s_setpc_b64 s[48:49]
KF_end:
.section .rodata,"a"
.p2align 6
.amdhsa_kernel standalone__mha_block_cached__near_ridge_kernel
  .amdhsa_next_free_vgpr 512
  .amdhsa_next_free_sgpr 102
  .amdhsa_accum_offset 256
  .amdhsa_group_segment_fixed_size 0
  .amdhsa_kernarg_size 64
  .amdhsa_user_sgpr_count 2
  .amdhsa_user_sgpr_kernarg_segment_ptr 1
  .amdhsa_system_sgpr_workgroup_id_x 1
.end_amdhsa_kernel
```
